```python
import torch

def _softmax(x, axis=-1):
    return torch.softmax(x, dim=axis)
def _gelu(x):
    return torch.nn.functional.gelu(x, approximate="tanh")
def _silu(x):
    return torch.nn.functional.silu(x)
def _sigmoid(x):
    return torch.sigmoid(x)
def _layernorm(x, axis=-1, eps=1e-5):
    m = x.mean(dim=axis, keepdim=True)
    v = x.var(dim=axis, keepdim=True, unbiased=False)
    return (x - m) / torch.sqrt(v + eps)
def _scatter_add(tgt, idx, src, axis=0):
    return tgt.clone().index_add_(axis, idx, src)
def _segment_sum(src, seg, n):
    out = torch.zeros((n,) + src.shape[1:], dtype=src.dtype)
    return out.index_add_(0, seg, src)
def _pad(x, pw):
    flat = tuple(v for pair in reversed(pw) for v in pair)
    return torch.nn.functional.pad(x, flat)

kernel_name = 'concat_heads__gqa_block_cached__gqa_block_cached__near_ridge'

def setup_inputs():

    _w = (lambda a: (lambda t: t.to(torch.bfloat16) if t.is_floating_point() else t)(torch.as_tensor(a)))
    def _A_setup():
        B, Sq, D = 8, 256, 640
        Hq, Hkv, Sk, Dh = 32, 32, 1024, 128
        assert Hq % Hkv == 0, (Hq, Hkv)
        return {
            "x": _w((lambda *s: torch.randn(*s, dtype=torch.bfloat16) * 0.8)(B, Sq, D)),
            "k_cache": _w((lambda *s: torch.randn(*s, dtype=torch.bfloat16) * 0.8)(B, Hkv, Sk, Dh)),
            "v_cache": _w((lambda *s: torch.randn(*s, dtype=torch.bfloat16) * 0.05)(B, Hkv, Sk, Dh)),
            "wq": _w((lambda *s: torch.randn(*s, dtype=torch.bfloat16) * 0.8)(D, Hq * Dh) * (D ** -0.5)),
            "wo": _w((lambda *s: torch.randn(*s, dtype=torch.bfloat16) * 0.05)(Hq * Dh, D) * ((Hq * Dh) ** -0.5)),
        }
    _A_in = _A_setup()

    def _B_setup():
        B, Sq, D = 8, 256, 640
        Hq, Hkv, Sk, Dh = 32, 32, 1024, 128
        assert Hq % Hkv == 0, (Hq, Hkv)
        return {
            "x": _w((lambda *s: torch.randn(*s, dtype=torch.bfloat16) * 0.8)(B, Sq, D)),
            "k_cache": _w((lambda *s: torch.randn(*s, dtype=torch.bfloat16) * 0.8)(B, Hkv, Sk, Dh)),
            "v_cache": _w((lambda *s: torch.randn(*s, dtype=torch.bfloat16) * 0.05)(B, Hkv, Sk, Dh)),
            "wq": _w((lambda *s: torch.randn(*s, dtype=torch.bfloat16) * 0.8)(D, Hq * Dh) * (D ** -0.5)),
            "wo": _w((lambda *s: torch.randn(*s, dtype=torch.bfloat16) * 0.05)(Hq * Dh, D) * ((Hq * Dh) ** -0.5)),
        }
    _B_in = _B_setup()

    return {
        "A_x": _A_in["x"],
        "A_k_cache": _A_in["k_cache"],
        "A_v_cache": _A_in["v_cache"],
        "A_wq": _A_in["wq"],
        "A_wo": _A_in["wo"],
        "B_x": _B_in["x"],
        "B_k_cache": _B_in["k_cache"],
        "B_v_cache": _B_in["v_cache"],
        "B_wq": _B_in["wq"],
        "B_wo": _B_in["wo"],
    }

def reference(A_x, A_k_cache, A_v_cache, A_wq, A_wo, B_x, B_k_cache, B_v_cache, B_wq, B_wo):
    def _A_ref(x, k_cache, v_cache, wq, wo):
        B, Sq, D = x.shape
        Hq, Dh = 32, 128
        Hkv = k_cache.shape[1]
        rep = Hq // Hkv
        q = (lambda x, *d: x.permute(*d))((x @ wq).reshape(B, Sq, Hq, Dh), 0, 2, 1, 3)
        k = (lambda x, n, axis: torch.repeat_interleave(x, n, dim=axis))(k_cache, rep, axis=1)
        v = (lambda x, n, axis: torch.repeat_interleave(x, n, dim=axis))(v_cache, rep, axis=1)
        scores = torch.einsum("bhqd,bhkd->bhqk", q, k) * (Dh ** -0.5)
        p = _softmax(scores, axis=-1)
        o = torch.einsum("bhqk,bhkd->bhqd", p, v)
        return (lambda x, *d: x.permute(*d))(o, 0, 2, 1, 3).reshape(B, Sq, Hq * Dh) @ wo

    def _B_ref(x, k_cache, v_cache, wq, wo):
        B, Sq, D = x.shape
        Hq, Dh = 32, 128
        Hkv = k_cache.shape[1]
        rep = Hq // Hkv
        q = (lambda x, *d: x.permute(*d))((x @ wq).reshape(B, Sq, Hq, Dh), 0, 2, 1, 3)
        k = (lambda x, n, axis: torch.repeat_interleave(x, n, dim=axis))(k_cache, rep, axis=1)
        v = (lambda x, n, axis: torch.repeat_interleave(x, n, dim=axis))(v_cache, rep, axis=1)
        scores = torch.einsum("bhqd,bhkd->bhqk", q, k) * (Dh ** -0.5)
        p = _softmax(scores, axis=-1)
        o = torch.einsum("bhqk,bhkd->bhqd", p, v)
        return (lambda x, *d: x.permute(*d))(o, 0, 2, 1, 3).reshape(B, Sq, Hq * Dh) @ wo

    a = _A_ref(A_x, A_k_cache, A_v_cache, A_wq, A_wo)
    b = _B_ref(B_x, B_k_cache, B_v_cache, B_wq, B_wo)
    return torch.concatenate([a, b], axis=-1)
```

```asm
; @launch kernel=attn_kernel grid=(256,1,1) block=(256,1,1) lds=163840
.amdgcn_target "amdgcn-amd-amdhsa--gfx950"
.text
.globl attn_kernel
.p2align 8
.type attn_kernel,@function
attn_kernel:
    s_cmp_ge_u32 s2, 256
    s_cbranch_scc1 L_end
    s_getpc_b64 s[84:85]
    s_and_b32 s84, s84, 0xffffff00
    s_and_b32 s85, s85, 0xffff
    s_mov_b32 s86, L_codeend-attn_kernel
    s_mov_b32 s87, 0x20000
    s_lshr_b32 s3, s2, 3
    s_lshl_b32 s3, s3, 13
    v_lshlrev_b32 v4, 5, v0
    buffer_load_dwordx4 v[252:255], v4, s[84:87], s3 offen
    s_nop 4
    s_load_dwordx16 s[64:79], s[0:1], 0
    s_load_dwordx8 s[80:87], s[0:1], 64
    s_load_dwordx2 s[46:47], s[0:1], 96
    s_and_b32 s3, s2, 7
    s_lshr_b32 s4, s2, 3
    s_lshr_b32 s5, s3, 2
    s_bfe_u32 s6, s3, 0x10001
    s_lshl_b32 s6, s6, 2
    s_lshr_b32 s7, s4, 3
    s_add_u32 s6, s6, s7
    s_and_b32 s7, s3, 1
    s_lshl_b32 s7, s7, 3
    s_and_b32 s4, s4, 7
    s_add_u32 s7, s7, s4
    v_lshrrev_b32 v52, 6, v0
    v_and_b32 v48, 63, v0
    v_readfirstlane_b32 s28, v52
    v_lshrrev_b32 v49, 4, v48
    v_and_b32 v50, 15, v48
    v_lshrrev_b32 v56, 5, v48
    s_and_b32 s44, s28, 1
    s_lshl_b32 s44, s44, 3
    s_lshl_b32 s37, s28, 16
    v_and_b32 v54, 31, v48
    v_xor_b32 v54, s44, v54
    v_add_u32 v52, 0, v56
    v_lshlrev_b32 v53, 1, v52
    v_xor_b32 v53, v53, v54
    v_lshlrev_b32 v53, 4, v53
    v_lshl_add_u32 v53, v52, 13, v53
    v_add_u32 v24, s37, v53
    v_add_u32 v26, 30720, v24
    v_add_u32 v52, 2, v56
    v_lshlrev_b32 v53, 1, v52
    v_xor_b32 v53, v53, v54
    v_lshlrev_b32 v53, 4, v53
    v_lshl_add_u32 v53, v52, 13, v53
    v_add_u32 v25, s37, v53
    v_subrev_u32 v25, 1024, v25
    v_add_u32 v27, 30720, v25
    s_mul_i32 s37, s28, 81920
    v_lshrrev_b32 v52, 3, v48
    v_mul_u32_u24 v52, 1280, v52
    v_add_u32 v52, s37, v52
    v_and_b32 v53, 7, v48
    v_xor_b32 v53, v53, v49
    v_lshl_add_u32 v28, v53, 4, v52
    v_xor_b32 v53, 4, v53
    v_lshl_add_u32 v52, v53, 4, v52
    v_add_u32 v29, 9216, v52
    v_add_u32 v30, 18432, v28
    v_add_u32 v31, 18432, v29
    v_add_u32 v32, 40960, v28
    v_add_u32 v33, 40960, v29
    v_add_u32 v34, 59392, v28
    v_add_u32 v35, 59392, v29
    s_lshl_b32 s29, s28, 12
    s_add_u32 s30, s29, 65536
    s_add_u32 s31, s29, 98304
    s_lshl_b32 s34, s28, 13
    s_lshl_b32 s4, s6, 4
    s_add_u32 s4, s4, s7
    s_lshl_b32 s37, s7, 9
    s_sub_u32 s14, 5242880, s37
    s_mov_b32 s15, 0x20000
    s_mul_i32 s39, s6, 327680
    s_mov_b32 s10, 327680
    s_mov_b32 s11, 0x20000
    s_cmp_eq_u32 s5, 1
    s_waitcnt lgkmcnt(0)
    s_cselect_b64 s[70:71], s[80:81], s[70:71]
    s_cselect_b64 s[64:65], s[74:75], s[64:65]
    s_cselect_b64 s[66:67], s[76:77], s[66:67]
    s_cselect_b64 s[68:69], s[78:79], s[68:69]
    s_cselect_b64 s[72:73], s[82:83], s[72:73]
    s_add_u32 s12, s70, s37
    s_addc_u32 s13, s71, 0
    s_and_b32 s13, s13, 0xffff
    s_add_u32 s8, s64, s39
    s_addc_u32 s9, s65, 0
    s_and_b32 s9, s9, 0xffff
    s_add_u32 m0, s31, 0
    s_mov_b32 s44, 0
    buffer_load_dwordx4 v24, s[12:15], s44 offen offset:0 nt lds
    buffer_load_dwordx4 v25, s[12:15], s44 offen offset:1024 nt lds
    buffer_load_dwordx4 v26, s[12:15], s44 offen offset:2048 nt lds
    buffer_load_dwordx4 v27, s[12:15], s44 offen offset:3072 nt lds
    s_add_u32 m0, s34, 16384
    s_movk_i32 s44, 0
    buffer_load_dwordx4 v28, s[8:11], s44 offen offset:0 nt lds
    buffer_load_dwordx4 v29, s[8:11], s44 offen offset:1024 nt lds
    buffer_load_dwordx4 v30, s[8:11], s44 offen offset:2048 nt lds
    buffer_load_dwordx4 v31, s[8:11], s44 offen offset:3072 nt lds
    s_add_u32 m0, s34, 20480
    s_nop 0
    buffer_load_dwordx4 v32, s[8:11], s44 offen offset:0 nt lds
    buffer_load_dwordx4 v33, s[8:11], s44 offen offset:1024 nt lds
    buffer_load_dwordx4 v34, s[8:11], s44 offen offset:2048 nt lds
    buffer_load_dwordx4 v35, s[8:11], s44 offen offset:3072 nt lds
    s_add_u32 m0, s31, 16384
    s_mov_b32 s44, 262144
    buffer_load_dwordx4 v24, s[12:15], s44 offen offset:0 nt lds
    buffer_load_dwordx4 v25, s[12:15], s44 offen offset:1024 nt lds
    buffer_load_dwordx4 v26, s[12:15], s44 offen offset:2048 nt lds
    buffer_load_dwordx4 v27, s[12:15], s44 offen offset:3072 nt lds
    s_add_u32 m0, s34, 49152
    s_movk_i32 s44, 128
    buffer_load_dwordx4 v28, s[8:11], s44 offen offset:0 nt lds
    buffer_load_dwordx4 v29, s[8:11], s44 offen offset:1024 nt lds
    buffer_load_dwordx4 v30, s[8:11], s44 offen offset:2048 nt lds
    buffer_load_dwordx4 v31, s[8:11], s44 offen offset:3072 nt lds
    s_add_u32 m0, s34, 53248
    s_nop 0
    buffer_load_dwordx4 v32, s[8:11], s44 offen offset:0 nt lds
    buffer_load_dwordx4 v33, s[8:11], s44 offen offset:1024 nt lds
    buffer_load_dwordx4 v34, s[8:11], s44 offen offset:2048 nt lds
    buffer_load_dwordx4 v35, s[8:11], s44 offen offset:3072 nt lds
    s_mov_b32 s88, s72
    s_and_b32 s89, s73, 0xffff
    s_lshl_b32 s37, s4, 19
    s_add_u32 s16, s66, s37
    s_addc_u32 s17, s67, 0
    s_and_b32 s17, s17, 0xffff
    s_mov_b32 s18, 0x80000
    s_mov_b32 s19, 0x20000
    s_add_u32 s20, s68, s37
    s_addc_u32 s21, s69, 0
    s_and_b32 s21, s21, 0xffff
    s_mov_b32 s22, 0x80000
    s_mov_b32 s23, 0x20000
    s_lshl_b32 s45, s5, 3
    s_add_u32 s45, s45, s6
    s_lshl_b32 s44, s45, 22
    s_add_u32 s24, s46, s44
    s_addc_u32 s25, s47, 0
    s_and_b32 s25, s25, 0xffff
    s_mov_b32 s26, 2424832
    s_mov_b32 s27, 0x20000
    s_lshl_b32 s37, s6, 1
    s_bfe_u32 s44, s7, 0x10002
    s_add_u32 s37, s37, s44
    s_mul_i32 s37, s37, 327680
    s_mul_i32 s44, s5, 1280
    s_add_u32 s37, s37, s44
    s_and_b32 s44, s7, 3
    s_mul_i32 s44, s44, 320
    s_add_u32 s37, s37, s44
    s_add_u32 s96, s84, s37
    s_addc_u32 s97, s85, 0
    s_and_b32 s97, s97, 0xffff
    s_mov_b32 s98, 325440
    s_mov_b32 s99, 0x20000
    s_add_u32 s80, s86, 0
    s_addc_u32 s81, s87, 0
    s_and_b32 s81, s81, 0xffff
    s_mov_b32 s82, 256
    s_mov_b32 s83, 0x20000
    s_lshl_b32 s45, s45, 4
    s_add_u32 s45, s45, s7
    s_lshl_b32 s42, s7, 13
    s_mov_b32 s32, 0
    s_mov_b32 s33, 0
    s_mov_b32 s43, 99
    s_mov_b32 s38, 0x4e800000
    s_mov_b32 s40, 0x3e0293ee
    s_mov_b32 s41, s40
    v_lshrrev_b32 v51, 2, v50
    v_and_b32 v52, 1, v49
    v_lshl_add_u32 v52, v52, 2, v51
    v_lshl_add_u32 v53, v49, 3, v51
    v_lshlrev_b32 v53, 9, v53
    v_and_b32 v54, 3, v50
    v_lshl_add_u32 v53, v54, 3, v53
    v_add_u32 v53, 98304, v53
    v_xor_b32 v55, 0, v52
    v_lshl_add_u32 v16, v55, 5, v53
    v_xor_b32 v55, 1, v52
    v_lshl_add_u32 v17, v55, 5, v53
    v_xor_b32 v55, 2, v52
    v_lshl_add_u32 v18, v55, 5, v53
    v_xor_b32 v55, 3, v52
    v_lshl_add_u32 v19, v55, 5, v53
    v_xor_b32 v55, 4, v52
    v_lshl_add_u32 v20, v55, 5, v53
    v_xor_b32 v55, 5, v52
    v_lshl_add_u32 v21, v55, 5, v53
    v_xor_b32 v55, 6, v52
    v_lshl_add_u32 v22, v55, 5, v53
    v_xor_b32 v55, 7, v52
    v_lshl_add_u32 v23, v55, 5, v53
    v_lshrrev_b32 v52, 1, v50
    v_xor_b32 v52, v52, v49
    v_lshlrev_b32 v53, 7, v50
    v_add_u32 v53, s34, v53
    v_lshl_add_u32 v36, v52, 4, v53
    v_xor_b32 v37, 64, v36
    v_lshl_add_u32 v53, v51, 4, v54
    v_lshlrev_b32 v53, 8, v53
    v_and_b32 v52, 1, v51
    v_lshlrev_b32 v52, 3, v52
    v_lshl_add_u32 v52, v54, 1, v52
    v_lshrrev_b32 v55, 3, v50
    v_add_u32 v52, v52, v55
    v_and_b32 v55, 1, v49
    v_lshl_add_u32 v55, v55, 1, v56
    v_xor_b32 v52, v52, v55
    v_lshl_add_u32 v1, v52, 4, v53
    v_xor_b32 v2, 64, v1
    v_xor_b32 v3, 128, v1
    v_xor_b32 v4, 192, v1
    v_lshl_add_u32 v53, v49, 4, v51
    v_lshlrev_b32 v53, 8, v53
    v_and_b32 v52, 1, v50
    v_lshl_add_u32 v53, v52, 3, v53
    v_add_u32 v53, 65536, v53
    v_and_b32 v52, 1, v49
    v_lshlrev_b32 v52, 3, v52
    v_lshl_add_u32 v52, v51, 1, v52
    v_add_u32 v52, v52, v56
    v_bfe_u32 v55, v50, 1, 1
    v_xor_b32 v52, v52, v55
    v_lshl_add_u32 v5, v52, 4, v53
    v_xor_b32 v6, 32, v5
    v_xor_b32 v7, 64, v5
    v_xor_b32 v8, 96, v5
    v_xor_b32 v9, 128, v5
    v_xor_b32 v10, 160, v5
    v_xor_b32 v11, 192, v5
    v_xor_b32 v12, 224, v5
    s_and_b32 s37, s28, 1
    s_lshl_b32 s37, s37, 3
    s_lshr_b32 s44, s28, 1
    s_add_u32 s37, s37, s44
    v_lshlrev_b32 v52, 1, v49
    v_add_u32 v52, s37, v52
    v_xor_b32 v52, v52, v50
    v_lshlrev_b32 v52, 4, v52
    v_lshl_add_u32 v52, v49, 8, v52
    s_lshl_b32 s37, s28, 12
    v_add_u32 v13, s37, v52
    s_lshl_b32 s37, s28, 19
    v_lshlrev_b32 v52, 4, v48
    v_add_u32 v14, s37, v52
    s_mul_i32 s37, s28, -519168
    s_add_u32 s37, s37, 0x200000
    s_mul_i32 s78, s7, 20480
    s_add_u32 s78, s78, s37
    s_xor_b32 s79, s7, 8
    s_mul_i32 s79, s79, 20480
    s_add_u32 s79, s79, s37
    v_mov_b32 v40, -1
    v_mov_b32 v41, -1
    v_mov_b32 v42, -1
    v_mov_b32 v43, -1
    s_waitcnt vmcnt(12)
    s_barrier
    ds_read_b128 a[128:131], v36 offset:16384
    ds_read_b128 a[132:135], v36 offset:18432
    ds_read_b128 a[136:139], v36 offset:20480
    ds_read_b128 a[140:143], v36 offset:22528
    ds_read_b128 a[144:147], v37 offset:16384
    ds_read_b128 a[148:151], v37 offset:18432
    ds_read_b128 a[152:155], v37 offset:20480
    ds_read_b128 a[156:159], v37 offset:22528
    ds_read_b64_tr_b16 a[0:1], v16 offset:0
    ds_read_b64_tr_b16 a[2:3], v16 offset:2048
    ds_read_b64_tr_b16 a[4:5], v17 offset:0
    ds_read_b64_tr_b16 a[6:7], v17 offset:2048
    ds_read_b64_tr_b16 a[8:9], v18 offset:0
    ds_read_b64_tr_b16 a[10:11], v18 offset:2048
    ds_read_b64_tr_b16 a[12:13], v19 offset:0
    ds_read_b64_tr_b16 a[14:15], v19 offset:2048
    ds_read_b64_tr_b16 a[16:17], v20 offset:0
    ds_read_b64_tr_b16 a[18:19], v20 offset:2048
    ds_read_b64_tr_b16 a[20:21], v21 offset:0
    ds_read_b64_tr_b16 a[22:23], v21 offset:2048
    ds_read_b64_tr_b16 a[24:25], v22 offset:0
    ds_read_b64_tr_b16 a[26:27], v22 offset:2048
    ds_read_b64_tr_b16 a[28:29], v23 offset:0
    ds_read_b64_tr_b16 a[30:31], v23 offset:2048
    ds_read_b64_tr_b16 a[32:33], v16 offset:256
    ds_read_b64_tr_b16 a[34:35], v16 offset:2304
    ds_read_b64_tr_b16 a[36:37], v17 offset:256
    ds_read_b64_tr_b16 a[38:39], v17 offset:2304
    ds_read_b64_tr_b16 a[40:41], v18 offset:256
    ds_read_b64_tr_b16 a[42:43], v18 offset:2304
    ds_read_b64_tr_b16 a[44:45], v19 offset:256
    ds_read_b64_tr_b16 a[46:47], v19 offset:2304
    ds_read_b64_tr_b16 a[48:49], v20 offset:256
    ds_read_b64_tr_b16 a[50:51], v20 offset:2304
    ds_read_b64_tr_b16 a[52:53], v21 offset:256
    ds_read_b64_tr_b16 a[54:55], v21 offset:2304
    ds_read_b64_tr_b16 a[56:57], v22 offset:256
    ds_read_b64_tr_b16 a[58:59], v22 offset:2304
    ds_read_b64_tr_b16 a[60:61], v23 offset:256
    ds_read_b64_tr_b16 a[62:63], v23 offset:2304
    s_add_u32 m0, s31, 32768
    s_mov_b32 s44, 524288
    buffer_load_dwordx4 v24, s[12:15], s44 offen offset:0 nt lds
    buffer_load_dwordx4 v25, s[12:15], s44 offen offset:1024 nt lds
    buffer_load_dwordx4 v26, s[12:15], s44 offen offset:2048 nt lds
    buffer_load_dwordx4 v27, s[12:15], s44 offen offset:3072 nt lds
    s_add_u32 m0, s31, 49152
    s_mov_b32 s44, 786432
    buffer_load_dwordx4 v24, s[12:15], s44 offen offset:0 nt lds
    buffer_load_dwordx4 v25, s[12:15], s44 offen offset:1024 nt lds
    buffer_load_dwordx4 v26, s[12:15], s44 offen offset:2048 nt lds
    buffer_load_dwordx4 v27, s[12:15], s44 offen offset:3072 nt lds
    s_waitcnt vmcnt(16) lgkmcnt(0)
    s_barrier
    v_mfma_f32_16x16x32_bf16 v[48:51], a[0:3], a[128:131], 0
    ds_read_b64_tr_b16 a[64:65], v16 offset:16384
    v_mfma_f32_16x16x32_bf16 v[52:55], a[0:3], a[132:135], 0
    s_add_u32 m0, s31, 0
    s_mov_b32 s44, 1048576
    v_mfma_f32_16x16x32_bf16 v[56:59], a[0:3], a[136:139], 0
    ds_read_b64_tr_b16 a[66:67], v16 offset:18432
    v_mfma_f32_16x16x32_bf16 v[60:63], a[0:3], a[140:143], 0
    ds_read_b64_tr_b16 a[68:69], v17 offset:16384
    v_mfma_f32_16x16x32_bf16 v[76:79], a[4:7], a[140:143], 0
    v_mfma_f32_16x16x32_bf16 v[72:75], a[4:7], a[136:139], 0
    buffer_load_dwordx4 v24, s[12:15], s44 offen offset:0 nt lds
    v_mfma_f32_16x16x32_bf16 v[68:71], a[4:7], a[132:135], 0
    ds_read_b64_tr_b16 a[70:71], v17 offset:18432
    v_mfma_f32_16x16x32_bf16 v[64:67], a[4:7], a[128:131], 0
    ds_read_b64_tr_b16 a[72:73], v18 offset:16384
    v_mfma_f32_16x16x32_bf16 v[80:83], a[8:11], a[128:131], 0
    v_mfma_f32_16x16x32_bf16 v[84:87], a[8:11], a[132:135], 0
    buffer_load_dwordx4 v25, s[12:15], s44 offen offset:1024 nt lds
    v_mfma_f32_16x16x32_bf16 v[88:91], a[8:11], a[136:139], 0
    ds_read_b64_tr_b16 a[74:75], v18 offset:18432
    v_mfma_f32_16x16x32_bf16 v[92:95], a[8:11], a[140:143], 0
    ds_read_b64_tr_b16 a[76:77], v19 offset:16384
    v_mfma_f32_16x16x32_bf16 v[108:111], a[12:15], a[140:143], 0
    v_mfma_f32_16x16x32_bf16 v[104:107], a[12:15], a[136:139], 0
    buffer_load_dwordx4 v26, s[12:15], s44 offen offset:2048 nt lds
    v_mfma_f32_16x16x32_bf16 v[100:103], a[12:15], a[132:135], 0
    ds_read_b64_tr_b16 a[78:79], v19 offset:18432
    v_mfma_f32_16x16x32_bf16 v[96:99], a[12:15], a[128:131], 0
    ds_read_b64_tr_b16 a[80:81], v20 offset:16384
    v_mfma_f32_16x16x32_bf16 v[112:115], a[16:19], a[128:131], 0
    ds_read_b64_tr_b16 a[82:83], v20 offset:18432
    v_mfma_f32_16x16x32_bf16 v[116:119], a[16:19], a[132:135], 0
    buffer_load_dwordx4 v27, s[12:15], s44 offen offset:3072 nt lds
    v_mfma_f32_16x16x32_bf16 v[120:123], a[16:19], a[136:139], 0
    v_mfma_f32_16x16x32_bf16 v[124:127], a[16:19], a[140:143], 0
    ds_read_b64_tr_b16 a[84:85], v21 offset:16384
    v_mfma_f32_16x16x32_bf16 v[140:143], a[20:23], a[140:143], 0
    ds_read_b64_tr_b16 a[86:87], v21 offset:18432
    v_mfma_f32_16x16x32_bf16 v[136:139], a[20:23], a[136:139], 0
    s_add_u32 m0, s34, 16384
    s_movk_i32 s44, 256
    v_mfma_f32_16x16x32_bf16 v[132:135], a[20:23], a[132:135], 0
    v_mfma_f32_16x16x32_bf16 v[128:131], a[20:23], a[128:131], 0
    ds_read_b64_tr_b16 a[88:89], v22 offset:16384
    v_mfma_f32_16x16x32_bf16 v[144:147], a[24:27], a[128:131], 0
    ds_read_b64_tr_b16 a[90:91], v22 offset:18432
    v_mfma_f32_16x16x32_bf16 v[148:151], a[24:27], a[132:135], 0
    buffer_load_dwordx4 v28, s[8:11], s44 offen offset:0 nt lds
    v_mfma_f32_16x16x32_bf16 v[152:155], a[24:27], a[136:139], 0
    v_mfma_f32_16x16x32_bf16 v[156:159], a[24:27], a[140:143], 0
    ds_read_b64_tr_b16 a[92:93], v23 offset:16384
    v_mfma_f32_16x16x32_bf16 v[172:175], a[28:31], a[140:143], 0
    ds_read_b64_tr_b16 a[94:95], v23 offset:18432
    v_mfma_f32_16x16x32_bf16 v[168:171], a[28:31], a[136:139], 0
    buffer_load_dwordx4 v29, s[8:11], s44 offen offset:1024 nt lds
    v_mfma_f32_16x16x32_bf16 v[164:167], a[28:31], a[132:135], 0
    v_mfma_f32_16x16x32_bf16 v[160:163], a[28:31], a[128:131], 0
    ds_read_b64_tr_b16 a[96:97], v16 offset:16640
    v_mfma_f32_16x16x32_bf16 v[176:179], a[32:35], a[128:131], 0
    ds_read_b64_tr_b16 a[98:99], v16 offset:18688
    v_mfma_f32_16x16x32_bf16 v[180:183], a[32:35], a[132:135], 0
    buffer_load_dwordx4 v30, s[8:11], s44 offen offset:2048 nt lds
    v_mfma_f32_16x16x32_bf16 v[184:187], a[32:35], a[136:139], 0
    ds_read_b64_tr_b16 a[100:101], v17 offset:16640
    v_mfma_f32_16x16x32_bf16 v[188:191], a[32:35], a[140:143], 0
    v_mfma_f32_16x16x32_bf16 v[204:207], a[36:39], a[140:143], 0
    ds_read_b64_tr_b16 a[102:103], v17 offset:18688
    v_mfma_f32_16x16x32_bf16 v[200:203], a[36:39], a[136:139], 0
    buffer_load_dwordx4 v31, s[8:11], s44 offen offset:3072 nt lds
    s_add_u32 m0, s34, 20480
    v_mfma_f32_16x16x32_bf16 v[196:199], a[36:39], a[132:135], 0
    ds_read_b64_tr_b16 a[104:105], v18 offset:16640
    v_mfma_f32_16x16x32_bf16 v[192:195], a[36:39], a[128:131], 0
    v_mfma_f32_16x16x32_bf16 v[208:211], a[40:43], a[128:131], 0
    ds_read_b64_tr_b16 a[106:107], v18 offset:18688
    v_mfma_f32_16x16x32_bf16 v[212:215], a[40:43], a[132:135], 0
    buffer_load_dwordx4 v32, s[8:11], s44 offen offset:0 nt lds
    v_mfma_f32_16x16x32_bf16 v[216:219], a[40:43], a[136:139], 0
    ds_read_b64_tr_b16 a[108:109], v19 offset:16640
    v_mfma_f32_16x16x32_bf16 v[220:223], a[40:43], a[140:143], 0
    v_mfma_f32_16x16x32_bf16 v[236:239], a[44:47], a[140:143], 0
    ds_read_b64_tr_b16 a[110:111], v19 offset:18688
    v_mfma_f32_16x16x32_bf16 v[232:235], a[44:47], a[136:139], 0
    buffer_load_dwordx4 v33, s[8:11], s44 offen offset:1024 nt lds
    v_mfma_f32_16x16x32_bf16 v[228:231], a[44:47], a[132:135], 0
    ds_read_b64_tr_b16 a[112:113], v20 offset:16640
    v_mfma_f32_16x16x32_bf16 v[224:227], a[44:47], a[128:131], 0
    ds_read_b64_tr_b16 a[114:115], v20 offset:18688
    v_mfma_f32_16x16x32_bf16 v[240:243], a[48:51], a[128:131], 0
    v_mfma_f32_16x16x32_bf16 v[244:247], a[48:51], a[132:135], 0
    buffer_load_dwordx4 v34, s[8:11], s44 offen offset:2048 nt lds
    v_mfma_f32_16x16x32_bf16 v[248:251], a[48:51], a[136:139], 0
    ds_read_b64_tr_b16 a[116:117], v21 offset:16640
    v_mfma_f32_16x16x32_bf16 v[252:255], a[48:51], a[140:143], 0
    ds_read_b64_tr_b16 a[118:119], v21 offset:18688
    v_mfma_f32_16x16x32_bf16 a[220:223], a[52:55], a[140:143], 0
    v_mfma_f32_16x16x32_bf16 a[216:219], a[52:55], a[136:139], 0
    buffer_load_dwordx4 v35, s[8:11], s44 offen offset:3072 nt lds
    v_mfma_f32_16x16x32_bf16 a[212:215], a[52:55], a[132:135], 0
    ds_read_b64_tr_b16 a[120:121], v22 offset:16640
    v_mfma_f32_16x16x32_bf16 a[208:211], a[52:55], a[128:131], 0
    ds_read_b64_tr_b16 a[122:123], v22 offset:18688
    v_mfma_f32_16x16x32_bf16 a[224:227], a[56:59], a[128:131], 0
    v_mfma_f32_16x16x32_bf16 a[228:231], a[56:59], a[132:135], 0
    ds_read_b64_tr_b16 a[124:125], v23 offset:16640
    v_mfma_f32_16x16x32_bf16 a[232:235], a[56:59], a[136:139], 0
    ds_read_b64_tr_b16 a[126:127], v23 offset:18688
    v_mfma_f32_16x16x32_bf16 a[236:239], a[56:59], a[140:143], 0
    v_mfma_f32_16x16x32_bf16 a[252:255], a[60:63], a[140:143], 0
    v_mfma_f32_16x16x32_bf16 a[248:251], a[60:63], a[136:139], 0
    v_mfma_f32_16x16x32_bf16 a[244:247], a[60:63], a[132:135], 0
    v_mfma_f32_16x16x32_bf16 a[240:243], a[60:63], a[128:131], 0
    s_waitcnt vmcnt(16) lgkmcnt(0)
    s_barrier
    v_mfma_f32_16x16x32_bf16 v[48:51], a[64:67], a[144:147], v[48:51]
    ds_read_b128 a[160:163], v36 offset:49152
    v_mfma_f32_16x16x32_bf16 v[52:55], a[64:67], a[148:151], v[52:55]
    s_add_u32 m0, s31, 16384
    s_mov_b32 s44, 1310720
    v_mfma_f32_16x16x32_bf16 v[56:59], a[64:67], a[152:155], v[56:59]
    ds_read_b128 a[164:167], v36 offset:51200
    v_mfma_f32_16x16x32_bf16 v[60:63], a[64:67], a[156:159], v[60:63]
    ds_read_b128 a[168:171], v36 offset:53248
    v_mfma_f32_16x16x32_bf16 v[76:79], a[68:71], a[156:159], v[76:79]
    v_mfma_f32_16x16x32_bf16 v[72:75], a[68:71], a[152:155], v[72:75]
    buffer_load_dwordx4 v24, s[12:15], s44 offen offset:0 nt lds
    v_mfma_f32_16x16x32_bf16 v[68:71], a[68:71], a[148:151], v[68:71]
    ds_read_b128 a[172:175], v36 offset:55296
    v_mfma_f32_16x16x32_bf16 v[64:67], a[68:71], a[144:147], v[64:67]
    ds_read_b128 a[176:179], v37 offset:49152
    v_mfma_f32_16x16x32_bf16 v[80:83], a[72:75], a[144:147], v[80:83]
    ds_read_b128 a[180:183], v37 offset:51200
    v_mfma_f32_16x16x32_bf16 v[84:87], a[72:75], a[148:151], v[84:87]
    buffer_load_dwordx4 v25, s[12:15], s44 offen offset:1024 nt lds
    v_mfma_f32_16x16x32_bf16 v[88:91], a[72:75], a[152:155], v[88:91]
    v_mfma_f32_16x16x32_bf16 v[92:95], a[72:75], a[156:159], v[92:95]
    ds_read_b128 a[184:187], v37 offset:53248
    v_mfma_f32_16x16x32_bf16 v[108:111], a[76:79], a[156:159], v[108:111]
    ds_read_b128 a[188:191], v37 offset:55296
    v_mfma_f32_16x16x32_bf16 v[104:107], a[76:79], a[152:155], v[104:107]
    buffer_load_dwordx4 v26, s[12:15], s44 offen offset:2048 nt lds
    v_mfma_f32_16x16x32_bf16 v[100:103], a[76:79], a[148:151], v[100:103]
    v_mfma_f32_16x16x32_bf16 v[96:99], a[76:79], a[144:147], v[96:99]
    ds_read_b64_tr_b16 a[0:1], v16 offset:32768
    v_mfma_f32_16x16x32_bf16 v[112:115], a[80:83], a[144:147], v[112:115]
    ds_read_b64_tr_b16 a[2:3], v16 offset:34816
    v_mfma_f32_16x16x32_bf16 v[116:119], a[80:83], a[148:151], v[116:119]
    buffer_load_dwordx4 v27, s[12:15], s44 offen offset:3072 nt lds
    v_mfma_f32_16x16x32_bf16 v[120:123], a[80:83], a[152:155], v[120:123]
    ds_read_b64_tr_b16 a[4:5], v17 offset:32768
    v_mfma_f32_16x16x32_bf16 v[124:127], a[80:83], a[156:159], v[124:127]
    v_mfma_f32_16x16x32_bf16 v[140:143], a[84:87], a[156:159], v[140:143]
    ds_read_b64_tr_b16 a[6:7], v17 offset:34816
    v_mfma_f32_16x16x32_bf16 v[136:139], a[84:87], a[152:155], v[136:139]
    ds_read_b64_tr_b16 a[8:9], v18 offset:32768
    v_mfma_f32_16x16x32_bf16 v[132:135], a[84:87], a[148:151], v[132:135]
    ds_read_b64_tr_b16 a[10:11], v18 offset:34816
    v_mfma_f32_16x16x32_bf16 v[128:131], a[84:87], a[144:147], v[128:131]
    v_mfma_f32_16x16x32_bf16 v[144:147], a[88:91], a[144:147], v[144:147]
    ds_read_b64_tr_b16 a[12:13], v19 offset:32768
    v_mfma_f32_16x16x32_bf16 v[148:151], a[88:91], a[148:151], v[148:151]
    ds_read_b64_tr_b16 a[14:15], v19 offset:34816
    v_mfma_f32_16x16x32_bf16 v[152:155], a[88:91], a[152:155], v[152:155]
    v_mfma_f32_16x16x32_bf16 v[156:159], a[88:91], a[156:159], v[156:159]
    ds_read_b64_tr_b16 a[16:17], v20 offset:32768
    v_mfma_f32_16x16x32_bf16 v[172:175], a[92:95], a[156:159], v[172:175]
    ds_read_b64_tr_b16 a[18:19], v20 offset:34816
    v_mfma_f32_16x16x32_bf16 v[168:171], a[92:95], a[152:155], v[168:171]
    ds_read_b64_tr_b16 a[20:21], v21 offset:32768
    v_mfma_f32_16x16x32_bf16 v[164:167], a[92:95], a[148:151], v[164:167]
    v_mfma_f32_16x16x32_bf16 v[160:163], a[92:95], a[144:147], v[160:163]
    ds_read_b64_tr_b16 a[22:23], v21 offset:34816
    v_mfma_f32_16x16x32_bf16 v[176:179], a[96:99], a[144:147], v[176:179]
    ds_read_b64_tr_b16 a[24:25], v22 offset:32768
    v_mfma_f32_16x16x32_bf16 v[180:183], a[96:99], a[148:151], v[180:183]
    ds_read_b64_tr_b16 a[26:27], v22 offset:34816
    v_mfma_f32_16x16x32_bf16 v[184:187], a[96:99], a[152:155], v[184:187]
    v_mfma_f32_16x16x32_bf16 v[188:191], a[96:99], a[156:159], v[188:191]
    ds_read_b64_tr_b16 a[28:29], v23 offset:32768
    v_mfma_f32_16x16x32_bf16 v[204:207], a[100:103], a[156:159], v[204:207]
    ds_read_b64_tr_b16 a[30:31], v23 offset:34816
    v_mfma_f32_16x16x32_bf16 v[200:203], a[100:103], a[152:155], v[200:203]
    v_mfma_f32_16x16x32_bf16 v[196:199], a[100:103], a[148:151], v[196:199]
    ds_read_b64_tr_b16 a[32:33], v16 offset:33024
    v_mfma_f32_16x16x32_bf16 v[192:195], a[100:103], a[144:147], v[192:195]
    ds_read_b64_tr_b16 a[34:35], v16 offset:35072
    v_mfma_f32_16x16x32_bf16 v[208:211], a[104:107], a[144:147], v[208:211]
    ds_read_b64_tr_b16 a[36:37], v17 offset:33024
    v_mfma_f32_16x16x32_bf16 v[212:215], a[104:107], a[148:151], v[212:215]
    v_mfma_f32_16x16x32_bf16 v[216:219], a[104:107], a[152:155], v[216:219]
    ds_read_b64_tr_b16 a[38:39], v17 offset:35072
    v_mfma_f32_16x16x32_bf16 v[220:223], a[104:107], a[156:159], v[220:223]
    ds_read_b64_tr_b16 a[40:41], v18 offset:33024
    v_mfma_f32_16x16x32_bf16 v[236:239], a[108:111], a[156:159], v[236:239]
    ds_read_b64_tr_b16 a[42:43], v18 offset:35072
    v_mfma_f32_16x16x32_bf16 v[232:235], a[108:111], a[152:155], v[232:235]
    v_mfma_f32_16x16x32_bf16 v[228:231], a[108:111], a[148:151], v[228:231]
    ds_read_b64_tr_b16 a[44:45], v19 offset:33024
    v_mfma_f32_16x16x32_bf16 v[224:227], a[108:111], a[144:147], v[224:227]
    ds_read_b64_tr_b16 a[46:47], v19 offset:35072
    v_mfma_f32_16x16x32_bf16 v[240:243], a[112:115], a[144:147], v[240:243]
    v_mfma_f32_16x16x32_bf16 v[244:247], a[112:115], a[148:151], v[244:247]
    ds_read_b64_tr_b16 a[48:49], v20 offset:33024
    v_mfma_f32_16x16x32_bf16 v[248:251], a[112:115], a[152:155], v[248:251]
    ds_read_b64_tr_b16 a[50:51], v20 offset:35072
    v_mfma_f32_16x16x32_bf16 v[252:255], a[112:115], a[156:159], v[252:255]
    ds_read_b64_tr_b16 a[52:53], v21 offset:33024
    v_mfma_f32_16x16x32_bf16 a[220:223], a[116:119], a[156:159], a[220:223]
    v_mfma_f32_16x16x32_bf16 a[216:219], a[116:119], a[152:155], a[216:219]
    ds_read_b64_tr_b16 a[54:55], v21 offset:35072
    v_mfma_f32_16x16x32_bf16 a[212:215], a[116:119], a[148:151], a[212:215]
    ds_read_b64_tr_b16 a[56:57], v22 offset:33024
    v_mfma_f32_16x16x32_bf16 a[208:211], a[116:119], a[144:147], a[208:211]
    ds_read_b64_tr_b16 a[58:59], v22 offset:35072
    v_mfma_f32_16x16x32_bf16 a[224:227], a[120:123], a[144:147], a[224:227]
    v_mfma_f32_16x16x32_bf16 a[228:231], a[120:123], a[148:151], a[228:231]
    ds_read_b64_tr_b16 a[60:61], v23 offset:33024
    v_mfma_f32_16x16x32_bf16 a[232:235], a[120:123], a[152:155], a[232:235]
    ds_read_b64_tr_b16 a[62:63], v23 offset:35072
    v_mfma_f32_16x16x32_bf16 a[236:239], a[120:123], a[156:159], a[236:239]
    v_mfma_f32_16x16x32_bf16 a[252:255], a[124:127], a[156:159], a[252:255]
    v_mfma_f32_16x16x32_bf16 a[248:251], a[124:127], a[152:155], a[248:251]
    v_mfma_f32_16x16x32_bf16 a[244:247], a[124:127], a[148:151], a[244:247]
    v_mfma_f32_16x16x32_bf16 a[240:243], a[124:127], a[144:147], a[240:243]
    s_waitcnt vmcnt(4) lgkmcnt(0)
    s_barrier
    v_mfma_f32_16x16x32_bf16 v[48:51], a[0:3], a[160:163], v[48:51]
    ds_read_b128 a[128:131], v36 offset:16384
    v_mfma_f32_16x16x32_bf16 v[52:55], a[0:3], a[164:167], v[52:55]
    s_add_u32 m0, s34, 49152
    s_movk_i32 s44, 384
    v_mfma_f32_16x16x32_bf16 v[56:59], a[0:3], a[168:171], v[56:59]
    ds_read_b128 a[132:135], v36 offset:18432
    v_mfma_f32_16x16x32_bf16 v[60:63], a[0:3], a[172:175], v[60:63]
    ds_read_b128 a[136:139], v36 offset:20480
    v_mfma_f32_16x16x32_bf16 v[76:79], a[4:7], a[172:175], v[76:79]
    ds_read_b128 a[140:143], v36 offset:22528
    v_mfma_f32_16x16x32_bf16 v[72:75], a[4:7], a[168:171], v[72:75]
    buffer_load_dwordx4 v28, s[8:11], s44 offen offset:0 nt lds
    v_mfma_f32_16x16x32_bf16 v[68:71], a[4:7], a[164:167], v[68:71]
    ds_read_b128 a[144:147], v37 offset:16384
    v_mfma_f32_16x16x32_bf16 v[64:67], a[4:7], a[160:163], v[64:67]
    ds_read_b128 a[148:151], v37 offset:18432
    v_mfma_f32_16x16x32_bf16 v[80:83], a[8:11], a[160:163], v[80:83]
    ds_read_b128 a[152:155], v37 offset:20480
    v_mfma_f32_16x16x32_bf16 v[84:87], a[8:11], a[164:167], v[84:87]
    buffer_load_dwordx4 v29, s[8:11], s44 offen offset:1024 nt lds
    v_mfma_f32_16x16x32_bf16 v[88:91], a[8:11], a[168:171], v[88:91]
    v_mfma_f32_16x16x32_bf16 v[92:95], a[8:11], a[172:175], v[92:95]
    ds_read_b128 a[156:159], v37 offset:22528
    v_mfma_f32_16x16x32_bf16 v[108:111], a[12:15], a[172:175], v[108:111]
    ds_read_b64_tr_b16 a[64:65], v16 offset:49152
    v_mfma_f32_16x16x32_bf16 v[104:107], a[12:15], a[168:171], v[104:107]
    buffer_load_dwordx4 v30, s[8:11], s44 offen offset:2048 nt lds
    v_mfma_f32_16x16x32_bf16 v[100:103], a[12:15], a[164:167], v[100:103]
    ds_read_b64_tr_b16 a[66:67], v16 offset:51200
    v_mfma_f32_16x16x32_bf16 v[96:99], a[12:15], a[160:163], v[96:99]
    ds_read_b64_tr_b16 a[68:69], v17 offset:49152
    v_mfma_f32_16x16x32_bf16 v[112:115], a[16:19], a[160:163], v[112:115]
    ds_read_b64_tr_b16 a[70:71], v17 offset:51200
    v_mfma_f32_16x16x32_bf16 v[116:119], a[16:19], a[164:167], v[116:119]
    buffer_load_dwordx4 v31, s[8:11], s44 offen offset:3072 nt lds
    s_add_u32 m0, s34, 53248
    v_mfma_f32_16x16x32_bf16 v[120:123], a[16:19], a[168:171], v[120:123]
    ds_read_b64_tr_b16 a[72:73], v18 offset:49152
    v_mfma_f32_16x16x32_bf16 v[124:127], a[16:19], a[172:175], v[124:127]
    ds_read_b64_tr_b16 a[74:75], v18 offset:51200
    v_mfma_f32_16x16x32_bf16 v[140:143], a[20:23], a[172:175], v[140:143]
    v_mfma_f32_16x16x32_bf16 v[136:139], a[20:23], a[168:171], v[136:139]
    buffer_load_dwordx4 v32, s[8:11], s44 offen offset:0 nt lds
    v_mfma_f32_16x16x32_bf16 v[132:135], a[20:23], a[164:167], v[132:135]
    ds_read_b64_tr_b16 a[76:77], v19 offset:49152
    v_mfma_f32_16x16x32_bf16 v[128:131], a[20:23], a[160:163], v[128:131]
    ds_read_b64_tr_b16 a[78:79], v19 offset:51200
    v_mfma_f32_16x16x32_bf16 v[144:147], a[24:27], a[160:163], v[144:147]
    ds_read_b64_tr_b16 a[80:81], v20 offset:49152
    v_mfma_f32_16x16x32_bf16 v[148:151], a[24:27], a[164:167], v[148:151]
    buffer_load_dwordx4 v33, s[8:11], s44 offen offset:1024 nt lds
    v_mfma_f32_16x16x32_bf16 v[152:155], a[24:27], a[168:171], v[152:155]
    ds_read_b64_tr_b16 a[82:83], v20 offset:51200
    v_mfma_f32_16x16x32_bf16 v[156:159], a[24:27], a[172:175], v[156:159]
    ds_read_b64_tr_b16 a[84:85], v21 offset:49152
    v_mfma_f32_16x16x32_bf16 v[172:175], a[28:31], a[172:175], v[172:175]
    ds_read_b64_tr_b16 a[86:87], v21 offset:51200
    v_mfma_f32_16x16x32_bf16 v[168:171], a[28:31], a[168:171], v[168:171]
    buffer_load_dwordx4 v34, s[8:11], s44 offen offset:2048 nt lds
    v_mfma_f32_16x16x32_bf16 v[164:167], a[28:31], a[164:167], v[164:167]
    v_mfma_f32_16x16x32_bf16 v[160:163], a[28:31], a[160:163], v[160:163]
    ds_read_b64_tr_b16 a[88:89], v22 offset:49152
    v_mfma_f32_16x16x32_bf16 v[176:179], a[32:35], a[160:163], v[176:179]
    ds_read_b64_tr_b16 a[90:91], v22 offset:51200
    v_mfma_f32_16x16x32_bf16 v[180:183], a[32:35], a[164:167], v[180:183]
    buffer_load_dwordx4 v35, s[8:11], s44 offen offset:3072 nt lds
    v_mfma_f32_16x16x32_bf16 v[184:187], a[32:35], a[168:171], v[184:187]
    ds_read_b64_tr_b16 a[92:93], v23 offset:49152
    v_mfma_f32_16x16x32_bf16 v[188:191], a[32:35], a[172:175], v[188:191]
    ds_read_b64_tr_b16 a[94:95], v23 offset:51200
    v_mfma_f32_16x16x32_bf16 v[204:207], a[36:39], a[172:175], v[204:207]
    ds_read_b64_tr_b16 a[96:97], v16 offset:49408
    v_mfma_f32_16x16x32_bf16 v[200:203], a[36:39], a[168:171], v[200:203]
    s_add_u32 m0, s31, 32768
    s_mov_b32 s44, 1572864
    v_mfma_f32_16x16x32_bf16 v[196:199], a[36:39], a[164:167], v[196:199]
    ds_read_b64_tr_b16 a[98:99], v16 offset:51456
    v_mfma_f32_16x16x32_bf16 v[192:195], a[36:39], a[160:163], v[192:195]
    ds_read_b64_tr_b16 a[100:101], v17 offset:49408
    v_mfma_f32_16x16x32_bf16 v[208:211], a[40:43], a[160:163], v[208:211]
    v_mfma_f32_16x16x32_bf16 v[212:215], a[40:43], a[164:167], v[212:215]
    buffer_load_dwordx4 v24, s[12:15], s44 offen offset:0 nt lds
    v_mfma_f32_16x16x32_bf16 v[216:219], a[40:43], a[168:171], v[216:219]
    ds_read_b64_tr_b16 a[102:103], v17 offset:51456
    v_mfma_f32_16x16x32_bf16 v[220:223], a[40:43], a[172:175], v[220:223]
    ds_read_b64_tr_b16 a[104:105], v18 offset:49408
    v_mfma_f32_16x16x32_bf16 v[236:239], a[44:47], a[172:175], v[236:239]
    ds_read_b64_tr_b16 a[106:107], v18 offset:51456
    v_mfma_f32_16x16x32_bf16 v[232:235], a[44:47], a[168:171], v[232:235]
    buffer_load_dwordx4 v25, s[12:15], s44 offen offset:1024 nt lds
    v_mfma_f32_16x16x32_bf16 v[228:231], a[44:47], a[164:167], v[228:231]
    ds_read_b64_tr_b16 a[108:109], v19 offset:49408
    v_mfma_f32_16x16x32_bf16 v[224:227], a[44:47], a[160:163], v[224:227]
    ds_read_b64_tr_b16 a[110:111], v19 offset:51456
    v_mfma_f32_16x16x32_bf16 v[240:243], a[48:51], a[160:163], v[240:243]
    ds_read_b64_tr_b16 a[112:113], v20 offset:49408
    v_mfma_f32_16x16x32_bf16 v[244:247], a[48:51], a[164:167], v[244:247]
    buffer_load_dwordx4 v26, s[12:15], s44 offen offset:2048 nt lds
    v_mfma_f32_16x16x32_bf16 v[248:251], a[48:51], a[168:171], v[248:251]
    ds_read_b64_tr_b16 a[114:115], v20 offset:51456
    v_mfma_f32_16x16x32_bf16 v[252:255], a[48:51], a[172:175], v[252:255]
    v_mfma_f32_16x16x32_bf16 a[220:223], a[52:55], a[172:175], a[220:223]
    ds_read_b64_tr_b16 a[116:117], v21 offset:49408
    v_mfma_f32_16x16x32_bf16 a[216:219], a[52:55], a[168:171], a[216:219]
    buffer_load_dwordx4 v27, s[12:15], s44 offen offset:3072 nt lds
    v_mfma_f32_16x16x32_bf16 a[212:215], a[52:55], a[164:167], a[212:215]
    ds_read_b64_tr_b16 a[118:119], v21 offset:51456
    v_mfma_f32_16x16x32_bf16 a[208:211], a[52:55], a[160:163], a[208:211]
    ds_read_b64_tr_b16 a[120:121], v22 offset:49408
    v_mfma_f32_16x16x32_bf16 a[224:227], a[56:59], a[160:163], a[224:227]
    ds_read_b64_tr_b16 a[122:123], v22 offset:51456
    v_mfma_f32_16x16x32_bf16 a[228:231], a[56:59], a[164:167], a[228:231]
    ds_read_b64_tr_b16 a[124:125], v23 offset:49408
    v_mfma_f32_16x16x32_bf16 a[232:235], a[56:59], a[168:171], a[232:235]
    ds_read_b64_tr_b16 a[126:127], v23 offset:51456
    v_mfma_f32_16x16x32_bf16 a[236:239], a[56:59], a[172:175], a[236:239]
    v_mfma_f32_16x16x32_bf16 a[252:255], a[60:63], a[172:175], a[252:255]
    v_mfma_f32_16x16x32_bf16 a[248:251], a[60:63], a[168:171], a[248:251]
    v_mfma_f32_16x16x32_bf16 a[244:247], a[60:63], a[164:167], a[244:247]
    v_mfma_f32_16x16x32_bf16 a[240:243], a[60:63], a[160:163], a[240:243]
    s_waitcnt lgkmcnt(0)
    s_barrier
    v_mfma_f32_16x16x32_bf16 v[48:51], a[64:67], a[176:179], v[48:51]
    ds_read_b64_tr_b16 a[0:1], v16 offset:0
    v_mfma_f32_16x16x32_bf16 v[52:55], a[64:67], a[180:183], v[52:55]
    s_add_u32 m0, s31, 49152
    s_mov_b32 s44, 1835008
    v_mfma_f32_16x16x32_bf16 v[56:59], a[64:67], a[184:187], v[56:59]
    ds_read_b64_tr_b16 a[2:3], v16 offset:2048
    v_mfma_f32_16x16x32_bf16 v[60:63], a[64:67], a[188:191], v[60:63]
    ds_read_b64_tr_b16 a[4:5], v17 offset:0
    v_mfma_f32_16x16x32_bf16 v[76:79], a[68:71], a[188:191], v[76:79]
    v_mfma_f32_16x16x32_bf16 v[72:75], a[68:71], a[184:187], v[72:75]
    buffer_load_dwordx4 v24, s[12:15], s44 offen offset:0 nt lds
    v_mfma_f32_16x16x32_bf16 v[68:71], a[68:71], a[180:183], v[68:71]
    ds_read_b64_tr_b16 a[6:7], v17 offset:2048
    v_mfma_f32_16x16x32_bf16 v[64:67], a[68:71], a[176:179], v[64:67]
    ds_read_b64_tr_b16 a[8:9], v18 offset:0
    v_mfma_f32_16x16x32_bf16 v[80:83], a[72:75], a[176:179], v[80:83]
    v_mfma_f32_16x16x32_bf16 v[84:87], a[72:75], a[180:183], v[84:87]
    buffer_load_dwordx4 v25, s[12:15], s44 offen offset:1024 nt lds
    v_mfma_f32_16x16x32_bf16 v[88:91], a[72:75], a[184:187], v[88:91]
    ds_read_b64_tr_b16 a[10:11], v18 offset:2048
    v_mfma_f32_16x16x32_bf16 v[92:95], a[72:75], a[188:191], v[92:95]
    ds_read_b64_tr_b16 a[12:13], v19 offset:0
    v_mfma_f32_16x16x32_bf16 v[108:111], a[76:79], a[188:191], v[108:111]
    v_mfma_f32_16x16x32_bf16 v[104:107], a[76:79], a[184:187], v[104:107]
    buffer_load_dwordx4 v26, s[12:15], s44 offen offset:2048 nt lds
    v_mfma_f32_16x16x32_bf16 v[100:103], a[76:79], a[180:183], v[100:103]
    ds_read_b64_tr_b16 a[14:15], v19 offset:2048
    v_mfma_f32_16x16x32_bf16 v[96:99], a[76:79], a[176:179], v[96:99]
    ds_read_b64_tr_b16 a[16:17], v20 offset:0
    v_mfma_f32_16x16x32_bf16 v[112:115], a[80:83], a[176:179], v[112:115]
    ds_read_b64_tr_b16 a[18:19], v20 offset:2048
    v_mfma_f32_16x16x32_bf16 v[116:119], a[80:83], a[180:183], v[116:119]
    buffer_load_dwordx4 v27, s[12:15], s44 offen offset:3072 nt lds
    v_mfma_f32_16x16x32_bf16 v[120:123], a[80:83], a[184:187], v[120:123]
    v_mfma_f32_16x16x32_bf16 v[124:127], a[80:83], a[188:191], v[124:127]
    ds_read_b64_tr_b16 a[20:21], v21 offset:0
    v_mfma_f32_16x16x32_bf16 v[140:143], a[84:87], a[188:191], v[140:143]
    ds_read_b64_tr_b16 a[22:23], v21 offset:2048
    v_mfma_f32_16x16x32_bf16 v[136:139], a[84:87], a[184:187], v[136:139]
    s_add_u32 m0, s34, 16384
    s_movk_i32 s44, 512
    v_mfma_f32_16x16x32_bf16 v[132:135], a[84:87], a[180:183], v[132:135]
    v_mfma_f32_16x16x32_bf16 v[128:131], a[84:87], a[176:179], v[128:131]
    ds_read_b64_tr_b16 a[24:25], v22 offset:0
    v_mfma_f32_16x16x32_bf16 v[144:147], a[88:91], a[176:179], v[144:147]
    ds_read_b64_tr_b16 a[26:27], v22 offset:2048
    v_mfma_f32_16x16x32_bf16 v[148:151], a[88:91], a[180:183], v[148:151]
    buffer_load_dwordx4 v28, s[8:11], s44 offen offset:0 nt lds
    v_mfma_f32_16x16x32_bf16 v[152:155], a[88:91], a[184:187], v[152:155]
    v_mfma_f32_16x16x32_bf16 v[156:159], a[88:91], a[188:191], v[156:159]
    ds_read_b64_tr_b16 a[28:29], v23 offset:0
    v_mfma_f32_16x16x32_bf16 v[172:175], a[92:95], a[188:191], v[172:175]
    ds_read_b64_tr_b16 a[30:31], v23 offset:2048
    v_mfma_f32_16x16x32_bf16 v[168:171], a[92:95], a[184:187], v[168:171]
    buffer_load_dwordx4 v29, s[8:11], s44 offen offset:1024 nt lds
    v_mfma_f32_16x16x32_bf16 v[164:167], a[92:95], a[180:183], v[164:167]
    v_mfma_f32_16x16x32_bf16 v[160:163], a[92:95], a[176:179], v[160:163]
    ds_read_b64_tr_b16 a[32:33], v16 offset:256
    v_mfma_f32_16x16x32_bf16 v[176:179], a[96:99], a[176:179], v[176:179]
    ds_read_b64_tr_b16 a[34:35], v16 offset:2304
    v_mfma_f32_16x16x32_bf16 v[180:183], a[96:99], a[180:183], v[180:183]
    buffer_load_dwordx4 v30, s[8:11], s44 offen offset:2048 nt lds
    v_mfma_f32_16x16x32_bf16 v[184:187], a[96:99], a[184:187], v[184:187]
    ds_read_b64_tr_b16 a[36:37], v17 offset:256
    v_mfma_f32_16x16x32_bf16 v[188:191], a[96:99], a[188:191], v[188:191]
    v_mfma_f32_16x16x32_bf16 v[204:207], a[100:103], a[188:191], v[204:207]
    ds_read_b64_tr_b16 a[38:39], v17 offset:2304
    v_mfma_f32_16x16x32_bf16 v[200:203], a[100:103], a[184:187], v[200:203]
    buffer_load_dwordx4 v31, s[8:11], s44 offen offset:3072 nt lds
    s_add_u32 m0, s34, 20480
    v_mfma_f32_16x16x32_bf16 v[196:199], a[100:103], a[180:183], v[196:199]
    ds_read_b64_tr_b16 a[40:41], v18 offset:256
    v_mfma_f32_16x16x32_bf16 v[192:195], a[100:103], a[176:179], v[192:195]
    v_mfma_f32_16x16x32_bf16 v[208:211], a[104:107], a[176:179], v[208:211]
    ds_read_b64_tr_b16 a[42:43], v18 offset:2304
    v_mfma_f32_16x16x32_bf16 v[212:215], a[104:107], a[180:183], v[212:215]
    buffer_load_dwordx4 v32, s[8:11], s44 offen offset:0 nt lds
    v_mfma_f32_16x16x32_bf16 v[216:219], a[104:107], a[184:187], v[216:219]
    ds_read_b64_tr_b16 a[44:45], v19 offset:256
    v_mfma_f32_16x16x32_bf16 v[220:223], a[104:107], a[188:191], v[220:223]
    v_mfma_f32_16x16x32_bf16 v[236:239], a[108:111], a[188:191], v[236:239]
    ds_read_b64_tr_b16 a[46:47], v19 offset:2304
    v_mfma_f32_16x16x32_bf16 v[232:235], a[108:111], a[184:187], v[232:235]
    buffer_load_dwordx4 v33, s[8:11], s44 offen offset:1024 nt lds
    v_mfma_f32_16x16x32_bf16 v[228:231], a[108:111], a[180:183], v[228:231]
    ds_read_b64_tr_b16 a[48:49], v20 offset:256
    v_mfma_f32_16x16x32_bf16 v[224:227], a[108:111], a[176:179], v[224:227]
    ds_read_b64_tr_b16 a[50:51], v20 offset:2304
    v_mfma_f32_16x16x32_bf16 v[240:243], a[112:115], a[176:179], v[240:243]
    v_mfma_f32_16x16x32_bf16 v[244:247], a[112:115], a[180:183], v[244:247]
    buffer_load_dwordx4 v34, s[8:11], s44 offen offset:2048 nt lds
    v_mfma_f32_16x16x32_bf16 v[248:251], a[112:115], a[184:187], v[248:251]
    ds_read_b64_tr_b16 a[52:53], v21 offset:256
    v_mfma_f32_16x16x32_bf16 v[252:255], a[112:115], a[188:191], v[252:255]
    ds_read_b64_tr_b16 a[54:55], v21 offset:2304
    v_mfma_f32_16x16x32_bf16 a[220:223], a[116:119], a[188:191], a[220:223]
    v_mfma_f32_16x16x32_bf16 a[216:219], a[116:119], a[184:187], a[216:219]
    buffer_load_dwordx4 v35, s[8:11], s44 offen offset:3072 nt lds
    v_mfma_f32_16x16x32_bf16 a[212:215], a[116:119], a[180:183], a[212:215]
    ds_read_b64_tr_b16 a[56:57], v22 offset:256
    v_mfma_f32_16x16x32_bf16 a[208:211], a[116:119], a[176:179], a[208:211]
    ds_read_b64_tr_b16 a[58:59], v22 offset:2304
    v_mfma_f32_16x16x32_bf16 a[224:227], a[120:123], a[176:179], a[224:227]
    v_mfma_f32_16x16x32_bf16 a[228:231], a[120:123], a[180:183], a[228:231]
    ds_read_b64_tr_b16 a[60:61], v23 offset:256
    v_mfma_f32_16x16x32_bf16 a[232:235], a[120:123], a[184:187], a[232:235]
    ds_read_b64_tr_b16 a[62:63], v23 offset:2304
    v_mfma_f32_16x16x32_bf16 a[236:239], a[120:123], a[188:191], a[236:239]
    v_mfma_f32_16x16x32_bf16 a[252:255], a[124:127], a[188:191], a[252:255]
    v_mfma_f32_16x16x32_bf16 a[248:251], a[124:127], a[184:187], a[248:251]
    v_mfma_f32_16x16x32_bf16 a[244:247], a[124:127], a[180:183], a[244:247]
    v_mfma_f32_16x16x32_bf16 a[240:243], a[124:127], a[176:179], a[240:243]
    s_waitcnt vmcnt(16) lgkmcnt(0)
    s_barrier
    v_mfma_f32_16x16x32_bf16 v[48:51], a[0:3], a[128:131], v[48:51]
    ds_read_b128 a[160:163], v36 offset:49152
    v_mfma_f32_16x16x32_bf16 v[52:55], a[0:3], a[132:135], v[52:55]
    s_add_u32 m0, s31, 0
    s_mov_b32 s44, 2097152
    v_mfma_f32_16x16x32_bf16 v[56:59], a[0:3], a[136:139], v[56:59]
    ds_read_b128 a[164:167], v36 offset:51200
    v_mfma_f32_16x16x32_bf16 v[60:63], a[0:3], a[140:143], v[60:63]
    ds_read_b128 a[168:171], v36 offset:53248
    v_mfma_f32_16x16x32_bf16 v[76:79], a[4:7], a[140:143], v[76:79]
    v_mfma_f32_16x16x32_bf16 v[72:75], a[4:7], a[136:139], v[72:75]
    buffer_load_dwordx4 v24, s[12:15], s44 offen offset:0 nt lds
    v_mfma_f32_16x16x32_bf16 v[68:71], a[4:7], a[132:135], v[68:71]
    ds_read_b128 a[172:175], v36 offset:55296
    v_mfma_f32_16x16x32_bf16 v[64:67], a[4:7], a[128:131], v[64:67]
    ds_read_b128 a[176:179], v37 offset:49152
    v_mfma_f32_16x16x32_bf16 v[80:83], a[8:11], a[128:131], v[80:83]
    ds_read_b128 a[180:183], v37 offset:51200
    v_mfma_f32_16x16x32_bf16 v[84:87], a[8:11], a[132:135], v[84:87]
    buffer_load_dwordx4 v25, s[12:15], s44 offen offset:1024 nt lds
    v_mfma_f32_16x16x32_bf16 v[88:91], a[8:11], a[136:139], v[88:91]
    v_mfma_f32_16x16x32_bf16 v[92:95], a[8:11], a[140:143], v[92:95]
    ds_read_b128 a[184:187], v37 offset:53248
    v_mfma_f32_16x16x32_bf16 v[108:111], a[12:15], a[140:143], v[108:111]
    ds_read_b128 a[188:191], v37 offset:55296
    v_mfma_f32_16x16x32_bf16 v[104:107], a[12:15], a[136:139], v[104:107]
    buffer_load_dwordx4 v26, s[12:15], s44 offen offset:2048 nt lds
    v_mfma_f32_16x16x32_bf16 v[100:103], a[12:15], a[132:135], v[100:103]
    v_mfma_f32_16x16x32_bf16 v[96:99], a[12:15], a[128:131], v[96:99]
    ds_read_b64_tr_b16 a[64:65], v16 offset:16384
    v_mfma_f32_16x16x32_bf16 v[112:115], a[16:19], a[128:131], v[112:115]
    ds_read_b64_tr_b16 a[66:67], v16 offset:18432
    v_mfma_f32_16x16x32_bf16 v[116:119], a[16:19], a[132:135], v[116:119]
    buffer_load_dwordx4 v27, s[12:15], s44 offen offset:3072 nt lds
    v_mfma_f32_16x16x32_bf16 v[120:123], a[16:19], a[136:139], v[120:123]
    ds_read_b64_tr_b16 a[68:69], v17 offset:16384
    v_mfma_f32_16x16x32_bf16 v[124:127], a[16:19], a[140:143], v[124:127]
    v_mfma_f32_16x16x32_bf16 v[140:143], a[20:23], a[140:143], v[140:143]
    ds_read_b64_tr_b16 a[70:71], v17 offset:18432
    v_mfma_f32_16x16x32_bf16 v[136:139], a[20:23], a[136:139], v[136:139]
    ds_read_b64_tr_b16 a[72:73], v18 offset:16384
    v_mfma_f32_16x16x32_bf16 v[132:135], a[20:23], a[132:135], v[132:135]
    ds_read_b64_tr_b16 a[74:75], v18 offset:18432
    v_mfma_f32_16x16x32_bf16 v[128:131], a[20:23], a[128:131], v[128:131]
    v_mfma_f32_16x16x32_bf16 v[144:147], a[24:27], a[128:131], v[144:147]
    ds_read_b64_tr_b16 a[76:77], v19 offset:16384
    v_mfma_f32_16x16x32_bf16 v[148:151], a[24:27], a[132:135], v[148:151]
    ds_read_b64_tr_b16 a[78:79], v19 offset:18432
    v_mfma_f32_16x16x32_bf16 v[152:155], a[24:27], a[136:139], v[152:155]
    v_mfma_f32_16x16x32_bf16 v[156:159], a[24:27], a[140:143], v[156:159]
    ds_read_b64_tr_b16 a[80:81], v20 offset:16384
    v_mfma_f32_16x16x32_bf16 v[172:175], a[28:31], a[140:143], v[172:175]
    ds_read_b64_tr_b16 a[82:83], v20 offset:18432
    v_mfma_f32_16x16x32_bf16 v[168:171], a[28:31], a[136:139], v[168:171]
    ds_read_b64_tr_b16 a[84:85], v21 offset:16384
    v_mfma_f32_16x16x32_bf16 v[164:167], a[28:31], a[132:135], v[164:167]
    v_mfma_f32_16x16x32_bf16 v[160:163], a[28:31], a[128:131], v[160:163]
    ds_read_b64_tr_b16 a[86:87], v21 offset:18432
    v_mfma_f32_16x16x32_bf16 v[176:179], a[32:35], a[128:131], v[176:179]
    ds_read_b64_tr_b16 a[88:89], v22 offset:16384
    v_mfma_f32_16x16x32_bf16 v[180:183], a[32:35], a[132:135], v[180:183]
    ds_read_b64_tr_b16 a[90:91], v22 offset:18432
    v_mfma_f32_16x16x32_bf16 v[184:187], a[32:35], a[136:139], v[184:187]
    v_mfma_f32_16x16x32_bf16 v[188:191], a[32:35], a[140:143], v[188:191]
    ds_read_b64_tr_b16 a[92:93], v23 offset:16384
    v_mfma_f32_16x16x32_bf16 v[204:207], a[36:39], a[140:143], v[204:207]
    ds_read_b64_tr_b16 a[94:95], v23 offset:18432
    v_mfma_f32_16x16x32_bf16 v[200:203], a[36:39], a[136:139], v[200:203]
    v_mfma_f32_16x16x32_bf16 v[196:199], a[36:39], a[132:135], v[196:199]
    ds_read_b64_tr_b16 a[96:97], v16 offset:16640
    v_mfma_f32_16x16x32_bf16 v[192:195], a[36:39], a[128:131], v[192:195]
    ds_read_b64_tr_b16 a[98:99], v16 offset:18688
    v_mfma_f32_16x16x32_bf16 v[208:211], a[40:43], a[128:131], v[208:211]
    ds_read_b64_tr_b16 a[100:101], v17 offset:16640
    v_mfma_f32_16x16x32_bf16 v[212:215], a[40:43], a[132:135], v[212:215]
    v_mfma_f32_16x16x32_bf16 v[216:219], a[40:43], a[136:139], v[216:219]
    ds_read_b64_tr_b16 a[102:103], v17 offset:18688
    v_mfma_f32_16x16x32_bf16 v[220:223], a[40:43], a[140:143], v[220:223]
    ds_read_b64_tr_b16 a[104:105], v18 offset:16640
    v_mfma_f32_16x16x32_bf16 v[236:239], a[44:47], a[140:143], v[236:239]
    ds_read_b64_tr_b16 a[106:107], v18 offset:18688
    v_mfma_f32_16x16x32_bf16 v[232:235], a[44:47], a[136:139], v[232:235]
    v_mfma_f32_16x16x32_bf16 v[228:231], a[44:47], a[132:135], v[228:231]
    ds_read_b64_tr_b16 a[108:109], v19 offset:16640
    v_mfma_f32_16x16x32_bf16 v[224:227], a[44:47], a[128:131], v[224:227]
    ds_read_b64_tr_b16 a[110:111], v19 offset:18688
    v_mfma_f32_16x16x32_bf16 v[240:243], a[48:51], a[128:131], v[240:243]
    v_mfma_f32_16x16x32_bf16 v[244:247], a[48:51], a[132:135], v[244:247]
    ds_read_b64_tr_b16 a[112:113], v20 offset:16640
    v_mfma_f32_16x16x32_bf16 v[248:251], a[48:51], a[136:139], v[248:251]
    ds_read_b64_tr_b16 a[114:115], v20 offset:18688
    v_mfma_f32_16x16x32_bf16 v[252:255], a[48:51], a[140:143], v[252:255]
    ds_read_b64_tr_b16 a[116:117], v21 offset:16640
    v_mfma_f32_16x16x32_bf16 a[220:223], a[52:55], a[140:143], a[220:223]
    v_mfma_f32_16x16x32_bf16 a[216:219], a[52:55], a[136:139], a[216:219]
    ds_read_b64_tr_b16 a[118:119], v21 offset:18688
    v_mfma_f32_16x16x32_bf16 a[212:215], a[52:55], a[132:135], a[212:215]
    ds_read_b64_tr_b16 a[120:121], v22 offset:16640
    v_mfma_f32_16x16x32_bf16 a[208:211], a[52:55], a[128:131], a[208:211]
    ds_read_b64_tr_b16 a[122:123], v22 offset:18688
    v_mfma_f32_16x16x32_bf16 a[224:227], a[56:59], a[128:131], a[224:227]
    v_mfma_f32_16x16x32_bf16 a[228:231], a[56:59], a[132:135], a[228:231]
    ds_read_b64_tr_b16 a[124:125], v23 offset:16640
    v_mfma_f32_16x16x32_bf16 a[232:235], a[56:59], a[136:139], a[232:235]
    ds_read_b64_tr_b16 a[126:127], v23 offset:18688
    v_mfma_f32_16x16x32_bf16 a[236:239], a[56:59], a[140:143], a[236:239]
    v_mfma_f32_16x16x32_bf16 a[252:255], a[60:63], a[140:143], a[252:255]
    v_mfma_f32_16x16x32_bf16 a[248:251], a[60:63], a[136:139], a[248:251]
    v_mfma_f32_16x16x32_bf16 a[244:247], a[60:63], a[132:135], a[244:247]
    v_mfma_f32_16x16x32_bf16 a[240:243], a[60:63], a[128:131], a[240:243]
    s_waitcnt vmcnt(16) lgkmcnt(0)
    s_barrier
    v_mfma_f32_16x16x32_bf16 v[48:51], a[64:67], a[144:147], v[48:51]
    ds_read_b64_tr_b16 a[0:1], v16 offset:32768
    v_mfma_f32_16x16x32_bf16 v[52:55], a[64:67], a[148:151], v[52:55]
    s_add_u32 m0, s31, 16384
    s_mov_b32 s44, 2359296
    v_mfma_f32_16x16x32_bf16 v[56:59], a[64:67], a[152:155], v[56:59]
    ds_read_b64_tr_b16 a[2:3], v16 offset:34816
    v_mfma_f32_16x16x32_bf16 v[60:63], a[64:67], a[156:159], v[60:63]
    ds_read_b64_tr_b16 a[4:5], v17 offset:32768
    v_mfma_f32_16x16x32_bf16 v[76:79], a[68:71], a[156:159], v[76:79]
    v_mfma_f32_16x16x32_bf16 v[72:75], a[68:71], a[152:155], v[72:75]
    buffer_load_dwordx4 v24, s[12:15], s44 offen offset:0 nt lds
    v_mfma_f32_16x16x32_bf16 v[68:71], a[68:71], a[148:151], v[68:71]
    ds_read_b64_tr_b16 a[6:7], v17 offset:34816
    v_mfma_f32_16x16x32_bf16 v[64:67], a[68:71], a[144:147], v[64:67]
    ds_read_b64_tr_b16 a[8:9], v18 offset:32768
    v_mfma_f32_16x16x32_bf16 v[80:83], a[72:75], a[144:147], v[80:83]
    v_mfma_f32_16x16x32_bf16 v[84:87], a[72:75], a[148:151], v[84:87]
    buffer_load_dwordx4 v25, s[12:15], s44 offen offset:1024 nt lds
    v_mfma_f32_16x16x32_bf16 v[88:91], a[72:75], a[152:155], v[88:91]
    ds_read_b64_tr_b16 a[10:11], v18 offset:34816
    v_mfma_f32_16x16x32_bf16 v[92:95], a[72:75], a[156:159], v[92:95]
    ds_read_b64_tr_b16 a[12:13], v19 offset:32768
    v_mfma_f32_16x16x32_bf16 v[108:111], a[76:79], a[156:159], v[108:111]
    v_mfma_f32_16x16x32_bf16 v[104:107], a[76:79], a[152:155], v[104:107]
    buffer_load_dwordx4 v26, s[12:15], s44 offen offset:2048 nt lds
    v_mfma_f32_16x16x32_bf16 v[100:103], a[76:79], a[148:151], v[100:103]
    ds_read_b64_tr_b16 a[14:15], v19 offset:34816
    v_mfma_f32_16x16x32_bf16 v[96:99], a[76:79], a[144:147], v[96:99]
    ds_read_b64_tr_b16 a[16:17], v20 offset:32768
    v_mfma_f32_16x16x32_bf16 v[112:115], a[80:83], a[144:147], v[112:115]
    ds_read_b64_tr_b16 a[18:19], v20 offset:34816
    v_mfma_f32_16x16x32_bf16 v[116:119], a[80:83], a[148:151], v[116:119]
    buffer_load_dwordx4 v27, s[12:15], s44 offen offset:3072 nt lds
    v_mfma_f32_16x16x32_bf16 v[120:123], a[80:83], a[152:155], v[120:123]
    v_mfma_f32_16x16x32_bf16 v[124:127], a[80:83], a[156:159], v[124:127]
    ds_read_b64_tr_b16 a[20:21], v21 offset:32768
    v_mfma_f32_16x16x32_bf16 v[140:143], a[84:87], a[156:159], v[140:143]
    ds_read_b64_tr_b16 a[22:23], v21 offset:34816
    v_mfma_f32_16x16x32_bf16 v[136:139], a[84:87], a[152:155], v[136:139]
    s_add_u32 m0, s34, 49152
    s_movk_i32 s44, 640
    v_mfma_f32_16x16x32_bf16 v[132:135], a[84:87], a[148:151], v[132:135]
    v_mfma_f32_16x16x32_bf16 v[128:131], a[84:87], a[144:147], v[128:131]
    ds_read_b64_tr_b16 a[24:25], v22 offset:32768
    v_mfma_f32_16x16x32_bf16 v[144:147], a[88:91], a[144:147], v[144:147]
    ds_read_b64_tr_b16 a[26:27], v22 offset:34816
    v_mfma_f32_16x16x32_bf16 v[148:151], a[88:91], a[148:151], v[148:151]
    buffer_load_dwordx4 v28, s[8:11], s44 offen offset:0 nt lds
    v_mfma_f32_16x16x32_bf16 v[152:155], a[88:91], a[152:155], v[152:155]
    v_mfma_f32_16x16x32_bf16 v[156:159], a[88:91], a[156:159], v[156:159]
    ds_read_b64_tr_b16 a[28:29], v23 offset:32768
    v_mfma_f32_16x16x32_bf16 v[172:175], a[92:95], a[156:159], v[172:175]
    ds_read_b64_tr_b16 a[30:31], v23 offset:34816
    v_mfma_f32_16x16x32_bf16 v[168:171], a[92:95], a[152:155], v[168:171]
    buffer_load_dwordx4 v29, s[8:11], s44 offen offset:1024 nt lds
    v_mfma_f32_16x16x32_bf16 v[164:167], a[92:95], a[148:151], v[164:167]
    v_mfma_f32_16x16x32_bf16 v[160:163], a[92:95], a[144:147], v[160:163]
    ds_read_b64_tr_b16 a[32:33], v16 offset:33024
    v_mfma_f32_16x16x32_bf16 v[176:179], a[96:99], a[144:147], v[176:179]
    ds_read_b64_tr_b16 a[34:35], v16 offset:35072
    v_mfma_f32_16x16x32_bf16 v[180:183], a[96:99], a[148:151], v[180:183]
    buffer_load_dwordx4 v30, s[8:11], s44 offen offset:2048 nt lds
    v_mfma_f32_16x16x32_bf16 v[184:187], a[96:99], a[152:155], v[184:187]
    ds_read_b64_tr_b16 a[36:37], v17 offset:33024
    v_mfma_f32_16x16x32_bf16 v[188:191], a[96:99], a[156:159], v[188:191]
    v_mfma_f32_16x16x32_bf16 v[204:207], a[100:103], a[156:159], v[204:207]
    ds_read_b64_tr_b16 a[38:39], v17 offset:35072
    v_mfma_f32_16x16x32_bf16 v[200:203], a[100:103], a[152:155], v[200:203]
    buffer_load_dwordx4 v31, s[8:11], s44 offen offset:3072 nt lds
    s_add_u32 m0, s34, 53248
    v_mfma_f32_16x16x32_bf16 v[196:199], a[100:103], a[148:151], v[196:199]
    ds_read_b64_tr_b16 a[40:41], v18 offset:33024
    v_mfma_f32_16x16x32_bf16 v[192:195], a[100:103], a[144:147], v[192:195]
    v_mfma_f32_16x16x32_bf16 v[208:211], a[104:107], a[144:147], v[208:211]
    ds_read_b64_tr_b16 a[42:43], v18 offset:35072
    v_mfma_f32_16x16x32_bf16 v[212:215], a[104:107], a[148:151], v[212:215]
    buffer_load_dwordx4 v32, s[8:11], s44 offen offset:0 nt lds
    v_mfma_f32_16x16x32_bf16 v[216:219], a[104:107], a[152:155], v[216:219]
    ds_read_b64_tr_b16 a[44:45], v19 offset:33024
    v_mfma_f32_16x16x32_bf16 v[220:223], a[104:107], a[156:159], v[220:223]
    v_mfma_f32_16x16x32_bf16 v[236:239], a[108:111], a[156:159], v[236:239]
    ds_read_b64_tr_b16 a[46:47], v19 offset:35072
    v_mfma_f32_16x16x32_bf16 v[232:235], a[108:111], a[152:155], v[232:235]
    buffer_load_dwordx4 v33, s[8:11], s44 offen offset:1024 nt lds
    v_mfma_f32_16x16x32_bf16 v[228:231], a[108:111], a[148:151], v[228:231]
    ds_read_b64_tr_b16 a[48:49], v20 offset:33024
    v_mfma_f32_16x16x32_bf16 v[224:227], a[108:111], a[144:147], v[224:227]
    ds_read_b64_tr_b16 a[50:51], v20 offset:35072
    v_mfma_f32_16x16x32_bf16 v[240:243], a[112:115], a[144:147], v[240:243]
    v_mfma_f32_16x16x32_bf16 v[244:247], a[112:115], a[148:151], v[244:247]
    buffer_load_dwordx4 v34, s[8:11], s44 offen offset:2048 nt lds
    v_mfma_f32_16x16x32_bf16 v[248:251], a[112:115], a[152:155], v[248:251]
    ds_read_b64_tr_b16 a[52:53], v21 offset:33024
    v_mfma_f32_16x16x32_bf16 v[252:255], a[112:115], a[156:159], v[252:255]
    ds_read_b64_tr_b16 a[54:55], v21 offset:35072
    v_mfma_f32_16x16x32_bf16 a[220:223], a[116:119], a[156:159], a[220:223]
    v_mfma_f32_16x16x32_bf16 a[216:219], a[116:119], a[152:155], a[216:219]
    buffer_load_dwordx4 v35, s[8:11], s44 offen offset:3072 nt lds
    v_mfma_f32_16x16x32_bf16 a[212:215], a[116:119], a[148:151], a[212:215]
    ds_read_b64_tr_b16 a[56:57], v22 offset:33024
    v_mfma_f32_16x16x32_bf16 a[208:211], a[116:119], a[144:147], a[208:211]
    ds_read_b64_tr_b16 a[58:59], v22 offset:35072
    v_mfma_f32_16x16x32_bf16 a[224:227], a[120:123], a[144:147], a[224:227]
    v_mfma_f32_16x16x32_bf16 a[228:231], a[120:123], a[148:151], a[228:231]
    ds_read_b64_tr_b16 a[60:61], v23 offset:33024
    v_mfma_f32_16x16x32_bf16 a[232:235], a[120:123], a[152:155], a[232:235]
    ds_read_b64_tr_b16 a[62:63], v23 offset:35072
    v_mfma_f32_16x16x32_bf16 a[236:239], a[120:123], a[156:159], a[236:239]
    v_mfma_f32_16x16x32_bf16 a[252:255], a[124:127], a[156:159], a[252:255]
    v_mfma_f32_16x16x32_bf16 a[248:251], a[124:127], a[152:155], a[248:251]
    v_mfma_f32_16x16x32_bf16 a[244:247], a[124:127], a[148:151], a[244:247]
    v_mfma_f32_16x16x32_bf16 a[240:243], a[124:127], a[144:147], a[240:243]
    s_waitcnt vmcnt(16) lgkmcnt(0)
    s_barrier
    v_mfma_f32_16x16x32_bf16 v[48:51], a[0:3], a[160:163], v[48:51]
    ds_read_b128 a[128:131], v36 offset:16384
    v_mfma_f32_16x16x32_bf16 v[52:55], a[0:3], a[164:167], v[52:55]
    s_add_u32 m0, s31, 32768
    s_mov_b32 s44, 2621440
    v_mfma_f32_16x16x32_bf16 v[56:59], a[0:3], a[168:171], v[56:59]
    ds_read_b128 a[132:135], v36 offset:18432
    v_mfma_f32_16x16x32_bf16 v[60:63], a[0:3], a[172:175], v[60:63]
    ds_read_b128 a[136:139], v36 offset:20480
    v_mfma_f32_16x16x32_bf16 v[76:79], a[4:7], a[172:175], v[76:79]
    v_mfma_f32_16x16x32_bf16 v[72:75], a[4:7], a[168:171], v[72:75]
    buffer_load_dwordx4 v24, s[12:15], s44 offen offset:0 nt lds
    v_mfma_f32_16x16x32_bf16 v[68:71], a[4:7], a[164:167], v[68:71]
    ds_read_b128 a[140:143], v36 offset:22528
    v_mfma_f32_16x16x32_bf16 v[64:67], a[4:7], a[160:163], v[64:67]
    ds_read_b128 a[144:147], v37 offset:16384
    v_mfma_f32_16x16x32_bf16 v[80:83], a[8:11], a[160:163], v[80:83]
    ds_read_b128 a[148:151], v37 offset:18432
    v_mfma_f32_16x16x32_bf16 v[84:87], a[8:11], a[164:167], v[84:87]
    buffer_load_dwordx4 v25, s[12:15], s44 offen offset:1024 nt lds
    v_mfma_f32_16x16x32_bf16 v[88:91], a[8:11], a[168:171], v[88:91]
    v_mfma_f32_16x16x32_bf16 v[92:95], a[8:11], a[172:175], v[92:95]
    ds_read_b128 a[152:155], v37 offset:20480
    v_mfma_f32_16x16x32_bf16 v[108:111], a[12:15], a[172:175], v[108:111]
    ds_read_b128 a[156:159], v37 offset:22528
    v_mfma_f32_16x16x32_bf16 v[104:107], a[12:15], a[168:171], v[104:107]
    buffer_load_dwordx4 v26, s[12:15], s44 offen offset:2048 nt lds
    v_mfma_f32_16x16x32_bf16 v[100:103], a[12:15], a[164:167], v[100:103]
    v_mfma_f32_16x16x32_bf16 v[96:99], a[12:15], a[160:163], v[96:99]
    ds_read_b64_tr_b16 a[64:65], v16 offset:49152
    v_mfma_f32_16x16x32_bf16 v[112:115], a[16:19], a[160:163], v[112:115]
    ds_read_b64_tr_b16 a[66:67], v16 offset:51200
    v_mfma_f32_16x16x32_bf16 v[116:119], a[16:19], a[164:167], v[116:119]
    buffer_load_dwordx4 v27, s[12:15], s44 offen offset:3072 nt lds
    v_mfma_f32_16x16x32_bf16 v[120:123], a[16:19], a[168:171], v[120:123]
    ds_read_b64_tr_b16 a[68:69], v17 offset:49152
    v_mfma_f32_16x16x32_bf16 v[124:127], a[16:19], a[172:175], v[124:127]
    v_mfma_f32_16x16x32_bf16 v[140:143], a[20:23], a[172:175], v[140:143]
    ds_read_b64_tr_b16 a[70:71], v17 offset:51200
    v_mfma_f32_16x16x32_bf16 v[136:139], a[20:23], a[168:171], v[136:139]
    ds_read_b64_tr_b16 a[72:73], v18 offset:49152
    v_mfma_f32_16x16x32_bf16 v[132:135], a[20:23], a[164:167], v[132:135]
    ds_read_b64_tr_b16 a[74:75], v18 offset:51200
    v_mfma_f32_16x16x32_bf16 v[128:131], a[20:23], a[160:163], v[128:131]
    v_mfma_f32_16x16x32_bf16 v[144:147], a[24:27], a[160:163], v[144:147]
    ds_read_b64_tr_b16 a[76:77], v19 offset:49152
    v_mfma_f32_16x16x32_bf16 v[148:151], a[24:27], a[164:167], v[148:151]
    ds_read_b64_tr_b16 a[78:79], v19 offset:51200
    v_mfma_f32_16x16x32_bf16 v[152:155], a[24:27], a[168:171], v[152:155]
    v_mfma_f32_16x16x32_bf16 v[156:159], a[24:27], a[172:175], v[156:159]
    ds_read_b64_tr_b16 a[80:81], v20 offset:49152
    v_mfma_f32_16x16x32_bf16 v[172:175], a[28:31], a[172:175], v[172:175]
    ds_read_b64_tr_b16 a[82:83], v20 offset:51200
    v_mfma_f32_16x16x32_bf16 v[168:171], a[28:31], a[168:171], v[168:171]
    ds_read_b64_tr_b16 a[84:85], v21 offset:49152
    v_mfma_f32_16x16x32_bf16 v[164:167], a[28:31], a[164:167], v[164:167]
    v_mfma_f32_16x16x32_bf16 v[160:163], a[28:31], a[160:163], v[160:163]
    ds_read_b64_tr_b16 a[86:87], v21 offset:51200
    v_mfma_f32_16x16x32_bf16 v[176:179], a[32:35], a[160:163], v[176:179]
    ds_read_b64_tr_b16 a[88:89], v22 offset:49152
    v_mfma_f32_16x16x32_bf16 v[180:183], a[32:35], a[164:167], v[180:183]
    ds_read_b64_tr_b16 a[90:91], v22 offset:51200
    v_mfma_f32_16x16x32_bf16 v[184:187], a[32:35], a[168:171], v[184:187]
    v_mfma_f32_16x16x32_bf16 v[188:191], a[32:35], a[172:175], v[188:191]
    ds_read_b64_tr_b16 a[92:93], v23 offset:49152
    v_mfma_f32_16x16x32_bf16 v[204:207], a[36:39], a[172:175], v[204:207]
    ds_read_b64_tr_b16 a[94:95], v23 offset:51200
    v_mfma_f32_16x16x32_bf16 v[200:203], a[36:39], a[168:171], v[200:203]
    v_mfma_f32_16x16x32_bf16 v[196:199], a[36:39], a[164:167], v[196:199]
    ds_read_b64_tr_b16 a[96:97], v16 offset:49408
    v_mfma_f32_16x16x32_bf16 v[192:195], a[36:39], a[160:163], v[192:195]
    ds_read_b64_tr_b16 a[98:99], v16 offset:51456
    v_mfma_f32_16x16x32_bf16 v[208:211], a[40:43], a[160:163], v[208:211]
    ds_read_b64_tr_b16 a[100:101], v17 offset:49408
    v_mfma_f32_16x16x32_bf16 v[212:215], a[40:43], a[164:167], v[212:215]
    v_mfma_f32_16x16x32_bf16 v[216:219], a[40:43], a[168:171], v[216:219]
    ds_read_b64_tr_b16 a[102:103], v17 offset:51456
    v_mfma_f32_16x16x32_bf16 v[220:223], a[40:43], a[172:175], v[220:223]
    ds_read_b64_tr_b16 a[104:105], v18 offset:49408
    v_mfma_f32_16x16x32_bf16 v[236:239], a[44:47], a[172:175], v[236:239]
    ds_read_b64_tr_b16 a[106:107], v18 offset:51456
    v_mfma_f32_16x16x32_bf16 v[232:235], a[44:47], a[168:171], v[232:235]
    v_mfma_f32_16x16x32_bf16 v[228:231], a[44:47], a[164:167], v[228:231]
    ds_read_b64_tr_b16 a[108:109], v19 offset:49408
    v_mfma_f32_16x16x32_bf16 v[224:227], a[44:47], a[160:163], v[224:227]
    ds_read_b64_tr_b16 a[110:111], v19 offset:51456
    v_mfma_f32_16x16x32_bf16 v[240:243], a[48:51], a[160:163], v[240:243]
    v_mfma_f32_16x16x32_bf16 v[244:247], a[48:51], a[164:167], v[244:247]
    ds_read_b64_tr_b16 a[112:113], v20 offset:49408
    v_mfma_f32_16x16x32_bf16 v[248:251], a[48:51], a[168:171], v[248:251]
    ds_read_b64_tr_b16 a[114:115], v20 offset:51456
    v_mfma_f32_16x16x32_bf16 v[252:255], a[48:51], a[172:175], v[252:255]
    ds_read_b64_tr_b16 a[116:117], v21 offset:49408
    v_mfma_f32_16x16x32_bf16 a[220:223], a[52:55], a[172:175], a[220:223]
    v_mfma_f32_16x16x32_bf16 a[216:219], a[52:55], a[168:171], a[216:219]
    ds_read_b64_tr_b16 a[118:119], v21 offset:51456
    v_mfma_f32_16x16x32_bf16 a[212:215], a[52:55], a[164:167], a[212:215]
    ds_read_b64_tr_b16 a[120:121], v22 offset:49408
    v_mfma_f32_16x16x32_bf16 a[208:211], a[52:55], a[160:163], a[208:211]
    ds_read_b64_tr_b16 a[122:123], v22 offset:51456
    v_mfma_f32_16x16x32_bf16 a[224:227], a[56:59], a[160:163], a[224:227]
    v_mfma_f32_16x16x32_bf16 a[228:231], a[56:59], a[164:167], a[228:231]
    ds_read_b64_tr_b16 a[124:125], v23 offset:49408
    v_mfma_f32_16x16x32_bf16 a[232:235], a[56:59], a[168:171], a[232:235]
    ds_read_b64_tr_b16 a[126:127], v23 offset:51456
    v_mfma_f32_16x16x32_bf16 a[236:239], a[56:59], a[172:175], a[236:239]
    v_mfma_f32_16x16x32_bf16 a[252:255], a[60:63], a[172:175], a[252:255]
    v_mfma_f32_16x16x32_bf16 a[248:251], a[60:63], a[168:171], a[248:251]
    v_mfma_f32_16x16x32_bf16 a[244:247], a[60:63], a[164:167], a[244:247]
    v_mfma_f32_16x16x32_bf16 a[240:243], a[60:63], a[160:163], a[240:243]
    s_waitcnt vmcnt(16) lgkmcnt(0)
    s_barrier
    v_mfma_f32_16x16x32_bf16 v[48:51], a[64:67], a[176:179], v[48:51]
    ds_read_b64_tr_b16 a[0:1], v16 offset:0
    v_mfma_f32_16x16x32_bf16 v[52:55], a[64:67], a[180:183], v[52:55]
    s_add_u32 m0, s31, 49152
    s_mov_b32 s44, 2883584
    v_mfma_f32_16x16x32_bf16 v[56:59], a[64:67], a[184:187], v[56:59]
    ds_read_b64_tr_b16 a[2:3], v16 offset:2048
    v_mfma_f32_16x16x32_bf16 v[60:63], a[64:67], a[188:191], v[60:63]
    ds_read_b64_tr_b16 a[4:5], v17 offset:0
    v_mfma_f32_16x16x32_bf16 v[76:79], a[68:71], a[188:191], v[76:79]
    v_mfma_f32_16x16x32_bf16 v[72:75], a[68:71], a[184:187], v[72:75]
    buffer_load_dwordx4 v24, s[12:15], s44 offen offset:0 nt lds
    v_mfma_f32_16x16x32_bf16 v[68:71], a[68:71], a[180:183], v[68:71]
    ds_read_b64_tr_b16 a[6:7], v17 offset:2048
    v_mfma_f32_16x16x32_bf16 v[64:67], a[68:71], a[176:179], v[64:67]
    ds_read_b64_tr_b16 a[8:9], v18 offset:0
    v_mfma_f32_16x16x32_bf16 v[80:83], a[72:75], a[176:179], v[80:83]
    v_mfma_f32_16x16x32_bf16 v[84:87], a[72:75], a[180:183], v[84:87]
    buffer_load_dwordx4 v25, s[12:15], s44 offen offset:1024 nt lds
    v_mfma_f32_16x16x32_bf16 v[88:91], a[72:75], a[184:187], v[88:91]
    ds_read_b64_tr_b16 a[10:11], v18 offset:2048
    v_mfma_f32_16x16x32_bf16 v[92:95], a[72:75], a[188:191], v[92:95]
    ds_read_b64_tr_b16 a[12:13], v19 offset:0
    v_mfma_f32_16x16x32_bf16 v[108:111], a[76:79], a[188:191], v[108:111]
    v_mfma_f32_16x16x32_bf16 v[104:107], a[76:79], a[184:187], v[104:107]
    buffer_load_dwordx4 v26, s[12:15], s44 offen offset:2048 nt lds
    v_mfma_f32_16x16x32_bf16 v[100:103], a[76:79], a[180:183], v[100:103]
    ds_read_b64_tr_b16 a[14:15], v19 offset:2048
    v_mfma_f32_16x16x32_bf16 v[96:99], a[76:79], a[176:179], v[96:99]
    ds_read_b64_tr_b16 a[16:17], v20 offset:0
    v_mfma_f32_16x16x32_bf16 v[112:115], a[80:83], a[176:179], v[112:115]
    ds_read_b64_tr_b16 a[18:19], v20 offset:2048
    v_mfma_f32_16x16x32_bf16 v[116:119], a[80:83], a[180:183], v[116:119]
    buffer_load_dwordx4 v27, s[12:15], s44 offen offset:3072 nt lds
    v_mfma_f32_16x16x32_bf16 v[120:123], a[80:83], a[184:187], v[120:123]
    v_mfma_f32_16x16x32_bf16 v[124:127], a[80:83], a[188:191], v[124:127]
    ds_read_b64_tr_b16 a[20:21], v21 offset:0
    v_mfma_f32_16x16x32_bf16 v[140:143], a[84:87], a[188:191], v[140:143]
    ds_read_b64_tr_b16 a[22:23], v21 offset:2048
    v_mfma_f32_16x16x32_bf16 v[136:139], a[84:87], a[184:187], v[136:139]
    s_add_u32 m0, s34, 16384
    s_movk_i32 s44, 768
    v_mfma_f32_16x16x32_bf16 v[132:135], a[84:87], a[180:183], v[132:135]
    v_mfma_f32_16x16x32_bf16 v[128:131], a[84:87], a[176:179], v[128:131]
    ds_read_b64_tr_b16 a[24:25], v22 offset:0
    v_mfma_f32_16x16x32_bf16 v[144:147], a[88:91], a[176:179], v[144:147]
    ds_read_b64_tr_b16 a[26:27], v22 offset:2048
    v_mfma_f32_16x16x32_bf16 v[148:151], a[88:91], a[180:183], v[148:151]
    buffer_load_dwordx4 v28, s[8:11], s44 offen offset:0 nt lds
    v_mfma_f32_16x16x32_bf16 v[152:155], a[88:91], a[184:187], v[152:155]
    v_mfma_f32_16x16x32_bf16 v[156:159], a[88:91], a[188:191], v[156:159]
    ds_read_b64_tr_b16 a[28:29], v23 offset:0
    v_mfma_f32_16x16x32_bf16 v[172:175], a[92:95], a[188:191], v[172:175]
    ds_read_b64_tr_b16 a[30:31], v23 offset:2048
    v_mfma_f32_16x16x32_bf16 v[168:171], a[92:95], a[184:187], v[168:171]
    buffer_load_dwordx4 v29, s[8:11], s44 offen offset:1024 nt lds
    v_mfma_f32_16x16x32_bf16 v[164:167], a[92:95], a[180:183], v[164:167]
    v_mfma_f32_16x16x32_bf16 v[160:163], a[92:95], a[176:179], v[160:163]
    ds_read_b64_tr_b16 a[32:33], v16 offset:256
    v_mfma_f32_16x16x32_bf16 v[176:179], a[96:99], a[176:179], v[176:179]
    ds_read_b64_tr_b16 a[34:35], v16 offset:2304
    v_mfma_f32_16x16x32_bf16 v[180:183], a[96:99], a[180:183], v[180:183]
    buffer_load_dwordx4 v30, s[8:11], s44 offen offset:2048 nt lds
    v_mfma_f32_16x16x32_bf16 v[184:187], a[96:99], a[184:187], v[184:187]
    ds_read_b64_tr_b16 a[36:37], v17 offset:256
    v_mfma_f32_16x16x32_bf16 v[188:191], a[96:99], a[188:191], v[188:191]
    v_mfma_f32_16x16x32_bf16 v[204:207], a[100:103], a[188:191], v[204:207]
    ds_read_b64_tr_b16 a[38:39], v17 offset:2304
    v_mfma_f32_16x16x32_bf16 v[200:203], a[100:103], a[184:187], v[200:203]
    buffer_load_dwordx4 v31, s[8:11], s44 offen offset:3072 nt lds
    s_add_u32 m0, s34, 20480
    v_mfma_f32_16x16x32_bf16 v[196:199], a[100:103], a[180:183], v[196:199]
    ds_read_b64_tr_b16 a[40:41], v18 offset:256
    v_mfma_f32_16x16x32_bf16 v[192:195], a[100:103], a[176:179], v[192:195]
    v_mfma_f32_16x16x32_bf16 v[208:211], a[104:107], a[176:179], v[208:211]
    ds_read_b64_tr_b16 a[42:43], v18 offset:2304
    v_mfma_f32_16x16x32_bf16 v[212:215], a[104:107], a[180:183], v[212:215]
    buffer_load_dwordx4 v32, s[8:11], s44 offen offset:0 nt lds
    v_mfma_f32_16x16x32_bf16 v[216:219], a[104:107], a[184:187], v[216:219]
    ds_read_b64_tr_b16 a[44:45], v19 offset:256
    v_mfma_f32_16x16x32_bf16 v[220:223], a[104:107], a[188:191], v[220:223]
    v_mfma_f32_16x16x32_bf16 v[236:239], a[108:111], a[188:191], v[236:239]
    ds_read_b64_tr_b16 a[46:47], v19 offset:2304
    v_mfma_f32_16x16x32_bf16 v[232:235], a[108:111], a[184:187], v[232:235]
    buffer_load_dwordx4 v33, s[8:11], s44 offen offset:1024 nt lds
    v_mfma_f32_16x16x32_bf16 v[228:231], a[108:111], a[180:183], v[228:231]
    ds_read_b64_tr_b16 a[48:49], v20 offset:256
    v_mfma_f32_16x16x32_bf16 v[224:227], a[108:111], a[176:179], v[224:227]
    ds_read_b64_tr_b16 a[50:51], v20 offset:2304
    v_mfma_f32_16x16x32_bf16 v[240:243], a[112:115], a[176:179], v[240:243]
    v_mfma_f32_16x16x32_bf16 v[244:247], a[112:115], a[180:183], v[244:247]
    buffer_load_dwordx4 v34, s[8:11], s44 offen offset:2048 nt lds
    v_mfma_f32_16x16x32_bf16 v[248:251], a[112:115], a[184:187], v[248:251]
    ds_read_b64_tr_b16 a[52:53], v21 offset:256
    v_mfma_f32_16x16x32_bf16 v[252:255], a[112:115], a[188:191], v[252:255]
    ds_read_b64_tr_b16 a[54:55], v21 offset:2304
    v_mfma_f32_16x16x32_bf16 a[220:223], a[116:119], a[188:191], a[220:223]
    v_mfma_f32_16x16x32_bf16 a[216:219], a[116:119], a[184:187], a[216:219]
    buffer_load_dwordx4 v35, s[8:11], s44 offen offset:3072 nt lds
    v_mfma_f32_16x16x32_bf16 a[212:215], a[116:119], a[180:183], a[212:215]
    ds_read_b64_tr_b16 a[56:57], v22 offset:256
    v_mfma_f32_16x16x32_bf16 a[208:211], a[116:119], a[176:179], a[208:211]
    ds_read_b64_tr_b16 a[58:59], v22 offset:2304
    v_mfma_f32_16x16x32_bf16 a[224:227], a[120:123], a[176:179], a[224:227]
    v_mfma_f32_16x16x32_bf16 a[228:231], a[120:123], a[180:183], a[228:231]
    ds_read_b64_tr_b16 a[60:61], v23 offset:256
    v_mfma_f32_16x16x32_bf16 a[232:235], a[120:123], a[184:187], a[232:235]
    ds_read_b64_tr_b16 a[62:63], v23 offset:2304
    v_mfma_f32_16x16x32_bf16 a[236:239], a[120:123], a[188:191], a[236:239]
    v_mfma_f32_16x16x32_bf16 a[252:255], a[124:127], a[188:191], a[252:255]
    v_mfma_f32_16x16x32_bf16 a[248:251], a[124:127], a[184:187], a[248:251]
    v_mfma_f32_16x16x32_bf16 a[244:247], a[124:127], a[180:183], a[244:247]
    v_mfma_f32_16x16x32_bf16 a[240:243], a[124:127], a[176:179], a[240:243]
    s_waitcnt vmcnt(16) lgkmcnt(0)
    s_barrier
    v_mfma_f32_16x16x32_bf16 v[48:51], a[0:3], a[128:131], v[48:51]
    ds_read_b128 a[160:163], v36 offset:49152
    v_mfma_f32_16x16x32_bf16 v[52:55], a[0:3], a[132:135], v[52:55]
    s_add_u32 m0, s31, 0
    s_mov_b32 s44, 3145728
    v_mfma_f32_16x16x32_bf16 v[56:59], a[0:3], a[136:139], v[56:59]
    ds_read_b128 a[164:167], v36 offset:51200
    v_mfma_f32_16x16x32_bf16 v[60:63], a[0:3], a[140:143], v[60:63]
    ds_read_b128 a[168:171], v36 offset:53248
    v_mfma_f32_16x16x32_bf16 v[76:79], a[4:7], a[140:143], v[76:79]
    v_mfma_f32_16x16x32_bf16 v[72:75], a[4:7], a[136:139], v[72:75]
    buffer_load_dwordx4 v24, s[12:15], s44 offen offset:0 nt lds
    v_mfma_f32_16x16x32_bf16 v[68:71], a[4:7], a[132:135], v[68:71]
    ds_read_b128 a[172:175], v36 offset:55296
    v_mfma_f32_16x16x32_bf16 v[64:67], a[4:7], a[128:131], v[64:67]
    ds_read_b128 a[176:179], v37 offset:49152
    v_mfma_f32_16x16x32_bf16 v[80:83], a[8:11], a[128:131], v[80:83]
    ds_read_b128 a[180:183], v37 offset:51200
    v_mfma_f32_16x16x32_bf16 v[84:87], a[8:11], a[132:135], v[84:87]
    buffer_load_dwordx4 v25, s[12:15], s44 offen offset:1024 nt lds
    v_mfma_f32_16x16x32_bf16 v[88:91], a[8:11], a[136:139], v[88:91]
    v_mfma_f32_16x16x32_bf16 v[92:95], a[8:11], a[140:143], v[92:95]
    ds_read_b128 a[184:187], v37 offset:53248
    v_mfma_f32_16x16x32_bf16 v[108:111], a[12:15], a[140:143], v[108:111]
    ds_read_b128 a[188:191], v37 offset:55296
    v_mfma_f32_16x16x32_bf16 v[104:107], a[12:15], a[136:139], v[104:107]
    buffer_load_dwordx4 v26, s[12:15], s44 offen offset:2048 nt lds
    v_mfma_f32_16x16x32_bf16 v[100:103], a[12:15], a[132:135], v[100:103]
    v_mfma_f32_16x16x32_bf16 v[96:99], a[12:15], a[128:131], v[96:99]
    ds_read_b64_tr_b16 a[64:65], v16 offset:16384
    v_mfma_f32_16x16x32_bf16 v[112:115], a[16:19], a[128:131], v[112:115]
    ds_read_b64_tr_b16 a[66:67], v16 offset:18432
    v_mfma_f32_16x16x32_bf16 v[116:119], a[16:19], a[132:135], v[116:119]
    buffer_load_dwordx4 v27, s[12:15], s44 offen offset:3072 nt lds
    v_mfma_f32_16x16x32_bf16 v[120:123], a[16:19], a[136:139], v[120:123]
    ds_read_b64_tr_b16 a[68:69], v17 offset:16384
    v_mfma_f32_16x16x32_bf16 v[124:127], a[16:19], a[140:143], v[124:127]
    v_mfma_f32_16x16x32_bf16 v[140:143], a[20:23], a[140:143], v[140:143]
    ds_read_b64_tr_b16 a[70:71], v17 offset:18432
    v_mfma_f32_16x16x32_bf16 v[136:139], a[20:23], a[136:139], v[136:139]
    ds_read_b64_tr_b16 a[72:73], v18 offset:16384
    v_mfma_f32_16x16x32_bf16 v[132:135], a[20:23], a[132:135], v[132:135]
    ds_read_b64_tr_b16 a[74:75], v18 offset:18432
    v_mfma_f32_16x16x32_bf16 v[128:131], a[20:23], a[128:131], v[128:131]
    v_mfma_f32_16x16x32_bf16 v[144:147], a[24:27], a[128:131], v[144:147]
    ds_read_b64_tr_b16 a[76:77], v19 offset:16384
    v_mfma_f32_16x16x32_bf16 v[148:151], a[24:27], a[132:135], v[148:151]
    ds_read_b64_tr_b16 a[78:79], v19 offset:18432
    v_mfma_f32_16x16x32_bf16 v[152:155], a[24:27], a[136:139], v[152:155]
    v_mfma_f32_16x16x32_bf16 v[156:159], a[24:27], a[140:143], v[156:159]
    ds_read_b64_tr_b16 a[80:81], v20 offset:16384
    v_mfma_f32_16x16x32_bf16 v[172:175], a[28:31], a[140:143], v[172:175]
    ds_read_b64_tr_b16 a[82:83], v20 offset:18432
    v_mfma_f32_16x16x32_bf16 v[168:171], a[28:31], a[136:139], v[168:171]
    ds_read_b64_tr_b16 a[84:85], v21 offset:16384
    v_mfma_f32_16x16x32_bf16 v[164:167], a[28:31], a[132:135], v[164:167]
    v_mfma_f32_16x16x32_bf16 v[160:163], a[28:31], a[128:131], v[160:163]
    ds_read_b64_tr_b16 a[86:87], v21 offset:18432
    v_mfma_f32_16x16x32_bf16 v[176:179], a[32:35], a[128:131], v[176:179]
    ds_read_b64_tr_b16 a[88:89], v22 offset:16384
    v_mfma_f32_16x16x32_bf16 v[180:183], a[32:35], a[132:135], v[180:183]
    ds_read_b64_tr_b16 a[90:91], v22 offset:18432
    v_mfma_f32_16x16x32_bf16 v[184:187], a[32:35], a[136:139], v[184:187]
    v_mfma_f32_16x16x32_bf16 v[188:191], a[32:35], a[140:143], v[188:191]
    ds_read_b64_tr_b16 a[92:93], v23 offset:16384
    v_mfma_f32_16x16x32_bf16 v[204:207], a[36:39], a[140:143], v[204:207]
    ds_read_b64_tr_b16 a[94:95], v23 offset:18432
    v_mfma_f32_16x16x32_bf16 v[200:203], a[36:39], a[136:139], v[200:203]
    v_mfma_f32_16x16x32_bf16 v[196:199], a[36:39], a[132:135], v[196:199]
    ds_read_b64_tr_b16 a[96:97], v16 offset:16640
    v_mfma_f32_16x16x32_bf16 v[192:195], a[36:39], a[128:131], v[192:195]
    ds_read_b64_tr_b16 a[98:99], v16 offset:18688
    v_mfma_f32_16x16x32_bf16 v[208:211], a[40:43], a[128:131], v[208:211]
    ds_read_b64_tr_b16 a[100:101], v17 offset:16640
    v_mfma_f32_16x16x32_bf16 v[212:215], a[40:43], a[132:135], v[212:215]
    v_mfma_f32_16x16x32_bf16 v[216:219], a[40:43], a[136:139], v[216:219]
    ds_read_b64_tr_b16 a[102:103], v17 offset:18688
    v_mfma_f32_16x16x32_bf16 v[220:223], a[40:43], a[140:143], v[220:223]
    ds_read_b64_tr_b16 a[104:105], v18 offset:16640
    v_mfma_f32_16x16x32_bf16 v[236:239], a[44:47], a[140:143], v[236:239]
    ds_read_b64_tr_b16 a[106:107], v18 offset:18688
    v_mfma_f32_16x16x32_bf16 v[232:235], a[44:47], a[136:139], v[232:235]
    v_mfma_f32_16x16x32_bf16 v[228:231], a[44:47], a[132:135], v[228:231]
    ds_read_b64_tr_b16 a[108:109], v19 offset:16640
    v_mfma_f32_16x16x32_bf16 v[224:227], a[44:47], a[128:131], v[224:227]
    ds_read_b64_tr_b16 a[110:111], v19 offset:18688
    v_mfma_f32_16x16x32_bf16 v[240:243], a[48:51], a[128:131], v[240:243]
    v_mfma_f32_16x16x32_bf16 v[244:247], a[48:51], a[132:135], v[244:247]
    ds_read_b64_tr_b16 a[112:113], v20 offset:16640
    v_mfma_f32_16x16x32_bf16 v[248:251], a[48:51], a[136:139], v[248:251]
    ds_read_b64_tr_b16 a[114:115], v20 offset:18688
    v_mfma_f32_16x16x32_bf16 v[252:255], a[48:51], a[140:143], v[252:255]
    ds_read_b64_tr_b16 a[116:117], v21 offset:16640
    v_mfma_f32_16x16x32_bf16 a[220:223], a[52:55], a[140:143], a[220:223]
    v_mfma_f32_16x16x32_bf16 a[216:219], a[52:55], a[136:139], a[216:219]
    ds_read_b64_tr_b16 a[118:119], v21 offset:18688
    v_mfma_f32_16x16x32_bf16 a[212:215], a[52:55], a[132:135], a[212:215]
    ds_read_b64_tr_b16 a[120:121], v22 offset:16640
    v_mfma_f32_16x16x32_bf16 a[208:211], a[52:55], a[128:131], a[208:211]
    ds_read_b64_tr_b16 a[122:123], v22 offset:18688
    v_mfma_f32_16x16x32_bf16 a[224:227], a[56:59], a[128:131], a[224:227]
    v_mfma_f32_16x16x32_bf16 a[228:231], a[56:59], a[132:135], a[228:231]
    ds_read_b64_tr_b16 a[124:125], v23 offset:16640
    v_mfma_f32_16x16x32_bf16 a[232:235], a[56:59], a[136:139], a[232:235]
    ds_read_b64_tr_b16 a[126:127], v23 offset:18688
    v_mfma_f32_16x16x32_bf16 a[236:239], a[56:59], a[140:143], a[236:239]
    v_mfma_f32_16x16x32_bf16 a[252:255], a[60:63], a[140:143], a[252:255]
    v_mfma_f32_16x16x32_bf16 a[248:251], a[60:63], a[136:139], a[248:251]
    v_mfma_f32_16x16x32_bf16 a[244:247], a[60:63], a[132:135], a[244:247]
    v_mfma_f32_16x16x32_bf16 a[240:243], a[60:63], a[128:131], a[240:243]
    s_waitcnt vmcnt(16) lgkmcnt(0)
    s_barrier
    v_mfma_f32_16x16x32_bf16 v[48:51], a[64:67], a[144:147], v[48:51]
    ds_read_b64_tr_b16 a[0:1], v16 offset:32768
    v_mfma_f32_16x16x32_bf16 v[52:55], a[64:67], a[148:151], v[52:55]
    s_add_u32 m0, s31, 16384
    s_mov_b32 s44, 3407872
    v_mfma_f32_16x16x32_bf16 v[56:59], a[64:67], a[152:155], v[56:59]
    ds_read_b64_tr_b16 a[2:3], v16 offset:34816
    v_mfma_f32_16x16x32_bf16 v[60:63], a[64:67], a[156:159], v[60:63]
    ds_read_b64_tr_b16 a[4:5], v17 offset:32768
    v_mfma_f32_16x16x32_bf16 v[76:79], a[68:71], a[156:159], v[76:79]
    v_mfma_f32_16x16x32_bf16 v[72:75], a[68:71], a[152:155], v[72:75]
    buffer_load_dwordx4 v24, s[12:15], s44 offen offset:0 nt lds
    v_mfma_f32_16x16x32_bf16 v[68:71], a[68:71], a[148:151], v[68:71]
    ds_read_b64_tr_b16 a[6:7], v17 offset:34816
    v_mfma_f32_16x16x32_bf16 v[64:67], a[68:71], a[144:147], v[64:67]
    ds_read_b64_tr_b16 a[8:9], v18 offset:32768
    v_mfma_f32_16x16x32_bf16 v[80:83], a[72:75], a[144:147], v[80:83]
    v_mfma_f32_16x16x32_bf16 v[84:87], a[72:75], a[148:151], v[84:87]
    buffer_load_dwordx4 v25, s[12:15], s44 offen offset:1024 nt lds
    v_mfma_f32_16x16x32_bf16 v[88:91], a[72:75], a[152:155], v[88:91]
    ds_read_b64_tr_b16 a[10:11], v18 offset:34816
    v_mfma_f32_16x16x32_bf16 v[92:95], a[72:75], a[156:159], v[92:95]
    ds_read_b64_tr_b16 a[12:13], v19 offset:32768
    v_mfma_f32_16x16x32_bf16 v[108:111], a[76:79], a[156:159], v[108:111]
    v_mfma_f32_16x16x32_bf16 v[104:107], a[76:79], a[152:155], v[104:107]
    buffer_load_dwordx4 v26, s[12:15], s44 offen offset:2048 nt lds
    v_mfma_f32_16x16x32_bf16 v[100:103], a[76:79], a[148:151], v[100:103]
    ds_read_b64_tr_b16 a[14:15], v19 offset:34816
    v_mfma_f32_16x16x32_bf16 v[96:99], a[76:79], a[144:147], v[96:99]
    ds_read_b64_tr_b16 a[16:17], v20 offset:32768
    v_mfma_f32_16x16x32_bf16 v[112:115], a[80:83], a[144:147], v[112:115]
    ds_read_b64_tr_b16 a[18:19], v20 offset:34816
    v_mfma_f32_16x16x32_bf16 v[116:119], a[80:83], a[148:151], v[116:119]
    buffer_load_dwordx4 v27, s[12:15], s44 offen offset:3072 nt lds
    v_mfma_f32_16x16x32_bf16 v[120:123], a[80:83], a[152:155], v[120:123]
    v_mfma_f32_16x16x32_bf16 v[124:127], a[80:83], a[156:159], v[124:127]
    ds_read_b64_tr_b16 a[20:21], v21 offset:32768
    v_mfma_f32_16x16x32_bf16 v[140:143], a[84:87], a[156:159], v[140:143]
    ds_read_b64_tr_b16 a[22:23], v21 offset:34816
    v_mfma_f32_16x16x32_bf16 v[136:139], a[84:87], a[152:155], v[136:139]
    s_add_u32 m0, s34, 49152
    s_movk_i32 s44, 896
    v_mfma_f32_16x16x32_bf16 v[132:135], a[84:87], a[148:151], v[132:135]
    v_mfma_f32_16x16x32_bf16 v[128:131], a[84:87], a[144:147], v[128:131]
    ds_read_b64_tr_b16 a[24:25], v22 offset:32768
    v_mfma_f32_16x16x32_bf16 v[144:147], a[88:91], a[144:147], v[144:147]
    ds_read_b64_tr_b16 a[26:27], v22 offset:34816
    v_mfma_f32_16x16x32_bf16 v[148:151], a[88:91], a[148:151], v[148:151]
    buffer_load_dwordx4 v28, s[8:11], s44 offen offset:0 nt lds
    v_mfma_f32_16x16x32_bf16 v[152:155], a[88:91], a[152:155], v[152:155]
    v_mfma_f32_16x16x32_bf16 v[156:159], a[88:91], a[156:159], v[156:159]
    ds_read_b64_tr_b16 a[28:29], v23 offset:32768
    v_mfma_f32_16x16x32_bf16 v[172:175], a[92:95], a[156:159], v[172:175]
    ds_read_b64_tr_b16 a[30:31], v23 offset:34816
    v_mfma_f32_16x16x32_bf16 v[168:171], a[92:95], a[152:155], v[168:171]
    buffer_load_dwordx4 v29, s[8:11], s44 offen offset:1024 nt lds
    v_mfma_f32_16x16x32_bf16 v[164:167], a[92:95], a[148:151], v[164:167]
    v_mfma_f32_16x16x32_bf16 v[160:163], a[92:95], a[144:147], v[160:163]
    ds_read_b64_tr_b16 a[32:33], v16 offset:33024
    v_mfma_f32_16x16x32_bf16 v[176:179], a[96:99], a[144:147], v[176:179]
    ds_read_b64_tr_b16 a[34:35], v16 offset:35072
    v_mfma_f32_16x16x32_bf16 v[180:183], a[96:99], a[148:151], v[180:183]
    buffer_load_dwordx4 v30, s[8:11], s44 offen offset:2048 nt lds
    v_mfma_f32_16x16x32_bf16 v[184:187], a[96:99], a[152:155], v[184:187]
    ds_read_b64_tr_b16 a[36:37], v17 offset:33024
    v_mfma_f32_16x16x32_bf16 v[188:191], a[96:99], a[156:159], v[188:191]
    v_mfma_f32_16x16x32_bf16 v[204:207], a[100:103], a[156:159], v[204:207]
    ds_read_b64_tr_b16 a[38:39], v17 offset:35072
    v_mfma_f32_16x16x32_bf16 v[200:203], a[100:103], a[152:155], v[200:203]
    buffer_load_dwordx4 v31, s[8:11], s44 offen offset:3072 nt lds
    s_add_u32 m0, s34, 53248
    v_mfma_f32_16x16x32_bf16 v[196:199], a[100:103], a[148:151], v[196:199]
    ds_read_b64_tr_b16 a[40:41], v18 offset:33024
    v_mfma_f32_16x16x32_bf16 v[192:195], a[100:103], a[144:147], v[192:195]
    v_mfma_f32_16x16x32_bf16 v[208:211], a[104:107], a[144:147], v[208:211]
    ds_read_b64_tr_b16 a[42:43], v18 offset:35072
    v_mfma_f32_16x16x32_bf16 v[212:215], a[104:107], a[148:151], v[212:215]
    buffer_load_dwordx4 v32, s[8:11], s44 offen offset:0 nt lds
    v_mfma_f32_16x16x32_bf16 v[216:219], a[104:107], a[152:155], v[216:219]
    ds_read_b64_tr_b16 a[44:45], v19 offset:33024
    v_mfma_f32_16x16x32_bf16 v[220:223], a[104:107], a[156:159], v[220:223]
    v_mfma_f32_16x16x32_bf16 v[236:239], a[108:111], a[156:159], v[236:239]
    ds_read_b64_tr_b16 a[46:47], v19 offset:35072
    v_mfma_f32_16x16x32_bf16 v[232:235], a[108:111], a[152:155], v[232:235]
    buffer_load_dwordx4 v33, s[8:11], s44 offen offset:1024 nt lds
    v_mfma_f32_16x16x32_bf16 v[228:231], a[108:111], a[148:151], v[228:231]
    ds_read_b64_tr_b16 a[48:49], v20 offset:33024
    v_mfma_f32_16x16x32_bf16 v[224:227], a[108:111], a[144:147], v[224:227]
    ds_read_b64_tr_b16 a[50:51], v20 offset:35072
    v_mfma_f32_16x16x32_bf16 v[240:243], a[112:115], a[144:147], v[240:243]
    v_mfma_f32_16x16x32_bf16 v[244:247], a[112:115], a[148:151], v[244:247]
    buffer_load_dwordx4 v34, s[8:11], s44 offen offset:2048 nt lds
    v_mfma_f32_16x16x32_bf16 v[248:251], a[112:115], a[152:155], v[248:251]
    ds_read_b64_tr_b16 a[52:53], v21 offset:33024
    v_mfma_f32_16x16x32_bf16 v[252:255], a[112:115], a[156:159], v[252:255]
    ds_read_b64_tr_b16 a[54:55], v21 offset:35072
    v_mfma_f32_16x16x32_bf16 a[220:223], a[116:119], a[156:159], a[220:223]
    v_mfma_f32_16x16x32_bf16 a[216:219], a[116:119], a[152:155], a[216:219]
    buffer_load_dwordx4 v35, s[8:11], s44 offen offset:3072 nt lds
    v_mfma_f32_16x16x32_bf16 a[212:215], a[116:119], a[148:151], a[212:215]
    ds_read_b64_tr_b16 a[56:57], v22 offset:33024
    v_mfma_f32_16x16x32_bf16 a[208:211], a[116:119], a[144:147], a[208:211]
    ds_read_b64_tr_b16 a[58:59], v22 offset:35072
    v_mfma_f32_16x16x32_bf16 a[224:227], a[120:123], a[144:147], a[224:227]
    v_mfma_f32_16x16x32_bf16 a[228:231], a[120:123], a[148:151], a[228:231]
    ds_read_b64_tr_b16 a[60:61], v23 offset:33024
    v_mfma_f32_16x16x32_bf16 a[232:235], a[120:123], a[152:155], a[232:235]
    ds_read_b64_tr_b16 a[62:63], v23 offset:35072
    v_mfma_f32_16x16x32_bf16 a[236:239], a[120:123], a[156:159], a[236:239]
    v_mfma_f32_16x16x32_bf16 a[252:255], a[124:127], a[156:159], a[252:255]
    v_mfma_f32_16x16x32_bf16 a[248:251], a[124:127], a[152:155], a[248:251]
    v_mfma_f32_16x16x32_bf16 a[244:247], a[124:127], a[148:151], a[244:247]
    v_mfma_f32_16x16x32_bf16 a[240:243], a[124:127], a[144:147], a[240:243]
    s_waitcnt vmcnt(16) lgkmcnt(0)
    s_barrier
    v_mfma_f32_16x16x32_bf16 v[48:51], a[0:3], a[160:163], v[48:51]
    ds_read_b128 a[128:131], v36 offset:16384
    v_mfma_f32_16x16x32_bf16 v[52:55], a[0:3], a[164:167], v[52:55]
    s_add_u32 m0, s31, 32768
    s_mov_b32 s44, 3670016
    v_mfma_f32_16x16x32_bf16 v[56:59], a[0:3], a[168:171], v[56:59]
    ds_read_b128 a[132:135], v36 offset:18432
    v_mfma_f32_16x16x32_bf16 v[60:63], a[0:3], a[172:175], v[60:63]
    ds_read_b128 a[136:139], v36 offset:20480
    v_mfma_f32_16x16x32_bf16 v[76:79], a[4:7], a[172:175], v[76:79]
    v_mfma_f32_16x16x32_bf16 v[72:75], a[4:7], a[168:171], v[72:75]
    buffer_load_dwordx4 v24, s[12:15], s44 offen offset:0 nt lds
    v_mfma_f32_16x16x32_bf16 v[68:71], a[4:7], a[164:167], v[68:71]
    ds_read_b128 a[140:143], v36 offset:22528
    v_mfma_f32_16x16x32_bf16 v[64:67], a[4:7], a[160:163], v[64:67]
    ds_read_b128 a[144:147], v37 offset:16384
    v_mfma_f32_16x16x32_bf16 v[80:83], a[8:11], a[160:163], v[80:83]
    ds_read_b128 a[148:151], v37 offset:18432
    v_mfma_f32_16x16x32_bf16 v[84:87], a[8:11], a[164:167], v[84:87]
    buffer_load_dwordx4 v25, s[12:15], s44 offen offset:1024 nt lds
    v_mfma_f32_16x16x32_bf16 v[88:91], a[8:11], a[168:171], v[88:91]
    v_mfma_f32_16x16x32_bf16 v[92:95], a[8:11], a[172:175], v[92:95]
    ds_read_b128 a[152:155], v37 offset:20480
    v_mfma_f32_16x16x32_bf16 v[108:111], a[12:15], a[172:175], v[108:111]
    ds_read_b128 a[156:159], v37 offset:22528
    v_mfma_f32_16x16x32_bf16 v[104:107], a[12:15], a[168:171], v[104:107]
    buffer_load_dwordx4 v26, s[12:15], s44 offen offset:2048 nt lds
    v_mfma_f32_16x16x32_bf16 v[100:103], a[12:15], a[164:167], v[100:103]
    v_mfma_f32_16x16x32_bf16 v[96:99], a[12:15], a[160:163], v[96:99]
    ds_read_b64_tr_b16 a[64:65], v16 offset:49152
    v_mfma_f32_16x16x32_bf16 v[112:115], a[16:19], a[160:163], v[112:115]
    ds_read_b64_tr_b16 a[66:67], v16 offset:51200
    v_mfma_f32_16x16x32_bf16 v[116:119], a[16:19], a[164:167], v[116:119]
    buffer_load_dwordx4 v27, s[12:15], s44 offen offset:3072 nt lds
    v_mfma_f32_16x16x32_bf16 v[120:123], a[16:19], a[168:171], v[120:123]
    ds_read_b64_tr_b16 a[68:69], v17 offset:49152
    v_mfma_f32_16x16x32_bf16 v[124:127], a[16:19], a[172:175], v[124:127]
    v_mfma_f32_16x16x32_bf16 v[140:143], a[20:23], a[172:175], v[140:143]
    ds_read_b64_tr_b16 a[70:71], v17 offset:51200
    v_mfma_f32_16x16x32_bf16 v[136:139], a[20:23], a[168:171], v[136:139]
    ds_read_b64_tr_b16 a[72:73], v18 offset:49152
    v_mfma_f32_16x16x32_bf16 v[132:135], a[20:23], a[164:167], v[132:135]
    ds_read_b64_tr_b16 a[74:75], v18 offset:51200
    v_mfma_f32_16x16x32_bf16 v[128:131], a[20:23], a[160:163], v[128:131]
    v_mfma_f32_16x16x32_bf16 v[144:147], a[24:27], a[160:163], v[144:147]
    ds_read_b64_tr_b16 a[76:77], v19 offset:49152
    v_mfma_f32_16x16x32_bf16 v[148:151], a[24:27], a[164:167], v[148:151]
    ds_read_b64_tr_b16 a[78:79], v19 offset:51200
    v_mfma_f32_16x16x32_bf16 v[152:155], a[24:27], a[168:171], v[152:155]
    v_mfma_f32_16x16x32_bf16 v[156:159], a[24:27], a[172:175], v[156:159]
    ds_read_b64_tr_b16 a[80:81], v20 offset:49152
    v_mfma_f32_16x16x32_bf16 v[172:175], a[28:31], a[172:175], v[172:175]
    ds_read_b64_tr_b16 a[82:83], v20 offset:51200
    v_mfma_f32_16x16x32_bf16 v[168:171], a[28:31], a[168:171], v[168:171]
    ds_read_b64_tr_b16 a[84:85], v21 offset:49152
    v_mfma_f32_16x16x32_bf16 v[164:167], a[28:31], a[164:167], v[164:167]
    v_mfma_f32_16x16x32_bf16 v[160:163], a[28:31], a[160:163], v[160:163]
    ds_read_b64_tr_b16 a[86:87], v21 offset:51200
    v_mfma_f32_16x16x32_bf16 v[176:179], a[32:35], a[160:163], v[176:179]
    ds_read_b64_tr_b16 a[88:89], v22 offset:49152
    v_mfma_f32_16x16x32_bf16 v[180:183], a[32:35], a[164:167], v[180:183]
    ds_read_b64_tr_b16 a[90:91], v22 offset:51200
    v_mfma_f32_16x16x32_bf16 v[184:187], a[32:35], a[168:171], v[184:187]
    v_mfma_f32_16x16x32_bf16 v[188:191], a[32:35], a[172:175], v[188:191]
    ds_read_b64_tr_b16 a[92:93], v23 offset:49152
    v_mfma_f32_16x16x32_bf16 v[204:207], a[36:39], a[172:175], v[204:207]
    ds_read_b64_tr_b16 a[94:95], v23 offset:51200
    v_mfma_f32_16x16x32_bf16 v[200:203], a[36:39], a[168:171], v[200:203]
    v_mfma_f32_16x16x32_bf16 v[196:199], a[36:39], a[164:167], v[196:199]
    ds_read_b64_tr_b16 a[96:97], v16 offset:49408
    v_mfma_f32_16x16x32_bf16 v[192:195], a[36:39], a[160:163], v[192:195]
    ds_read_b64_tr_b16 a[98:99], v16 offset:51456
    v_mfma_f32_16x16x32_bf16 v[208:211], a[40:43], a[160:163], v[208:211]
    ds_read_b64_tr_b16 a[100:101], v17 offset:49408
    v_mfma_f32_16x16x32_bf16 v[212:215], a[40:43], a[164:167], v[212:215]
    v_mfma_f32_16x16x32_bf16 v[216:219], a[40:43], a[168:171], v[216:219]
    ds_read_b64_tr_b16 a[102:103], v17 offset:51456
    v_mfma_f32_16x16x32_bf16 v[220:223], a[40:43], a[172:175], v[220:223]
    ds_read_b64_tr_b16 a[104:105], v18 offset:49408
    v_mfma_f32_16x16x32_bf16 v[236:239], a[44:47], a[172:175], v[236:239]
    ds_read_b64_tr_b16 a[106:107], v18 offset:51456
    v_mfma_f32_16x16x32_bf16 v[232:235], a[44:47], a[168:171], v[232:235]
    v_mfma_f32_16x16x32_bf16 v[228:231], a[44:47], a[164:167], v[228:231]
    ds_read_b64_tr_b16 a[108:109], v19 offset:49408
    v_mfma_f32_16x16x32_bf16 v[224:227], a[44:47], a[160:163], v[224:227]
    ds_read_b64_tr_b16 a[110:111], v19 offset:51456
    v_mfma_f32_16x16x32_bf16 v[240:243], a[48:51], a[160:163], v[240:243]
    v_mfma_f32_16x16x32_bf16 v[244:247], a[48:51], a[164:167], v[244:247]
    ds_read_b64_tr_b16 a[112:113], v20 offset:49408
    v_mfma_f32_16x16x32_bf16 v[248:251], a[48:51], a[168:171], v[248:251]
    ds_read_b64_tr_b16 a[114:115], v20 offset:51456
    v_mfma_f32_16x16x32_bf16 v[252:255], a[48:51], a[172:175], v[252:255]
    ds_read_b64_tr_b16 a[116:117], v21 offset:49408
    v_mfma_f32_16x16x32_bf16 a[220:223], a[52:55], a[172:175], a[220:223]
    v_mfma_f32_16x16x32_bf16 a[216:219], a[52:55], a[168:171], a[216:219]
    ds_read_b64_tr_b16 a[118:119], v21 offset:51456
    v_mfma_f32_16x16x32_bf16 a[212:215], a[52:55], a[164:167], a[212:215]
    ds_read_b64_tr_b16 a[120:121], v22 offset:49408
    v_mfma_f32_16x16x32_bf16 a[208:211], a[52:55], a[160:163], a[208:211]
    ds_read_b64_tr_b16 a[122:123], v22 offset:51456
    v_mfma_f32_16x16x32_bf16 a[224:227], a[56:59], a[160:163], a[224:227]
    v_mfma_f32_16x16x32_bf16 a[228:231], a[56:59], a[164:167], a[228:231]
    ds_read_b64_tr_b16 a[124:125], v23 offset:49408
    v_mfma_f32_16x16x32_bf16 a[232:235], a[56:59], a[168:171], a[232:235]
    ds_read_b64_tr_b16 a[126:127], v23 offset:51456
    v_mfma_f32_16x16x32_bf16 a[236:239], a[56:59], a[172:175], a[236:239]
    v_mfma_f32_16x16x32_bf16 a[252:255], a[60:63], a[172:175], a[252:255]
    v_mfma_f32_16x16x32_bf16 a[248:251], a[60:63], a[168:171], a[248:251]
    v_mfma_f32_16x16x32_bf16 a[244:247], a[60:63], a[164:167], a[244:247]
    v_mfma_f32_16x16x32_bf16 a[240:243], a[60:63], a[160:163], a[240:243]
    s_waitcnt vmcnt(16) lgkmcnt(0)
    s_barrier
    v_mfma_f32_16x16x32_bf16 v[48:51], a[64:67], a[176:179], v[48:51]
    ds_read_b64_tr_b16 a[0:1], v16 offset:0
    v_mfma_f32_16x16x32_bf16 v[52:55], a[64:67], a[180:183], v[52:55]
    s_add_u32 m0, s31, 49152
    s_mov_b32 s44, 3932160
    v_mfma_f32_16x16x32_bf16 v[56:59], a[64:67], a[184:187], v[56:59]
    ds_read_b64_tr_b16 a[2:3], v16 offset:2048
    v_mfma_f32_16x16x32_bf16 v[60:63], a[64:67], a[188:191], v[60:63]
    ds_read_b64_tr_b16 a[4:5], v17 offset:0
    v_mfma_f32_16x16x32_bf16 v[76:79], a[68:71], a[188:191], v[76:79]
    v_mfma_f32_16x16x32_bf16 v[72:75], a[68:71], a[184:187], v[72:75]
    buffer_load_dwordx4 v24, s[12:15], s44 offen offset:0 nt lds
    v_mfma_f32_16x16x32_bf16 v[68:71], a[68:71], a[180:183], v[68:71]
    ds_read_b64_tr_b16 a[6:7], v17 offset:2048
    v_mfma_f32_16x16x32_bf16 v[64:67], a[68:71], a[176:179], v[64:67]
    ds_read_b64_tr_b16 a[8:9], v18 offset:0
    v_mfma_f32_16x16x32_bf16 v[80:83], a[72:75], a[176:179], v[80:83]
    v_mfma_f32_16x16x32_bf16 v[84:87], a[72:75], a[180:183], v[84:87]
    buffer_load_dwordx4 v25, s[12:15], s44 offen offset:1024 nt lds
    v_mfma_f32_16x16x32_bf16 v[88:91], a[72:75], a[184:187], v[88:91]
    ds_read_b64_tr_b16 a[10:11], v18 offset:2048
    v_mfma_f32_16x16x32_bf16 v[92:95], a[72:75], a[188:191], v[92:95]
    ds_read_b64_tr_b16 a[12:13], v19 offset:0
    v_mfma_f32_16x16x32_bf16 v[108:111], a[76:79], a[188:191], v[108:111]
    v_mfma_f32_16x16x32_bf16 v[104:107], a[76:79], a[184:187], v[104:107]
    buffer_load_dwordx4 v26, s[12:15], s44 offen offset:2048 nt lds
    v_mfma_f32_16x16x32_bf16 v[100:103], a[76:79], a[180:183], v[100:103]
    ds_read_b64_tr_b16 a[14:15], v19 offset:2048
    v_mfma_f32_16x16x32_bf16 v[96:99], a[76:79], a[176:179], v[96:99]
    ds_read_b64_tr_b16 a[16:17], v20 offset:0
    v_mfma_f32_16x16x32_bf16 v[112:115], a[80:83], a[176:179], v[112:115]
    ds_read_b64_tr_b16 a[18:19], v20 offset:2048
    v_mfma_f32_16x16x32_bf16 v[116:119], a[80:83], a[180:183], v[116:119]
    buffer_load_dwordx4 v27, s[12:15], s44 offen offset:3072 nt lds
    v_mfma_f32_16x16x32_bf16 v[120:123], a[80:83], a[184:187], v[120:123]
    v_mfma_f32_16x16x32_bf16 v[124:127], a[80:83], a[188:191], v[124:127]
    ds_read_b64_tr_b16 a[20:21], v21 offset:0
    v_mfma_f32_16x16x32_bf16 v[140:143], a[84:87], a[188:191], v[140:143]
    ds_read_b64_tr_b16 a[22:23], v21 offset:2048
    v_mfma_f32_16x16x32_bf16 v[136:139], a[84:87], a[184:187], v[136:139]
    s_add_u32 m0, s34, 16384
    s_movk_i32 s44, 1024
    v_mfma_f32_16x16x32_bf16 v[132:135], a[84:87], a[180:183], v[132:135]
    v_mfma_f32_16x16x32_bf16 v[128:131], a[84:87], a[176:179], v[128:131]
    ds_read_b64_tr_b16 a[24:25], v22 offset:0
    v_mfma_f32_16x16x32_bf16 v[144:147], a[88:91], a[176:179], v[144:147]
    ds_read_b64_tr_b16 a[26:27], v22 offset:2048
    v_mfma_f32_16x16x32_bf16 v[148:151], a[88:91], a[180:183], v[148:151]
    buffer_load_dwordx4 v28, s[8:11], s44 offen offset:0 nt lds
    v_mfma_f32_16x16x32_bf16 v[152:155], a[88:91], a[184:187], v[152:155]
    v_mfma_f32_16x16x32_bf16 v[156:159], a[88:91], a[188:191], v[156:159]
    ds_read_b64_tr_b16 a[28:29], v23 offset:0
    v_mfma_f32_16x16x32_bf16 v[172:175], a[92:95], a[188:191], v[172:175]
    ds_read_b64_tr_b16 a[30:31], v23 offset:2048
    v_mfma_f32_16x16x32_bf16 v[168:171], a[92:95], a[184:187], v[168:171]
    buffer_load_dwordx4 v29, s[8:11], s44 offen offset:1024 nt lds
    v_mfma_f32_16x16x32_bf16 v[164:167], a[92:95], a[180:183], v[164:167]
    v_mfma_f32_16x16x32_bf16 v[160:163], a[92:95], a[176:179], v[160:163]
    ds_read_b64_tr_b16 a[32:33], v16 offset:256
    v_mfma_f32_16x16x32_bf16 v[176:179], a[96:99], a[176:179], v[176:179]
    ds_read_b64_tr_b16 a[34:35], v16 offset:2304
    v_mfma_f32_16x16x32_bf16 v[180:183], a[96:99], a[180:183], v[180:183]
    buffer_load_dwordx4 v30, s[8:11], s44 offen offset:2048 nt lds
    v_mfma_f32_16x16x32_bf16 v[184:187], a[96:99], a[184:187], v[184:187]
    ds_read_b64_tr_b16 a[36:37], v17 offset:256
    v_mfma_f32_16x16x32_bf16 v[188:191], a[96:99], a[188:191], v[188:191]
    v_mfma_f32_16x16x32_bf16 v[204:207], a[100:103], a[188:191], v[204:207]
    ds_read_b64_tr_b16 a[38:39], v17 offset:2304
    v_mfma_f32_16x16x32_bf16 v[200:203], a[100:103], a[184:187], v[200:203]
    buffer_load_dwordx4 v31, s[8:11], s44 offen offset:3072 nt lds
    s_add_u32 m0, s34, 20480
    v_mfma_f32_16x16x32_bf16 v[196:199], a[100:103], a[180:183], v[196:199]
    ds_read_b64_tr_b16 a[40:41], v18 offset:256
    v_mfma_f32_16x16x32_bf16 v[192:195], a[100:103], a[176:179], v[192:195]
    v_mfma_f32_16x16x32_bf16 v[208:211], a[104:107], a[176:179], v[208:211]
    ds_read_b64_tr_b16 a[42:43], v18 offset:2304
    v_mfma_f32_16x16x32_bf16 v[212:215], a[104:107], a[180:183], v[212:215]
    buffer_load_dwordx4 v32, s[8:11], s44 offen offset:0 nt lds
    v_mfma_f32_16x16x32_bf16 v[216:219], a[104:107], a[184:187], v[216:219]
    ds_read_b64_tr_b16 a[44:45], v19 offset:256
    v_mfma_f32_16x16x32_bf16 v[220:223], a[104:107], a[188:191], v[220:223]
    v_mfma_f32_16x16x32_bf16 v[236:239], a[108:111], a[188:191], v[236:239]
    ds_read_b64_tr_b16 a[46:47], v19 offset:2304
    v_mfma_f32_16x16x32_bf16 v[232:235], a[108:111], a[184:187], v[232:235]
    buffer_load_dwordx4 v33, s[8:11], s44 offen offset:1024 nt lds
    v_mfma_f32_16x16x32_bf16 v[228:231], a[108:111], a[180:183], v[228:231]
    ds_read_b64_tr_b16 a[48:49], v20 offset:256
    v_mfma_f32_16x16x32_bf16 v[224:227], a[108:111], a[176:179], v[224:227]
    ds_read_b64_tr_b16 a[50:51], v20 offset:2304
    v_mfma_f32_16x16x32_bf16 v[240:243], a[112:115], a[176:179], v[240:243]
    v_mfma_f32_16x16x32_bf16 v[244:247], a[112:115], a[180:183], v[244:247]
    buffer_load_dwordx4 v34, s[8:11], s44 offen offset:2048 nt lds
    v_mfma_f32_16x16x32_bf16 v[248:251], a[112:115], a[184:187], v[248:251]
    ds_read_b64_tr_b16 a[52:53], v21 offset:256
    v_mfma_f32_16x16x32_bf16 v[252:255], a[112:115], a[188:191], v[252:255]
    ds_read_b64_tr_b16 a[54:55], v21 offset:2304
    v_mfma_f32_16x16x32_bf16 a[220:223], a[116:119], a[188:191], a[220:223]
    v_mfma_f32_16x16x32_bf16 a[216:219], a[116:119], a[184:187], a[216:219]
    buffer_load_dwordx4 v35, s[8:11], s44 offen offset:3072 nt lds
    v_mfma_f32_16x16x32_bf16 a[212:215], a[116:119], a[180:183], a[212:215]
    ds_read_b64_tr_b16 a[56:57], v22 offset:256
    v_mfma_f32_16x16x32_bf16 a[208:211], a[116:119], a[176:179], a[208:211]
    ds_read_b64_tr_b16 a[58:59], v22 offset:2304
    v_mfma_f32_16x16x32_bf16 a[224:227], a[120:123], a[176:179], a[224:227]
    v_mfma_f32_16x16x32_bf16 a[228:231], a[120:123], a[180:183], a[228:231]
    ds_read_b64_tr_b16 a[60:61], v23 offset:256
    v_mfma_f32_16x16x32_bf16 a[232:235], a[120:123], a[184:187], a[232:235]
    ds_read_b64_tr_b16 a[62:63], v23 offset:2304
    v_mfma_f32_16x16x32_bf16 a[236:239], a[120:123], a[188:191], a[236:239]
    v_mfma_f32_16x16x32_bf16 a[252:255], a[124:127], a[188:191], a[252:255]
    v_mfma_f32_16x16x32_bf16 a[248:251], a[124:127], a[184:187], a[248:251]
    v_mfma_f32_16x16x32_bf16 a[244:247], a[124:127], a[180:183], a[244:247]
    v_mfma_f32_16x16x32_bf16 a[240:243], a[124:127], a[176:179], a[240:243]
    s_waitcnt vmcnt(16) lgkmcnt(0)
    s_barrier
    v_mfma_f32_16x16x32_bf16 v[48:51], a[0:3], a[128:131], v[48:51]
    ds_read_b128 a[160:163], v36 offset:49152
    v_mfma_f32_16x16x32_bf16 v[52:55], a[0:3], a[132:135], v[52:55]
    s_add_u32 m0, s31, 0
    s_mov_b32 s44, 4194304
    v_mfma_f32_16x16x32_bf16 v[56:59], a[0:3], a[136:139], v[56:59]
    ds_read_b128 a[164:167], v36 offset:51200
    v_mfma_f32_16x16x32_bf16 v[60:63], a[0:3], a[140:143], v[60:63]
    ds_read_b128 a[168:171], v36 offset:53248
    v_mfma_f32_16x16x32_bf16 v[76:79], a[4:7], a[140:143], v[76:79]
    v_mfma_f32_16x16x32_bf16 v[72:75], a[4:7], a[136:139], v[72:75]
    buffer_load_dwordx4 v24, s[12:15], s44 offen offset:0 nt lds
    v_mfma_f32_16x16x32_bf16 v[68:71], a[4:7], a[132:135], v[68:71]
    ds_read_b128 a[172:175], v36 offset:55296
    v_mfma_f32_16x16x32_bf16 v[64:67], a[4:7], a[128:131], v[64:67]
    ds_read_b128 a[176:179], v37 offset:49152
    v_mfma_f32_16x16x32_bf16 v[80:83], a[8:11], a[128:131], v[80:83]
    ds_read_b128 a[180:183], v37 offset:51200
    v_mfma_f32_16x16x32_bf16 v[84:87], a[8:11], a[132:135], v[84:87]
    buffer_load_dwordx4 v25, s[12:15], s44 offen offset:1024 nt lds
    v_mfma_f32_16x16x32_bf16 v[88:91], a[8:11], a[136:139], v[88:91]
    v_mfma_f32_16x16x32_bf16 v[92:95], a[8:11], a[140:143], v[92:95]
    ds_read_b128 a[184:187], v37 offset:53248
    v_mfma_f32_16x16x32_bf16 v[108:111], a[12:15], a[140:143], v[108:111]
    ds_read_b128 a[188:191], v37 offset:55296
    v_mfma_f32_16x16x32_bf16 v[104:107], a[12:15], a[136:139], v[104:107]
    buffer_load_dwordx4 v26, s[12:15], s44 offen offset:2048 nt lds
    v_mfma_f32_16x16x32_bf16 v[100:103], a[12:15], a[132:135], v[100:103]
    v_mfma_f32_16x16x32_bf16 v[96:99], a[12:15], a[128:131], v[96:99]
    ds_read_b64_tr_b16 a[64:65], v16 offset:16384
    v_mfma_f32_16x16x32_bf16 v[112:115], a[16:19], a[128:131], v[112:115]
    ds_read_b64_tr_b16 a[66:67], v16 offset:18432
    v_mfma_f32_16x16x32_bf16 v[116:119], a[16:19], a[132:135], v[116:119]
    buffer_load_dwordx4 v27, s[12:15], s44 offen offset:3072 nt lds
    v_mfma_f32_16x16x32_bf16 v[120:123], a[16:19], a[136:139], v[120:123]
    ds_read_b64_tr_b16 a[68:69], v17 offset:16384
    v_mfma_f32_16x16x32_bf16 v[124:127], a[16:19], a[140:143], v[124:127]
    v_mfma_f32_16x16x32_bf16 v[140:143], a[20:23], a[140:143], v[140:143]
    ds_read_b64_tr_b16 a[70:71], v17 offset:18432
    v_mfma_f32_16x16x32_bf16 v[136:139], a[20:23], a[136:139], v[136:139]
    ds_read_b64_tr_b16 a[72:73], v18 offset:16384
    v_mfma_f32_16x16x32_bf16 v[132:135], a[20:23], a[132:135], v[132:135]
    ds_read_b64_tr_b16 a[74:75], v18 offset:18432
    v_mfma_f32_16x16x32_bf16 v[128:131], a[20:23], a[128:131], v[128:131]
    v_mfma_f32_16x16x32_bf16 v[144:147], a[24:27], a[128:131], v[144:147]
    ds_read_b64_tr_b16 a[76:77], v19 offset:16384
    v_mfma_f32_16x16x32_bf16 v[148:151], a[24:27], a[132:135], v[148:151]
    ds_read_b64_tr_b16 a[78:79], v19 offset:18432
    v_mfma_f32_16x16x32_bf16 v[152:155], a[24:27], a[136:139], v[152:155]
    v_mfma_f32_16x16x32_bf16 v[156:159], a[24:27], a[140:143], v[156:159]
    ds_read_b64_tr_b16 a[80:81], v20 offset:16384
    v_mfma_f32_16x16x32_bf16 v[172:175], a[28:31], a[140:143], v[172:175]
    ds_read_b64_tr_b16 a[82:83], v20 offset:18432
    v_mfma_f32_16x16x32_bf16 v[168:171], a[28:31], a[136:139], v[168:171]
    ds_read_b64_tr_b16 a[84:85], v21 offset:16384
    v_mfma_f32_16x16x32_bf16 v[164:167], a[28:31], a[132:135], v[164:167]
    v_mfma_f32_16x16x32_bf16 v[160:163], a[28:31], a[128:131], v[160:163]
    ds_read_b64_tr_b16 a[86:87], v21 offset:18432
    v_mfma_f32_16x16x32_bf16 v[176:179], a[32:35], a[128:131], v[176:179]
    ds_read_b64_tr_b16 a[88:89], v22 offset:16384
    v_mfma_f32_16x16x32_bf16 v[180:183], a[32:35], a[132:135], v[180:183]
    ds_read_b64_tr_b16 a[90:91], v22 offset:18432
    v_mfma_f32_16x16x32_bf16 v[184:187], a[32:35], a[136:139], v[184:187]
    v_mfma_f32_16x16x32_bf16 v[188:191], a[32:35], a[140:143], v[188:191]
    ds_read_b64_tr_b16 a[92:93], v23 offset:16384
    v_mfma_f32_16x16x32_bf16 v[204:207], a[36:39], a[140:143], v[204:207]
    ds_read_b64_tr_b16 a[94:95], v23 offset:18432
    v_mfma_f32_16x16x32_bf16 v[200:203], a[36:39], a[136:139], v[200:203]
    v_mfma_f32_16x16x32_bf16 v[196:199], a[36:39], a[132:135], v[196:199]
    ds_read_b64_tr_b16 a[96:97], v16 offset:16640
    v_mfma_f32_16x16x32_bf16 v[192:195], a[36:39], a[128:131], v[192:195]
    ds_read_b64_tr_b16 a[98:99], v16 offset:18688
    v_mfma_f32_16x16x32_bf16 v[208:211], a[40:43], a[128:131], v[208:211]
    ds_read_b64_tr_b16 a[100:101], v17 offset:16640
    v_mfma_f32_16x16x32_bf16 v[212:215], a[40:43], a[132:135], v[212:215]
    v_mfma_f32_16x16x32_bf16 v[216:219], a[40:43], a[136:139], v[216:219]
    ds_read_b64_tr_b16 a[102:103], v17 offset:18688
    v_mfma_f32_16x16x32_bf16 v[220:223], a[40:43], a[140:143], v[220:223]
    ds_read_b64_tr_b16 a[104:105], v18 offset:16640
    v_mfma_f32_16x16x32_bf16 v[236:239], a[44:47], a[140:143], v[236:239]
    ds_read_b64_tr_b16 a[106:107], v18 offset:18688
    v_mfma_f32_16x16x32_bf16 v[232:235], a[44:47], a[136:139], v[232:235]
    v_mfma_f32_16x16x32_bf16 v[228:231], a[44:47], a[132:135], v[228:231]
    ds_read_b64_tr_b16 a[108:109], v19 offset:16640
    v_mfma_f32_16x16x32_bf16 v[224:227], a[44:47], a[128:131], v[224:227]
    ds_read_b64_tr_b16 a[110:111], v19 offset:18688
    v_mfma_f32_16x16x32_bf16 v[240:243], a[48:51], a[128:131], v[240:243]
    v_mfma_f32_16x16x32_bf16 v[244:247], a[48:51], a[132:135], v[244:247]
    ds_read_b64_tr_b16 a[112:113], v20 offset:16640
    v_mfma_f32_16x16x32_bf16 v[248:251], a[48:51], a[136:139], v[248:251]
    ds_read_b64_tr_b16 a[114:115], v20 offset:18688
    v_mfma_f32_16x16x32_bf16 v[252:255], a[48:51], a[140:143], v[252:255]
    ds_read_b64_tr_b16 a[116:117], v21 offset:16640
    v_mfma_f32_16x16x32_bf16 a[220:223], a[52:55], a[140:143], a[220:223]
    v_mfma_f32_16x16x32_bf16 a[216:219], a[52:55], a[136:139], a[216:219]
    ds_read_b64_tr_b16 a[118:119], v21 offset:18688
    v_mfma_f32_16x16x32_bf16 a[212:215], a[52:55], a[132:135], a[212:215]
    ds_read_b64_tr_b16 a[120:121], v22 offset:16640
    v_mfma_f32_16x16x32_bf16 a[208:211], a[52:55], a[128:131], a[208:211]
    ds_read_b64_tr_b16 a[122:123], v22 offset:18688
    v_mfma_f32_16x16x32_bf16 a[224:227], a[56:59], a[128:131], a[224:227]
    v_mfma_f32_16x16x32_bf16 a[228:231], a[56:59], a[132:135], a[228:231]
    ds_read_b64_tr_b16 a[124:125], v23 offset:16640
    v_mfma_f32_16x16x32_bf16 a[232:235], a[56:59], a[136:139], a[232:235]
    ds_read_b64_tr_b16 a[126:127], v23 offset:18688
    v_mfma_f32_16x16x32_bf16 a[236:239], a[56:59], a[140:143], a[236:239]
    v_mfma_f32_16x16x32_bf16 a[252:255], a[60:63], a[140:143], a[252:255]
    v_mfma_f32_16x16x32_bf16 a[248:251], a[60:63], a[136:139], a[248:251]
    v_mfma_f32_16x16x32_bf16 a[244:247], a[60:63], a[132:135], a[244:247]
    v_mfma_f32_16x16x32_bf16 a[240:243], a[60:63], a[128:131], a[240:243]
    s_waitcnt vmcnt(16) lgkmcnt(0)
    s_barrier
    v_mfma_f32_16x16x32_bf16 v[48:51], a[64:67], a[144:147], v[48:51]
    ds_read_b64_tr_b16 a[0:1], v16 offset:32768
    v_mfma_f32_16x16x32_bf16 v[52:55], a[64:67], a[148:151], v[52:55]
    s_add_u32 m0, s31, 16384
    s_mov_b32 s44, 4456448
    v_mfma_f32_16x16x32_bf16 v[56:59], a[64:67], a[152:155], v[56:59]
    ds_read_b64_tr_b16 a[2:3], v16 offset:34816
    v_mfma_f32_16x16x32_bf16 v[60:63], a[64:67], a[156:159], v[60:63]
    buffer_load_dwordx4 v24, s[12:15], s44 offen offset:0 nt lds
    v_mfma_f32_16x16x32_bf16 v[76:79], a[68:71], a[156:159], v[76:79]
    ds_read_b64_tr_b16 a[4:5], v17 offset:32768
    v_mfma_f32_16x16x32_bf16 v[72:75], a[68:71], a[152:155], v[72:75]
    buffer_load_dwordx4 v25, s[12:15], s44 offen offset:1024 nt lds
    v_mfma_f32_16x16x32_bf16 v[68:71], a[68:71], a[148:151], v[68:71]
    ds_read_b64_tr_b16 a[6:7], v17 offset:34816
    v_mfma_f32_16x16x32_bf16 v[64:67], a[68:71], a[144:147], v[64:67]
    buffer_load_dwordx4 v26, s[12:15], s44 offen offset:2048 nt lds
    v_mfma_f32_16x16x32_bf16 v[80:83], a[72:75], a[144:147], v[80:83]
    v_mfma_f32_16x16x32_bf16 v[84:87], a[72:75], a[148:151], v[84:87]
    buffer_load_dwordx4 v27, s[12:15], s44 offen offset:3072 nt lds
    v_mfma_f32_16x16x32_bf16 v[88:91], a[72:75], a[152:155], v[88:91]
    ds_read_b64_tr_b16 a[8:9], v18 offset:32768
    v_mfma_f32_16x16x32_bf16 v[92:95], a[72:75], a[156:159], v[92:95]
    s_add_u32 m0, s34, 49152
    s_movk_i32 s44, 1152
    v_mfma_f32_16x16x32_bf16 v[108:111], a[76:79], a[156:159], v[108:111]
    ds_read_b64_tr_b16 a[10:11], v18 offset:34816
    v_mfma_f32_16x16x32_bf16 v[104:107], a[76:79], a[152:155], v[104:107]
    buffer_load_dwordx4 v28, s[8:11], s44 offen offset:0 nt lds
    v_mfma_f32_16x16x32_bf16 v[100:103], a[76:79], a[148:151], v[100:103]
    ds_read_b64_tr_b16 a[12:13], v19 offset:32768
    v_mfma_f32_16x16x32_bf16 v[96:99], a[76:79], a[144:147], v[96:99]
    buffer_load_dwordx4 v29, s[8:11], s44 offen offset:1024 nt lds
    v_mfma_f32_16x16x32_bf16 v[112:115], a[80:83], a[144:147], v[112:115]
    ds_read_b64_tr_b16 a[14:15], v19 offset:34816
    v_mfma_f32_16x16x32_bf16 v[116:119], a[80:83], a[148:151], v[116:119]
    buffer_load_dwordx4 v30, s[8:11], s44 offen offset:2048 nt lds
    v_mfma_f32_16x16x32_bf16 v[120:123], a[80:83], a[152:155], v[120:123]
    v_mfma_f32_16x16x32_bf16 v[124:127], a[80:83], a[156:159], v[124:127]
    buffer_load_dwordx4 v31, s[8:11], s44 offen offset:3072 nt lds
    s_add_u32 m0, s34, 53248
    v_mfma_f32_16x16x32_bf16 v[140:143], a[84:87], a[156:159], v[140:143]
    ds_read_b64_tr_b16 a[16:17], v20 offset:32768
    v_mfma_f32_16x16x32_bf16 v[136:139], a[84:87], a[152:155], v[136:139]
    buffer_load_dwordx4 v32, s[8:11], s44 offen offset:0 nt lds
    v_mfma_f32_16x16x32_bf16 v[132:135], a[84:87], a[148:151], v[132:135]
    ds_read_b64_tr_b16 a[18:19], v20 offset:34816
    v_mfma_f32_16x16x32_bf16 v[128:131], a[84:87], a[144:147], v[128:131]
    buffer_load_dwordx4 v33, s[8:11], s44 offen offset:1024 nt lds
    v_mfma_f32_16x16x32_bf16 v[144:147], a[88:91], a[144:147], v[144:147]
    ds_read_b64_tr_b16 a[20:21], v21 offset:32768
    v_mfma_f32_16x16x32_bf16 v[148:151], a[88:91], a[148:151], v[148:151]
    buffer_load_dwordx4 v34, s[8:11], s44 offen offset:2048 nt lds
    v_mfma_f32_16x16x32_bf16 v[152:155], a[88:91], a[152:155], v[152:155]
    v_mfma_f32_16x16x32_bf16 v[156:159], a[88:91], a[156:159], v[156:159]
    buffer_load_dwordx4 v35, s[8:11], s44 offen offset:3072 nt lds
    v_mfma_f32_16x16x32_bf16 v[172:175], a[92:95], a[156:159], v[172:175]
    ds_read_b64_tr_b16 a[22:23], v21 offset:34816
    v_mfma_f32_16x16x32_bf16 v[168:171], a[92:95], a[152:155], v[168:171]
    s_add_u32 m0, s29, 0
    v_mfma_f32_16x16x32_bf16 v[164:167], a[92:95], a[148:151], v[164:167]
    ds_read_b64_tr_b16 a[24:25], v22 offset:32768
    v_mfma_f32_16x16x32_bf16 v[160:163], a[92:95], a[144:147], v[160:163]
    buffer_load_dwordx4 v13, s[16:19], s32 offen offset:0 nt lds
    v_mfma_f32_16x16x32_bf16 v[176:179], a[96:99], a[144:147], v[176:179]
    ds_read_b64_tr_b16 a[26:27], v22 offset:34816
    v_mfma_f32_16x16x32_bf16 v[180:183], a[96:99], a[148:151], v[180:183]
    buffer_load_dwordx4 v13, s[16:19], s32 offen offset:1024 nt lds
    v_mfma_f32_16x16x32_bf16 v[184:187], a[96:99], a[152:155], v[184:187]
    ds_read_b64_tr_b16 a[28:29], v23 offset:32768
    v_mfma_f32_16x16x32_bf16 v[188:191], a[96:99], a[156:159], v[188:191]
    buffer_load_dwordx4 v13, s[16:19], s32 offen offset:2048 nt lds
    v_mfma_f32_16x16x32_bf16 v[204:207], a[100:103], a[156:159], v[204:207]
    v_mfma_f32_16x16x32_bf16 v[200:203], a[100:103], a[152:155], v[200:203]
    buffer_load_dwordx4 v13, s[16:19], s32 offen offset:3072 nt lds
    s_add_u32 s32, s32, 0x4000
    v_mfma_f32_16x16x32_bf16 v[196:199], a[100:103], a[148:151], v[196:199]
    ds_read_b64_tr_b16 a[30:31], v23 offset:34816
    v_mfma_f32_16x16x32_bf16 v[192:195], a[100:103], a[144:147], v[192:195]
    ds_read_b64_tr_b16 a[32:33], v16 offset:33024
    v_mfma_f32_16x16x32_bf16 v[208:211], a[104:107], a[144:147], v[208:211]
    ds_read_b64_tr_b16 a[34:35], v16 offset:35072
    v_mfma_f32_16x16x32_bf16 v[212:215], a[104:107], a[148:151], v[212:215]
    v_mfma_f32_16x16x32_bf16 v[216:219], a[104:107], a[152:155], v[216:219]
    ds_read_b64_tr_b16 a[36:37], v17 offset:33024
    v_mfma_f32_16x16x32_bf16 v[220:223], a[104:107], a[156:159], v[220:223]
    ds_read_b64_tr_b16 a[38:39], v17 offset:35072
    v_mfma_f32_16x16x32_bf16 v[236:239], a[108:111], a[156:159], v[236:239]
    ds_read_b64_tr_b16 a[40:41], v18 offset:33024
    v_mfma_f32_16x16x32_bf16 v[232:235], a[108:111], a[152:155], v[232:235]
    ds_read_b64_tr_b16 a[42:43], v18 offset:35072
    v_mfma_f32_16x16x32_bf16 v[228:231], a[108:111], a[148:151], v[228:231]
    v_mfma_f32_16x16x32_bf16 v[224:227], a[108:111], a[144:147], v[224:227]
    ds_read_b64_tr_b16 a[44:45], v19 offset:33024
    v_mfma_f32_16x16x32_bf16 v[240:243], a[112:115], a[144:147], v[240:243]
    ds_read_b64_tr_b16 a[46:47], v19 offset:35072
    v_mfma_f32_16x16x32_bf16 v[244:247], a[112:115], a[148:151], v[244:247]
    ds_read_b64_tr_b16 a[48:49], v20 offset:33024
    v_mfma_f32_16x16x32_bf16 v[248:251], a[112:115], a[152:155], v[248:251]
    v_mfma_f32_16x16x32_bf16 v[252:255], a[112:115], a[156:159], v[252:255]
    ds_read_b64_tr_b16 a[50:51], v20 offset:35072
    v_mfma_f32_16x16x32_bf16 a[220:223], a[116:119], a[156:159], a[220:223]
    ds_read_b64_tr_b16 a[52:53], v21 offset:33024
    v_mfma_f32_16x16x32_bf16 a[216:219], a[116:119], a[152:155], a[216:219]
    ds_read_b64_tr_b16 a[54:55], v21 offset:35072
    v_mfma_f32_16x16x32_bf16 a[212:215], a[116:119], a[148:151], a[212:215]
    ds_read_b64_tr_b16 a[56:57], v22 offset:33024
    v_mfma_f32_16x16x32_bf16 a[208:211], a[116:119], a[144:147], a[208:211]
    v_mfma_f32_16x16x32_bf16 a[224:227], a[120:123], a[144:147], a[224:227]
    ds_read_b64_tr_b16 a[58:59], v22 offset:35072
    v_mfma_f32_16x16x32_bf16 a[228:231], a[120:123], a[148:151], a[228:231]
    ds_read_b64_tr_b16 a[60:61], v23 offset:33024
    v_mfma_f32_16x16x32_bf16 a[232:235], a[120:123], a[152:155], a[232:235]
    ds_read_b64_tr_b16 a[62:63], v23 offset:35072
    v_mfma_f32_16x16x32_bf16 a[236:239], a[120:123], a[156:159], a[236:239]
    v_mfma_f32_16x16x32_bf16 a[252:255], a[124:127], a[156:159], a[252:255]
    v_mfma_f32_16x16x32_bf16 a[248:251], a[124:127], a[152:155], a[248:251]
    v_mfma_f32_16x16x32_bf16 a[244:247], a[124:127], a[148:151], a[244:247]
    v_mfma_f32_16x16x32_bf16 a[240:243], a[124:127], a[144:147], a[240:243]
    s_waitcnt vmcnt(20) lgkmcnt(0)
    s_barrier
    v_mfma_f32_16x16x32_bf16 v[48:51], a[0:3], a[160:163], v[48:51]
    ds_read_b128 a[128:131], v36 offset:16384
    v_mfma_f32_16x16x32_bf16 v[52:55], a[0:3], a[164:167], v[52:55]
    s_add_u32 m0, s31, 32768
    s_mov_b32 s44, 4718592
    v_mfma_f32_16x16x32_bf16 v[56:59], a[0:3], a[168:171], v[56:59]
    ds_read_b128 a[132:135], v36 offset:18432
    v_mfma_f32_16x16x32_bf16 v[60:63], a[0:3], a[172:175], v[60:63]
    ds_read_b128 a[136:139], v36 offset:20480
    v_mfma_f32_16x16x32_bf16 v[76:79], a[4:7], a[172:175], v[76:79]
    ds_read_b128 a[140:143], v36 offset:22528
    v_mfma_f32_16x16x32_bf16 v[72:75], a[4:7], a[168:171], v[72:75]
    buffer_load_dwordx4 v24, s[12:15], s44 offen offset:0 nt lds
    v_mfma_f32_16x16x32_bf16 v[68:71], a[4:7], a[164:167], v[68:71]
    v_mfma_f32_16x16x32_bf16 v[64:67], a[4:7], a[160:163], v[64:67]
    ds_read_b128 a[144:147], v37 offset:16384
    v_mfma_f32_16x16x32_bf16 v[80:83], a[8:11], a[160:163], v[80:83]
    ds_read_b128 a[148:151], v37 offset:18432
    v_mfma_f32_16x16x32_bf16 v[84:87], a[8:11], a[164:167], v[84:87]
    buffer_load_dwordx4 v25, s[12:15], s44 offen offset:1024 nt lds
    v_mfma_f32_16x16x32_bf16 v[88:91], a[8:11], a[168:171], v[88:91]
    ds_read_b128 a[152:155], v37 offset:20480
    v_mfma_f32_16x16x32_bf16 v[92:95], a[8:11], a[172:175], v[92:95]
    ds_read_b128 a[156:159], v37 offset:22528
    v_mfma_f32_16x16x32_bf16 v[108:111], a[12:15], a[172:175], v[108:111]
    v_mfma_f32_16x16x32_bf16 v[104:107], a[12:15], a[168:171], v[104:107]
    buffer_load_dwordx4 v26, s[12:15], s44 offen offset:2048 nt lds
    v_mfma_f32_16x16x32_bf16 v[100:103], a[12:15], a[164:167], v[100:103]
    ds_read_b64_tr_b16 a[64:65], v16 offset:49152
    v_mfma_f32_16x16x32_bf16 v[96:99], a[12:15], a[160:163], v[96:99]
    ds_read_b64_tr_b16 a[66:67], v16 offset:51200
    v_mfma_f32_16x16x32_bf16 v[112:115], a[16:19], a[160:163], v[112:115]
    ds_read_b64_tr_b16 a[68:69], v17 offset:49152
    v_mfma_f32_16x16x32_bf16 v[116:119], a[16:19], a[164:167], v[116:119]
    buffer_load_dwordx4 v27, s[12:15], s44 offen offset:3072 nt lds
    v_mfma_f32_16x16x32_bf16 v[120:123], a[16:19], a[168:171], v[120:123]
    ds_read_b64_tr_b16 a[70:71], v17 offset:51200
    v_mfma_f32_16x16x32_bf16 v[124:127], a[16:19], a[172:175], v[124:127]
    v_mfma_f32_16x16x32_bf16 v[140:143], a[20:23], a[172:175], v[140:143]
    ds_read_b64_tr_b16 a[72:73], v18 offset:49152
    v_mfma_f32_16x16x32_bf16 v[136:139], a[20:23], a[168:171], v[136:139]
    s_add_u32 m0, s30, 16384
    v_mfma_f32_16x16x32_bf16 v[132:135], a[20:23], a[164:167], v[132:135]
    ds_read_b64_tr_b16 a[74:75], v18 offset:51200
    v_mfma_f32_16x16x32_bf16 v[128:131], a[20:23], a[160:163], v[128:131]
    ds_read_b64_tr_b16 a[76:77], v19 offset:49152
    v_mfma_f32_16x16x32_bf16 v[144:147], a[24:27], a[160:163], v[144:147]
    ds_read_b64_tr_b16 a[78:79], v19 offset:51200
    v_mfma_f32_16x16x32_bf16 v[148:151], a[24:27], a[164:167], v[148:151]
    buffer_load_dwordx4 v13, s[20:23], s33 offen offset:0 nt lds
    v_mfma_f32_16x16x32_bf16 v[152:155], a[24:27], a[168:171], v[152:155]
    v_mfma_f32_16x16x32_bf16 v[156:159], a[24:27], a[172:175], v[156:159]
    ds_read_b64_tr_b16 a[80:81], v20 offset:49152
    v_mfma_f32_16x16x32_bf16 v[172:175], a[28:31], a[172:175], v[172:175]
    ds_read_b64_tr_b16 a[82:83], v20 offset:51200
    v_mfma_f32_16x16x32_bf16 v[168:171], a[28:31], a[168:171], v[168:171]
    buffer_load_dwordx4 v13, s[20:23], s33 offen offset:1024 nt lds
    v_mfma_f32_16x16x32_bf16 v[164:167], a[28:31], a[164:167], v[164:167]
    ds_read_b64_tr_b16 a[84:85], v21 offset:49152
    v_mfma_f32_16x16x32_bf16 v[160:163], a[28:31], a[160:163], v[160:163]
    ds_read_b64_tr_b16 a[86:87], v21 offset:51200
    v_mfma_f32_16x16x32_bf16 v[176:179], a[32:35], a[160:163], v[176:179]
    v_mfma_f32_16x16x32_bf16 v[180:183], a[32:35], a[164:167], v[180:183]
    buffer_load_dwordx4 v13, s[20:23], s33 offen offset:2048 nt lds
    v_mfma_f32_16x16x32_bf16 v[184:187], a[32:35], a[168:171], v[184:187]
    ds_read_b64_tr_b16 a[88:89], v22 offset:49152
    v_mfma_f32_16x16x32_bf16 v[188:191], a[32:35], a[172:175], v[188:191]
    ds_read_b64_tr_b16 a[90:91], v22 offset:51200
    v_mfma_f32_16x16x32_bf16 v[204:207], a[36:39], a[172:175], v[204:207]
    ds_read_b64_tr_b16 a[92:93], v23 offset:49152
    v_mfma_f32_16x16x32_bf16 v[200:203], a[36:39], a[168:171], v[200:203]
    buffer_load_dwordx4 v13, s[20:23], s33 offen offset:3072 nt lds
    s_add_u32 s33, s33, 0x4000
    v_mfma_f32_16x16x32_bf16 v[196:199], a[36:39], a[164:167], v[196:199]
    ds_read_b64_tr_b16 a[94:95], v23 offset:51200
    v_mfma_f32_16x16x32_bf16 v[192:195], a[36:39], a[160:163], v[192:195]
    v_mfma_f32_16x16x32_bf16 v[208:211], a[40:43], a[160:163], v[208:211]
    ds_read_b64_tr_b16 a[96:97], v16 offset:49408
    v_mfma_f32_16x16x32_bf16 v[212:215], a[40:43], a[164:167], v[212:215]
    ds_read_b64_tr_b16 a[98:99], v16 offset:51456
    v_mfma_f32_16x16x32_bf16 v[216:219], a[40:43], a[168:171], v[216:219]
    ds_read_b64_tr_b16 a[100:101], v17 offset:49408
    v_mfma_f32_16x16x32_bf16 v[220:223], a[40:43], a[172:175], v[220:223]
    ds_read_b64_tr_b16 a[102:103], v17 offset:51456
    v_mfma_f32_16x16x32_bf16 v[236:239], a[44:47], a[172:175], v[236:239]
    v_mfma_f32_16x16x32_bf16 v[232:235], a[44:47], a[168:171], v[232:235]
    ds_read_b64_tr_b16 a[104:105], v18 offset:49408
    v_mfma_f32_16x16x32_bf16 v[228:231], a[44:47], a[164:167], v[228:231]
    ds_read_b64_tr_b16 a[106:107], v18 offset:51456
    v_mfma_f32_16x16x32_bf16 v[224:227], a[44:47], a[160:163], v[224:227]
    ds_read_b64_tr_b16 a[108:109], v19 offset:49408
    v_mfma_f32_16x16x32_bf16 v[240:243], a[48:51], a[160:163], v[240:243]
    ds_read_b64_tr_b16 a[110:111], v19 offset:51456
    v_mfma_f32_16x16x32_bf16 v[244:247], a[48:51], a[164:167], v[244:247]
    v_mfma_f32_16x16x32_bf16 v[248:251], a[48:51], a[168:171], v[248:251]
    ds_read_b64_tr_b16 a[112:113], v20 offset:49408
    v_mfma_f32_16x16x32_bf16 v[252:255], a[48:51], a[172:175], v[252:255]
    ds_read_b64_tr_b16 a[114:115], v20 offset:51456
    v_mfma_f32_16x16x32_bf16 a[220:223], a[52:55], a[172:175], a[220:223]
    ds_read_b64_tr_b16 a[116:117], v21 offset:49408
    v_mfma_f32_16x16x32_bf16 a[216:219], a[52:55], a[168:171], a[216:219]
    ds_read_b64_tr_b16 a[118:119], v21 offset:51456
    v_mfma_f32_16x16x32_bf16 a[212:215], a[52:55], a[164:167], a[212:215]
    v_mfma_f32_16x16x32_bf16 a[208:211], a[52:55], a[160:163], a[208:211]
    ds_read_b64_tr_b16 a[120:121], v22 offset:49408
    v_mfma_f32_16x16x32_bf16 a[224:227], a[56:59], a[160:163], a[224:227]
    ds_read_b64_tr_b16 a[122:123], v22 offset:51456
    v_mfma_f32_16x16x32_bf16 a[228:231], a[56:59], a[164:167], a[228:231]
    ds_read_b64_tr_b16 a[124:125], v23 offset:49408
    v_mfma_f32_16x16x32_bf16 a[232:235], a[56:59], a[168:171], a[232:235]
    ds_read_b64_tr_b16 a[126:127], v23 offset:51456
    v_mfma_f32_16x16x32_bf16 a[236:239], a[56:59], a[172:175], a[236:239]
    v_mfma_f32_16x16x32_bf16 a[252:255], a[60:63], a[172:175], a[252:255]
    v_mfma_f32_16x16x32_bf16 a[248:251], a[60:63], a[168:171], a[248:251]
    v_mfma_f32_16x16x32_bf16 a[244:247], a[60:63], a[164:167], a[244:247]
    v_mfma_f32_16x16x32_bf16 a[240:243], a[60:63], a[160:163], a[240:243]
    s_waitcnt vmcnt(24) lgkmcnt(0)
    s_barrier
    v_mfma_f32_16x16x32_bf16 v[48:51], a[64:67], a[176:179], v[48:51]
    ds_read_b64_tr_b16 a[0:1], v16 offset:0
    v_mfma_f32_16x16x32_bf16 v[52:55], a[64:67], a[180:183], v[52:55]
    s_add_u32 m0, s31, 49152
    s_mov_b32 s44, 4980736
    v_mfma_f32_16x16x32_bf16 v[56:59], a[64:67], a[184:187], v[56:59]
    ds_read_b64_tr_b16 a[2:3], v16 offset:2048
    v_mfma_f32_16x16x32_bf16 v[60:63], a[64:67], a[188:191], v[60:63]
    v_mfma_f32_16x16x32_bf16 v[76:79], a[68:71], a[188:191], v[76:79]
    ds_read_b64_tr_b16 a[4:5], v17 offset:0
    v_mfma_f32_16x16x32_bf16 v[72:75], a[68:71], a[184:187], v[72:75]
    buffer_load_dwordx4 v24, s[12:15], s44 offen offset:0 nt lds
    v_mfma_f32_16x16x32_bf16 v[68:71], a[68:71], a[180:183], v[68:71]
    ds_read_b64_tr_b16 a[6:7], v17 offset:2048
    v_mfma_f32_16x16x32_bf16 v[64:67], a[68:71], a[176:179], v[64:67]
    v_mfma_f32_16x16x32_bf16 v[80:83], a[72:75], a[176:179], v[80:83]
    ds_read_b64_tr_b16 a[8:9], v18 offset:0
    v_mfma_f32_16x16x32_bf16 v[84:87], a[72:75], a[180:183], v[84:87]
    buffer_load_dwordx4 v25, s[12:15], s44 offen offset:1024 nt lds
    v_mfma_f32_16x16x32_bf16 v[88:91], a[72:75], a[184:187], v[88:91]
    ds_read_b64_tr_b16 a[10:11], v18 offset:2048
    v_mfma_f32_16x16x32_bf16 v[92:95], a[72:75], a[188:191], v[92:95]
    v_mfma_f32_16x16x32_bf16 v[108:111], a[76:79], a[188:191], v[108:111]
    ds_read_b64_tr_b16 a[12:13], v19 offset:0
    v_mfma_f32_16x16x32_bf16 v[104:107], a[76:79], a[184:187], v[104:107]
    buffer_load_dwordx4 v26, s[12:15], s44 offen offset:2048 nt lds
    v_mfma_f32_16x16x32_bf16 v[100:103], a[76:79], a[180:183], v[100:103]
    ds_read_b64_tr_b16 a[14:15], v19 offset:2048
    v_mfma_f32_16x16x32_bf16 v[96:99], a[76:79], a[176:179], v[96:99]
    v_mfma_f32_16x16x32_bf16 v[112:115], a[80:83], a[176:179], v[112:115]
    ds_read_b64_tr_b16 a[16:17], v20 offset:0
    v_mfma_f32_16x16x32_bf16 v[116:119], a[80:83], a[180:183], v[116:119]
    buffer_load_dwordx4 v27, s[12:15], s44 offen offset:3072 nt lds
    v_mfma_f32_16x16x32_bf16 v[120:123], a[80:83], a[184:187], v[120:123]
    v_mfma_f32_16x16x32_bf16 v[124:127], a[80:83], a[188:191], v[124:127]
    ds_read_b64_tr_b16 a[18:19], v20 offset:2048
    v_mfma_f32_16x16x32_bf16 v[140:143], a[84:87], a[188:191], v[140:143]
    ds_read_b64_tr_b16 a[20:21], v21 offset:0
    v_mfma_f32_16x16x32_bf16 v[136:139], a[84:87], a[184:187], v[136:139]
    s_add_u32 m0, s29, 16384
    v_mfma_f32_16x16x32_bf16 v[132:135], a[84:87], a[180:183], v[132:135]
    v_mfma_f32_16x16x32_bf16 v[128:131], a[84:87], a[176:179], v[128:131]
    ds_read_b64_tr_b16 a[22:23], v21 offset:2048
    v_mfma_f32_16x16x32_bf16 v[144:147], a[88:91], a[176:179], v[144:147]
    ds_read_b64_tr_b16 a[24:25], v22 offset:0
    v_mfma_f32_16x16x32_bf16 v[148:151], a[88:91], a[180:183], v[148:151]
    buffer_load_dwordx4 v13, s[16:19], s32 offen offset:0 nt lds
    v_mfma_f32_16x16x32_bf16 v[152:155], a[88:91], a[184:187], v[152:155]
    v_mfma_f32_16x16x32_bf16 v[156:159], a[88:91], a[188:191], v[156:159]
    ds_read_b64_tr_b16 a[26:27], v22 offset:2048
    v_mfma_f32_16x16x32_bf16 v[172:175], a[92:95], a[188:191], v[172:175]
    ds_read_b64_tr_b16 a[28:29], v23 offset:0
    v_mfma_f32_16x16x32_bf16 v[168:171], a[92:95], a[184:187], v[168:171]
    buffer_load_dwordx4 v13, s[16:19], s32 offen offset:1024 nt lds
    v_mfma_f32_16x16x32_bf16 v[164:167], a[92:95], a[180:183], v[164:167]
    v_mfma_f32_16x16x32_bf16 v[160:163], a[92:95], a[176:179], v[160:163]
    ds_read_b64_tr_b16 a[30:31], v23 offset:2048
    v_mfma_f32_16x16x32_bf16 v[176:179], a[96:99], a[176:179], v[176:179]
    v_mfma_f32_16x16x32_bf16 v[180:183], a[96:99], a[180:183], v[180:183]
    buffer_load_dwordx4 v13, s[16:19], s32 offen offset:2048 nt lds
    v_mfma_f32_16x16x32_bf16 v[184:187], a[96:99], a[184:187], v[184:187]
    ds_read_b64_tr_b16 a[32:33], v16 offset:256
    v_mfma_f32_16x16x32_bf16 v[188:191], a[96:99], a[188:191], v[188:191]
    ds_read_b64_tr_b16 a[34:35], v16 offset:2304
    v_mfma_f32_16x16x32_bf16 v[204:207], a[100:103], a[188:191], v[204:207]
    v_mfma_f32_16x16x32_bf16 v[200:203], a[100:103], a[184:187], v[200:203]
    buffer_load_dwordx4 v13, s[16:19], s32 offen offset:3072 nt lds
    s_add_u32 s32, s32, 0x4000
    v_mfma_f32_16x16x32_bf16 v[196:199], a[100:103], a[180:183], v[196:199]
    ds_read_b64_tr_b16 a[36:37], v17 offset:256
    v_mfma_f32_16x16x32_bf16 v[192:195], a[100:103], a[176:179], v[192:195]
    ds_read_b64_tr_b16 a[38:39], v17 offset:2304
    v_mfma_f32_16x16x32_bf16 v[208:211], a[104:107], a[176:179], v[208:211]
    v_mfma_f32_16x16x32_bf16 v[212:215], a[104:107], a[180:183], v[212:215]
    ds_read_b64_tr_b16 a[40:41], v18 offset:256
    v_mfma_f32_16x16x32_bf16 v[216:219], a[104:107], a[184:187], v[216:219]
    ds_read_b64_tr_b16 a[42:43], v18 offset:2304
    v_mfma_f32_16x16x32_bf16 v[220:223], a[104:107], a[188:191], v[220:223]
    v_mfma_f32_16x16x32_bf16 v[236:239], a[108:111], a[188:191], v[236:239]
    ds_read_b64_tr_b16 a[44:45], v19 offset:256
    v_mfma_f32_16x16x32_bf16 v[232:235], a[108:111], a[184:187], v[232:235]
    ds_read_b64_tr_b16 a[46:47], v19 offset:2304
    v_mfma_f32_16x16x32_bf16 v[228:231], a[108:111], a[180:183], v[228:231]
    v_mfma_f32_16x16x32_bf16 v[224:227], a[108:111], a[176:179], v[224:227]
    ds_read_b64_tr_b16 a[48:49], v20 offset:256
    v_mfma_f32_16x16x32_bf16 v[240:243], a[112:115], a[176:179], v[240:243]
    v_mfma_f32_16x16x32_bf16 v[244:247], a[112:115], a[180:183], v[244:247]
    ds_read_b64_tr_b16 a[50:51], v20 offset:2304
    v_mfma_f32_16x16x32_bf16 v[248:251], a[112:115], a[184:187], v[248:251]
    ds_read_b64_tr_b16 a[52:53], v21 offset:256
    v_mfma_f32_16x16x32_bf16 v[252:255], a[112:115], a[188:191], v[252:255]
    v_mfma_f32_16x16x32_bf16 a[220:223], a[116:119], a[188:191], a[220:223]
    ds_read_b64_tr_b16 a[54:55], v21 offset:2304
    v_mfma_f32_16x16x32_bf16 a[216:219], a[116:119], a[184:187], a[216:219]
    ds_read_b64_tr_b16 a[56:57], v22 offset:256
    v_mfma_f32_16x16x32_bf16 a[212:215], a[116:119], a[180:183], a[212:215]
    v_mfma_f32_16x16x32_bf16 a[208:211], a[116:119], a[176:179], a[208:211]
    ds_read_b64_tr_b16 a[58:59], v22 offset:2304
    v_mfma_f32_16x16x32_bf16 a[224:227], a[120:123], a[176:179], a[224:227]
    ds_read_b64_tr_b16 a[60:61], v23 offset:256
    v_mfma_f32_16x16x32_bf16 a[228:231], a[120:123], a[180:183], a[228:231]
    v_mfma_f32_16x16x32_bf16 a[232:235], a[120:123], a[184:187], a[232:235]
    ds_read_b64_tr_b16 a[62:63], v23 offset:2304
    v_mfma_f32_16x16x32_bf16 a[236:239], a[120:123], a[188:191], a[236:239]
    v_mfma_f32_16x16x32_bf16 a[252:255], a[124:127], a[188:191], a[252:255]
    v_mfma_f32_16x16x32_bf16 a[248:251], a[124:127], a[184:187], a[248:251]
    v_mfma_f32_16x16x32_bf16 a[244:247], a[124:127], a[180:183], a[244:247]
    v_mfma_f32_16x16x32_bf16 a[240:243], a[124:127], a[176:179], a[240:243]
    s_waitcnt vmcnt(20) lgkmcnt(0)
    s_barrier
    v_mfma_f32_16x16x32_bf16 v[48:51], a[0:3], a[128:131], v[48:51]
    ds_read_b128 a[160:163], v36 offset:49152
    v_mfma_f32_16x16x32_bf16 v[52:55], a[0:3], a[132:135], v[52:55]
    s_add_u32 m0, s29, 32768
    v_mfma_f32_16x16x32_bf16 v[56:59], a[0:3], a[136:139], v[56:59]
    ds_read_b128 a[164:167], v36 offset:51200
    v_mfma_f32_16x16x32_bf16 v[60:63], a[0:3], a[140:143], v[60:63]
    ds_read_b128 a[168:171], v36 offset:53248
    v_mfma_f32_16x16x32_bf16 v[76:79], a[4:7], a[140:143], v[76:79]
    v_mfma_f32_16x16x32_bf16 v[72:75], a[4:7], a[136:139], v[72:75]
    buffer_load_dwordx4 v13, s[16:19], s32 offen offset:0 nt lds
    v_mfma_f32_16x16x32_bf16 v[68:71], a[4:7], a[132:135], v[68:71]
    ds_read_b128 a[172:175], v36 offset:55296
    v_mfma_f32_16x16x32_bf16 v[64:67], a[4:7], a[128:131], v[64:67]
    ds_read_b128 a[176:179], v37 offset:49152
    v_mfma_f32_16x16x32_bf16 v[80:83], a[8:11], a[128:131], v[80:83]
    ds_read_b128 a[180:183], v37 offset:51200
    v_mfma_f32_16x16x32_bf16 v[84:87], a[8:11], a[132:135], v[84:87]
    buffer_load_dwordx4 v13, s[16:19], s32 offen offset:1024 nt lds
    v_mfma_f32_16x16x32_bf16 v[88:91], a[8:11], a[136:139], v[88:91]
    v_mfma_f32_16x16x32_bf16 v[92:95], a[8:11], a[140:143], v[92:95]
    ds_read_b128 a[184:187], v37 offset:53248
    v_mfma_f32_16x16x32_bf16 v[108:111], a[12:15], a[140:143], v[108:111]
    ds_read_b128 a[188:191], v37 offset:55296
    v_mfma_f32_16x16x32_bf16 v[104:107], a[12:15], a[136:139], v[104:107]
    buffer_load_dwordx4 v13, s[16:19], s32 offen offset:2048 nt lds
    v_mfma_f32_16x16x32_bf16 v[100:103], a[12:15], a[132:135], v[100:103]
    v_mfma_f32_16x16x32_bf16 v[96:99], a[12:15], a[128:131], v[96:99]
    ds_read_b64_tr_b16 a[64:65], v16 offset:16384
    v_mfma_f32_16x16x32_bf16 v[112:115], a[16:19], a[128:131], v[112:115]
    ds_read_b64_tr_b16 a[66:67], v16 offset:18432
    v_mfma_f32_16x16x32_bf16 v[116:119], a[16:19], a[132:135], v[116:119]
    buffer_load_dwordx4 v13, s[16:19], s32 offen offset:3072 nt lds
    s_add_u32 s32, s32, 0x4000
    v_mfma_f32_16x16x32_bf16 v[120:123], a[16:19], a[136:139], v[120:123]
    ds_read_b64_tr_b16 a[68:69], v17 offset:16384
    v_mfma_f32_16x16x32_bf16 v[124:127], a[16:19], a[140:143], v[124:127]
    v_mfma_f32_16x16x32_bf16 v[140:143], a[20:23], a[140:143], v[140:143]
    ds_read_b64_tr_b16 a[70:71], v17 offset:18432
    v_mfma_f32_16x16x32_bf16 v[136:139], a[20:23], a[136:139], v[136:139]
    ds_read_b64_tr_b16 a[72:73], v18 offset:16384
    v_mfma_f32_16x16x32_bf16 v[132:135], a[20:23], a[132:135], v[132:135]
    ds_read_b64_tr_b16 a[74:75], v18 offset:18432
    v_mfma_f32_16x16x32_bf16 v[128:131], a[20:23], a[128:131], v[128:131]
    v_mfma_f32_16x16x32_bf16 v[144:147], a[24:27], a[128:131], v[144:147]
    ds_read_b64_tr_b16 a[76:77], v19 offset:16384
    v_mfma_f32_16x16x32_bf16 v[148:151], a[24:27], a[132:135], v[148:151]
    ds_read_b64_tr_b16 a[78:79], v19 offset:18432
    v_mfma_f32_16x16x32_bf16 v[152:155], a[24:27], a[136:139], v[152:155]
    v_mfma_f32_16x16x32_bf16 v[156:159], a[24:27], a[140:143], v[156:159]
    ds_read_b64_tr_b16 a[80:81], v20 offset:16384
    v_mfma_f32_16x16x32_bf16 v[172:175], a[28:31], a[140:143], v[172:175]
    ds_read_b64_tr_b16 a[82:83], v20 offset:18432
    v_mfma_f32_16x16x32_bf16 v[168:171], a[28:31], a[136:139], v[168:171]
    ds_read_b64_tr_b16 a[84:85], v21 offset:16384
    v_mfma_f32_16x16x32_bf16 v[164:167], a[28:31], a[132:135], v[164:167]
    v_mfma_f32_16x16x32_bf16 v[160:163], a[28:31], a[128:131], v[160:163]
    ds_read_b64_tr_b16 a[86:87], v21 offset:18432
    v_mfma_f32_16x16x32_bf16 v[176:179], a[32:35], a[128:131], v[176:179]
    ds_read_b64_tr_b16 a[88:89], v22 offset:16384
    v_mfma_f32_16x16x32_bf16 v[180:183], a[32:35], a[132:135], v[180:183]
    ds_read_b64_tr_b16 a[90:91], v22 offset:18432
    v_mfma_f32_16x16x32_bf16 v[184:187], a[32:35], a[136:139], v[184:187]
    v_mfma_f32_16x16x32_bf16 v[188:191], a[32:35], a[140:143], v[188:191]
    ds_read_b64_tr_b16 a[92:93], v23 offset:16384
    v_mfma_f32_16x16x32_bf16 v[204:207], a[36:39], a[140:143], v[204:207]
    ds_read_b64_tr_b16 a[94:95], v23 offset:18432
    v_mfma_f32_16x16x32_bf16 v[200:203], a[36:39], a[136:139], v[200:203]
    v_mfma_f32_16x16x32_bf16 v[196:199], a[36:39], a[132:135], v[196:199]
    ds_read_b64_tr_b16 a[96:97], v16 offset:16640
    v_mfma_f32_16x16x32_bf16 v[192:195], a[36:39], a[128:131], v[192:195]
    ds_read_b64_tr_b16 a[98:99], v16 offset:18688
    v_mfma_f32_16x16x32_bf16 v[208:211], a[40:43], a[128:131], v[208:211]
    ds_read_b64_tr_b16 a[100:101], v17 offset:16640
    v_mfma_f32_16x16x32_bf16 v[212:215], a[40:43], a[132:135], v[212:215]
    v_mfma_f32_16x16x32_bf16 v[216:219], a[40:43], a[136:139], v[216:219]
    ds_read_b64_tr_b16 a[102:103], v17 offset:18688
    v_mfma_f32_16x16x32_bf16 v[220:223], a[40:43], a[140:143], v[220:223]
    ds_read_b64_tr_b16 a[104:105], v18 offset:16640
    v_mfma_f32_16x16x32_bf16 v[236:239], a[44:47], a[140:143], v[236:239]
    ds_read_b64_tr_b16 a[106:107], v18 offset:18688
    v_mfma_f32_16x16x32_bf16 v[232:235], a[44:47], a[136:139], v[232:235]
    v_mfma_f32_16x16x32_bf16 v[228:231], a[44:47], a[132:135], v[228:231]
    ds_read_b64_tr_b16 a[108:109], v19 offset:16640
    v_mfma_f32_16x16x32_bf16 v[224:227], a[44:47], a[128:131], v[224:227]
    ds_read_b64_tr_b16 a[110:111], v19 offset:18688
    v_mfma_f32_16x16x32_bf16 v[240:243], a[48:51], a[128:131], v[240:243]
    v_mfma_f32_16x16x32_bf16 v[244:247], a[48:51], a[132:135], v[244:247]
    ds_read_b64_tr_b16 a[112:113], v20 offset:16640
    v_mfma_f32_16x16x32_bf16 v[248:251], a[48:51], a[136:139], v[248:251]
    ds_read_b64_tr_b16 a[114:115], v20 offset:18688
    v_mfma_f32_16x16x32_bf16 v[252:255], a[48:51], a[140:143], v[252:255]
    ds_read_b64_tr_b16 a[116:117], v21 offset:16640
    v_mfma_f32_16x16x32_bf16 a[220:223], a[52:55], a[140:143], a[220:223]
    v_mfma_f32_16x16x32_bf16 a[216:219], a[52:55], a[136:139], a[216:219]
    ds_read_b64_tr_b16 a[118:119], v21 offset:18688
    v_mfma_f32_16x16x32_bf16 a[212:215], a[52:55], a[132:135], a[212:215]
    ds_read_b64_tr_b16 a[120:121], v22 offset:16640
    v_mfma_f32_16x16x32_bf16 a[208:211], a[52:55], a[128:131], a[208:211]
    ds_read_b64_tr_b16 a[122:123], v22 offset:18688
    v_mfma_f32_16x16x32_bf16 a[224:227], a[56:59], a[128:131], a[224:227]
    v_mfma_f32_16x16x32_bf16 a[228:231], a[56:59], a[132:135], a[228:231]
    ds_read_b64_tr_b16 a[124:125], v23 offset:16640
    v_mfma_f32_16x16x32_bf16 a[232:235], a[56:59], a[136:139], a[232:235]
    ds_read_b64_tr_b16 a[126:127], v23 offset:18688
    v_mfma_f32_16x16x32_bf16 a[236:239], a[56:59], a[140:143], a[236:239]
    v_mfma_f32_16x16x32_bf16 a[252:255], a[60:63], a[140:143], a[252:255]
    v_mfma_f32_16x16x32_bf16 a[248:251], a[60:63], a[136:139], a[248:251]
    v_mfma_f32_16x16x32_bf16 a[244:247], a[60:63], a[132:135], a[244:247]
    v_mfma_f32_16x16x32_bf16 a[240:243], a[60:63], a[128:131], a[240:243]
    s_waitcnt vmcnt(16) lgkmcnt(0)
    s_barrier
    v_mfma_f32_16x16x32_bf16 v[48:51], a[64:67], a[144:147], v[48:51]
    ds_read_b64_tr_b16 a[0:1], v16 offset:32768
    v_mfma_f32_16x16x32_bf16 v[52:55], a[64:67], a[148:151], v[52:55]
    s_add_u32 m0, s30, 32768
    v_mfma_f32_16x16x32_bf16 v[56:59], a[64:67], a[152:155], v[56:59]
    ds_read_b64_tr_b16 a[2:3], v16 offset:34816
    v_mfma_f32_16x16x32_bf16 v[60:63], a[64:67], a[156:159], v[60:63]
    v_mfma_f32_16x16x32_bf16 v[76:79], a[68:71], a[156:159], v[76:79]
    ds_read_b64_tr_b16 a[4:5], v17 offset:32768
    v_mfma_f32_16x16x32_bf16 v[72:75], a[68:71], a[152:155], v[72:75]
    buffer_load_dwordx4 v13, s[20:23], s33 offen offset:0 nt lds
    v_mfma_f32_16x16x32_bf16 v[68:71], a[68:71], a[148:151], v[68:71]
    v_mfma_f32_16x16x32_bf16 v[64:67], a[68:71], a[144:147], v[64:67]
    ds_read_b64_tr_b16 a[6:7], v17 offset:34816
    v_mfma_f32_16x16x32_bf16 v[80:83], a[72:75], a[144:147], v[80:83]
    ds_read_b64_tr_b16 a[8:9], v18 offset:32768
    v_mfma_f32_16x16x32_bf16 v[84:87], a[72:75], a[148:151], v[84:87]
    buffer_load_dwordx4 v13, s[20:23], s33 offen offset:1024 nt lds
    v_mfma_f32_16x16x32_bf16 v[88:91], a[72:75], a[152:155], v[88:91]
    v_mfma_f32_16x16x32_bf16 v[92:95], a[72:75], a[156:159], v[92:95]
    ds_read_b64_tr_b16 a[10:11], v18 offset:34816
    v_mfma_f32_16x16x32_bf16 v[108:111], a[76:79], a[156:159], v[108:111]
    v_mfma_f32_16x16x32_bf16 v[104:107], a[76:79], a[152:155], v[104:107]
    buffer_load_dwordx4 v13, s[20:23], s33 offen offset:2048 nt lds
    v_mfma_f32_16x16x32_bf16 v[100:103], a[76:79], a[148:151], v[100:103]
    ds_read_b64_tr_b16 a[12:13], v19 offset:32768
    v_mfma_f32_16x16x32_bf16 v[96:99], a[76:79], a[144:147], v[96:99]
    v_mfma_f32_16x16x32_bf16 v[112:115], a[80:83], a[144:147], v[112:115]
    ds_read_b64_tr_b16 a[14:15], v19 offset:34816
    v_mfma_f32_16x16x32_bf16 v[116:119], a[80:83], a[148:151], v[116:119]
    buffer_load_dwordx4 v13, s[20:23], s33 offen offset:3072 nt lds
    s_add_u32 s33, s33, 0x4000
    v_mfma_f32_16x16x32_bf16 v[120:123], a[80:83], a[152:155], v[120:123]
    ds_read_b64_tr_b16 a[16:17], v20 offset:32768
    v_mfma_f32_16x16x32_bf16 v[124:127], a[80:83], a[156:159], v[124:127]
    v_mfma_f32_16x16x32_bf16 v[140:143], a[84:87], a[156:159], v[140:143]
    ds_read_b64_tr_b16 a[18:19], v20 offset:34816
    v_mfma_f32_16x16x32_bf16 v[136:139], a[84:87], a[152:155], v[136:139]
    v_mfma_f32_16x16x32_bf16 v[132:135], a[84:87], a[148:151], v[132:135]
    ds_read_b64_tr_b16 a[20:21], v21 offset:32768
    v_mfma_f32_16x16x32_bf16 v[128:131], a[84:87], a[144:147], v[128:131]
    ds_read_b64_tr_b16 a[22:23], v21 offset:34816
    v_mfma_f32_16x16x32_bf16 v[144:147], a[88:91], a[144:147], v[144:147]
    v_mfma_f32_16x16x32_bf16 v[148:151], a[88:91], a[148:151], v[148:151]
    ds_read_b64_tr_b16 a[24:25], v22 offset:32768
    v_mfma_f32_16x16x32_bf16 v[152:155], a[88:91], a[152:155], v[152:155]
    v_mfma_f32_16x16x32_bf16 v[156:159], a[88:91], a[156:159], v[156:159]
    ds_read_b64_tr_b16 a[26:27], v22 offset:34816
    v_mfma_f32_16x16x32_bf16 v[172:175], a[92:95], a[156:159], v[172:175]
    v_mfma_f32_16x16x32_bf16 v[168:171], a[92:95], a[152:155], v[168:171]
    ds_read_b64_tr_b16 a[28:29], v23 offset:32768
    v_mfma_f32_16x16x32_bf16 v[164:167], a[92:95], a[148:151], v[164:167]
    ds_read_b64_tr_b16 a[30:31], v23 offset:34816
    v_mfma_f32_16x16x32_bf16 v[160:163], a[92:95], a[144:147], v[160:163]
    v_mfma_f32_16x16x32_bf16 v[176:179], a[96:99], a[144:147], v[176:179]
    ds_read_b64_tr_b16 a[32:33], v16 offset:33024
    v_mfma_f32_16x16x32_bf16 v[180:183], a[96:99], a[148:151], v[180:183]
    v_mfma_f32_16x16x32_bf16 v[184:187], a[96:99], a[152:155], v[184:187]
    ds_read_b64_tr_b16 a[34:35], v16 offset:35072
    v_mfma_f32_16x16x32_bf16 v[188:191], a[96:99], a[156:159], v[188:191]
    ds_read_b64_tr_b16 a[36:37], v17 offset:33024
    v_mfma_f32_16x16x32_bf16 v[204:207], a[100:103], a[156:159], v[204:207]
    v_mfma_f32_16x16x32_bf16 v[200:203], a[100:103], a[152:155], v[200:203]
    ds_read_b64_tr_b16 a[38:39], v17 offset:35072
    v_mfma_f32_16x16x32_bf16 v[196:199], a[100:103], a[148:151], v[196:199]
    v_mfma_f32_16x16x32_bf16 v[192:195], a[100:103], a[144:147], v[192:195]
    ds_read_b64_tr_b16 a[40:41], v18 offset:33024
    v_mfma_f32_16x16x32_bf16 v[208:211], a[104:107], a[144:147], v[208:211]
    v_mfma_f32_16x16x32_bf16 v[212:215], a[104:107], a[148:151], v[212:215]
    ds_read_b64_tr_b16 a[42:43], v18 offset:35072
    v_mfma_f32_16x16x32_bf16 v[216:219], a[104:107], a[152:155], v[216:219]
    ds_read_b64_tr_b16 a[44:45], v19 offset:33024
    v_mfma_f32_16x16x32_bf16 v[220:223], a[104:107], a[156:159], v[220:223]
    v_mfma_f32_16x16x32_bf16 v[236:239], a[108:111], a[156:159], v[236:239]
    ds_read_b64_tr_b16 a[46:47], v19 offset:35072
    v_mfma_f32_16x16x32_bf16 v[232:235], a[108:111], a[152:155], v[232:235]
    v_mfma_f32_16x16x32_bf16 v[228:231], a[108:111], a[148:151], v[228:231]
    ds_read_b64_tr_b16 a[48:49], v20 offset:33024
    v_mfma_f32_16x16x32_bf16 v[224:227], a[108:111], a[144:147], v[224:227]
    ds_read_b64_tr_b16 a[50:51], v20 offset:35072
    v_mfma_f32_16x16x32_bf16 v[240:243], a[112:115], a[144:147], v[240:243]
    v_mfma_f32_16x16x32_bf16 v[244:247], a[112:115], a[148:151], v[244:247]
    ds_read_b64_tr_b16 a[52:53], v21 offset:33024
    v_mfma_f32_16x16x32_bf16 v[248:251], a[112:115], a[152:155], v[248:251]
    v_mfma_f32_16x16x32_bf16 v[252:255], a[112:115], a[156:159], v[252:255]
    ds_read_b64_tr_b16 a[54:55], v21 offset:35072
    v_mfma_f32_16x16x32_bf16 a[220:223], a[116:119], a[156:159], a[220:223]
    v_mfma_f32_16x16x32_bf16 a[216:219], a[116:119], a[152:155], a[216:219]
    ds_read_b64_tr_b16 a[56:57], v22 offset:33024
    v_mfma_f32_16x16x32_bf16 a[212:215], a[116:119], a[148:151], a[212:215]
    ds_read_b64_tr_b16 a[58:59], v22 offset:35072
    v_mfma_f32_16x16x32_bf16 a[208:211], a[116:119], a[144:147], a[208:211]
    v_mfma_f32_16x16x32_bf16 a[224:227], a[120:123], a[144:147], a[224:227]
    ds_read_b64_tr_b16 a[60:61], v23 offset:33024
    v_mfma_f32_16x16x32_bf16 a[228:231], a[120:123], a[148:151], a[228:231]
    v_mfma_f32_16x16x32_bf16 a[232:235], a[120:123], a[152:155], a[232:235]
    ds_read_b64_tr_b16 a[62:63], v23 offset:35072
    v_mfma_f32_16x16x32_bf16 a[236:239], a[120:123], a[156:159], a[236:239]
    v_mfma_f32_16x16x32_bf16 a[252:255], a[124:127], a[156:159], a[252:255]
    v_mfma_f32_16x16x32_bf16 a[248:251], a[124:127], a[152:155], a[248:251]
    v_mfma_f32_16x16x32_bf16 a[244:247], a[124:127], a[148:151], a[244:247]
    v_mfma_f32_16x16x32_bf16 a[240:243], a[124:127], a[144:147], a[240:243]
    s_waitcnt vmcnt(12) lgkmcnt(0)
    s_barrier
    v_mfma_f32_16x16x32_bf16 v[48:51], a[0:3], a[160:163], v[48:51]
    ds_read_b64_tr_b16 a[64:65], v16 offset:49152
    v_mfma_f32_16x16x32_bf16 v[52:55], a[0:3], a[164:167], v[52:55]
    buffer_store_dwordx4 v[40:43], v14, s[24:27], s78 offen offset:0 sc1
    v_mfma_f32_16x16x32_bf16 v[56:59], a[0:3], a[168:171], v[56:59]
    ds_read_b64_tr_b16 a[66:67], v16 offset:51200
    v_mfma_f32_16x16x32_bf16 v[60:63], a[0:3], a[172:175], v[60:63]
    v_mfma_f32_16x16x32_bf16 v[76:79], a[4:7], a[172:175], v[76:79]
    ds_read_b64_tr_b16 a[68:69], v17 offset:49152
    v_mfma_f32_16x16x32_bf16 v[72:75], a[4:7], a[168:171], v[72:75]
    buffer_store_dwordx4 v[40:43], v14, s[24:27], s78 offen offset:1024 sc1
    v_mfma_f32_16x16x32_bf16 v[68:71], a[4:7], a[164:167], v[68:71]
    ds_read_b64_tr_b16 a[70:71], v17 offset:51200
    v_mfma_f32_16x16x32_bf16 v[64:67], a[4:7], a[160:163], v[64:67]
    v_mfma_f32_16x16x32_bf16 v[80:83], a[8:11], a[160:163], v[80:83]
    ds_read_b64_tr_b16 a[72:73], v18 offset:49152
    v_mfma_f32_16x16x32_bf16 v[84:87], a[8:11], a[164:167], v[84:87]
    buffer_store_dwordx4 v[40:43], v14, s[24:27], s78 offen offset:2048 sc1
    v_mfma_f32_16x16x32_bf16 v[88:91], a[8:11], a[168:171], v[88:91]
    ds_read_b64_tr_b16 a[74:75], v18 offset:51200
    v_mfma_f32_16x16x32_bf16 v[92:95], a[8:11], a[172:175], v[92:95]
    v_mfma_f32_16x16x32_bf16 v[108:111], a[12:15], a[172:175], v[108:111]
    ds_read_b64_tr_b16 a[76:77], v19 offset:49152
    v_mfma_f32_16x16x32_bf16 v[104:107], a[12:15], a[168:171], v[104:107]
    buffer_store_dwordx4 v[40:43], v14, s[24:27], s78 offen offset:3072 sc1
    s_add_u32 s37, s78, 4096
    v_mfma_f32_16x16x32_bf16 v[100:103], a[12:15], a[164:167], v[100:103]
    ds_read_b64_tr_b16 a[78:79], v19 offset:51200
    v_mfma_f32_16x16x32_bf16 v[96:99], a[12:15], a[160:163], v[96:99]
    v_mfma_f32_16x16x32_bf16 v[112:115], a[16:19], a[160:163], v[112:115]
    ds_read_b64_tr_b16 a[80:81], v20 offset:49152
    v_mfma_f32_16x16x32_bf16 v[116:119], a[16:19], a[164:167], v[116:119]
    buffer_store_dwordx4 v[40:43], v14, s[24:27], s37 offen offset:0 sc1
    v_mfma_f32_16x16x32_bf16 v[120:123], a[16:19], a[168:171], v[120:123]
    v_mfma_f32_16x16x32_bf16 v[124:127], a[16:19], a[172:175], v[124:127]
    ds_read_b64_tr_b16 a[82:83], v20 offset:51200
    v_mfma_f32_16x16x32_bf16 v[140:143], a[20:23], a[172:175], v[140:143]
    ds_read_b64_tr_b16 a[84:85], v21 offset:49152
    v_mfma_f32_16x16x32_bf16 v[136:139], a[20:23], a[168:171], v[136:139]
    s_add_u32 m0, s29, 49152
    v_mfma_f32_16x16x32_bf16 v[132:135], a[20:23], a[164:167], v[132:135]
    v_mfma_f32_16x16x32_bf16 v[128:131], a[20:23], a[160:163], v[128:131]
    ds_read_b64_tr_b16 a[86:87], v21 offset:51200
    v_mfma_f32_16x16x32_bf16 v[144:147], a[24:27], a[160:163], v[144:147]
    ds_read_b64_tr_b16 a[88:89], v22 offset:49152
    v_mfma_f32_16x16x32_bf16 v[148:151], a[24:27], a[164:167], v[148:151]
    buffer_load_dwordx4 v13, s[16:19], s32 offen offset:0 nt lds
    v_mfma_f32_16x16x32_bf16 v[152:155], a[24:27], a[168:171], v[152:155]
    v_mfma_f32_16x16x32_bf16 v[156:159], a[24:27], a[172:175], v[156:159]
    ds_read_b64_tr_b16 a[90:91], v22 offset:51200
    v_mfma_f32_16x16x32_bf16 v[172:175], a[28:31], a[172:175], v[172:175]
    ds_read_b64_tr_b16 a[92:93], v23 offset:49152
    v_mfma_f32_16x16x32_bf16 v[168:171], a[28:31], a[168:171], v[168:171]
    buffer_load_dwordx4 v13, s[16:19], s32 offen offset:1024 nt lds
    v_mfma_f32_16x16x32_bf16 v[164:167], a[28:31], a[164:167], v[164:167]
    v_mfma_f32_16x16x32_bf16 v[160:163], a[28:31], a[160:163], v[160:163]
    ds_read_b64_tr_b16 a[94:95], v23 offset:51200
    v_mfma_f32_16x16x32_bf16 v[176:179], a[32:35], a[160:163], v[176:179]
    v_mfma_f32_16x16x32_bf16 v[180:183], a[32:35], a[164:167], v[180:183]
    buffer_load_dwordx4 v13, s[16:19], s32 offen offset:2048 nt lds
    v_mfma_f32_16x16x32_bf16 v[184:187], a[32:35], a[168:171], v[184:187]
    ds_read_b64_tr_b16 a[96:97], v16 offset:49408
    v_mfma_f32_16x16x32_bf16 v[188:191], a[32:35], a[172:175], v[188:191]
    ds_read_b64_tr_b16 a[98:99], v16 offset:51456
    v_mfma_f32_16x16x32_bf16 v[204:207], a[36:39], a[172:175], v[204:207]
    v_mfma_f32_16x16x32_bf16 v[200:203], a[36:39], a[168:171], v[200:203]
    buffer_load_dwordx4 v13, s[16:19], s32 offen offset:3072 nt lds
    s_add_u32 s32, s32, 0x4000
    v_mfma_f32_16x16x32_bf16 v[196:199], a[36:39], a[164:167], v[196:199]
    ds_read_b64_tr_b16 a[100:101], v17 offset:49408
    v_mfma_f32_16x16x32_bf16 v[192:195], a[36:39], a[160:163], v[192:195]
    ds_read_b64_tr_b16 a[102:103], v17 offset:51456
    v_mfma_f32_16x16x32_bf16 v[208:211], a[40:43], a[160:163], v[208:211]
    v_mfma_f32_16x16x32_bf16 v[212:215], a[40:43], a[164:167], v[212:215]
    ds_read_b64_tr_b16 a[104:105], v18 offset:49408
    v_mfma_f32_16x16x32_bf16 v[216:219], a[40:43], a[168:171], v[216:219]
    ds_read_b64_tr_b16 a[106:107], v18 offset:51456
    v_mfma_f32_16x16x32_bf16 v[220:223], a[40:43], a[172:175], v[220:223]
    v_mfma_f32_16x16x32_bf16 v[236:239], a[44:47], a[172:175], v[236:239]
    ds_read_b64_tr_b16 a[108:109], v19 offset:49408
    v_mfma_f32_16x16x32_bf16 v[232:235], a[44:47], a[168:171], v[232:235]
    ds_read_b64_tr_b16 a[110:111], v19 offset:51456
    v_mfma_f32_16x16x32_bf16 v[228:231], a[44:47], a[164:167], v[228:231]
    v_mfma_f32_16x16x32_bf16 v[224:227], a[44:47], a[160:163], v[224:227]
    ds_read_b64_tr_b16 a[112:113], v20 offset:49408
    v_mfma_f32_16x16x32_bf16 v[240:243], a[48:51], a[160:163], v[240:243]
    v_mfma_f32_16x16x32_bf16 v[244:247], a[48:51], a[164:167], v[244:247]
    ds_read_b64_tr_b16 a[114:115], v20 offset:51456
    v_mfma_f32_16x16x32_bf16 v[248:251], a[48:51], a[168:171], v[248:251]
    ds_read_b64_tr_b16 a[116:117], v21 offset:49408
    v_mfma_f32_16x16x32_bf16 v[252:255], a[48:51], a[172:175], v[252:255]
    v_mfma_f32_16x16x32_bf16 a[220:223], a[52:55], a[172:175], a[220:223]
    ds_read_b64_tr_b16 a[118:119], v21 offset:51456
    v_mfma_f32_16x16x32_bf16 a[216:219], a[52:55], a[168:171], a[216:219]
    ds_read_b64_tr_b16 a[120:121], v22 offset:49408
    v_mfma_f32_16x16x32_bf16 a[212:215], a[52:55], a[164:167], a[212:215]
    v_mfma_f32_16x16x32_bf16 a[208:211], a[52:55], a[160:163], a[208:211]
    ds_read_b64_tr_b16 a[122:123], v22 offset:51456
    v_mfma_f32_16x16x32_bf16 a[224:227], a[56:59], a[160:163], a[224:227]
    ds_read_b64_tr_b16 a[124:125], v23 offset:49408
    v_mfma_f32_16x16x32_bf16 a[228:231], a[56:59], a[164:167], a[228:231]
    v_mfma_f32_16x16x32_bf16 a[232:235], a[56:59], a[168:171], a[232:235]
    ds_read_b64_tr_b16 a[126:127], v23 offset:51456
    v_mfma_f32_16x16x32_bf16 a[236:239], a[56:59], a[172:175], a[236:239]
    v_mfma_f32_16x16x32_bf16 a[252:255], a[60:63], a[172:175], a[252:255]
    v_mfma_f32_16x16x32_bf16 a[248:251], a[60:63], a[168:171], a[248:251]
    v_mfma_f32_16x16x32_bf16 a[244:247], a[60:63], a[164:167], a[244:247]
    v_mfma_f32_16x16x32_bf16 a[240:243], a[60:63], a[160:163], a[240:243]
    s_waitcnt lgkmcnt(0)
    s_barrier
    v_mfma_f32_16x16x32_bf16 v[48:51], a[64:67], a[176:179], v[48:51]
    v_mfma_f32_16x16x32_bf16 v[52:55], a[64:67], a[180:183], v[52:55]
    s_add_u32 m0, s30, 49152
    v_mfma_f32_16x16x32_bf16 v[56:59], a[64:67], a[184:187], v[56:59]
    v_mfma_f32_16x16x32_bf16 v[60:63], a[64:67], a[188:191], v[60:63]
    v_mfma_f32_16x16x32_bf16 v[76:79], a[68:71], a[188:191], v[76:79]
    v_mfma_f32_16x16x32_bf16 v[72:75], a[68:71], a[184:187], v[72:75]
    buffer_load_dwordx4 v13, s[20:23], s33 offen offset:0 nt lds
    v_mfma_f32_16x16x32_bf16 v[68:71], a[68:71], a[180:183], v[68:71]
    v_mfma_f32_16x16x32_bf16 v[64:67], a[68:71], a[176:179], v[64:67]
    v_mfma_f32_16x16x32_bf16 v[80:83], a[72:75], a[176:179], v[80:83]
    v_mfma_f32_16x16x32_bf16 v[84:87], a[72:75], a[180:183], v[84:87]
    buffer_load_dwordx4 v13, s[20:23], s33 offen offset:1024 nt lds
    v_mfma_f32_16x16x32_bf16 v[88:91], a[72:75], a[184:187], v[88:91]
    v_mfma_f32_16x16x32_bf16 v[92:95], a[72:75], a[188:191], v[92:95]
    v_mfma_f32_16x16x32_bf16 v[108:111], a[76:79], a[188:191], v[108:111]
    v_mfma_f32_16x16x32_bf16 v[104:107], a[76:79], a[184:187], v[104:107]
    buffer_load_dwordx4 v13, s[20:23], s33 offen offset:2048 nt lds
    v_mfma_f32_16x16x32_bf16 v[100:103], a[76:79], a[180:183], v[100:103]
    v_mfma_f32_16x16x32_bf16 v[96:99], a[76:79], a[176:179], v[96:99]
    v_mul_f32 v48, s40, v48
    v_mul_f32 v49, s40, v49
    v_mul_f32 v50, s40, v50
    v_mfma_f32_16x16x32_bf16 v[112:115], a[80:83], a[176:179], v[112:115]
    v_mul_f32 v51, s40, v51
    v_mul_f32 v64, s40, v64
    v_mul_f32 v65, s40, v65
    v_mfma_f32_16x16x32_bf16 v[116:119], a[80:83], a[180:183], v[116:119]
    buffer_load_dwordx4 v13, s[20:23], s33 offen offset:3072 nt lds
    s_add_u32 s33, s33, 0x4000
    v_mfma_f32_16x16x32_bf16 v[120:123], a[80:83], a[184:187], v[120:123]
    v_mul_f32 v66, s40, v66
    v_mul_f32 v67, s40, v67
    v_cvt_pk_bf16_f32 v16, v48, v49
    v_mfma_f32_16x16x32_bf16 v[124:127], a[80:83], a[188:191], v[124:127]
    v_cvt_pk_bf16_f32 v17, v50, v51
    v_cvt_pk_bf16_f32 v18, v64, v65
    v_mfma_f32_16x16x32_bf16 v[140:143], a[84:87], a[188:191], v[140:143]
    v_cvt_pk_bf16_f32 v19, v66, v67
    v_mul_f32 v52, s40, v52
    v_mul_f32 v53, s40, v53
    v_mfma_f32_16x16x32_bf16 v[136:139], a[84:87], a[184:187], v[136:139]
    v_mul_f32 v54, s40, v54
    v_mul_f32 v55, s40, v55
    v_mul_f32 v68, s40, v68
    v_mfma_f32_16x16x32_bf16 v[132:135], a[84:87], a[180:183], v[132:135]
    v_mul_f32 v69, s40, v69
    v_mul_f32 v70, s40, v70
    v_mul_f32 v71, s40, v71
    v_mfma_f32_16x16x32_bf16 v[128:131], a[84:87], a[176:179], v[128:131]
    v_cvt_pk_bf16_f32 v20, v52, v53
    v_cvt_pk_bf16_f32 v21, v54, v55
    v_mfma_f32_16x16x32_bf16 v[144:147], a[88:91], a[176:179], v[144:147]
    v_cvt_pk_bf16_f32 v22, v68, v69
    v_cvt_pk_bf16_f32 v23, v70, v71
    v_mfma_f32_16x16x32_bf16 v[148:151], a[88:91], a[180:183], v[148:151]
    v_permlane16_swap_b32 v16, v18
    v_permlane16_swap_b32 v17, v19
    v_mfma_f32_16x16x32_bf16 v[152:155], a[88:91], a[184:187], v[152:155]
    v_mul_f32 v56, s40, v56
    v_mul_f32 v57, s40, v57
    v_mul_f32 v58, s40, v58
    v_mfma_f32_16x16x32_bf16 v[156:159], a[88:91], a[188:191], v[156:159]
    v_mul_f32 v59, s40, v59
    v_mul_f32 v72, s40, v72
    v_mul_f32 v73, s40, v73
    v_mfma_f32_16x16x32_bf16 v[172:175], a[92:95], a[188:191], v[172:175]
    v_mul_f32 v74, s40, v74
    v_mul_f32 v75, s40, v75
    v_cvt_pk_bf16_f32 v24, v56, v57
    v_mfma_f32_16x16x32_bf16 v[168:171], a[92:95], a[184:187], v[168:171]
    v_cvt_pk_bf16_f32 v25, v58, v59
    v_cvt_pk_bf16_f32 v26, v72, v73
    v_mfma_f32_16x16x32_bf16 v[164:167], a[92:95], a[180:183], v[164:167]
    v_cvt_pk_bf16_f32 v27, v74, v75
    v_permlane16_swap_b32 v20, v22
    v_mfma_f32_16x16x32_bf16 v[160:163], a[92:95], a[176:179], v[160:163]
    v_permlane16_swap_b32 v21, v23
    v_accvgpr_write_b32 a0, v16
    v_accvgpr_write_b32 a1, v17
    v_mfma_f32_16x16x32_bf16 v[176:179], a[96:99], a[176:179], v[176:179]
    v_accvgpr_write_b32 a2, v18
    v_accvgpr_write_b32 a3, v19
    v_mul_f32 v60, s40, v60
    v_mfma_f32_16x16x32_bf16 v[180:183], a[96:99], a[180:183], v[180:183]
    v_mul_f32 v61, s40, v61
    v_mul_f32 v62, s40, v62
    v_mul_f32 v63, s40, v63
    v_mfma_f32_16x16x32_bf16 v[184:187], a[96:99], a[184:187], v[184:187]
    v_mul_f32 v76, s40, v76
    v_mul_f32 v77, s40, v77
    v_mul_f32 v78, s40, v78
    v_mfma_f32_16x16x32_bf16 v[188:191], a[96:99], a[188:191], v[188:191]
    v_mul_f32 v79, s40, v79
    v_cvt_pk_bf16_f32 v28, v60, v61
    v_mfma_f32_16x16x32_bf16 v[204:207], a[100:103], a[188:191], v[204:207]
    v_cvt_pk_bf16_f32 v29, v62, v63
    v_cvt_pk_bf16_f32 v30, v76, v77
    v_mfma_f32_16x16x32_bf16 v[200:203], a[100:103], a[184:187], v[200:203]
    v_cvt_pk_bf16_f32 v31, v78, v79
    v_permlane16_swap_b32 v24, v26
    v_mfma_f32_16x16x32_bf16 v[196:199], a[100:103], a[180:183], v[196:199]
    v_permlane16_swap_b32 v25, v27
    v_accvgpr_write_b32 a16, v20
    v_accvgpr_write_b32 a17, v21
    v_mfma_f32_16x16x32_bf16 v[192:195], a[100:103], a[176:179], v[192:195]
    v_accvgpr_write_b32 a18, v22
    v_accvgpr_write_b32 a19, v23
    v_mul_f32 v80, s40, v80
    v_mfma_f32_16x16x32_bf16 v[208:211], a[104:107], a[176:179], v[208:211]
    v_mul_f32 v81, s40, v81
    v_mul_f32 v82, s40, v82
    v_mul_f32 v83, s40, v83
    v_mfma_f32_16x16x32_bf16 v[212:215], a[104:107], a[180:183], v[212:215]
    v_mul_f32 v96, s40, v96
    v_mul_f32 v97, s40, v97
    v_mul_f32 v98, s40, v98
    v_mfma_f32_16x16x32_bf16 v[216:219], a[104:107], a[184:187], v[216:219]
    v_mul_f32 v99, s40, v99
    v_cvt_pk_bf16_f32 v16, v80, v81
    v_mfma_f32_16x16x32_bf16 v[220:223], a[104:107], a[188:191], v[220:223]
    v_cvt_pk_bf16_f32 v17, v82, v83
    v_cvt_pk_bf16_f32 v18, v96, v97
    v_mfma_f32_16x16x32_bf16 v[236:239], a[108:111], a[188:191], v[236:239]
    v_cvt_pk_bf16_f32 v19, v98, v99
    v_permlane16_swap_b32 v28, v30
    v_mfma_f32_16x16x32_bf16 v[232:235], a[108:111], a[184:187], v[232:235]
    v_permlane16_swap_b32 v29, v31
    v_accvgpr_write_b32 a32, v24
    v_accvgpr_write_b32 a33, v25
    v_mfma_f32_16x16x32_bf16 v[228:231], a[108:111], a[180:183], v[228:231]
    v_accvgpr_write_b32 a34, v26
    v_accvgpr_write_b32 a35, v27
    v_mul_f32 v84, s40, v84
    v_mfma_f32_16x16x32_bf16 v[224:227], a[108:111], a[176:179], v[224:227]
    v_mul_f32 v85, s40, v85
    v_mul_f32 v86, s40, v86
    v_mul_f32 v87, s40, v87
    v_mfma_f32_16x16x32_bf16 v[240:243], a[112:115], a[176:179], v[240:243]
    v_mul_f32 v100, s40, v100
    v_mul_f32 v101, s40, v101
    v_mul_f32 v102, s40, v102
    v_mfma_f32_16x16x32_bf16 v[244:247], a[112:115], a[180:183], v[244:247]
    v_mul_f32 v103, s40, v103
    v_cvt_pk_bf16_f32 v20, v84, v85
    v_mfma_f32_16x16x32_bf16 v[248:251], a[112:115], a[184:187], v[248:251]
    v_cvt_pk_bf16_f32 v21, v86, v87
    v_cvt_pk_bf16_f32 v22, v100, v101
    v_mfma_f32_16x16x32_bf16 v[252:255], a[112:115], a[188:191], v[252:255]
    v_cvt_pk_bf16_f32 v23, v102, v103
    v_permlane16_swap_b32 v16, v18
    v_mfma_f32_16x16x32_bf16 a[220:223], a[116:119], a[188:191], a[220:223]
    v_permlane16_swap_b32 v17, v19
    v_accvgpr_write_b32 a48, v28
    v_accvgpr_write_b32 a49, v29
    v_mfma_f32_16x16x32_bf16 a[216:219], a[116:119], a[184:187], a[216:219]
    v_accvgpr_write_b32 a50, v30
    v_accvgpr_write_b32 a51, v31
    v_mul_f32 v88, s40, v88
    v_mfma_f32_16x16x32_bf16 a[212:215], a[116:119], a[180:183], a[212:215]
    v_mul_f32 v89, s40, v89
    v_mul_f32 v90, s40, v90
    v_mul_f32 v91, s40, v91
    v_mfma_f32_16x16x32_bf16 a[208:211], a[116:119], a[176:179], a[208:211]
    v_mul_f32 v104, s40, v104
    v_mul_f32 v105, s40, v105
    v_mul_f32 v106, s40, v106
    v_mfma_f32_16x16x32_bf16 a[224:227], a[120:123], a[176:179], a[224:227]
    v_mul_f32 v107, s40, v107
    v_cvt_pk_bf16_f32 v24, v88, v89
    v_mfma_f32_16x16x32_bf16 a[228:231], a[120:123], a[180:183], a[228:231]
    v_cvt_pk_bf16_f32 v25, v90, v91
    v_cvt_pk_bf16_f32 v26, v104, v105
    v_mfma_f32_16x16x32_bf16 a[232:235], a[120:123], a[184:187], a[232:235]
    v_cvt_pk_bf16_f32 v27, v106, v107
    v_permlane16_swap_b32 v20, v22
    v_mfma_f32_16x16x32_bf16 a[236:239], a[120:123], a[188:191], a[236:239]
    v_permlane16_swap_b32 v21, v23
    v_accvgpr_write_b32 a4, v16
    v_accvgpr_write_b32 a5, v17
    v_mfma_f32_16x16x32_bf16 a[252:255], a[124:127], a[188:191], a[252:255]
    v_accvgpr_write_b32 a6, v18
    v_accvgpr_write_b32 a7, v19
    v_mul_f32 v92, s40, v92
    v_mfma_f32_16x16x32_bf16 a[248:251], a[124:127], a[184:187], a[248:251]
    v_mul_f32 v93, s40, v93
    v_mul_f32 v94, s40, v94
    v_mul_f32 v95, s40, v95
    v_mfma_f32_16x16x32_bf16 a[244:247], a[124:127], a[180:183], a[244:247]
    v_mul_f32 v108, s40, v108
    v_mul_f32 v109, s40, v109
    v_mul_f32 v110, s40, v110
    v_mfma_f32_16x16x32_bf16 a[240:243], a[124:127], a[176:179], a[240:243]
    v_mul_f32 v111, s40, v111
    v_cvt_pk_bf16_f32 v28, v92, v93
    s_nop 7
    v_cvt_pk_bf16_f32 v29, v94, v95
    v_cvt_pk_bf16_f32 v30, v108, v109
    v_cvt_pk_bf16_f32 v31, v110, v111
    v_permlane16_swap_b32 v24, v26
    v_permlane16_swap_b32 v25, v27
    v_accvgpr_write_b32 a20, v20
    v_accvgpr_write_b32 a21, v21
    v_accvgpr_write_b32 a22, v22
    v_accvgpr_write_b32 a23, v23
    v_pk_mul_f32 v[112:113], v[112:113], s[40:41]
    v_pk_mul_f32 v[114:115], v[114:115], s[40:41]
    v_pk_mul_f32 v[128:129], v[128:129], s[40:41]
    v_pk_mul_f32 v[130:131], v[130:131], s[40:41]
    v_cvt_pk_bf16_f32 v16, v112, v113
    v_cvt_pk_bf16_f32 v17, v114, v115
    v_cvt_pk_bf16_f32 v18, v128, v129
    v_cvt_pk_bf16_f32 v19, v130, v131
    v_permlane16_swap_b32 v28, v30
    v_permlane16_swap_b32 v29, v31
    v_accvgpr_write_b32 a36, v24
    v_accvgpr_write_b32 a37, v25
    v_accvgpr_write_b32 a38, v26
    v_accvgpr_write_b32 a39, v27
    v_pk_mul_f32 v[116:117], v[116:117], s[40:41]
    v_pk_mul_f32 v[118:119], v[118:119], s[40:41]
    v_pk_mul_f32 v[132:133], v[132:133], s[40:41]
    v_pk_mul_f32 v[134:135], v[134:135], s[40:41]
    v_cvt_pk_bf16_f32 v20, v116, v117
    v_cvt_pk_bf16_f32 v21, v118, v119
    v_cvt_pk_bf16_f32 v22, v132, v133
    v_cvt_pk_bf16_f32 v23, v134, v135
    v_permlane16_swap_b32 v16, v18
    v_permlane16_swap_b32 v17, v19
    v_accvgpr_write_b32 a52, v28
    v_accvgpr_write_b32 a53, v29
    v_accvgpr_write_b32 a54, v30
    v_accvgpr_write_b32 a55, v31
    v_pk_mul_f32 v[120:121], v[120:121], s[40:41]
    v_pk_mul_f32 v[122:123], v[122:123], s[40:41]
    v_pk_mul_f32 v[136:137], v[136:137], s[40:41]
    v_pk_mul_f32 v[138:139], v[138:139], s[40:41]
    v_cvt_pk_bf16_f32 v24, v120, v121
    v_cvt_pk_bf16_f32 v25, v122, v123
    v_cvt_pk_bf16_f32 v26, v136, v137
    v_cvt_pk_bf16_f32 v27, v138, v139
    v_permlane16_swap_b32 v20, v22
    v_permlane16_swap_b32 v21, v23
    v_accvgpr_write_b32 a8, v16
    v_accvgpr_write_b32 a9, v17
    v_accvgpr_write_b32 a10, v18
    v_accvgpr_write_b32 a11, v19
    v_pk_mul_f32 v[124:125], v[124:125], s[40:41]
    v_pk_mul_f32 v[126:127], v[126:127], s[40:41]
    v_pk_mul_f32 v[140:141], v[140:141], s[40:41]
    v_pk_mul_f32 v[142:143], v[142:143], s[40:41]
    v_cvt_pk_bf16_f32 v28, v124, v125
    v_cvt_pk_bf16_f32 v29, v126, v127
    v_cvt_pk_bf16_f32 v30, v140, v141
    v_cvt_pk_bf16_f32 v31, v142, v143
    v_permlane16_swap_b32 v24, v26
    v_permlane16_swap_b32 v25, v27
    v_accvgpr_write_b32 a24, v20
    v_accvgpr_write_b32 a25, v21
    v_accvgpr_write_b32 a26, v22
    v_accvgpr_write_b32 a27, v23
    v_pk_mul_f32 v[144:145], v[144:145], s[40:41]
    v_pk_mul_f32 v[146:147], v[146:147], s[40:41]
    v_pk_mul_f32 v[160:161], v[160:161], s[40:41]
    v_pk_mul_f32 v[162:163], v[162:163], s[40:41]
    v_cvt_pk_bf16_f32 v16, v144, v145
    v_cvt_pk_bf16_f32 v17, v146, v147
    v_cvt_pk_bf16_f32 v18, v160, v161
    v_cvt_pk_bf16_f32 v19, v162, v163
    v_permlane16_swap_b32 v28, v30
    v_permlane16_swap_b32 v29, v31
    v_accvgpr_write_b32 a40, v24
    v_accvgpr_write_b32 a41, v25
    v_accvgpr_write_b32 a42, v26
    v_accvgpr_write_b32 a43, v27
    v_pk_mul_f32 v[148:149], v[148:149], s[40:41]
    v_pk_mul_f32 v[150:151], v[150:151], s[40:41]
    v_pk_mul_f32 v[164:165], v[164:165], s[40:41]
    v_pk_mul_f32 v[166:167], v[166:167], s[40:41]
    v_cvt_pk_bf16_f32 v20, v148, v149
    v_cvt_pk_bf16_f32 v21, v150, v151
    v_cvt_pk_bf16_f32 v22, v164, v165
    v_cvt_pk_bf16_f32 v23, v166, v167
    v_permlane16_swap_b32 v16, v18
    v_permlane16_swap_b32 v17, v19
    v_accvgpr_write_b32 a56, v28
    v_accvgpr_write_b32 a57, v29
    v_accvgpr_write_b32 a58, v30
    v_accvgpr_write_b32 a59, v31
    v_pk_mul_f32 v[152:153], v[152:153], s[40:41]
    v_pk_mul_f32 v[154:155], v[154:155], s[40:41]
    v_pk_mul_f32 v[168:169], v[168:169], s[40:41]
    v_pk_mul_f32 v[170:171], v[170:171], s[40:41]
    v_cvt_pk_bf16_f32 v24, v152, v153
    v_cvt_pk_bf16_f32 v25, v154, v155
    v_cvt_pk_bf16_f32 v26, v168, v169
    v_cvt_pk_bf16_f32 v27, v170, v171
    v_permlane16_swap_b32 v20, v22
    v_permlane16_swap_b32 v21, v23
    v_accvgpr_write_b32 a12, v16
    v_accvgpr_write_b32 a13, v17
    v_accvgpr_write_b32 a14, v18
    v_accvgpr_write_b32 a15, v19
    v_pk_mul_f32 v[156:157], v[156:157], s[40:41]
    v_pk_mul_f32 v[158:159], v[158:159], s[40:41]
    v_pk_mul_f32 v[172:173], v[172:173], s[40:41]
    v_pk_mul_f32 v[174:175], v[174:175], s[40:41]
    v_cvt_pk_bf16_f32 v28, v156, v157
    v_cvt_pk_bf16_f32 v29, v158, v159
    v_cvt_pk_bf16_f32 v30, v172, v173
    v_cvt_pk_bf16_f32 v31, v174, v175
    v_permlane16_swap_b32 v24, v26
    v_permlane16_swap_b32 v25, v27
    v_accvgpr_write_b32 a28, v20
    v_accvgpr_write_b32 a29, v21
    v_accvgpr_write_b32 a30, v22
    v_accvgpr_write_b32 a31, v23
    v_pk_mul_f32 v[176:177], v[176:177], s[40:41]
    v_pk_mul_f32 v[178:179], v[178:179], s[40:41]
    v_pk_mul_f32 v[192:193], v[192:193], s[40:41]
    v_pk_mul_f32 v[194:195], v[194:195], s[40:41]
    v_cvt_pk_bf16_f32 v16, v176, v177
    v_cvt_pk_bf16_f32 v17, v178, v179
    v_cvt_pk_bf16_f32 v18, v192, v193
    v_cvt_pk_bf16_f32 v19, v194, v195
    v_permlane16_swap_b32 v28, v30
    v_permlane16_swap_b32 v29, v31
    v_accvgpr_write_b32 a44, v24
    v_accvgpr_write_b32 a45, v25
    v_accvgpr_write_b32 a46, v26
    v_accvgpr_write_b32 a47, v27
    v_pk_mul_f32 v[180:181], v[180:181], s[40:41]
    v_pk_mul_f32 v[182:183], v[182:183], s[40:41]
    v_pk_mul_f32 v[196:197], v[196:197], s[40:41]
    v_pk_mul_f32 v[198:199], v[198:199], s[40:41]
    v_cvt_pk_bf16_f32 v20, v180, v181
    v_cvt_pk_bf16_f32 v21, v182, v183
    v_cvt_pk_bf16_f32 v22, v196, v197
    v_cvt_pk_bf16_f32 v23, v198, v199
    v_permlane16_swap_b32 v16, v18
    v_permlane16_swap_b32 v17, v19
    v_accvgpr_write_b32 a60, v28
    v_accvgpr_write_b32 a61, v29
    v_accvgpr_write_b32 a62, v30
    v_accvgpr_write_b32 a63, v31
    v_pk_mul_f32 v[184:185], v[184:185], s[40:41]
    v_pk_mul_f32 v[186:187], v[186:187], s[40:41]
    v_pk_mul_f32 v[200:201], v[200:201], s[40:41]
    v_pk_mul_f32 v[202:203], v[202:203], s[40:41]
    v_cvt_pk_bf16_f32 v24, v184, v185
    v_cvt_pk_bf16_f32 v25, v186, v187
    v_cvt_pk_bf16_f32 v26, v200, v201
    v_cvt_pk_bf16_f32 v27, v202, v203
    v_permlane16_swap_b32 v20, v22
    v_permlane16_swap_b32 v21, v23
    v_accvgpr_write_b32 a64, v16
    v_accvgpr_write_b32 a65, v17
    v_accvgpr_write_b32 a66, v18
    v_accvgpr_write_b32 a67, v19
    v_pk_mul_f32 v[188:189], v[188:189], s[40:41]
    v_pk_mul_f32 v[190:191], v[190:191], s[40:41]
    v_pk_mul_f32 v[204:205], v[204:205], s[40:41]
    v_pk_mul_f32 v[206:207], v[206:207], s[40:41]
    v_cvt_pk_bf16_f32 v28, v188, v189
    v_cvt_pk_bf16_f32 v29, v190, v191
    v_cvt_pk_bf16_f32 v30, v204, v205
    v_cvt_pk_bf16_f32 v31, v206, v207
    v_permlane16_swap_b32 v24, v26
    v_permlane16_swap_b32 v25, v27
    v_accvgpr_write_b32 a80, v20
    v_accvgpr_write_b32 a81, v21
    v_accvgpr_write_b32 a82, v22
    v_accvgpr_write_b32 a83, v23
    v_pk_mul_f32 v[208:209], v[208:209], s[40:41]
    v_pk_mul_f32 v[210:211], v[210:211], s[40:41]
    v_pk_mul_f32 v[224:225], v[224:225], s[40:41]
    v_pk_mul_f32 v[226:227], v[226:227], s[40:41]
    v_cvt_pk_bf16_f32 v16, v208, v209
    v_cvt_pk_bf16_f32 v17, v210, v211
    v_cvt_pk_bf16_f32 v18, v224, v225
    v_cvt_pk_bf16_f32 v19, v226, v227
    v_permlane16_swap_b32 v28, v30
    v_permlane16_swap_b32 v29, v31
    v_accvgpr_write_b32 a96, v24
    v_accvgpr_write_b32 a97, v25
    v_accvgpr_write_b32 a98, v26
    v_accvgpr_write_b32 a99, v27
    v_pk_mul_f32 v[212:213], v[212:213], s[40:41]
    v_pk_mul_f32 v[214:215], v[214:215], s[40:41]
    v_pk_mul_f32 v[228:229], v[228:229], s[40:41]
    v_pk_mul_f32 v[230:231], v[230:231], s[40:41]
    v_cvt_pk_bf16_f32 v20, v212, v213
    v_cvt_pk_bf16_f32 v21, v214, v215
    v_cvt_pk_bf16_f32 v22, v228, v229
    v_cvt_pk_bf16_f32 v23, v230, v231
    v_permlane16_swap_b32 v16, v18
    v_permlane16_swap_b32 v17, v19
    v_accvgpr_write_b32 a112, v28
    v_accvgpr_write_b32 a113, v29
    v_accvgpr_write_b32 a114, v30
    v_accvgpr_write_b32 a115, v31
    v_pk_mul_f32 v[216:217], v[216:217], s[40:41]
    v_pk_mul_f32 v[218:219], v[218:219], s[40:41]
    v_pk_mul_f32 v[232:233], v[232:233], s[40:41]
    v_pk_mul_f32 v[234:235], v[234:235], s[40:41]
    v_cvt_pk_bf16_f32 v24, v216, v217
    v_cvt_pk_bf16_f32 v25, v218, v219
    v_cvt_pk_bf16_f32 v26, v232, v233
    v_cvt_pk_bf16_f32 v27, v234, v235
    v_permlane16_swap_b32 v20, v22
    v_permlane16_swap_b32 v21, v23
    v_accvgpr_write_b32 a68, v16
    v_accvgpr_write_b32 a69, v17
    v_accvgpr_write_b32 a70, v18
    v_accvgpr_write_b32 a71, v19
    v_pk_mul_f32 v[220:221], v[220:221], s[40:41]
    v_pk_mul_f32 v[222:223], v[222:223], s[40:41]
    v_pk_mul_f32 v[236:237], v[236:237], s[40:41]
    v_pk_mul_f32 v[238:239], v[238:239], s[40:41]
    v_cvt_pk_bf16_f32 v28, v220, v221
    v_cvt_pk_bf16_f32 v29, v222, v223
    v_cvt_pk_bf16_f32 v30, v236, v237
    v_cvt_pk_bf16_f32 v31, v238, v239
    v_permlane16_swap_b32 v24, v26
    v_permlane16_swap_b32 v25, v27
    v_accvgpr_write_b32 a84, v20
    v_accvgpr_write_b32 a85, v21
    v_accvgpr_write_b32 a86, v22
    v_accvgpr_write_b32 a87, v23
    v_accvgpr_read_b32 v48, a208
    v_accvgpr_read_b32 v49, a209
    v_accvgpr_read_b32 v50, a210
    v_accvgpr_read_b32 v51, a211
    v_accvgpr_read_b32 v52, a212
    v_accvgpr_read_b32 v53, a213
    v_accvgpr_read_b32 v54, a214
    v_accvgpr_read_b32 v55, a215
    v_accvgpr_read_b32 v56, a216
    v_accvgpr_read_b32 v57, a217
    v_accvgpr_read_b32 v58, a218
    v_accvgpr_read_b32 v59, a219
    v_accvgpr_read_b32 v60, a220
    v_accvgpr_read_b32 v61, a221
    v_accvgpr_read_b32 v62, a222
    v_accvgpr_read_b32 v63, a223
    v_accvgpr_read_b32 v64, a224
    v_accvgpr_read_b32 v65, a225
    v_accvgpr_read_b32 v66, a226
    v_accvgpr_read_b32 v67, a227
    v_accvgpr_read_b32 v68, a228
    v_accvgpr_read_b32 v69, a229
    v_accvgpr_read_b32 v70, a230
    v_accvgpr_read_b32 v71, a231
    v_accvgpr_read_b32 v72, a232
    v_accvgpr_read_b32 v73, a233
    v_accvgpr_read_b32 v74, a234
    v_accvgpr_read_b32 v75, a235
    v_accvgpr_read_b32 v76, a236
    v_accvgpr_read_b32 v77, a237
    v_accvgpr_read_b32 v78, a238
    v_accvgpr_read_b32 v79, a239
    v_accvgpr_read_b32 v80, a240
    v_accvgpr_read_b32 v81, a241
    v_accvgpr_read_b32 v82, a242
    v_accvgpr_read_b32 v83, a243
    v_accvgpr_read_b32 v84, a244
    v_accvgpr_read_b32 v85, a245
    v_accvgpr_read_b32 v86, a246
    v_accvgpr_read_b32 v87, a247
    v_accvgpr_read_b32 v88, a248
    v_accvgpr_read_b32 v89, a249
    v_accvgpr_read_b32 v90, a250
    v_accvgpr_read_b32 v91, a251
    v_accvgpr_read_b32 v92, a252
    v_accvgpr_read_b32 v93, a253
    v_accvgpr_read_b32 v94, a254
    v_accvgpr_read_b32 v95, a255
    v_pk_mul_f32 v[240:241], v[240:241], s[40:41]
    v_pk_mul_f32 v[242:243], v[242:243], s[40:41]
    v_pk_mul_f32 v[48:49], v[48:49], s[40:41]
    v_pk_mul_f32 v[50:51], v[50:51], s[40:41]
    v_cvt_pk_bf16_f32 v16, v240, v241
    v_cvt_pk_bf16_f32 v17, v242, v243
    v_cvt_pk_bf16_f32 v18, v48, v49
    v_cvt_pk_bf16_f32 v19, v50, v51
    v_permlane16_swap_b32 v28, v30
    v_permlane16_swap_b32 v29, v31
    v_accvgpr_write_b32 a100, v24
    v_accvgpr_write_b32 a101, v25
    v_accvgpr_write_b32 a102, v26
    v_accvgpr_write_b32 a103, v27
    v_pk_mul_f32 v[244:245], v[244:245], s[40:41]
    v_pk_mul_f32 v[246:247], v[246:247], s[40:41]
    v_pk_mul_f32 v[52:53], v[52:53], s[40:41]
    v_pk_mul_f32 v[54:55], v[54:55], s[40:41]
    v_cvt_pk_bf16_f32 v20, v244, v245
    v_cvt_pk_bf16_f32 v21, v246, v247
    v_cvt_pk_bf16_f32 v22, v52, v53
    v_cvt_pk_bf16_f32 v23, v54, v55
    v_permlane16_swap_b32 v16, v18
    v_permlane16_swap_b32 v17, v19
    v_accvgpr_write_b32 a116, v28
    v_accvgpr_write_b32 a117, v29
    v_accvgpr_write_b32 a118, v30
    v_accvgpr_write_b32 a119, v31
    v_pk_mul_f32 v[248:249], v[248:249], s[40:41]
    v_pk_mul_f32 v[250:251], v[250:251], s[40:41]
    v_pk_mul_f32 v[56:57], v[56:57], s[40:41]
    v_pk_mul_f32 v[58:59], v[58:59], s[40:41]
    v_cvt_pk_bf16_f32 v24, v248, v249
    v_cvt_pk_bf16_f32 v25, v250, v251
    v_cvt_pk_bf16_f32 v26, v56, v57
    v_cvt_pk_bf16_f32 v27, v58, v59
    v_permlane16_swap_b32 v20, v22
    v_permlane16_swap_b32 v21, v23
    v_accvgpr_write_b32 a72, v16
    v_accvgpr_write_b32 a73, v17
    v_accvgpr_write_b32 a74, v18
    v_accvgpr_write_b32 a75, v19
    v_pk_mul_f32 v[252:253], v[252:253], s[40:41]
    v_pk_mul_f32 v[254:255], v[254:255], s[40:41]
    v_pk_mul_f32 v[60:61], v[60:61], s[40:41]
    v_pk_mul_f32 v[62:63], v[62:63], s[40:41]
    v_cvt_pk_bf16_f32 v28, v252, v253
    v_cvt_pk_bf16_f32 v29, v254, v255
    v_cvt_pk_bf16_f32 v30, v60, v61
    v_cvt_pk_bf16_f32 v31, v62, v63
    v_permlane16_swap_b32 v24, v26
    v_permlane16_swap_b32 v25, v27
    v_accvgpr_write_b32 a88, v20
    v_accvgpr_write_b32 a89, v21
    v_accvgpr_write_b32 a90, v22
    v_accvgpr_write_b32 a91, v23
    v_pk_mul_f32 v[64:65], v[64:65], s[40:41]
    v_pk_mul_f32 v[66:67], v[66:67], s[40:41]
    v_pk_mul_f32 v[80:81], v[80:81], s[40:41]
    v_pk_mul_f32 v[82:83], v[82:83], s[40:41]
    v_cvt_pk_bf16_f32 v16, v64, v65
    v_cvt_pk_bf16_f32 v17, v66, v67
    v_cvt_pk_bf16_f32 v18, v80, v81
    v_cvt_pk_bf16_f32 v19, v82, v83
    v_permlane16_swap_b32 v28, v30
    v_permlane16_swap_b32 v29, v31
    v_accvgpr_write_b32 a104, v24
    v_accvgpr_write_b32 a105, v25
    v_accvgpr_write_b32 a106, v26
    v_accvgpr_write_b32 a107, v27
    v_pk_mul_f32 v[68:69], v[68:69], s[40:41]
    v_pk_mul_f32 v[70:71], v[70:71], s[40:41]
    v_pk_mul_f32 v[84:85], v[84:85], s[40:41]
    v_pk_mul_f32 v[86:87], v[86:87], s[40:41]
    v_cvt_pk_bf16_f32 v20, v68, v69
    v_cvt_pk_bf16_f32 v21, v70, v71
    v_cvt_pk_bf16_f32 v22, v84, v85
    v_cvt_pk_bf16_f32 v23, v86, v87
    v_permlane16_swap_b32 v16, v18
    v_permlane16_swap_b32 v17, v19
    v_accvgpr_write_b32 a120, v28
    v_accvgpr_write_b32 a121, v29
    v_accvgpr_write_b32 a122, v30
    v_accvgpr_write_b32 a123, v31
    v_pk_mul_f32 v[72:73], v[72:73], s[40:41]
    v_pk_mul_f32 v[74:75], v[74:75], s[40:41]
    v_pk_mul_f32 v[88:89], v[88:89], s[40:41]
    v_pk_mul_f32 v[90:91], v[90:91], s[40:41]
    v_cvt_pk_bf16_f32 v24, v72, v73
    v_cvt_pk_bf16_f32 v25, v74, v75
    v_cvt_pk_bf16_f32 v26, v88, v89
    v_cvt_pk_bf16_f32 v27, v90, v91
    v_permlane16_swap_b32 v20, v22
    v_permlane16_swap_b32 v21, v23
    v_accvgpr_write_b32 a76, v16
    v_accvgpr_write_b32 a77, v17
    v_accvgpr_write_b32 a78, v18
    v_accvgpr_write_b32 a79, v19
    v_pk_mul_f32 v[76:77], v[76:77], s[40:41]
    v_pk_mul_f32 v[78:79], v[78:79], s[40:41]
    v_pk_mul_f32 v[92:93], v[92:93], s[40:41]
    v_pk_mul_f32 v[94:95], v[94:95], s[40:41]
    v_cvt_pk_bf16_f32 v28, v76, v77
    v_cvt_pk_bf16_f32 v29, v78, v79
    v_cvt_pk_bf16_f32 v30, v92, v93
    v_cvt_pk_bf16_f32 v31, v94, v95
    v_permlane16_swap_b32 v24, v26
    v_permlane16_swap_b32 v25, v27
    v_accvgpr_write_b32 a92, v20
    v_accvgpr_write_b32 a93, v21
    v_accvgpr_write_b32 a94, v22
    v_accvgpr_write_b32 a95, v23
    s_nop 1
    v_permlane16_swap_b32 v28, v30
    v_permlane16_swap_b32 v29, v31
    v_accvgpr_write_b32 a108, v24
    v_accvgpr_write_b32 a109, v25
    v_accvgpr_write_b32 a110, v26
    v_accvgpr_write_b32 a111, v27
    s_nop 0
    v_accvgpr_write_b32 a124, v28
    v_accvgpr_write_b32 a125, v29
    v_accvgpr_write_b32 a126, v30
    v_accvgpr_write_b32 a127, v31
    s_mov_b32 s39, 0x3f803f80
    s_bfe_u32 s3, s7, 0x10002
    s_lshr_b32 s4, s7, 3
    s_lshr_b32 s37, s45, 4
    s_lshl_b32 s37, s37, 22
    s_lshl_b32 s44, s3, 20
    s_add_u32 s37, s37, s44
    s_lshl_b32 s44, s4, 16
    s_add_u32 s37, s37, s44
    s_add_u32 s8, s46, s37
    s_addc_u32 s9, s47, 0
    s_and_b32 s9, s9, 0xffff
    s_mov_b32 s10, 0xf0000
    s_mov_b32 s11, 0x20000
    s_mov_b64 s[12:13], s[88:89]
    s_mov_b32 s14, 5242880
    s_lshl_b32 s37, s4, 6
    s_add_u32 s37, s37, s28
    s_mul_i32 s31, s37, 40960
    s_and_b32 s37, s7, 3
    s_mul_i32 s37, s37, 320
    s_add_u32 s31, s31, s37
    s_and_b32 s34, s7, 7
    s_lshl_b32 s34, s34, 13
    s_xor_b32 s37, s34, 0
    s_mul_i32 s37, s37, 40
    s_add_u32 s84, s37, s31
    s_xor_b32 s37, s34, 8192
    s_mul_i32 s37, s37, 40
    s_add_u32 s85, s37, s31
    s_xor_b32 s37, s34, 16384
    s_mul_i32 s37, s37, 40
    s_add_u32 s86, s37, s31
    s_xor_b32 s37, s34, 24576
    s_mul_i32 s37, s37, 40
    s_add_u32 s87, s37, s31
    s_xor_b32 s37, s34, 32768
    s_mul_i32 s37, s37, 40
    s_add_u32 s88, s37, s31
    s_xor_b32 s37, s34, 40960
    s_mul_i32 s37, s37, 40
    s_add_u32 s89, s37, s31
    s_xor_b32 s37, s34, 49152
    s_mul_i32 s37, s37, 40
    s_add_u32 s90, s37, s31
    s_xor_b32 s37, s34, 57344
    s_mul_i32 s37, s37, 40
    s_add_u32 s91, s37, s31
    s_lshl_b32 s37, s28, 2
    s_lshr_b32 s44, 0xfed, s37
    s_and_b32 s44, s44, 15
    s_mul_i32 s92, s44, 10240
    s_lshr_b32 s44, 0x9821, s37
    s_and_b32 s44, s44, 15
    s_mul_i32 s93, s44, 10240
    s_lshr_b32 s44, 0x54a3, s37
    s_and_b32 s44, s44, 15
    s_mul_i32 s94, s44, 10240
    s_lshr_b32 s44, 0xcb76, s37
    s_and_b32 s44, s44, 15
    s_mul_i32 s95, s44, 10240
    v_bfe_u32 v16, v14, 4, 6
    s_and_b32 s3, s7, 1
    s_xor_b32 s4, s4, 1
    v_lshrrev_b32 v17, 3, v16
    v_mul_u32_u24 v17, 1280, v17
    v_lshrrev_b32 v18, 3, v16
    v_and_b32 v18, 6, v18
    v_and_b32 v19, 7, v16
    v_xor_b32 v18, v18, v19
    v_lshl_add_u32 v17, v18, 4, v17
    s_xor_b32 s37, s4, 0
    s_lshl_b32 s37, s37, 1
    s_add_u32 s37, s37, s3
    s_lshl_b32 s37, s37, 6
    v_add_u32 v18, s37, v17
    v_accvgpr_write_b32 a212, v18
    s_add_u32 s37, s37, 9216
    v_add_u32 v18, s37, v17
    v_accvgpr_write_b32 a213, v18
    s_add_u32 s37, s37, 9216
    v_add_u32 v18, s37, v17
    v_accvgpr_write_b32 a214, v18
    s_add_u32 s37, s37, 9216
    v_add_u32 v18, s37, v17
    v_accvgpr_write_b32 a215, v18
    s_xor_b32 s37, s4, 1
    s_lshl_b32 s37, s37, 1
    s_add_u32 s37, s37, s3
    s_lshl_b32 s37, s37, 6
    v_add_u32 v18, s37, v17
    v_accvgpr_write_b32 a217, v18
    s_add_u32 s37, s37, 9216
    v_add_u32 v18, s37, v17
    v_accvgpr_write_b32 a218, v18
    s_add_u32 s37, s37, 9216
    v_add_u32 v18, s37, v17
    v_accvgpr_write_b32 a219, v18
    s_add_u32 s37, s37, 9216
    v_add_u32 v18, s37, v17
    v_accvgpr_write_b32 a220, v18
    v_lshrrev_b32 v17, 2, v16
    v_mul_u32_u24 v17, 1280, v17
    v_bfe_u32 v18, v16, 4, 1
    v_xor_b32 v18, s4, v18
    v_lshlrev_b32 v18, 1, v18
    v_and_b32 v19, 3, v16
    v_xor_b32 v18, v18, v19
    v_lshl_add_u32 v17, v18, 4, v17
    s_xor_b32 s3, s3, 1
    s_lshl_b32 s3, s3, 8
    v_add_u32 v17, s3, v17
    v_add_u32 v18, 19456, v17
    v_accvgpr_write_b32 a216, v17
    v_accvgpr_write_b32 a221, v18
    s_and_b32 s37, s45, 127
    s_mul_i32 s37, s37, 10240
    s_mul_i32 s65, s28, 786432
    s_add_u32 s65, s65, s37
    s_add_u32 s64, s65, 9216
    s_and_b32 s37, s45, 0xf0
    v_and_b32 v17, 3, v16
    v_lshlrev_b32 v17, 2, v17
    v_add_u32 v17, s37, v17
    v_accvgpr_write_b32 a222, v17
    v_lshrrev_b32 v17, 4, v16
    v_xor_b32 v17, v17, v16
    v_bfe_i32 v17, v17, 1, 1
    v_bfi_b32 v17, v17, 0, s39
    v_accvgpr_write_b32 a208, v17
    v_accvgpr_write_b32 a209, v17
    v_accvgpr_write_b32 a210, v17
    v_accvgpr_write_b32 a211, v17
    v_bfe_i32 v17, v16, 0, 1
    v_and_b32 v17, 0xaaaaaaaa, v17
    v_or_b32 v15, 0x44444444, v17
    s_barrier
    s_mov_b32 s36, 0
L_unit:
    s_mov_b32 s35, 3
L_first_0:
    ds_read_b128 a[160:163], v1 offset:0
    ds_read_b128 a[164:167], v2 offset:0
    ds_read_b128 a[168:171], v3 offset:0
    ds_read_b128 a[172:175], v4 offset:0
    ds_read_b128 a[176:179], v1 offset:1024
    ds_read_b128 a[180:183], v2 offset:1024
    ds_read_b128 a[184:187], v3 offset:1024
    ds_read_b128 a[188:191], v4 offset:1024
    ds_read_b128 a[128:131], v1 offset:2048
    ds_read_b128 a[132:135], v2 offset:2048
    ds_read_b128 a[136:139], v3 offset:2048
    ds_read_b128 a[140:143], v4 offset:2048
    ds_read_b128 a[144:147], v1 offset:3072
    ds_read_b128 a[148:151], v2 offset:3072
    ds_read_b128 a[152:155], v3 offset:3072
    ds_read_b128 a[156:159], v4 offset:3072
    s_cmp_eq_u32 s36, 0
    s_cbranch_scc1 L_nomv
    v_accvgpr_mov_b32 a0, a64
    v_accvgpr_mov_b32 a1, a65
    v_accvgpr_mov_b32 a2, a66
    v_accvgpr_mov_b32 a3, a67
    v_accvgpr_mov_b32 a4, a68
    v_accvgpr_mov_b32 a5, a69
    v_accvgpr_mov_b32 a6, a70
    v_accvgpr_mov_b32 a7, a71
    v_accvgpr_mov_b32 a8, a72
    v_accvgpr_mov_b32 a9, a73
    v_accvgpr_mov_b32 a10, a74
    v_accvgpr_mov_b32 a11, a75
    v_accvgpr_mov_b32 a12, a76
    v_accvgpr_mov_b32 a13, a77
    v_accvgpr_mov_b32 a14, a78
    v_accvgpr_mov_b32 a15, a79
    v_accvgpr_mov_b32 a16, a80
    v_accvgpr_mov_b32 a17, a81
    v_accvgpr_mov_b32 a18, a82
    v_accvgpr_mov_b32 a19, a83
    v_accvgpr_mov_b32 a20, a84
    v_accvgpr_mov_b32 a21, a85
    v_accvgpr_mov_b32 a22, a86
    v_accvgpr_mov_b32 a23, a87
    v_accvgpr_mov_b32 a24, a88
    v_accvgpr_mov_b32 a25, a89
    v_accvgpr_mov_b32 a26, a90
    v_accvgpr_mov_b32 a27, a91
    v_accvgpr_mov_b32 a28, a92
    v_accvgpr_mov_b32 a29, a93
    v_accvgpr_mov_b32 a30, a94
    v_accvgpr_mov_b32 a31, a95
    v_accvgpr_mov_b32 a32, a96
    v_accvgpr_mov_b32 a33, a97
    v_accvgpr_mov_b32 a34, a98
    v_accvgpr_mov_b32 a35, a99
    v_accvgpr_mov_b32 a36, a100
    v_accvgpr_mov_b32 a37, a101
    v_accvgpr_mov_b32 a38, a102
    v_accvgpr_mov_b32 a39, a103
    v_accvgpr_mov_b32 a40, a104
    v_accvgpr_mov_b32 a41, a105
    v_accvgpr_mov_b32 a42, a106
    v_accvgpr_mov_b32 a43, a107
    v_accvgpr_mov_b32 a44, a108
    v_accvgpr_mov_b32 a45, a109
    v_accvgpr_mov_b32 a46, a110
    v_accvgpr_mov_b32 a47, a111
    v_accvgpr_mov_b32 a48, a112
    v_accvgpr_mov_b32 a49, a113
    v_accvgpr_mov_b32 a50, a114
    v_accvgpr_mov_b32 a51, a115
    v_accvgpr_mov_b32 a52, a116
    v_accvgpr_mov_b32 a53, a117
    v_accvgpr_mov_b32 a54, a118
    v_accvgpr_mov_b32 a55, a119
    v_accvgpr_mov_b32 a56, a120
    v_accvgpr_mov_b32 a57, a121
    v_accvgpr_mov_b32 a58, a122
    v_accvgpr_mov_b32 a59, a123
    v_accvgpr_mov_b32 a60, a124
    v_accvgpr_mov_b32 a61, a125
    v_accvgpr_mov_b32 a62, a126
    v_accvgpr_mov_b32 a63, a127
    v_accvgpr_write_b32 a80, v48
    v_accvgpr_write_b32 a81, v49
    v_accvgpr_write_b32 a82, v50
    v_accvgpr_write_b32 a83, v51
    v_accvgpr_write_b32 a84, v52
    v_accvgpr_write_b32 a85, v53
    v_accvgpr_write_b32 a86, v54
    v_accvgpr_write_b32 a87, v55
    v_accvgpr_write_b32 a88, v56
    v_accvgpr_write_b32 a89, v57
    v_accvgpr_write_b32 a90, v58
    v_accvgpr_write_b32 a91, v59
    v_accvgpr_write_b32 a92, v60
    v_accvgpr_write_b32 a93, v61
    v_accvgpr_write_b32 a94, v62
    v_accvgpr_write_b32 a95, v63
    v_accvgpr_write_b32 a96, v64
    v_accvgpr_write_b32 a97, v65
    v_accvgpr_write_b32 a98, v66
    v_accvgpr_write_b32 a99, v67
    v_accvgpr_write_b32 a100, v68
    v_accvgpr_write_b32 a101, v69
    v_accvgpr_write_b32 a102, v70
    v_accvgpr_write_b32 a103, v71
    v_accvgpr_write_b32 a104, v72
    v_accvgpr_write_b32 a105, v73
    v_accvgpr_write_b32 a106, v74
    v_accvgpr_write_b32 a107, v75
    v_accvgpr_write_b32 a108, v76
    v_accvgpr_write_b32 a109, v77
    v_accvgpr_write_b32 a110, v78
    v_accvgpr_write_b32 a111, v79
    v_accvgpr_write_b32 a112, v80
    v_accvgpr_write_b32 a113, v81
    v_accvgpr_write_b32 a114, v82
    v_accvgpr_write_b32 a115, v83
    v_accvgpr_write_b32 a116, v84
    v_accvgpr_write_b32 a117, v85
    v_accvgpr_write_b32 a118, v86
    v_accvgpr_write_b32 a119, v87
    v_accvgpr_write_b32 a120, v88
    v_accvgpr_write_b32 a121, v89
    v_accvgpr_write_b32 a122, v90
    v_accvgpr_write_b32 a123, v91
    v_accvgpr_write_b32 a124, v92
    v_accvgpr_write_b32 a125, v93
    v_accvgpr_write_b32 a126, v94
    v_accvgpr_write_b32 a127, v95
L_nomv:
    s_waitcnt lgkmcnt(14)
    v_mfma_f32_16x16x32_bf16 v[32:35], a[160:163], a[0:3], 0
    v_mfma_f32_16x16x32_bf16 v[32:35], a[164:167], a[4:7], v[32:35]
    s_waitcnt lgkmcnt(12)
    v_mfma_f32_16x16x32_bf16 v[32:35], a[168:171], a[8:11], v[32:35]
    v_mfma_f32_16x16x32_bf16 v[32:35], a[172:175], a[12:15], v[32:35]
    s_waitcnt lgkmcnt(10)
    v_mfma_f32_16x16x32_bf16 v[36:39], a[176:179], a[0:3], 0
    v_mfma_f32_16x16x32_bf16 v[36:39], a[180:183], a[4:7], v[36:39]
    s_waitcnt lgkmcnt(8)
    v_mfma_f32_16x16x32_bf16 v[36:39], a[184:187], a[8:11], v[36:39]
    s_add_u32 m0, s29, 0
    v_mfma_f32_16x16x32_bf16 v[36:39], a[188:191], a[12:15], v[36:39]
    s_waitcnt vmcnt(20) lgkmcnt(0)
    s_barrier
    v_mfma_f32_16x16x32_bf16 v[40:43], a[160:163], a[16:19], 0
    v_mfma_f32_16x16x32_bf16 v[40:43], a[164:167], a[20:23], v[40:43]
    buffer_load_dwordx4 v13, s[16:19], s32 offen offset:0 nt lds
    v_mfma_f32_16x16x32_bf16 v[40:43], a[168:171], a[24:27], v[40:43]
    buffer_load_dwordx4 v13, s[16:19], s32 offen offset:1024 nt lds
    v_mfma_f32_16x16x32_bf16 v[40:43], a[172:175], a[28:31], v[40:43]
    buffer_load_dwordx4 v13, s[16:19], s32 offen offset:2048 nt lds
    v_mfma_f32_16x16x32_bf16 v[44:47], a[176:179], a[16:19], 0
    buffer_load_dwordx4 v13, s[16:19], s32 offen offset:3072 nt lds
    s_add_u32 m0, s30, 0
    v_mfma_f32_16x16x32_bf16 v[44:47], a[180:183], a[20:23], v[44:47]
    buffer_load_dwordx4 v13, s[20:23], s33 offen offset:0 nt lds
    v_mfma_f32_16x16x32_bf16 v[44:47], a[184:187], a[24:27], v[44:47]
    buffer_load_dwordx4 v13, s[20:23], s33 offen offset:1024 nt lds
    v_mfma_f32_16x16x32_bf16 v[44:47], a[188:191], a[28:31], v[44:47]
    buffer_load_dwordx4 v13, s[20:23], s33 offen offset:2048 nt lds
    v_mfma_f32_16x16x32_bf16 v[48:51], a[160:163], a[32:35], 0
    buffer_load_dwordx4 v13, s[20:23], s33 offen offset:3072 nt lds
    v_mfma_f32_16x16x32_bf16 v[48:51], a[164:167], a[36:39], v[48:51]
    s_add_u32 s32, s32, 0x4000
    s_add_u32 s33, s33, 0x4000
    v_accvgpr_write_b32 a192, 0
    v_mfma_f32_16x16x32_bf16 v[48:51], a[168:171], a[40:43], v[48:51]
    v_accvgpr_write_b32 a193, 0
    v_accvgpr_write_b32 a194, 0
    v_mfma_f32_16x16x32_bf16 v[48:51], a[172:175], a[44:47], v[48:51]
    v_max3_f32 v128, v32, v33, v34
    v_max3_f32 v130, v40, v41, v42
    v_mfma_f32_16x16x32_bf16 v[52:55], a[176:179], a[32:35], 0
    v_max3_f32 v129, v35, v36, v37
    v_max3_f32 v131, v43, v44, v45
    v_mfma_f32_16x16x32_bf16 v[52:55], a[180:183], a[36:39], v[52:55]
    v_max3_f32 v128, v128, v38, v39
    v_max3_f32 v130, v130, v46, v47
    v_mfma_f32_16x16x32_bf16 v[52:55], a[184:187], a[40:43], v[52:55]
    v_max_f32 v128, v128, v129
    v_max_f32 v130, v130, v131
    v_mov_b32 v129, v128
    v_mfma_f32_16x16x32_bf16 v[52:55], a[188:191], a[44:47], v[52:55]
    v_mov_b32 v131, v130
    s_nop 0
    v_permlane32_swap_b32 v128, v129
    v_mfma_f32_16x16x32_bf16 v[56:59], a[160:163], a[48:51], 0
    v_permlane32_swap_b32 v130, v131
    v_max_f32 v128, v128, v129
    v_max_f32 v130, v130, v131
    v_mfma_f32_16x16x32_bf16 v[56:59], a[164:167], a[52:55], v[56:59]
    v_mov_b32 v129, v128
    v_mov_b32 v131, v130
    s_nop 0
    v_mfma_f32_16x16x32_bf16 v[56:59], a[168:171], a[56:59], v[56:59]
    v_permlane16_swap_b32 v128, v129
    v_permlane16_swap_b32 v130, v131
    v_mfma_f32_16x16x32_bf16 v[56:59], a[172:175], a[60:63], v[56:59]
    v_max_f32 v128, v128, v129
    v_max_f32 v130, v130, v131
    v_sub_f32 v16, 0, v128
    v_mfma_f32_16x16x32_bf16 v[60:63], a[176:179], a[48:51], 0
    v_sub_f32 v17, 0, v128
    v_sub_f32 v18, 0, v128
    v_sub_f32 v19, 0, v128
    v_mfma_f32_16x16x32_bf16 v[60:63], a[180:183], a[52:55], v[60:63]
    v_sub_f32 v20, 0, v130
    v_sub_f32 v21, 0, v130
    v_sub_f32 v22, 0, v130
    v_mfma_f32_16x16x32_bf16 v[60:63], a[184:187], a[56:59], v[60:63]
    v_sub_f32 v23, 0, v130
    v_accvgpr_write_b32 a195, 0
    v_accvgpr_write_b32 a196, 0
    v_mfma_f32_16x16x32_bf16 v[60:63], a[188:191], a[60:63], v[60:63]
    v_accvgpr_write_b32 a197, 0
    v_accvgpr_write_b32 a198, 0
    v_accvgpr_write_b32 a199, 0
    s_nop 1
    v_mfma_f32_16x16x32_bf16 v[64:67], a[128:131], a[0:3], v[16:19]
    v_sub_f32 v32, v32, v128
    v_sub_f32 v33, v33, v128
    v_sub_f32 v34, v34, v128
    v_mfma_f32_16x16x32_bf16 v[64:67], a[132:135], a[4:7], v[64:67]
    ds_read_b64_tr_b16 a[160:161], v5 offset:16384
    v_sub_f32 v35, v35, v128
    v_sub_f32 v36, v36, v128
    v_mfma_f32_16x16x32_bf16 v[64:67], a[136:139], a[8:11], v[64:67]
    v_sub_f32 v37, v37, v128
    v_sub_f32 v38, v38, v128
    v_sub_f32 v39, v39, v128
    v_mfma_f32_16x16x32_bf16 v[64:67], a[140:143], a[12:15], v[64:67]
    ds_read_b64_tr_b16 a[162:163], v5 offset:17408
    v_max3_f32 v132, v48, v49, v50
    v_mfma_f32_16x16x32_bf16 v[68:71], a[144:147], a[0:3], v[16:19]
    v_max3_f32 v134, v56, v57, v58
    v_max3_f32 v133, v51, v52, v53
    v_mfma_f32_16x16x32_bf16 v[68:71], a[148:151], a[4:7], v[68:71]
    ds_read_b64_tr_b16 a[164:165], v6 offset:16384
    v_max3_f32 v135, v59, v60, v61
    v_mfma_f32_16x16x32_bf16 v[68:71], a[152:155], a[8:11], v[68:71]
    v_max3_f32 v132, v132, v54, v55
    v_max3_f32 v134, v134, v62, v63
    v_mfma_f32_16x16x32_bf16 v[68:71], a[156:159], a[12:15], v[68:71]
    ds_read_b64_tr_b16 a[166:167], v6 offset:17408
    v_max_f32 v132, v132, v133
    v_max_f32 v134, v134, v135
    v_mfma_f32_16x16x32_bf16 v[72:75], a[128:131], a[16:19], v[20:23]
    v_mov_b32 v133, v132
    v_mov_b32 v135, v134
    s_nop 0
    v_mfma_f32_16x16x32_bf16 v[72:75], a[132:135], a[20:23], v[72:75]
    ds_read_b64_tr_b16 a[168:169], v7 offset:16384
    v_permlane32_swap_b32 v132, v133
    v_mfma_f32_16x16x32_bf16 v[72:75], a[136:139], a[24:27], v[72:75]
    v_permlane32_swap_b32 v134, v135
    v_max_f32 v132, v132, v133
    v_max_f32 v134, v134, v135
    v_mfma_f32_16x16x32_bf16 v[72:75], a[140:143], a[28:31], v[72:75]
    ds_read_b64_tr_b16 a[170:171], v7 offset:17408
    v_mov_b32 v133, v132
    v_mov_b32 v135, v134
    v_mfma_f32_16x16x32_bf16 v[76:79], a[144:147], a[16:19], v[20:23]
    s_nop 0
    v_permlane16_swap_b32 v132, v133
    v_mfma_f32_16x16x32_bf16 v[76:79], a[148:151], a[20:23], v[76:79]
    ds_read_b64_tr_b16 a[172:173], v8 offset:16384
    v_permlane16_swap_b32 v134, v135
    v_max_f32 v132, v132, v133
    v_mfma_f32_16x16x32_bf16 v[76:79], a[152:155], a[24:27], v[76:79]
    v_max_f32 v134, v134, v135
    v_sub_f32 v24, 0, v132
    v_sub_f32 v25, 0, v132
    v_mfma_f32_16x16x32_bf16 v[76:79], a[156:159], a[28:31], v[76:79]
    ds_read_b64_tr_b16 a[174:175], v8 offset:17408
    v_sub_f32 v26, 0, v132
    v_sub_f32 v27, 0, v132
    v_sub_f32 v28, 0, v134
    v_sub_f32 v29, 0, v134
    v_sub_f32 v30, 0, v134
    v_sub_f32 v31, 0, v134
    s_nop 1
    v_mfma_f32_16x16x32_bf16 v[80:83], a[128:131], a[32:35], v[24:27]
    v_sub_f32 v40, v40, v130
    v_sub_f32 v41, v41, v130
    v_sub_f32 v42, v42, v130
    v_mfma_f32_16x16x32_bf16 v[80:83], a[132:135], a[36:39], v[80:83]
    ds_read_b64_tr_b16 a[176:177], v9 offset:16384
    v_sub_f32 v43, v43, v130
    v_sub_f32 v44, v44, v130
    v_mfma_f32_16x16x32_bf16 v[80:83], a[136:139], a[40:43], v[80:83]
    v_sub_f32 v45, v45, v130
    v_sub_f32 v46, v46, v130
    v_sub_f32 v47, v47, v130
    v_mfma_f32_16x16x32_bf16 v[80:83], a[140:143], a[44:47], v[80:83]
    ds_read_b64_tr_b16 a[178:179], v9 offset:17408
    v_exp_f32 v32, v32
    v_mfma_f32_16x16x32_bf16 v[84:87], a[144:147], a[32:35], v[24:27]
    v_exp_f32 v33, v33
    v_mfma_f32_16x16x32_bf16 v[84:87], a[148:151], a[36:39], v[84:87]
    ds_read_b64_tr_b16 a[180:181], v10 offset:16384
    v_exp_f32 v34, v34
    v_mfma_f32_16x16x32_bf16 v[84:87], a[152:155], a[40:43], v[84:87]
    v_cvt_pk_bf16_f32 v96, v32, v33
    v_exp_f32 v35, v35
    v_mfma_f32_16x16x32_bf16 v[84:87], a[156:159], a[44:47], v[84:87]
    ds_read_b64_tr_b16 a[182:183], v10 offset:17408
    v_exp_f32 v36, v36
    v_mfma_f32_16x16x32_bf16 v[88:91], a[128:131], a[48:51], v[28:31]
    v_cvt_pk_bf16_f32 v97, v34, v35
    v_exp_f32 v37, v37
    v_mfma_f32_16x16x32_bf16 v[88:91], a[132:135], a[52:55], v[88:91]
    ds_read_b64_tr_b16 a[184:185], v11 offset:16384
    v_exp_f32 v38, v38
    v_mfma_f32_16x16x32_bf16 v[88:91], a[136:139], a[56:59], v[88:91]
    v_cvt_pk_bf16_f32 v98, v36, v37
    v_exp_f32 v39, v39
    v_mfma_f32_16x16x32_bf16 v[88:91], a[140:143], a[60:63], v[88:91]
    ds_read_b64_tr_b16 a[186:187], v11 offset:17408
    v_exp_f32 v40, v40
    v_mfma_f32_16x16x32_bf16 v[92:95], a[144:147], a[48:51], v[28:31]
    v_cvt_pk_bf16_f32 v99, v38, v39
    v_exp_f32 v41, v41
    v_mfma_f32_16x16x32_bf16 v[92:95], a[148:151], a[52:55], v[92:95]
    ds_read_b64_tr_b16 a[188:189], v12 offset:16384
    v_exp_f32 v42, v42
    v_mfma_f32_16x16x32_bf16 v[92:95], a[152:155], a[56:59], v[92:95]
    v_cvt_pk_bf16_f32 v100, v40, v41
    v_exp_f32 v43, v43
    v_mfma_f32_16x16x32_bf16 v[92:95], a[156:159], a[60:63], v[92:95]
    ds_read_b64_tr_b16 a[190:191], v12 offset:17408
    v_exp_f32 v44, v44
    v_cvt_pk_bf16_f32 v101, v42, v43
    v_exp_f32 v45, v45
    v_exp_f32 v46, v46
    v_cvt_pk_bf16_f32 v102, v44, v45
    v_exp_f32 v47, v47
    v_sub_f32 v48, v48, v132
    v_sub_f32 v49, v49, v132
    v_sub_f32 v50, v50, v132
    v_sub_f32 v51, v51, v132
    v_sub_f32 v52, v52, v132
    v_sub_f32 v53, v53, v132
    v_sub_f32 v54, v54, v132
    v_sub_f32 v55, v55, v132
    v_sub_f32 v56, v56, v134
    v_sub_f32 v57, v57, v134
    v_sub_f32 v58, v58, v134
    v_sub_f32 v59, v59, v134
    v_sub_f32 v60, v60, v134
    v_sub_f32 v61, v61, v134
    v_sub_f32 v62, v62, v134
    v_sub_f32 v63, v63, v134
    v_exp_f32 v48, v48
    v_cvt_pk_bf16_f32 v103, v46, v47
    v_exp_f32 v49, v49
    v_exp_f32 v50, v50
    v_cvt_pk_bf16_f32 v104, v48, v49
    v_exp_f32 v51, v51
    v_exp_f32 v52, v52
    v_cvt_pk_bf16_f32 v105, v50, v51
    v_exp_f32 v53, v53
    v_exp_f32 v54, v54
    v_cvt_pk_bf16_f32 v106, v52, v53
    v_exp_f32 v55, v55
    v_exp_f32 v56, v56
    v_cvt_pk_bf16_f32 v107, v54, v55
    v_exp_f32 v57, v57
    v_exp_f32 v58, v58
    v_cvt_pk_bf16_f32 v108, v56, v57
    v_exp_f32 v59, v59
    v_exp_f32 v60, v60
    v_cvt_pk_bf16_f32 v109, v58, v59
    v_exp_f32 v61, v61
    v_exp_f32 v62, v62
    v_cvt_pk_bf16_f32 v110, v60, v61
    v_exp_f32 v63, v63
    s_nop 0
    v_cvt_pk_bf16_f32 v111, v62, v63
    v_exp_f32 v64, v64
    v_exp_f32 v65, v65
    v_exp_f32 v66, v66
    v_cvt_pk_bf16_f32 v112, v64, v65
    v_exp_f32 v67, v67
    v_exp_f32 v68, v68
    v_cvt_pk_bf16_f32 v113, v66, v67
    v_exp_f32 v69, v69
    s_nop 0
    v_cvt_pk_bf16_f32 v114, v68, v69
    s_nop 1
    s_waitcnt lgkmcnt(0)
    v_mfma_f32_16x16x32_bf16 v[128:131], a[160:163], v[96:99], 0
    v_exp_f32 v70, v70
    v_mfma_f32_16x16x32_bf16 v[160:163], a[160:163], v[100:103], 0
    ds_read_b128 a[128:131], v1 offset:16384
    v_mfma_f32_16x16x32_bf16 v[192:195], a[160:163], v[104:107], 0
    v_exp_f32 v71, v71
    v_mfma_f32_16x16x32_bf16 v[224:227], a[160:163], v[108:111], 0
    ds_read_b128 a[132:135], v2 offset:16384
    v_cvt_pk_bf16_f32 v115, v70, v71
    v_mfma_f32_16x16x32_bf16 v[228:231], a[164:167], v[108:111], 0
    v_exp_f32 v72, v72
    v_mfma_f32_16x16x32_bf16 v[196:199], a[164:167], v[104:107], 0
    ds_read_b128 a[136:139], v3 offset:16384
    v_mfma_f32_16x16x32_bf16 v[164:167], a[164:167], v[100:103], 0
    v_exp_f32 v73, v73
    v_mfma_f32_16x16x32_bf16 v[132:135], a[164:167], v[96:99], 0
    ds_read_b128 a[140:143], v4 offset:16384
    v_cvt_pk_bf16_f32 v116, v72, v73
    v_mfma_f32_16x16x32_bf16 v[136:139], a[168:171], v[96:99], 0
    v_exp_f32 v74, v74
    v_mfma_f32_16x16x32_bf16 v[168:171], a[168:171], v[100:103], 0
    ds_read_b128 a[144:147], v1 offset:17408
    v_mfma_f32_16x16x32_bf16 v[200:203], a[168:171], v[104:107], 0
    v_exp_f32 v75, v75
    v_mfma_f32_16x16x32_bf16 v[232:235], a[168:171], v[108:111], 0
    ds_read_b128 a[148:151], v2 offset:17408
    v_cvt_pk_bf16_f32 v117, v74, v75
    v_mfma_f32_16x16x32_bf16 v[236:239], a[172:175], v[108:111], 0
    v_exp_f32 v76, v76
    v_mfma_f32_16x16x32_bf16 v[204:207], a[172:175], v[104:107], 0
    ds_read_b128 a[152:155], v3 offset:17408
    v_mfma_f32_16x16x32_bf16 v[172:175], a[172:175], v[100:103], 0
    v_exp_f32 v77, v77
    v_mfma_f32_16x16x32_bf16 v[140:143], a[172:175], v[96:99], 0
    ds_read_b128 a[156:159], v4 offset:17408
    v_cvt_pk_bf16_f32 v118, v76, v77
    v_smfmac_f32_16x16x64_bf16 a[192:195], a[208:211], v[96:103], v15
    v_exp_f32 v78, v78
    v_mfma_f32_16x16x32_bf16 v[144:147], a[176:179], v[96:99], 0
    ds_read_b64_tr_b16 a[160:161], v5 offset:18432
    v_mfma_f32_16x16x32_bf16 v[176:179], a[176:179], v[100:103], 0
    v_exp_f32 v79, v79
    v_mfma_f32_16x16x32_bf16 v[208:211], a[176:179], v[104:107], 0
    ds_read_b64_tr_b16 a[162:163], v5 offset:19456
    v_cvt_pk_bf16_f32 v119, v78, v79
    v_mfma_f32_16x16x32_bf16 v[240:243], a[176:179], v[108:111], 0
    v_exp_f32 v80, v80
    v_mfma_f32_16x16x32_bf16 v[244:247], a[180:183], v[108:111], 0
    ds_read_b64_tr_b16 a[164:165], v6 offset:18432
    v_mfma_f32_16x16x32_bf16 v[212:215], a[180:183], v[104:107], 0
    v_exp_f32 v81, v81
    v_mfma_f32_16x16x32_bf16 v[180:183], a[180:183], v[100:103], 0
    ds_read_b64_tr_b16 a[166:167], v6 offset:19456
    v_cvt_pk_bf16_f32 v120, v80, v81
    v_mfma_f32_16x16x32_bf16 v[148:151], a[180:183], v[96:99], 0
    v_exp_f32 v82, v82
    v_mfma_f32_16x16x32_bf16 v[152:155], a[184:187], v[96:99], 0
    ds_read_b64_tr_b16 a[168:169], v7 offset:18432
    s_waitcnt lgkmcnt(5)
    v_mfma_f32_16x16x32_bf16 v[184:187], a[184:187], v[100:103], 0
    v_exp_f32 v83, v83
    v_mfma_f32_16x16x32_bf16 v[216:219], a[184:187], v[104:107], 0
    ds_read_b64_tr_b16 a[170:171], v7 offset:19456
    v_cvt_pk_bf16_f32 v121, v82, v83
    v_mfma_f32_16x16x32_bf16 v[248:251], a[184:187], v[108:111], 0
    v_exp_f32 v84, v84
    v_mfma_f32_16x16x32_bf16 v[252:255], a[188:191], v[108:111], 0
    ds_read_b64_tr_b16 a[172:173], v8 offset:18432
    v_mfma_f32_16x16x32_bf16 v[220:223], a[188:191], v[104:107], 0
    v_exp_f32 v85, v85
    v_mfma_f32_16x16x32_bf16 v[188:191], a[188:191], v[100:103], 0
    ds_read_b64_tr_b16 a[174:175], v8 offset:19456
    v_cvt_pk_bf16_f32 v122, v84, v85
    v_mfma_f32_16x16x32_bf16 v[156:159], a[188:191], v[96:99], 0
    v_exp_f32 v86, v86
    v_smfmac_f32_16x16x64_bf16 a[196:199], a[208:211], v[104:111], v15
    ds_read_b64_tr_b16 a[176:177], v9 offset:18432
    v_mfma_f32_16x16x32_bf16 v[32:35], a[128:131], a[0:3], v[16:19]
    v_exp_f32 v87, v87
    v_mfma_f32_16x16x32_bf16 v[40:43], a[128:131], a[16:19], v[20:23]
    ds_read_b64_tr_b16 a[178:179], v9 offset:19456
    v_cvt_pk_bf16_f32 v123, v86, v87
    v_mfma_f32_16x16x32_bf16 v[44:47], a[144:147], a[16:19], v[20:23]
    v_exp_f32 v88, v88
    v_mfma_f32_16x16x32_bf16 v[36:39], a[144:147], a[0:3], v[16:19]
    ds_read_b64_tr_b16 a[180:181], v10 offset:18432
    v_mfma_f32_16x16x32_bf16 v[44:47], a[148:151], a[20:23], v[44:47]
    v_exp_f32 v89, v89
    v_mfma_f32_16x16x32_bf16 v[36:39], a[148:151], a[4:7], v[36:39]
    ds_read_b64_tr_b16 a[182:183], v10 offset:19456
    v_cvt_pk_bf16_f32 v124, v88, v89
    v_mfma_f32_16x16x32_bf16 v[32:35], a[132:135], a[4:7], v[32:35]
    v_exp_f32 v90, v90
    v_mfma_f32_16x16x32_bf16 v[40:43], a[132:135], a[20:23], v[40:43]
    v_mfma_f32_16x16x32_bf16 v[32:35], a[136:139], a[8:11], v[32:35]
    v_exp_f32 v91, v91
    v_mfma_f32_16x16x32_bf16 v[40:43], a[136:139], a[24:27], v[40:43]
    v_cvt_pk_bf16_f32 v125, v90, v91
    v_mfma_f32_16x16x32_bf16 v[44:47], a[152:155], a[24:27], v[44:47]
    v_exp_f32 v92, v92
    v_mfma_f32_16x16x32_bf16 v[36:39], a[152:155], a[8:11], v[36:39]
    v_mfma_f32_16x16x32_bf16 v[44:47], a[156:159], a[28:31], v[44:47]
    v_exp_f32 v93, v93
    v_mfma_f32_16x16x32_bf16 v[36:39], a[156:159], a[12:15], v[36:39]
    v_cvt_pk_bf16_f32 v126, v92, v93
    v_mfma_f32_16x16x32_bf16 v[32:35], a[140:143], a[12:15], v[32:35]
    v_exp_f32 v94, v94
    v_mfma_f32_16x16x32_bf16 v[40:43], a[140:143], a[28:31], v[40:43]
    v_mfma_f32_16x16x32_bf16 v[48:51], a[128:131], a[32:35], v[24:27]
    v_exp_f32 v95, v95
    v_mfma_f32_16x16x32_bf16 v[56:59], a[128:131], a[48:51], v[28:31]
    v_cvt_pk_bf16_f32 v127, v94, v95
    v_mfma_f32_16x16x32_bf16 v[60:63], a[144:147], a[48:51], v[28:31]
    v_mfma_f32_16x16x32_bf16 v[52:55], a[144:147], a[32:35], v[24:27]
    v_mfma_f32_16x16x32_bf16 v[60:63], a[148:151], a[52:55], v[60:63]
    v_exp_f32 v32, v32
    v_mfma_f32_16x16x32_bf16 v[52:55], a[148:151], a[36:39], v[52:55]
    v_mfma_f32_16x16x32_bf16 v[48:51], a[132:135], a[36:39], v[48:51]
    v_exp_f32 v33, v33
    v_mfma_f32_16x16x32_bf16 v[56:59], a[132:135], a[52:55], v[56:59]
    v_cvt_pk_bf16_f32 v96, v32, v33
    v_mfma_f32_16x16x32_bf16 v[48:51], a[136:139], a[40:43], v[48:51]
    v_exp_f32 v34, v34
    v_mfma_f32_16x16x32_bf16 v[56:59], a[136:139], a[56:59], v[56:59]
    v_mfma_f32_16x16x32_bf16 v[60:63], a[152:155], a[56:59], v[60:63]
    v_exp_f32 v35, v35
    v_mfma_f32_16x16x32_bf16 v[52:55], a[152:155], a[40:43], v[52:55]
    v_cvt_pk_bf16_f32 v97, v34, v35
    v_mfma_f32_16x16x32_bf16 v[60:63], a[156:159], a[60:63], v[60:63]
    v_exp_f32 v36, v36
    v_mfma_f32_16x16x32_bf16 v[52:55], a[156:159], a[44:47], v[52:55]
    v_mfma_f32_16x16x32_bf16 v[48:51], a[140:143], a[44:47], v[48:51]
    v_exp_f32 v37, v37
    v_mfma_f32_16x16x32_bf16 v[56:59], a[140:143], a[60:63], v[56:59]
    ds_read_b64_tr_b16 a[184:185], v11 offset:18432
    ds_read_b64_tr_b16 a[186:187], v11 offset:19456
    ds_read_b64_tr_b16 a[188:189], v12 offset:18432
    ds_read_b64_tr_b16 a[190:191], v12 offset:19456
    v_cvt_pk_bf16_f32 v98, v36, v37
    s_cmp_lg_u32 s36, 0
    s_cbranch_scc1 L_loop_1
L_loop_0:
    s_waitcnt lgkmcnt(0)
    v_mfma_f32_16x16x32_bf16 v[128:131], a[160:163], v[112:115], v[128:131]
    v_exp_f32 v38, v38
    v_mfma_f32_16x16x32_bf16 v[160:163], a[160:163], v[116:119], v[160:163]
    ds_read_b128 a[128:131], v1 offset:18432
    v_mfma_f32_16x16x32_bf16 v[192:195], a[160:163], v[120:123], v[192:195]
    v_exp_f32 v39, v39
    v_mfma_f32_16x16x32_bf16 v[224:227], a[160:163], v[124:127], v[224:227]
    ds_read_b128 a[132:135], v2 offset:18432
    v_cvt_pk_bf16_f32 v99, v38, v39
    v_mfma_f32_16x16x32_bf16 v[228:231], a[164:167], v[124:127], v[228:231]
    v_exp_f32 v40, v40
    v_mfma_f32_16x16x32_bf16 v[196:199], a[164:167], v[120:123], v[196:199]
    ds_read_b128 a[136:139], v3 offset:18432
    v_mfma_f32_16x16x32_bf16 v[164:167], a[164:167], v[116:119], v[164:167]
    v_exp_f32 v41, v41
    v_mfma_f32_16x16x32_bf16 v[132:135], a[164:167], v[112:115], v[132:135]
    ds_read_b128 a[140:143], v4 offset:18432
    v_cvt_pk_bf16_f32 v100, v40, v41
    v_mfma_f32_16x16x32_bf16 v[136:139], a[168:171], v[112:115], v[136:139]
    v_exp_f32 v42, v42
    v_mfma_f32_16x16x32_bf16 v[168:171], a[168:171], v[116:119], v[168:171]
    ds_read_b128 a[144:147], v1 offset:19456
    v_mfma_f32_16x16x32_bf16 v[200:203], a[168:171], v[120:123], v[200:203]
    v_exp_f32 v43, v43
    v_mfma_f32_16x16x32_bf16 v[232:235], a[168:171], v[124:127], v[232:235]
    ds_read_b128 a[148:151], v2 offset:19456
    v_cvt_pk_bf16_f32 v101, v42, v43
    v_mfma_f32_16x16x32_bf16 v[236:239], a[172:175], v[124:127], v[236:239]
    v_exp_f32 v44, v44
    v_mfma_f32_16x16x32_bf16 v[204:207], a[172:175], v[120:123], v[204:207]
    ds_read_b128 a[152:155], v3 offset:19456
    v_mfma_f32_16x16x32_bf16 v[172:175], a[172:175], v[116:119], v[172:175]
    v_exp_f32 v45, v45
    v_mfma_f32_16x16x32_bf16 v[140:143], a[172:175], v[112:115], v[140:143]
    ds_read_b128 a[156:159], v4 offset:19456
    v_cvt_pk_bf16_f32 v102, v44, v45
    v_smfmac_f32_16x16x64_bf16 a[192:195], a[208:211], v[112:119], v15
    v_exp_f32 v46, v46
    v_mfma_f32_16x16x32_bf16 v[144:147], a[176:179], v[112:115], v[144:147]
    s_add_u32 m0, s29, 16384
    v_mfma_f32_16x16x32_bf16 v[176:179], a[176:179], v[116:119], v[176:179]
    v_exp_f32 v47, v47
    v_mfma_f32_16x16x32_bf16 v[208:211], a[176:179], v[120:123], v[208:211]
    v_cvt_pk_bf16_f32 v103, v46, v47
    s_waitcnt vmcnt(0) lgkmcnt(0)
    s_barrier
    v_mfma_f32_16x16x32_bf16 v[240:243], a[176:179], v[124:127], v[240:243]
    v_exp_f32 v48, v48
    v_mfma_f32_16x16x32_bf16 v[244:247], a[180:183], v[124:127], v[244:247]
    buffer_load_dwordx4 v13, s[16:19], s32 offen offset:0 nt lds
    v_mfma_f32_16x16x32_bf16 v[212:215], a[180:183], v[120:123], v[212:215]
    v_exp_f32 v49, v49
    v_mfma_f32_16x16x32_bf16 v[180:183], a[180:183], v[116:119], v[180:183]
    ds_read_b64_tr_b16 a[160:161], v5 offset:32768
    v_cvt_pk_bf16_f32 v104, v48, v49
    v_mfma_f32_16x16x32_bf16 v[148:151], a[180:183], v[112:115], v[148:151]
    v_exp_f32 v50, v50
    v_mfma_f32_16x16x32_bf16 v[152:155], a[184:187], v[112:115], v[152:155]
    ds_read_b64_tr_b16 a[162:163], v5 offset:33792
    v_mfma_f32_16x16x32_bf16 v[184:187], a[184:187], v[116:119], v[184:187]
    v_exp_f32 v51, v51
    v_mfma_f32_16x16x32_bf16 v[216:219], a[184:187], v[120:123], v[216:219]
    ds_read_b64_tr_b16 a[164:165], v6 offset:32768
    v_cvt_pk_bf16_f32 v105, v50, v51
    v_mfma_f32_16x16x32_bf16 v[248:251], a[184:187], v[124:127], v[248:251]
    v_exp_f32 v52, v52
    v_mfma_f32_16x16x32_bf16 v[252:255], a[188:191], v[124:127], v[252:255]
    buffer_load_dwordx4 v13, s[16:19], s32 offen offset:1024 nt lds
    v_mfma_f32_16x16x32_bf16 v[220:223], a[188:191], v[120:123], v[220:223]
    v_exp_f32 v53, v53
    v_mfma_f32_16x16x32_bf16 v[188:191], a[188:191], v[116:119], v[188:191]
    ds_read_b64_tr_b16 a[166:167], v6 offset:33792
    v_cvt_pk_bf16_f32 v106, v52, v53
    v_mfma_f32_16x16x32_bf16 v[156:159], a[188:191], v[112:115], v[156:159]
    v_exp_f32 v54, v54
    v_smfmac_f32_16x16x64_bf16 a[196:199], a[208:211], v[120:127], v15
    ds_read_b64_tr_b16 a[168:169], v7 offset:32768
    v_mfma_f32_16x16x32_bf16 v[64:67], a[128:131], a[0:3], v[16:19]
    v_exp_f32 v55, v55
    v_mfma_f32_16x16x32_bf16 v[72:75], a[128:131], a[16:19], v[20:23]
    ds_read_b64_tr_b16 a[170:171], v7 offset:33792
    v_cvt_pk_bf16_f32 v107, v54, v55
    v_mfma_f32_16x16x32_bf16 v[76:79], a[144:147], a[16:19], v[20:23]
    v_exp_f32 v56, v56
    v_mfma_f32_16x16x32_bf16 v[68:71], a[144:147], a[0:3], v[16:19]
    buffer_load_dwordx4 v13, s[16:19], s32 offen offset:2048 nt lds
    v_mfma_f32_16x16x32_bf16 v[76:79], a[148:151], a[20:23], v[76:79]
    v_exp_f32 v57, v57
    v_mfma_f32_16x16x32_bf16 v[68:71], a[148:151], a[4:7], v[68:71]
    ds_read_b64_tr_b16 a[172:173], v8 offset:32768
    v_cvt_pk_bf16_f32 v108, v56, v57
    v_mfma_f32_16x16x32_bf16 v[64:67], a[132:135], a[4:7], v[64:67]
    v_exp_f32 v58, v58
    v_mfma_f32_16x16x32_bf16 v[72:75], a[132:135], a[20:23], v[72:75]
    ds_read_b64_tr_b16 a[174:175], v8 offset:33792
    v_mfma_f32_16x16x32_bf16 v[64:67], a[136:139], a[8:11], v[64:67]
    v_exp_f32 v59, v59
    v_mfma_f32_16x16x32_bf16 v[72:75], a[136:139], a[24:27], v[72:75]
    ds_read_b64_tr_b16 a[176:177], v9 offset:32768
    v_cvt_pk_bf16_f32 v109, v58, v59
    v_mfma_f32_16x16x32_bf16 v[76:79], a[152:155], a[24:27], v[76:79]
    v_exp_f32 v60, v60
    v_mfma_f32_16x16x32_bf16 v[68:71], a[152:155], a[8:11], v[68:71]
    buffer_load_dwordx4 v13, s[16:19], s32 offen offset:3072 nt lds
    v_mfma_f32_16x16x32_bf16 v[76:79], a[156:159], a[28:31], v[76:79]
    v_exp_f32 v61, v61
    v_mfma_f32_16x16x32_bf16 v[68:71], a[156:159], a[12:15], v[68:71]
    ds_read_b64_tr_b16 a[178:179], v9 offset:33792
    v_cvt_pk_bf16_f32 v110, v60, v61
    v_mfma_f32_16x16x32_bf16 v[64:67], a[140:143], a[12:15], v[64:67]
    v_exp_f32 v62, v62
    v_mfma_f32_16x16x32_bf16 v[72:75], a[140:143], a[28:31], v[72:75]
    ds_read_b64_tr_b16 a[180:181], v10 offset:32768
    s_add_u32 m0, s30, 16384
    v_mfma_f32_16x16x32_bf16 v[80:83], a[128:131], a[32:35], v[24:27]
    v_exp_f32 v63, v63
    v_mfma_f32_16x16x32_bf16 v[88:91], a[128:131], a[48:51], v[28:31]
    ds_read_b64_tr_b16 a[182:183], v10 offset:33792
    v_cvt_pk_bf16_f32 v111, v62, v63
    v_mfma_f32_16x16x32_bf16 v[92:95], a[144:147], a[48:51], v[28:31]
    buffer_load_dwordx4 v13, s[20:23], s33 offen offset:0 nt lds
    v_mfma_f32_16x16x32_bf16 v[84:87], a[144:147], a[32:35], v[24:27]
    ds_read_b64_tr_b16 a[184:185], v11 offset:32768
    s_add_u32 s32, s32, 0x4000
    v_mfma_f32_16x16x32_bf16 v[92:95], a[148:151], a[52:55], v[92:95]
    v_exp_f32 v64, v64
    v_mfma_f32_16x16x32_bf16 v[84:87], a[148:151], a[36:39], v[84:87]
    ds_read_b64_tr_b16 a[186:187], v11 offset:33792
    v_mfma_f32_16x16x32_bf16 v[80:83], a[132:135], a[36:39], v[80:83]
    v_exp_f32 v65, v65
    v_mfma_f32_16x16x32_bf16 v[88:91], a[132:135], a[52:55], v[88:91]
    ds_read_b64_tr_b16 a[188:189], v12 offset:32768
    v_cvt_pk_bf16_f32 v112, v64, v65
    v_mfma_f32_16x16x32_bf16 v[80:83], a[136:139], a[40:43], v[80:83]
    v_exp_f32 v66, v66
    v_mfma_f32_16x16x32_bf16 v[88:91], a[136:139], a[56:59], v[88:91]
    buffer_load_dwordx4 v13, s[20:23], s33 offen offset:1024 nt lds
    v_mfma_f32_16x16x32_bf16 v[92:95], a[152:155], a[56:59], v[92:95]
    v_exp_f32 v67, v67
    v_mfma_f32_16x16x32_bf16 v[84:87], a[152:155], a[40:43], v[84:87]
    buffer_load_dwordx4 v13, s[20:23], s33 offen offset:2048 nt lds
    v_cvt_pk_bf16_f32 v113, v66, v67
    v_mfma_f32_16x16x32_bf16 v[92:95], a[156:159], a[60:63], v[92:95]
    v_exp_f32 v68, v68
    v_mfma_f32_16x16x32_bf16 v[84:87], a[156:159], a[44:47], v[84:87]
    buffer_load_dwordx4 v13, s[20:23], s33 offen offset:3072 nt lds
    s_add_u32 s33, s33, 0x4000
    v_mfma_f32_16x16x32_bf16 v[80:83], a[140:143], a[44:47], v[80:83]
    v_exp_f32 v69, v69
    v_mfma_f32_16x16x32_bf16 v[88:91], a[140:143], a[60:63], v[88:91]
    ds_read_b64_tr_b16 a[190:191], v12 offset:33792
    v_cvt_pk_bf16_f32 v114, v68, v69
    s_waitcnt lgkmcnt(0)
    v_mfma_f32_16x16x32_bf16 v[128:131], a[160:163], v[96:99], v[128:131]
    v_exp_f32 v70, v70
    v_mfma_f32_16x16x32_bf16 v[160:163], a[160:163], v[100:103], v[160:163]
    v_mfma_f32_16x16x32_bf16 v[192:195], a[160:163], v[104:107], v[192:195]
    v_exp_f32 v71, v71
    v_mfma_f32_16x16x32_bf16 v[224:227], a[160:163], v[108:111], v[224:227]
    v_cvt_pk_bf16_f32 v115, v70, v71
    v_mfma_f32_16x16x32_bf16 v[228:231], a[164:167], v[108:111], v[228:231]
    v_exp_f32 v72, v72
    v_mfma_f32_16x16x32_bf16 v[196:199], a[164:167], v[104:107], v[196:199]
    v_mfma_f32_16x16x32_bf16 v[164:167], a[164:167], v[100:103], v[164:167]
    v_exp_f32 v73, v73
    v_mfma_f32_16x16x32_bf16 v[132:135], a[164:167], v[96:99], v[132:135]
    v_cvt_pk_bf16_f32 v116, v72, v73
    v_mfma_f32_16x16x32_bf16 v[136:139], a[168:171], v[96:99], v[136:139]
    v_exp_f32 v74, v74
    v_mfma_f32_16x16x32_bf16 v[168:171], a[168:171], v[100:103], v[168:171]
    v_mfma_f32_16x16x32_bf16 v[200:203], a[168:171], v[104:107], v[200:203]
    v_exp_f32 v75, v75
    v_mfma_f32_16x16x32_bf16 v[232:235], a[168:171], v[108:111], v[232:235]
    v_cvt_pk_bf16_f32 v117, v74, v75
    v_mfma_f32_16x16x32_bf16 v[236:239], a[172:175], v[108:111], v[236:239]
    v_exp_f32 v76, v76
    v_mfma_f32_16x16x32_bf16 v[204:207], a[172:175], v[104:107], v[204:207]
    v_mfma_f32_16x16x32_bf16 v[172:175], a[172:175], v[100:103], v[172:175]
    v_exp_f32 v77, v77
    v_mfma_f32_16x16x32_bf16 v[140:143], a[172:175], v[96:99], v[140:143]
    v_cvt_pk_bf16_f32 v118, v76, v77
    v_smfmac_f32_16x16x64_bf16 a[192:195], a[208:211], v[96:103], v15
    v_exp_f32 v78, v78
    v_mfma_f32_16x16x32_bf16 v[144:147], a[176:179], v[96:99], v[144:147]
    ds_read_b64_tr_b16 a[160:161], v5 offset:34816
    v_mfma_f32_16x16x32_bf16 v[176:179], a[176:179], v[100:103], v[176:179]
    v_exp_f32 v79, v79
    v_mfma_f32_16x16x32_bf16 v[208:211], a[176:179], v[104:107], v[208:211]
    ds_read_b64_tr_b16 a[162:163], v5 offset:35840
    v_cvt_pk_bf16_f32 v119, v78, v79
    v_mfma_f32_16x16x32_bf16 v[240:243], a[176:179], v[108:111], v[240:243]
    v_exp_f32 v80, v80
    v_mfma_f32_16x16x32_bf16 v[244:247], a[180:183], v[108:111], v[244:247]
    ds_read_b64_tr_b16 a[164:165], v6 offset:34816
    v_mfma_f32_16x16x32_bf16 v[212:215], a[180:183], v[104:107], v[212:215]
    v_exp_f32 v81, v81
    v_mfma_f32_16x16x32_bf16 v[180:183], a[180:183], v[100:103], v[180:183]
    ds_read_b64_tr_b16 a[166:167], v6 offset:35840
    v_cvt_pk_bf16_f32 v120, v80, v81
    v_mfma_f32_16x16x32_bf16 v[148:151], a[180:183], v[96:99], v[148:151]
    v_exp_f32 v82, v82
    v_mfma_f32_16x16x32_bf16 v[152:155], a[184:187], v[96:99], v[152:155]
    ds_read_b64_tr_b16 a[168:169], v7 offset:34816
    v_mfma_f32_16x16x32_bf16 v[184:187], a[184:187], v[100:103], v[184:187]
    v_exp_f32 v83, v83
    v_mfma_f32_16x16x32_bf16 v[216:219], a[184:187], v[104:107], v[216:219]
    ds_read_b64_tr_b16 a[170:171], v7 offset:35840
    v_cvt_pk_bf16_f32 v121, v82, v83
    v_mfma_f32_16x16x32_bf16 v[248:251], a[184:187], v[108:111], v[248:251]
    v_exp_f32 v84, v84
    v_mfma_f32_16x16x32_bf16 v[252:255], a[188:191], v[108:111], v[252:255]
    ds_read_b64_tr_b16 a[172:173], v8 offset:34816
    v_mfma_f32_16x16x32_bf16 v[220:223], a[188:191], v[104:107], v[220:223]
    v_exp_f32 v85, v85
    v_mfma_f32_16x16x32_bf16 v[188:191], a[188:191], v[100:103], v[188:191]
    ds_read_b64_tr_b16 a[174:175], v8 offset:35840
    v_cvt_pk_bf16_f32 v122, v84, v85
    v_mfma_f32_16x16x32_bf16 v[156:159], a[188:191], v[96:99], v[156:159]
    v_exp_f32 v86, v86
    v_smfmac_f32_16x16x64_bf16 a[196:199], a[208:211], v[104:111], v15
    ds_read_b128 a[128:131], v1 offset:32768
    ds_read_b128 a[132:135], v2 offset:32768
    ds_read_b128 a[136:139], v3 offset:32768
    ds_read_b128 a[140:143], v4 offset:32768
    ds_read_b128 a[144:147], v1 offset:33792
    ds_read_b128 a[148:151], v2 offset:33792
    ds_read_b128 a[152:155], v3 offset:33792
    ds_read_b128 a[156:159], v4 offset:33792
    s_waitcnt lgkmcnt(3)
    v_mfma_f32_16x16x32_bf16 v[32:35], a[128:131], a[0:3], v[16:19]
    v_exp_f32 v87, v87
    v_mfma_f32_16x16x32_bf16 v[40:43], a[128:131], a[16:19], v[20:23]
    ds_read_b64_tr_b16 a[176:177], v9 offset:34816
    v_cvt_pk_bf16_f32 v123, v86, v87
    v_mfma_f32_16x16x32_bf16 v[44:47], a[144:147], a[16:19], v[20:23]
    v_exp_f32 v88, v88
    v_mfma_f32_16x16x32_bf16 v[36:39], a[144:147], a[0:3], v[16:19]
    ds_read_b64_tr_b16 a[178:179], v9 offset:35840
    s_waitcnt lgkmcnt(4)
    v_mfma_f32_16x16x32_bf16 v[44:47], a[148:151], a[20:23], v[44:47]
    v_exp_f32 v89, v89
    v_mfma_f32_16x16x32_bf16 v[36:39], a[148:151], a[4:7], v[36:39]
    ds_read_b64_tr_b16 a[180:181], v10 offset:34816
    v_cvt_pk_bf16_f32 v124, v88, v89
    v_mfma_f32_16x16x32_bf16 v[32:35], a[132:135], a[4:7], v[32:35]
    v_exp_f32 v90, v90
    v_mfma_f32_16x16x32_bf16 v[40:43], a[132:135], a[20:23], v[40:43]
    ds_read_b64_tr_b16 a[182:183], v10 offset:35840
    s_waitcnt lgkmcnt(5)
    v_mfma_f32_16x16x32_bf16 v[32:35], a[136:139], a[8:11], v[32:35]
    v_exp_f32 v91, v91
    v_mfma_f32_16x16x32_bf16 v[40:43], a[136:139], a[24:27], v[40:43]
    ds_read_b64_tr_b16 a[184:185], v11 offset:34816
    v_cvt_pk_bf16_f32 v125, v90, v91
    v_mfma_f32_16x16x32_bf16 v[44:47], a[152:155], a[24:27], v[44:47]
    v_exp_f32 v92, v92
    v_mfma_f32_16x16x32_bf16 v[36:39], a[152:155], a[8:11], v[36:39]
    ds_read_b64_tr_b16 a[186:187], v11 offset:35840
    s_waitcnt lgkmcnt(6)
    v_mfma_f32_16x16x32_bf16 v[44:47], a[156:159], a[28:31], v[44:47]
    v_exp_f32 v93, v93
    v_mfma_f32_16x16x32_bf16 v[36:39], a[156:159], a[12:15], v[36:39]
    ds_read_b64_tr_b16 a[188:189], v12 offset:34816
    v_cvt_pk_bf16_f32 v126, v92, v93
    v_mfma_f32_16x16x32_bf16 v[32:35], a[140:143], a[12:15], v[32:35]
    v_exp_f32 v94, v94
    v_mfma_f32_16x16x32_bf16 v[40:43], a[140:143], a[28:31], v[40:43]
    v_mfma_f32_16x16x32_bf16 v[48:51], a[128:131], a[32:35], v[24:27]
    v_exp_f32 v95, v95
    v_mfma_f32_16x16x32_bf16 v[56:59], a[128:131], a[48:51], v[28:31]
    v_cvt_pk_bf16_f32 v127, v94, v95
    v_mfma_f32_16x16x32_bf16 v[60:63], a[144:147], a[48:51], v[28:31]
    v_mfma_f32_16x16x32_bf16 v[52:55], a[144:147], a[32:35], v[24:27]
    v_mfma_f32_16x16x32_bf16 v[60:63], a[148:151], a[52:55], v[60:63]
    v_exp_f32 v32, v32
    v_mfma_f32_16x16x32_bf16 v[52:55], a[148:151], a[36:39], v[52:55]
    v_mfma_f32_16x16x32_bf16 v[48:51], a[132:135], a[36:39], v[48:51]
    v_exp_f32 v33, v33
    v_mfma_f32_16x16x32_bf16 v[56:59], a[132:135], a[52:55], v[56:59]
    v_cvt_pk_bf16_f32 v96, v32, v33
    v_mfma_f32_16x16x32_bf16 v[48:51], a[136:139], a[40:43], v[48:51]
    v_exp_f32 v34, v34
    v_mfma_f32_16x16x32_bf16 v[56:59], a[136:139], a[56:59], v[56:59]
    v_mfma_f32_16x16x32_bf16 v[60:63], a[152:155], a[56:59], v[60:63]
    v_exp_f32 v35, v35
    v_mfma_f32_16x16x32_bf16 v[52:55], a[152:155], a[40:43], v[52:55]
    v_cvt_pk_bf16_f32 v97, v34, v35
    v_mfma_f32_16x16x32_bf16 v[60:63], a[156:159], a[60:63], v[60:63]
    v_exp_f32 v36, v36
    v_mfma_f32_16x16x32_bf16 v[52:55], a[156:159], a[44:47], v[52:55]
    v_mfma_f32_16x16x32_bf16 v[48:51], a[140:143], a[44:47], v[48:51]
    v_exp_f32 v37, v37
    v_mfma_f32_16x16x32_bf16 v[56:59], a[140:143], a[60:63], v[56:59]
    ds_read_b64_tr_b16 a[190:191], v12 offset:35840
    v_cvt_pk_bf16_f32 v98, v36, v37
    s_waitcnt lgkmcnt(0)
    v_mfma_f32_16x16x32_bf16 v[128:131], a[160:163], v[112:115], v[128:131]
    v_exp_f32 v38, v38
    v_mfma_f32_16x16x32_bf16 v[160:163], a[160:163], v[116:119], v[160:163]
    ds_read_b128 a[128:131], v1 offset:34816
    v_mfma_f32_16x16x32_bf16 v[192:195], a[160:163], v[120:123], v[192:195]
    v_exp_f32 v39, v39
    v_mfma_f32_16x16x32_bf16 v[224:227], a[160:163], v[124:127], v[224:227]
    ds_read_b128 a[132:135], v2 offset:34816
    v_cvt_pk_bf16_f32 v99, v38, v39
    v_mfma_f32_16x16x32_bf16 v[228:231], a[164:167], v[124:127], v[228:231]
    v_exp_f32 v40, v40
    v_mfma_f32_16x16x32_bf16 v[196:199], a[164:167], v[120:123], v[196:199]
    ds_read_b128 a[136:139], v3 offset:34816
    v_mfma_f32_16x16x32_bf16 v[164:167], a[164:167], v[116:119], v[164:167]
    v_exp_f32 v41, v41
    v_mfma_f32_16x16x32_bf16 v[132:135], a[164:167], v[112:115], v[132:135]
    ds_read_b128 a[140:143], v4 offset:34816
    v_cvt_pk_bf16_f32 v100, v40, v41
    v_mfma_f32_16x16x32_bf16 v[136:139], a[168:171], v[112:115], v[136:139]
    v_exp_f32 v42, v42
    v_mfma_f32_16x16x32_bf16 v[168:171], a[168:171], v[116:119], v[168:171]
    ds_read_b128 a[144:147], v1 offset:35840
    v_mfma_f32_16x16x32_bf16 v[200:203], a[168:171], v[120:123], v[200:203]
    v_exp_f32 v43, v43
    v_mfma_f32_16x16x32_bf16 v[232:235], a[168:171], v[124:127], v[232:235]
    ds_read_b128 a[148:151], v2 offset:35840
    v_cvt_pk_bf16_f32 v101, v42, v43
    v_mfma_f32_16x16x32_bf16 v[236:239], a[172:175], v[124:127], v[236:239]
    v_exp_f32 v44, v44
    v_mfma_f32_16x16x32_bf16 v[204:207], a[172:175], v[120:123], v[204:207]
    ds_read_b128 a[152:155], v3 offset:35840
    v_mfma_f32_16x16x32_bf16 v[172:175], a[172:175], v[116:119], v[172:175]
    v_exp_f32 v45, v45
    v_mfma_f32_16x16x32_bf16 v[140:143], a[172:175], v[112:115], v[140:143]
    ds_read_b128 a[156:159], v4 offset:35840
    v_cvt_pk_bf16_f32 v102, v44, v45
    v_smfmac_f32_16x16x64_bf16 a[192:195], a[208:211], v[112:119], v15
    v_exp_f32 v46, v46
    v_mfma_f32_16x16x32_bf16 v[144:147], a[176:179], v[112:115], v[144:147]
    s_add_u32 m0, s29, 32768
    v_mfma_f32_16x16x32_bf16 v[176:179], a[176:179], v[116:119], v[176:179]
    v_exp_f32 v47, v47
    v_mfma_f32_16x16x32_bf16 v[208:211], a[176:179], v[120:123], v[208:211]
    v_cvt_pk_bf16_f32 v103, v46, v47
    s_waitcnt vmcnt(0) lgkmcnt(0)
    s_barrier
    v_mfma_f32_16x16x32_bf16 v[240:243], a[176:179], v[124:127], v[240:243]
    v_exp_f32 v48, v48
    v_mfma_f32_16x16x32_bf16 v[244:247], a[180:183], v[124:127], v[244:247]
    buffer_load_dwordx4 v13, s[16:19], s32 offen offset:0 nt lds
    v_mfma_f32_16x16x32_bf16 v[212:215], a[180:183], v[120:123], v[212:215]
    v_exp_f32 v49, v49
    v_mfma_f32_16x16x32_bf16 v[180:183], a[180:183], v[116:119], v[180:183]
    ds_read_b64_tr_b16 a[160:161], v5 offset:49152
    v_cvt_pk_bf16_f32 v104, v48, v49
    v_mfma_f32_16x16x32_bf16 v[148:151], a[180:183], v[112:115], v[148:151]
    v_exp_f32 v50, v50
    v_mfma_f32_16x16x32_bf16 v[152:155], a[184:187], v[112:115], v[152:155]
    ds_read_b64_tr_b16 a[162:163], v5 offset:50176
    v_mfma_f32_16x16x32_bf16 v[184:187], a[184:187], v[116:119], v[184:187]
    v_exp_f32 v51, v51
    v_mfma_f32_16x16x32_bf16 v[216:219], a[184:187], v[120:123], v[216:219]
    ds_read_b64_tr_b16 a[164:165], v6 offset:49152
    v_cvt_pk_bf16_f32 v105, v50, v51
    v_mfma_f32_16x16x32_bf16 v[248:251], a[184:187], v[124:127], v[248:251]
    v_exp_f32 v52, v52
    v_mfma_f32_16x16x32_bf16 v[252:255], a[188:191], v[124:127], v[252:255]
    buffer_load_dwordx4 v13, s[16:19], s32 offen offset:1024 nt lds
    v_mfma_f32_16x16x32_bf16 v[220:223], a[188:191], v[120:123], v[220:223]
    v_exp_f32 v53, v53
    v_mfma_f32_16x16x32_bf16 v[188:191], a[188:191], v[116:119], v[188:191]
    ds_read_b64_tr_b16 a[166:167], v6 offset:50176
    v_cvt_pk_bf16_f32 v106, v52, v53
    v_mfma_f32_16x16x32_bf16 v[156:159], a[188:191], v[112:115], v[156:159]
    v_exp_f32 v54, v54
    v_smfmac_f32_16x16x64_bf16 a[196:199], a[208:211], v[120:127], v15
    ds_read_b64_tr_b16 a[168:169], v7 offset:49152
    v_mfma_f32_16x16x32_bf16 v[64:67], a[128:131], a[0:3], v[16:19]
    v_exp_f32 v55, v55
    v_mfma_f32_16x16x32_bf16 v[72:75], a[128:131], a[16:19], v[20:23]
    ds_read_b64_tr_b16 a[170:171], v7 offset:50176
    v_cvt_pk_bf16_f32 v107, v54, v55
    v_mfma_f32_16x16x32_bf16 v[76:79], a[144:147], a[16:19], v[20:23]
    v_exp_f32 v56, v56
    v_mfma_f32_16x16x32_bf16 v[68:71], a[144:147], a[0:3], v[16:19]
    buffer_load_dwordx4 v13, s[16:19], s32 offen offset:2048 nt lds
    v_mfma_f32_16x16x32_bf16 v[76:79], a[148:151], a[20:23], v[76:79]
    v_exp_f32 v57, v57
    v_mfma_f32_16x16x32_bf16 v[68:71], a[148:151], a[4:7], v[68:71]
    ds_read_b64_tr_b16 a[172:173], v8 offset:49152
    v_cvt_pk_bf16_f32 v108, v56, v57
    v_mfma_f32_16x16x32_bf16 v[64:67], a[132:135], a[4:7], v[64:67]
    v_exp_f32 v58, v58
    v_mfma_f32_16x16x32_bf16 v[72:75], a[132:135], a[20:23], v[72:75]
    ds_read_b64_tr_b16 a[174:175], v8 offset:50176
    v_mfma_f32_16x16x32_bf16 v[64:67], a[136:139], a[8:11], v[64:67]
    v_exp_f32 v59, v59
    v_mfma_f32_16x16x32_bf16 v[72:75], a[136:139], a[24:27], v[72:75]
    ds_read_b64_tr_b16 a[176:177], v9 offset:49152
    v_cvt_pk_bf16_f32 v109, v58, v59
    v_mfma_f32_16x16x32_bf16 v[76:79], a[152:155], a[24:27], v[76:79]
    v_exp_f32 v60, v60
    v_mfma_f32_16x16x32_bf16 v[68:71], a[152:155], a[8:11], v[68:71]
    buffer_load_dwordx4 v13, s[16:19], s32 offen offset:3072 nt lds
    v_mfma_f32_16x16x32_bf16 v[76:79], a[156:159], a[28:31], v[76:79]
    v_exp_f32 v61, v61
    v_mfma_f32_16x16x32_bf16 v[68:71], a[156:159], a[12:15], v[68:71]
    ds_read_b64_tr_b16 a[178:179], v9 offset:50176
    v_cvt_pk_bf16_f32 v110, v60, v61
    v_mfma_f32_16x16x32_bf16 v[64:67], a[140:143], a[12:15], v[64:67]
    v_exp_f32 v62, v62
    v_mfma_f32_16x16x32_bf16 v[72:75], a[140:143], a[28:31], v[72:75]
    ds_read_b64_tr_b16 a[180:181], v10 offset:49152
    s_add_u32 m0, s30, 32768
    v_mfma_f32_16x16x32_bf16 v[80:83], a[128:131], a[32:35], v[24:27]
    v_exp_f32 v63, v63
    v_mfma_f32_16x16x32_bf16 v[88:91], a[128:131], a[48:51], v[28:31]
    ds_read_b64_tr_b16 a[182:183], v10 offset:50176
    v_cvt_pk_bf16_f32 v111, v62, v63
    v_mfma_f32_16x16x32_bf16 v[92:95], a[144:147], a[48:51], v[28:31]
    buffer_load_dwordx4 v13, s[20:23], s33 offen offset:0 nt lds
    v_mfma_f32_16x16x32_bf16 v[84:87], a[144:147], a[32:35], v[24:27]
    ds_read_b64_tr_b16 a[184:185], v11 offset:49152
    s_add_u32 s32, s32, 0x4000
    v_mfma_f32_16x16x32_bf16 v[92:95], a[148:151], a[52:55], v[92:95]
    v_exp_f32 v64, v64
    v_mfma_f32_16x16x32_bf16 v[84:87], a[148:151], a[36:39], v[84:87]
    ds_read_b64_tr_b16 a[186:187], v11 offset:50176
    v_mfma_f32_16x16x32_bf16 v[80:83], a[132:135], a[36:39], v[80:83]
    v_exp_f32 v65, v65
    v_mfma_f32_16x16x32_bf16 v[88:91], a[132:135], a[52:55], v[88:91]
    ds_read_b64_tr_b16 a[188:189], v12 offset:49152
    v_cvt_pk_bf16_f32 v112, v64, v65
    v_mfma_f32_16x16x32_bf16 v[80:83], a[136:139], a[40:43], v[80:83]
    v_exp_f32 v66, v66
    v_mfma_f32_16x16x32_bf16 v[88:91], a[136:139], a[56:59], v[88:91]
    buffer_load_dwordx4 v13, s[20:23], s33 offen offset:1024 nt lds
    v_mfma_f32_16x16x32_bf16 v[92:95], a[152:155], a[56:59], v[92:95]
    v_exp_f32 v67, v67
    v_mfma_f32_16x16x32_bf16 v[84:87], a[152:155], a[40:43], v[84:87]
    buffer_load_dwordx4 v13, s[20:23], s33 offen offset:2048 nt lds
    v_cvt_pk_bf16_f32 v113, v66, v67
    v_mfma_f32_16x16x32_bf16 v[92:95], a[156:159], a[60:63], v[92:95]
    v_exp_f32 v68, v68
    v_mfma_f32_16x16x32_bf16 v[84:87], a[156:159], a[44:47], v[84:87]
    buffer_load_dwordx4 v13, s[20:23], s33 offen offset:3072 nt lds
    s_add_u32 s33, s33, 0x4000
    v_mfma_f32_16x16x32_bf16 v[80:83], a[140:143], a[44:47], v[80:83]
    v_exp_f32 v69, v69
    v_mfma_f32_16x16x32_bf16 v[88:91], a[140:143], a[60:63], v[88:91]
    ds_read_b64_tr_b16 a[190:191], v12 offset:50176
    v_cvt_pk_bf16_f32 v114, v68, v69
    s_waitcnt lgkmcnt(0)
    v_mfma_f32_16x16x32_bf16 v[128:131], a[160:163], v[96:99], v[128:131]
    v_exp_f32 v70, v70
    v_mfma_f32_16x16x32_bf16 v[160:163], a[160:163], v[100:103], v[160:163]
    v_mfma_f32_16x16x32_bf16 v[192:195], a[160:163], v[104:107], v[192:195]
    v_exp_f32 v71, v71
    v_mfma_f32_16x16x32_bf16 v[224:227], a[160:163], v[108:111], v[224:227]
    v_cvt_pk_bf16_f32 v115, v70, v71
    v_mfma_f32_16x16x32_bf16 v[228:231], a[164:167], v[108:111], v[228:231]
    v_exp_f32 v72, v72
    v_mfma_f32_16x16x32_bf16 v[196:199], a[164:167], v[104:107], v[196:199]
    v_mfma_f32_16x16x32_bf16 v[164:167], a[164:167], v[100:103], v[164:167]
    v_exp_f32 v73, v73
    v_mfma_f32_16x16x32_bf16 v[132:135], a[164:167], v[96:99], v[132:135]
    v_cvt_pk_bf16_f32 v116, v72, v73
    v_mfma_f32_16x16x32_bf16 v[136:139], a[168:171], v[96:99], v[136:139]
    v_exp_f32 v74, v74
    v_mfma_f32_16x16x32_bf16 v[168:171], a[168:171], v[100:103], v[168:171]
    v_mfma_f32_16x16x32_bf16 v[200:203], a[168:171], v[104:107], v[200:203]
    v_exp_f32 v75, v75
    v_mfma_f32_16x16x32_bf16 v[232:235], a[168:171], v[108:111], v[232:235]
    v_cvt_pk_bf16_f32 v117, v74, v75
    v_mfma_f32_16x16x32_bf16 v[236:239], a[172:175], v[108:111], v[236:239]
    v_exp_f32 v76, v76
    v_mfma_f32_16x16x32_bf16 v[204:207], a[172:175], v[104:107], v[204:207]
    v_mfma_f32_16x16x32_bf16 v[172:175], a[172:175], v[100:103], v[172:175]
    v_exp_f32 v77, v77
    v_mfma_f32_16x16x32_bf16 v[140:143], a[172:175], v[96:99], v[140:143]
    v_cvt_pk_bf16_f32 v118, v76, v77
    v_smfmac_f32_16x16x64_bf16 a[192:195], a[208:211], v[96:103], v15
    v_exp_f32 v78, v78
    v_mfma_f32_16x16x32_bf16 v[144:147], a[176:179], v[96:99], v[144:147]
    ds_read_b64_tr_b16 a[160:161], v5 offset:51200
    v_mfma_f32_16x16x32_bf16 v[176:179], a[176:179], v[100:103], v[176:179]
    v_exp_f32 v79, v79
    v_mfma_f32_16x16x32_bf16 v[208:211], a[176:179], v[104:107], v[208:211]
    ds_read_b64_tr_b16 a[162:163], v5 offset:52224
    v_cvt_pk_bf16_f32 v119, v78, v79
    v_mfma_f32_16x16x32_bf16 v[240:243], a[176:179], v[108:111], v[240:243]
    v_exp_f32 v80, v80
    v_mfma_f32_16x16x32_bf16 v[244:247], a[180:183], v[108:111], v[244:247]
    ds_read_b64_tr_b16 a[164:165], v6 offset:51200
    v_mfma_f32_16x16x32_bf16 v[212:215], a[180:183], v[104:107], v[212:215]
    v_exp_f32 v81, v81
    v_mfma_f32_16x16x32_bf16 v[180:183], a[180:183], v[100:103], v[180:183]
    ds_read_b64_tr_b16 a[166:167], v6 offset:52224
    v_cvt_pk_bf16_f32 v120, v80, v81
    v_mfma_f32_16x16x32_bf16 v[148:151], a[180:183], v[96:99], v[148:151]
    v_exp_f32 v82, v82
    v_mfma_f32_16x16x32_bf16 v[152:155], a[184:187], v[96:99], v[152:155]
    ds_read_b64_tr_b16 a[168:169], v7 offset:51200
    v_mfma_f32_16x16x32_bf16 v[184:187], a[184:187], v[100:103], v[184:187]
    v_exp_f32 v83, v83
    v_mfma_f32_16x16x32_bf16 v[216:219], a[184:187], v[104:107], v[216:219]
    ds_read_b64_tr_b16 a[170:171], v7 offset:52224
    v_cvt_pk_bf16_f32 v121, v82, v83
    v_mfma_f32_16x16x32_bf16 v[248:251], a[184:187], v[108:111], v[248:251]
    v_exp_f32 v84, v84
    v_mfma_f32_16x16x32_bf16 v[252:255], a[188:191], v[108:111], v[252:255]
    ds_read_b64_tr_b16 a[172:173], v8 offset:51200
    v_mfma_f32_16x16x32_bf16 v[220:223], a[188:191], v[104:107], v[220:223]
    v_exp_f32 v85, v85
    v_mfma_f32_16x16x32_bf16 v[188:191], a[188:191], v[100:103], v[188:191]
    ds_read_b64_tr_b16 a[174:175], v8 offset:52224
    v_cvt_pk_bf16_f32 v122, v84, v85
    v_mfma_f32_16x16x32_bf16 v[156:159], a[188:191], v[96:99], v[156:159]
    v_exp_f32 v86, v86
    v_smfmac_f32_16x16x64_bf16 a[196:199], a[208:211], v[104:111], v15
    ds_read_b128 a[128:131], v1 offset:49152
    ds_read_b128 a[132:135], v2 offset:49152
    ds_read_b128 a[136:139], v3 offset:49152
    ds_read_b128 a[140:143], v4 offset:49152
    ds_read_b128 a[144:147], v1 offset:50176
    ds_read_b128 a[148:151], v2 offset:50176
    ds_read_b128 a[152:155], v3 offset:50176
    ds_read_b128 a[156:159], v4 offset:50176
    s_waitcnt lgkmcnt(3)
    v_mfma_f32_16x16x32_bf16 v[32:35], a[128:131], a[0:3], v[16:19]
    v_exp_f32 v87, v87
    v_mfma_f32_16x16x32_bf16 v[40:43], a[128:131], a[16:19], v[20:23]
    ds_read_b64_tr_b16 a[176:177], v9 offset:51200
    v_cvt_pk_bf16_f32 v123, v86, v87
    v_mfma_f32_16x16x32_bf16 v[44:47], a[144:147], a[16:19], v[20:23]
    v_exp_f32 v88, v88
    v_mfma_f32_16x16x32_bf16 v[36:39], a[144:147], a[0:3], v[16:19]
    ds_read_b64_tr_b16 a[178:179], v9 offset:52224
    s_waitcnt lgkmcnt(4)
    v_mfma_f32_16x16x32_bf16 v[44:47], a[148:151], a[20:23], v[44:47]
    v_exp_f32 v89, v89
    v_mfma_f32_16x16x32_bf16 v[36:39], a[148:151], a[4:7], v[36:39]
    ds_read_b64_tr_b16 a[180:181], v10 offset:51200
    v_cvt_pk_bf16_f32 v124, v88, v89
    v_mfma_f32_16x16x32_bf16 v[32:35], a[132:135], a[4:7], v[32:35]
    v_exp_f32 v90, v90
    v_mfma_f32_16x16x32_bf16 v[40:43], a[132:135], a[20:23], v[40:43]
    ds_read_b64_tr_b16 a[182:183], v10 offset:52224
    s_waitcnt lgkmcnt(5)
    v_mfma_f32_16x16x32_bf16 v[32:35], a[136:139], a[8:11], v[32:35]
    v_exp_f32 v91, v91
    v_mfma_f32_16x16x32_bf16 v[40:43], a[136:139], a[24:27], v[40:43]
    ds_read_b64_tr_b16 a[184:185], v11 offset:51200
    v_cvt_pk_bf16_f32 v125, v90, v91
    v_mfma_f32_16x16x32_bf16 v[44:47], a[152:155], a[24:27], v[44:47]
    v_exp_f32 v92, v92
    v_mfma_f32_16x16x32_bf16 v[36:39], a[152:155], a[8:11], v[36:39]
    ds_read_b64_tr_b16 a[186:187], v11 offset:52224
    s_waitcnt lgkmcnt(6)
    v_mfma_f32_16x16x32_bf16 v[44:47], a[156:159], a[28:31], v[44:47]
    v_exp_f32 v93, v93
    v_mfma_f32_16x16x32_bf16 v[36:39], a[156:159], a[12:15], v[36:39]
    ds_read_b64_tr_b16 a[188:189], v12 offset:51200
    v_cvt_pk_bf16_f32 v126, v92, v93
    v_mfma_f32_16x16x32_bf16 v[32:35], a[140:143], a[12:15], v[32:35]
    v_exp_f32 v94, v94
    v_mfma_f32_16x16x32_bf16 v[40:43], a[140:143], a[28:31], v[40:43]
    v_mfma_f32_16x16x32_bf16 v[48:51], a[128:131], a[32:35], v[24:27]
    v_exp_f32 v95, v95
    v_mfma_f32_16x16x32_bf16 v[56:59], a[128:131], a[48:51], v[28:31]
    v_cvt_pk_bf16_f32 v127, v94, v95
    v_mfma_f32_16x16x32_bf16 v[60:63], a[144:147], a[48:51], v[28:31]
    v_mfma_f32_16x16x32_bf16 v[52:55], a[144:147], a[32:35], v[24:27]
    v_mfma_f32_16x16x32_bf16 v[60:63], a[148:151], a[52:55], v[60:63]
    v_exp_f32 v32, v32
    v_mfma_f32_16x16x32_bf16 v[52:55], a[148:151], a[36:39], v[52:55]
    v_mfma_f32_16x16x32_bf16 v[48:51], a[132:135], a[36:39], v[48:51]
    v_exp_f32 v33, v33
    v_mfma_f32_16x16x32_bf16 v[56:59], a[132:135], a[52:55], v[56:59]
    v_cvt_pk_bf16_f32 v96, v32, v33
    v_mfma_f32_16x16x32_bf16 v[48:51], a[136:139], a[40:43], v[48:51]
    v_exp_f32 v34, v34
    v_mfma_f32_16x16x32_bf16 v[56:59], a[136:139], a[56:59], v[56:59]
    v_mfma_f32_16x16x32_bf16 v[60:63], a[152:155], a[56:59], v[60:63]
    v_exp_f32 v35, v35
    v_mfma_f32_16x16x32_bf16 v[52:55], a[152:155], a[40:43], v[52:55]
    v_cvt_pk_bf16_f32 v97, v34, v35
    v_mfma_f32_16x16x32_bf16 v[60:63], a[156:159], a[60:63], v[60:63]
    v_exp_f32 v36, v36
    v_mfma_f32_16x16x32_bf16 v[52:55], a[156:159], a[44:47], v[52:55]
    v_mfma_f32_16x16x32_bf16 v[48:51], a[140:143], a[44:47], v[48:51]
    v_exp_f32 v37, v37
    v_mfma_f32_16x16x32_bf16 v[56:59], a[140:143], a[60:63], v[56:59]
    ds_read_b64_tr_b16 a[190:191], v12 offset:52224
    v_cvt_pk_bf16_f32 v98, v36, v37
    s_waitcnt lgkmcnt(0)
    v_mfma_f32_16x16x32_bf16 v[128:131], a[160:163], v[112:115], v[128:131]
    v_exp_f32 v38, v38
    v_mfma_f32_16x16x32_bf16 v[160:163], a[160:163], v[116:119], v[160:163]
    ds_read_b128 a[128:131], v1 offset:51200
    v_mfma_f32_16x16x32_bf16 v[192:195], a[160:163], v[120:123], v[192:195]
    v_exp_f32 v39, v39
    v_mfma_f32_16x16x32_bf16 v[224:227], a[160:163], v[124:127], v[224:227]
    ds_read_b128 a[132:135], v2 offset:51200
    v_cvt_pk_bf16_f32 v99, v38, v39
    v_mfma_f32_16x16x32_bf16 v[228:231], a[164:167], v[124:127], v[228:231]
    v_exp_f32 v40, v40
    v_mfma_f32_16x16x32_bf16 v[196:199], a[164:167], v[120:123], v[196:199]
    ds_read_b128 a[136:139], v3 offset:51200
    v_mfma_f32_16x16x32_bf16 v[164:167], a[164:167], v[116:119], v[164:167]
    v_exp_f32 v41, v41
    v_mfma_f32_16x16x32_bf16 v[132:135], a[164:167], v[112:115], v[132:135]
    ds_read_b128 a[140:143], v4 offset:51200
    v_cvt_pk_bf16_f32 v100, v40, v41
    v_mfma_f32_16x16x32_bf16 v[136:139], a[168:171], v[112:115], v[136:139]
    v_exp_f32 v42, v42
    v_mfma_f32_16x16x32_bf16 v[168:171], a[168:171], v[116:119], v[168:171]
    ds_read_b128 a[144:147], v1 offset:52224
    v_mfma_f32_16x16x32_bf16 v[200:203], a[168:171], v[120:123], v[200:203]
    v_exp_f32 v43, v43
    v_mfma_f32_16x16x32_bf16 v[232:235], a[168:171], v[124:127], v[232:235]
    ds_read_b128 a[148:151], v2 offset:52224
    v_cvt_pk_bf16_f32 v101, v42, v43
    v_mfma_f32_16x16x32_bf16 v[236:239], a[172:175], v[124:127], v[236:239]
    v_exp_f32 v44, v44
    v_mfma_f32_16x16x32_bf16 v[204:207], a[172:175], v[120:123], v[204:207]
    ds_read_b128 a[152:155], v3 offset:52224
    v_mfma_f32_16x16x32_bf16 v[172:175], a[172:175], v[116:119], v[172:175]
    v_exp_f32 v45, v45
    v_mfma_f32_16x16x32_bf16 v[140:143], a[172:175], v[112:115], v[140:143]
    ds_read_b128 a[156:159], v4 offset:52224
    v_cvt_pk_bf16_f32 v102, v44, v45
    v_smfmac_f32_16x16x64_bf16 a[192:195], a[208:211], v[112:119], v15
    v_exp_f32 v46, v46
    v_mfma_f32_16x16x32_bf16 v[144:147], a[176:179], v[112:115], v[144:147]
    s_add_u32 m0, s29, 49152
    v_mfma_f32_16x16x32_bf16 v[176:179], a[176:179], v[116:119], v[176:179]
    v_exp_f32 v47, v47
    v_mfma_f32_16x16x32_bf16 v[208:211], a[176:179], v[120:123], v[208:211]
    v_cvt_pk_bf16_f32 v103, v46, v47
    s_waitcnt vmcnt(0) lgkmcnt(0)
    s_barrier
    v_mfma_f32_16x16x32_bf16 v[240:243], a[176:179], v[124:127], v[240:243]
    v_exp_f32 v48, v48
    v_mfma_f32_16x16x32_bf16 v[244:247], a[180:183], v[124:127], v[244:247]
    buffer_load_dwordx4 v13, s[16:19], s32 offen offset:0 nt lds
    v_mfma_f32_16x16x32_bf16 v[212:215], a[180:183], v[120:123], v[212:215]
    v_exp_f32 v49, v49
    v_mfma_f32_16x16x32_bf16 v[180:183], a[180:183], v[116:119], v[180:183]
    ds_read_b64_tr_b16 a[160:161], v5 offset:0
    v_cvt_pk_bf16_f32 v104, v48, v49
    v_mfma_f32_16x16x32_bf16 v[148:151], a[180:183], v[112:115], v[148:151]
    v_exp_f32 v50, v50
    v_mfma_f32_16x16x32_bf16 v[152:155], a[184:187], v[112:115], v[152:155]
    ds_read_b64_tr_b16 a[162:163], v5 offset:1024
    v_mfma_f32_16x16x32_bf16 v[184:187], a[184:187], v[116:119], v[184:187]
    v_exp_f32 v51, v51
    v_mfma_f32_16x16x32_bf16 v[216:219], a[184:187], v[120:123], v[216:219]
    ds_read_b64_tr_b16 a[164:165], v6 offset:0
    v_cvt_pk_bf16_f32 v105, v50, v51
    v_mfma_f32_16x16x32_bf16 v[248:251], a[184:187], v[124:127], v[248:251]
    v_exp_f32 v52, v52
    v_mfma_f32_16x16x32_bf16 v[252:255], a[188:191], v[124:127], v[252:255]
    buffer_load_dwordx4 v13, s[16:19], s32 offen offset:1024 nt lds
    v_mfma_f32_16x16x32_bf16 v[220:223], a[188:191], v[120:123], v[220:223]
    v_exp_f32 v53, v53
    v_mfma_f32_16x16x32_bf16 v[188:191], a[188:191], v[116:119], v[188:191]
    ds_read_b64_tr_b16 a[166:167], v6 offset:1024
    v_cvt_pk_bf16_f32 v106, v52, v53
    v_mfma_f32_16x16x32_bf16 v[156:159], a[188:191], v[112:115], v[156:159]
    v_exp_f32 v54, v54
    v_smfmac_f32_16x16x64_bf16 a[196:199], a[208:211], v[120:127], v15
    ds_read_b64_tr_b16 a[168:169], v7 offset:0
    v_mfma_f32_16x16x32_bf16 v[64:67], a[128:131], a[0:3], v[16:19]
    v_exp_f32 v55, v55
    v_mfma_f32_16x16x32_bf16 v[72:75], a[128:131], a[16:19], v[20:23]
    ds_read_b64_tr_b16 a[170:171], v7 offset:1024
    v_cvt_pk_bf16_f32 v107, v54, v55
    v_mfma_f32_16x16x32_bf16 v[76:79], a[144:147], a[16:19], v[20:23]
    v_exp_f32 v56, v56
    v_mfma_f32_16x16x32_bf16 v[68:71], a[144:147], a[0:3], v[16:19]
    buffer_load_dwordx4 v13, s[16:19], s32 offen offset:2048 nt lds
    v_mfma_f32_16x16x32_bf16 v[76:79], a[148:151], a[20:23], v[76:79]
    v_exp_f32 v57, v57
    v_mfma_f32_16x16x32_bf16 v[68:71], a[148:151], a[4:7], v[68:71]
    ds_read_b64_tr_b16 a[172:173], v8 offset:0
    v_cvt_pk_bf16_f32 v108, v56, v57
    v_mfma_f32_16x16x32_bf16 v[64:67], a[132:135], a[4:7], v[64:67]
    v_exp_f32 v58, v58
    v_mfma_f32_16x16x32_bf16 v[72:75], a[132:135], a[20:23], v[72:75]
    ds_read_b64_tr_b16 a[174:175], v8 offset:1024
    v_mfma_f32_16x16x32_bf16 v[64:67], a[136:139], a[8:11], v[64:67]
    v_exp_f32 v59, v59
    v_mfma_f32_16x16x32_bf16 v[72:75], a[136:139], a[24:27], v[72:75]
    ds_read_b64_tr_b16 a[176:177], v9 offset:0
    v_cvt_pk_bf16_f32 v109, v58, v59
    v_mfma_f32_16x16x32_bf16 v[76:79], a[152:155], a[24:27], v[76:79]
    v_exp_f32 v60, v60
    v_mfma_f32_16x16x32_bf16 v[68:71], a[152:155], a[8:11], v[68:71]
    buffer_load_dwordx4 v13, s[16:19], s32 offen offset:3072 nt lds
    v_mfma_f32_16x16x32_bf16 v[76:79], a[156:159], a[28:31], v[76:79]
    v_exp_f32 v61, v61
    v_mfma_f32_16x16x32_bf16 v[68:71], a[156:159], a[12:15], v[68:71]
    ds_read_b64_tr_b16 a[178:179], v9 offset:1024
    v_cvt_pk_bf16_f32 v110, v60, v61
    v_mfma_f32_16x16x32_bf16 v[64:67], a[140:143], a[12:15], v[64:67]
    v_exp_f32 v62, v62
    v_mfma_f32_16x16x32_bf16 v[72:75], a[140:143], a[28:31], v[72:75]
    ds_read_b64_tr_b16 a[180:181], v10 offset:0
    s_add_u32 m0, s30, 49152
    v_mfma_f32_16x16x32_bf16 v[80:83], a[128:131], a[32:35], v[24:27]
    v_exp_f32 v63, v63
    v_mfma_f32_16x16x32_bf16 v[88:91], a[128:131], a[48:51], v[28:31]
    ds_read_b64_tr_b16 a[182:183], v10 offset:1024
    v_cvt_pk_bf16_f32 v111, v62, v63
    v_mfma_f32_16x16x32_bf16 v[92:95], a[144:147], a[48:51], v[28:31]
    buffer_load_dwordx4 v13, s[20:23], s33 offen offset:0 nt lds
    v_mfma_f32_16x16x32_bf16 v[84:87], a[144:147], a[32:35], v[24:27]
    ds_read_b64_tr_b16 a[184:185], v11 offset:0
    s_add_u32 s32, s32, 0x4000
    v_mfma_f32_16x16x32_bf16 v[92:95], a[148:151], a[52:55], v[92:95]
    v_exp_f32 v64, v64
    v_mfma_f32_16x16x32_bf16 v[84:87], a[148:151], a[36:39], v[84:87]
    ds_read_b64_tr_b16 a[186:187], v11 offset:1024
    v_mfma_f32_16x16x32_bf16 v[80:83], a[132:135], a[36:39], v[80:83]
    v_exp_f32 v65, v65
    v_mfma_f32_16x16x32_bf16 v[88:91], a[132:135], a[52:55], v[88:91]
    ds_read_b64_tr_b16 a[188:189], v12 offset:0
    v_cvt_pk_bf16_f32 v112, v64, v65
    v_mfma_f32_16x16x32_bf16 v[80:83], a[136:139], a[40:43], v[80:83]
    v_exp_f32 v66, v66
    v_mfma_f32_16x16x32_bf16 v[88:91], a[136:139], a[56:59], v[88:91]
    buffer_load_dwordx4 v13, s[20:23], s33 offen offset:1024 nt lds
    v_mfma_f32_16x16x32_bf16 v[92:95], a[152:155], a[56:59], v[92:95]
    v_exp_f32 v67, v67
    v_mfma_f32_16x16x32_bf16 v[84:87], a[152:155], a[40:43], v[84:87]
    buffer_load_dwordx4 v13, s[20:23], s33 offen offset:2048 nt lds
    v_cvt_pk_bf16_f32 v113, v66, v67
    v_mfma_f32_16x16x32_bf16 v[92:95], a[156:159], a[60:63], v[92:95]
    v_exp_f32 v68, v68
    v_mfma_f32_16x16x32_bf16 v[84:87], a[156:159], a[44:47], v[84:87]
    buffer_load_dwordx4 v13, s[20:23], s33 offen offset:3072 nt lds
    s_add_u32 s33, s33, 0x4000
    v_mfma_f32_16x16x32_bf16 v[80:83], a[140:143], a[44:47], v[80:83]
    v_exp_f32 v69, v69
    v_mfma_f32_16x16x32_bf16 v[88:91], a[140:143], a[60:63], v[88:91]
    ds_read_b64_tr_b16 a[190:191], v12 offset:1024
    v_cvt_pk_bf16_f32 v114, v68, v69
    s_cmp_eq_u32 s35, 0
    s_cbranch_scc1 L_last
    s_waitcnt lgkmcnt(0)
    v_mfma_f32_16x16x32_bf16 v[128:131], a[160:163], v[96:99], v[128:131]
    v_exp_f32 v70, v70
    v_mfma_f32_16x16x32_bf16 v[160:163], a[160:163], v[100:103], v[160:163]
    v_mfma_f32_16x16x32_bf16 v[192:195], a[160:163], v[104:107], v[192:195]
    v_exp_f32 v71, v71
    v_mfma_f32_16x16x32_bf16 v[224:227], a[160:163], v[108:111], v[224:227]
    v_cvt_pk_bf16_f32 v115, v70, v71
    v_mfma_f32_16x16x32_bf16 v[228:231], a[164:167], v[108:111], v[228:231]
    v_exp_f32 v72, v72
    v_mfma_f32_16x16x32_bf16 v[196:199], a[164:167], v[104:107], v[196:199]
    v_mfma_f32_16x16x32_bf16 v[164:167], a[164:167], v[100:103], v[164:167]
    v_exp_f32 v73, v73
    v_mfma_f32_16x16x32_bf16 v[132:135], a[164:167], v[96:99], v[132:135]
    v_cvt_pk_bf16_f32 v116, v72, v73
    v_mfma_f32_16x16x32_bf16 v[136:139], a[168:171], v[96:99], v[136:139]
    v_exp_f32 v74, v74
    v_mfma_f32_16x16x32_bf16 v[168:171], a[168:171], v[100:103], v[168:171]
    v_mfma_f32_16x16x32_bf16 v[200:203], a[168:171], v[104:107], v[200:203]
    v_exp_f32 v75, v75
    v_mfma_f32_16x16x32_bf16 v[232:235], a[168:171], v[108:111], v[232:235]
    v_cvt_pk_bf16_f32 v117, v74, v75
    v_mfma_f32_16x16x32_bf16 v[236:239], a[172:175], v[108:111], v[236:239]
    v_exp_f32 v76, v76
    v_mfma_f32_16x16x32_bf16 v[204:207], a[172:175], v[104:107], v[204:207]
    v_mfma_f32_16x16x32_bf16 v[172:175], a[172:175], v[100:103], v[172:175]
    v_exp_f32 v77, v77
    v_mfma_f32_16x16x32_bf16 v[140:143], a[172:175], v[96:99], v[140:143]
    v_cvt_pk_bf16_f32 v118, v76, v77
    v_smfmac_f32_16x16x64_bf16 a[192:195], a[208:211], v[96:103], v15
    v_exp_f32 v78, v78
    v_mfma_f32_16x16x32_bf16 v[144:147], a[176:179], v[96:99], v[144:147]
    ds_read_b64_tr_b16 a[160:161], v5 offset:2048
    v_mfma_f32_16x16x32_bf16 v[176:179], a[176:179], v[100:103], v[176:179]
    v_exp_f32 v79, v79
    v_mfma_f32_16x16x32_bf16 v[208:211], a[176:179], v[104:107], v[208:211]
    ds_read_b64_tr_b16 a[162:163], v5 offset:3072
    v_cvt_pk_bf16_f32 v119, v78, v79
    v_mfma_f32_16x16x32_bf16 v[240:243], a[176:179], v[108:111], v[240:243]
    v_exp_f32 v80, v80
    v_mfma_f32_16x16x32_bf16 v[244:247], a[180:183], v[108:111], v[244:247]
    ds_read_b64_tr_b16 a[164:165], v6 offset:2048
    v_mfma_f32_16x16x32_bf16 v[212:215], a[180:183], v[104:107], v[212:215]
    v_exp_f32 v81, v81
    v_mfma_f32_16x16x32_bf16 v[180:183], a[180:183], v[100:103], v[180:183]
    ds_read_b64_tr_b16 a[166:167], v6 offset:3072
    v_cvt_pk_bf16_f32 v120, v80, v81
    v_mfma_f32_16x16x32_bf16 v[148:151], a[180:183], v[96:99], v[148:151]
    v_exp_f32 v82, v82
    v_mfma_f32_16x16x32_bf16 v[152:155], a[184:187], v[96:99], v[152:155]
    ds_read_b64_tr_b16 a[168:169], v7 offset:2048
    v_mfma_f32_16x16x32_bf16 v[184:187], a[184:187], v[100:103], v[184:187]
    v_exp_f32 v83, v83
    v_mfma_f32_16x16x32_bf16 v[216:219], a[184:187], v[104:107], v[216:219]
    ds_read_b64_tr_b16 a[170:171], v7 offset:3072
    v_cvt_pk_bf16_f32 v121, v82, v83
    v_mfma_f32_16x16x32_bf16 v[248:251], a[184:187], v[108:111], v[248:251]
    v_exp_f32 v84, v84
    v_mfma_f32_16x16x32_bf16 v[252:255], a[188:191], v[108:111], v[252:255]
    ds_read_b64_tr_b16 a[172:173], v8 offset:2048
    v_mfma_f32_16x16x32_bf16 v[220:223], a[188:191], v[104:107], v[220:223]
    v_exp_f32 v85, v85
    v_mfma_f32_16x16x32_bf16 v[188:191], a[188:191], v[100:103], v[188:191]
    ds_read_b64_tr_b16 a[174:175], v8 offset:3072
    v_cvt_pk_bf16_f32 v122, v84, v85
    v_mfma_f32_16x16x32_bf16 v[156:159], a[188:191], v[96:99], v[156:159]
    v_exp_f32 v86, v86
    v_smfmac_f32_16x16x64_bf16 a[196:199], a[208:211], v[104:111], v15
    ds_read_b128 a[128:131], v1 offset:0
    ds_read_b128 a[132:135], v2 offset:0
    ds_read_b128 a[136:139], v3 offset:0
    ds_read_b128 a[140:143], v4 offset:0
    ds_read_b128 a[144:147], v1 offset:1024
    ds_read_b128 a[148:151], v2 offset:1024
    ds_read_b128 a[152:155], v3 offset:1024
    ds_read_b128 a[156:159], v4 offset:1024
    s_waitcnt lgkmcnt(3)
    v_mfma_f32_16x16x32_bf16 v[32:35], a[128:131], a[0:3], v[16:19]
    v_exp_f32 v87, v87
    v_mfma_f32_16x16x32_bf16 v[40:43], a[128:131], a[16:19], v[20:23]
    ds_read_b64_tr_b16 a[176:177], v9 offset:2048
    v_cvt_pk_bf16_f32 v123, v86, v87
    v_mfma_f32_16x16x32_bf16 v[44:47], a[144:147], a[16:19], v[20:23]
    v_exp_f32 v88, v88
    v_mfma_f32_16x16x32_bf16 v[36:39], a[144:147], a[0:3], v[16:19]
    ds_read_b64_tr_b16 a[178:179], v9 offset:3072
    s_waitcnt lgkmcnt(4)
    v_mfma_f32_16x16x32_bf16 v[44:47], a[148:151], a[20:23], v[44:47]
    v_exp_f32 v89, v89
    v_mfma_f32_16x16x32_bf16 v[36:39], a[148:151], a[4:7], v[36:39]
    ds_read_b64_tr_b16 a[180:181], v10 offset:2048
    v_cvt_pk_bf16_f32 v124, v88, v89
    v_mfma_f32_16x16x32_bf16 v[32:35], a[132:135], a[4:7], v[32:35]
    v_exp_f32 v90, v90
    v_mfma_f32_16x16x32_bf16 v[40:43], a[132:135], a[20:23], v[40:43]
    ds_read_b64_tr_b16 a[182:183], v10 offset:3072
    s_waitcnt lgkmcnt(5)
    v_mfma_f32_16x16x32_bf16 v[32:35], a[136:139], a[8:11], v[32:35]
    v_exp_f32 v91, v91
    v_mfma_f32_16x16x32_bf16 v[40:43], a[136:139], a[24:27], v[40:43]
    ds_read_b64_tr_b16 a[184:185], v11 offset:2048
    v_cvt_pk_bf16_f32 v125, v90, v91
    v_mfma_f32_16x16x32_bf16 v[44:47], a[152:155], a[24:27], v[44:47]
    v_exp_f32 v92, v92
    v_mfma_f32_16x16x32_bf16 v[36:39], a[152:155], a[8:11], v[36:39]
    ds_read_b64_tr_b16 a[186:187], v11 offset:3072
    s_waitcnt lgkmcnt(6)
    v_mfma_f32_16x16x32_bf16 v[44:47], a[156:159], a[28:31], v[44:47]
    v_exp_f32 v93, v93
    v_mfma_f32_16x16x32_bf16 v[36:39], a[156:159], a[12:15], v[36:39]
    ds_read_b64_tr_b16 a[188:189], v12 offset:2048
    v_cvt_pk_bf16_f32 v126, v92, v93
    v_mfma_f32_16x16x32_bf16 v[32:35], a[140:143], a[12:15], v[32:35]
    v_exp_f32 v94, v94
    v_mfma_f32_16x16x32_bf16 v[40:43], a[140:143], a[28:31], v[40:43]
    v_mfma_f32_16x16x32_bf16 v[48:51], a[128:131], a[32:35], v[24:27]
    v_exp_f32 v95, v95
    v_mfma_f32_16x16x32_bf16 v[56:59], a[128:131], a[48:51], v[28:31]
    v_cvt_pk_bf16_f32 v127, v94, v95
    v_mfma_f32_16x16x32_bf16 v[60:63], a[144:147], a[48:51], v[28:31]
    v_mfma_f32_16x16x32_bf16 v[52:55], a[144:147], a[32:35], v[24:27]
    v_mfma_f32_16x16x32_bf16 v[60:63], a[148:151], a[52:55], v[60:63]
    v_exp_f32 v32, v32
    v_mfma_f32_16x16x32_bf16 v[52:55], a[148:151], a[36:39], v[52:55]
    v_mfma_f32_16x16x32_bf16 v[48:51], a[132:135], a[36:39], v[48:51]
    v_exp_f32 v33, v33
    v_mfma_f32_16x16x32_bf16 v[56:59], a[132:135], a[52:55], v[56:59]
    v_cvt_pk_bf16_f32 v96, v32, v33
    v_mfma_f32_16x16x32_bf16 v[48:51], a[136:139], a[40:43], v[48:51]
    v_exp_f32 v34, v34
    v_mfma_f32_16x16x32_bf16 v[56:59], a[136:139], a[56:59], v[56:59]
    v_mfma_f32_16x16x32_bf16 v[60:63], a[152:155], a[56:59], v[60:63]
    v_exp_f32 v35, v35
    v_mfma_f32_16x16x32_bf16 v[52:55], a[152:155], a[40:43], v[52:55]
    v_cvt_pk_bf16_f32 v97, v34, v35
    v_mfma_f32_16x16x32_bf16 v[60:63], a[156:159], a[60:63], v[60:63]
    v_exp_f32 v36, v36
    v_mfma_f32_16x16x32_bf16 v[52:55], a[156:159], a[44:47], v[52:55]
    v_mfma_f32_16x16x32_bf16 v[48:51], a[140:143], a[44:47], v[48:51]
    v_exp_f32 v37, v37
    v_mfma_f32_16x16x32_bf16 v[56:59], a[140:143], a[60:63], v[56:59]
    ds_read_b64_tr_b16 a[190:191], v12 offset:3072
    v_cvt_pk_bf16_f32 v98, v36, v37
    s_waitcnt lgkmcnt(0)
    v_mfma_f32_16x16x32_bf16 v[128:131], a[160:163], v[112:115], v[128:131]
    v_exp_f32 v38, v38
    v_mfma_f32_16x16x32_bf16 v[160:163], a[160:163], v[116:119], v[160:163]
    ds_read_b128 a[128:131], v1 offset:2048
    v_mfma_f32_16x16x32_bf16 v[192:195], a[160:163], v[120:123], v[192:195]
    v_exp_f32 v39, v39
    v_mfma_f32_16x16x32_bf16 v[224:227], a[160:163], v[124:127], v[224:227]
    ds_read_b128 a[132:135], v2 offset:2048
    v_cvt_pk_bf16_f32 v99, v38, v39
    v_mfma_f32_16x16x32_bf16 v[228:231], a[164:167], v[124:127], v[228:231]
    v_exp_f32 v40, v40
    v_mfma_f32_16x16x32_bf16 v[196:199], a[164:167], v[120:123], v[196:199]
    ds_read_b128 a[136:139], v3 offset:2048
    v_mfma_f32_16x16x32_bf16 v[164:167], a[164:167], v[116:119], v[164:167]
    v_exp_f32 v41, v41
    v_mfma_f32_16x16x32_bf16 v[132:135], a[164:167], v[112:115], v[132:135]
    ds_read_b128 a[140:143], v4 offset:2048
    v_cvt_pk_bf16_f32 v100, v40, v41
    v_mfma_f32_16x16x32_bf16 v[136:139], a[168:171], v[112:115], v[136:139]
    v_exp_f32 v42, v42
    v_mfma_f32_16x16x32_bf16 v[168:171], a[168:171], v[116:119], v[168:171]
    ds_read_b128 a[144:147], v1 offset:3072
    v_mfma_f32_16x16x32_bf16 v[200:203], a[168:171], v[120:123], v[200:203]
    v_exp_f32 v43, v43
    v_mfma_f32_16x16x32_bf16 v[232:235], a[168:171], v[124:127], v[232:235]
    ds_read_b128 a[148:151], v2 offset:3072
    v_cvt_pk_bf16_f32 v101, v42, v43
    v_mfma_f32_16x16x32_bf16 v[236:239], a[172:175], v[124:127], v[236:239]
    v_exp_f32 v44, v44
    v_mfma_f32_16x16x32_bf16 v[204:207], a[172:175], v[120:123], v[204:207]
    ds_read_b128 a[152:155], v3 offset:3072
    v_mfma_f32_16x16x32_bf16 v[172:175], a[172:175], v[116:119], v[172:175]
    v_exp_f32 v45, v45
    v_mfma_f32_16x16x32_bf16 v[140:143], a[172:175], v[112:115], v[140:143]
    ds_read_b128 a[156:159], v4 offset:3072
    v_cvt_pk_bf16_f32 v102, v44, v45
    v_smfmac_f32_16x16x64_bf16 a[192:195], a[208:211], v[112:119], v15
    v_exp_f32 v46, v46
    v_mfma_f32_16x16x32_bf16 v[144:147], a[176:179], v[112:115], v[144:147]
    s_add_u32 m0, s29, 0
    v_mfma_f32_16x16x32_bf16 v[176:179], a[176:179], v[116:119], v[176:179]
    v_exp_f32 v47, v47
    v_mfma_f32_16x16x32_bf16 v[208:211], a[176:179], v[120:123], v[208:211]
    v_cvt_pk_bf16_f32 v103, v46, v47
    s_waitcnt vmcnt(0) lgkmcnt(0)
    s_barrier
    v_mfma_f32_16x16x32_bf16 v[240:243], a[176:179], v[124:127], v[240:243]
    v_exp_f32 v48, v48
    v_mfma_f32_16x16x32_bf16 v[244:247], a[180:183], v[124:127], v[244:247]
    buffer_load_dwordx4 v13, s[16:19], s32 offen offset:0 nt lds
    v_mfma_f32_16x16x32_bf16 v[212:215], a[180:183], v[120:123], v[212:215]
    v_exp_f32 v49, v49
    v_mfma_f32_16x16x32_bf16 v[180:183], a[180:183], v[116:119], v[180:183]
    ds_read_b64_tr_b16 a[160:161], v5 offset:16384
    v_cvt_pk_bf16_f32 v104, v48, v49
    v_mfma_f32_16x16x32_bf16 v[148:151], a[180:183], v[112:115], v[148:151]
    v_exp_f32 v50, v50
    v_mfma_f32_16x16x32_bf16 v[152:155], a[184:187], v[112:115], v[152:155]
    ds_read_b64_tr_b16 a[162:163], v5 offset:17408
    v_mfma_f32_16x16x32_bf16 v[184:187], a[184:187], v[116:119], v[184:187]
    v_exp_f32 v51, v51
    v_mfma_f32_16x16x32_bf16 v[216:219], a[184:187], v[120:123], v[216:219]
    ds_read_b64_tr_b16 a[164:165], v6 offset:16384
    v_cvt_pk_bf16_f32 v105, v50, v51
    v_mfma_f32_16x16x32_bf16 v[248:251], a[184:187], v[124:127], v[248:251]
    v_exp_f32 v52, v52
    v_mfma_f32_16x16x32_bf16 v[252:255], a[188:191], v[124:127], v[252:255]
    buffer_load_dwordx4 v13, s[16:19], s32 offen offset:1024 nt lds
    v_mfma_f32_16x16x32_bf16 v[220:223], a[188:191], v[120:123], v[220:223]
    v_exp_f32 v53, v53
    v_mfma_f32_16x16x32_bf16 v[188:191], a[188:191], v[116:119], v[188:191]
    ds_read_b64_tr_b16 a[166:167], v6 offset:17408
    v_cvt_pk_bf16_f32 v106, v52, v53
    v_mfma_f32_16x16x32_bf16 v[156:159], a[188:191], v[112:115], v[156:159]
    v_exp_f32 v54, v54
    v_smfmac_f32_16x16x64_bf16 a[196:199], a[208:211], v[120:127], v15
    ds_read_b64_tr_b16 a[168:169], v7 offset:16384
    v_mfma_f32_16x16x32_bf16 v[64:67], a[128:131], a[0:3], v[16:19]
    v_exp_f32 v55, v55
    v_mfma_f32_16x16x32_bf16 v[72:75], a[128:131], a[16:19], v[20:23]
    ds_read_b64_tr_b16 a[170:171], v7 offset:17408
    v_cvt_pk_bf16_f32 v107, v54, v55
    v_mfma_f32_16x16x32_bf16 v[76:79], a[144:147], a[16:19], v[20:23]
    v_exp_f32 v56, v56
    v_mfma_f32_16x16x32_bf16 v[68:71], a[144:147], a[0:3], v[16:19]
    buffer_load_dwordx4 v13, s[16:19], s32 offen offset:2048 nt lds
    v_mfma_f32_16x16x32_bf16 v[76:79], a[148:151], a[20:23], v[76:79]
    v_exp_f32 v57, v57
    v_mfma_f32_16x16x32_bf16 v[68:71], a[148:151], a[4:7], v[68:71]
    ds_read_b64_tr_b16 a[172:173], v8 offset:16384
    v_cvt_pk_bf16_f32 v108, v56, v57
    v_mfma_f32_16x16x32_bf16 v[64:67], a[132:135], a[4:7], v[64:67]
    v_exp_f32 v58, v58
    v_mfma_f32_16x16x32_bf16 v[72:75], a[132:135], a[20:23], v[72:75]
    ds_read_b64_tr_b16 a[174:175], v8 offset:17408
    v_mfma_f32_16x16x32_bf16 v[64:67], a[136:139], a[8:11], v[64:67]
    v_exp_f32 v59, v59
    v_mfma_f32_16x16x32_bf16 v[72:75], a[136:139], a[24:27], v[72:75]
    ds_read_b64_tr_b16 a[176:177], v9 offset:16384
    v_cvt_pk_bf16_f32 v109, v58, v59
    v_mfma_f32_16x16x32_bf16 v[76:79], a[152:155], a[24:27], v[76:79]
    v_exp_f32 v60, v60
    v_mfma_f32_16x16x32_bf16 v[68:71], a[152:155], a[8:11], v[68:71]
    buffer_load_dwordx4 v13, s[16:19], s32 offen offset:3072 nt lds
    v_mfma_f32_16x16x32_bf16 v[76:79], a[156:159], a[28:31], v[76:79]
    v_exp_f32 v61, v61
    v_mfma_f32_16x16x32_bf16 v[68:71], a[156:159], a[12:15], v[68:71]
    ds_read_b64_tr_b16 a[178:179], v9 offset:17408
    v_cvt_pk_bf16_f32 v110, v60, v61
    v_mfma_f32_16x16x32_bf16 v[64:67], a[140:143], a[12:15], v[64:67]
    v_exp_f32 v62, v62
    v_mfma_f32_16x16x32_bf16 v[72:75], a[140:143], a[28:31], v[72:75]
    ds_read_b64_tr_b16 a[180:181], v10 offset:16384
    s_add_u32 m0, s30, 0
    v_mfma_f32_16x16x32_bf16 v[80:83], a[128:131], a[32:35], v[24:27]
    v_exp_f32 v63, v63
    v_mfma_f32_16x16x32_bf16 v[88:91], a[128:131], a[48:51], v[28:31]
    ds_read_b64_tr_b16 a[182:183], v10 offset:17408
    v_cvt_pk_bf16_f32 v111, v62, v63
    v_mfma_f32_16x16x32_bf16 v[92:95], a[144:147], a[48:51], v[28:31]
    buffer_load_dwordx4 v13, s[20:23], s33 offen offset:0 nt lds
    v_mfma_f32_16x16x32_bf16 v[84:87], a[144:147], a[32:35], v[24:27]
    ds_read_b64_tr_b16 a[184:185], v11 offset:16384
    s_add_u32 s32, s32, 0x4000
    v_mfma_f32_16x16x32_bf16 v[92:95], a[148:151], a[52:55], v[92:95]
    v_exp_f32 v64, v64
    v_mfma_f32_16x16x32_bf16 v[84:87], a[148:151], a[36:39], v[84:87]
    ds_read_b64_tr_b16 a[186:187], v11 offset:17408
    v_mfma_f32_16x16x32_bf16 v[80:83], a[132:135], a[36:39], v[80:83]
    v_exp_f32 v65, v65
    v_mfma_f32_16x16x32_bf16 v[88:91], a[132:135], a[52:55], v[88:91]
    ds_read_b64_tr_b16 a[188:189], v12 offset:16384
    v_cvt_pk_bf16_f32 v112, v64, v65
    v_mfma_f32_16x16x32_bf16 v[80:83], a[136:139], a[40:43], v[80:83]
    v_exp_f32 v66, v66
    v_mfma_f32_16x16x32_bf16 v[88:91], a[136:139], a[56:59], v[88:91]
    buffer_load_dwordx4 v13, s[20:23], s33 offen offset:1024 nt lds
    v_mfma_f32_16x16x32_bf16 v[92:95], a[152:155], a[56:59], v[92:95]
    v_exp_f32 v67, v67
    v_mfma_f32_16x16x32_bf16 v[84:87], a[152:155], a[40:43], v[84:87]
    buffer_load_dwordx4 v13, s[20:23], s33 offen offset:2048 nt lds
    v_cvt_pk_bf16_f32 v113, v66, v67
    v_mfma_f32_16x16x32_bf16 v[92:95], a[156:159], a[60:63], v[92:95]
    v_exp_f32 v68, v68
    v_mfma_f32_16x16x32_bf16 v[84:87], a[156:159], a[44:47], v[84:87]
    buffer_load_dwordx4 v13, s[20:23], s33 offen offset:3072 nt lds
    s_add_u32 s33, s33, 0x4000
    v_mfma_f32_16x16x32_bf16 v[80:83], a[140:143], a[44:47], v[80:83]
    v_exp_f32 v69, v69
    v_mfma_f32_16x16x32_bf16 v[88:91], a[140:143], a[60:63], v[88:91]
    ds_read_b64_tr_b16 a[190:191], v12 offset:17408
    v_cvt_pk_bf16_f32 v114, v68, v69
    s_waitcnt lgkmcnt(0)
    v_mfma_f32_16x16x32_bf16 v[128:131], a[160:163], v[96:99], v[128:131]
    v_exp_f32 v70, v70
    v_mfma_f32_16x16x32_bf16 v[160:163], a[160:163], v[100:103], v[160:163]
    v_mfma_f32_16x16x32_bf16 v[192:195], a[160:163], v[104:107], v[192:195]
    v_exp_f32 v71, v71
    v_mfma_f32_16x16x32_bf16 v[224:227], a[160:163], v[108:111], v[224:227]
    v_cvt_pk_bf16_f32 v115, v70, v71
    v_mfma_f32_16x16x32_bf16 v[228:231], a[164:167], v[108:111], v[228:231]
    v_exp_f32 v72, v72
    v_mfma_f32_16x16x32_bf16 v[196:199], a[164:167], v[104:107], v[196:199]
    v_mfma_f32_16x16x32_bf16 v[164:167], a[164:167], v[100:103], v[164:167]
    v_exp_f32 v73, v73
    v_mfma_f32_16x16x32_bf16 v[132:135], a[164:167], v[96:99], v[132:135]
    v_cvt_pk_bf16_f32 v116, v72, v73
    v_mfma_f32_16x16x32_bf16 v[136:139], a[168:171], v[96:99], v[136:139]
    v_exp_f32 v74, v74
    v_mfma_f32_16x16x32_bf16 v[168:171], a[168:171], v[100:103], v[168:171]
    v_mfma_f32_16x16x32_bf16 v[200:203], a[168:171], v[104:107], v[200:203]
    v_exp_f32 v75, v75
    v_mfma_f32_16x16x32_bf16 v[232:235], a[168:171], v[108:111], v[232:235]
    v_cvt_pk_bf16_f32 v117, v74, v75
    v_mfma_f32_16x16x32_bf16 v[236:239], a[172:175], v[108:111], v[236:239]
    v_exp_f32 v76, v76
    v_mfma_f32_16x16x32_bf16 v[204:207], a[172:175], v[104:107], v[204:207]
    v_mfma_f32_16x16x32_bf16 v[172:175], a[172:175], v[100:103], v[172:175]
    v_exp_f32 v77, v77
    v_mfma_f32_16x16x32_bf16 v[140:143], a[172:175], v[96:99], v[140:143]
    v_cvt_pk_bf16_f32 v118, v76, v77
    v_smfmac_f32_16x16x64_bf16 a[192:195], a[208:211], v[96:103], v15
    v_exp_f32 v78, v78
    v_mfma_f32_16x16x32_bf16 v[144:147], a[176:179], v[96:99], v[144:147]
    ds_read_b64_tr_b16 a[160:161], v5 offset:18432
    v_mfma_f32_16x16x32_bf16 v[176:179], a[176:179], v[100:103], v[176:179]
    v_exp_f32 v79, v79
    v_mfma_f32_16x16x32_bf16 v[208:211], a[176:179], v[104:107], v[208:211]
    ds_read_b64_tr_b16 a[162:163], v5 offset:19456
    v_cvt_pk_bf16_f32 v119, v78, v79
    v_mfma_f32_16x16x32_bf16 v[240:243], a[176:179], v[108:111], v[240:243]
    v_exp_f32 v80, v80
    v_mfma_f32_16x16x32_bf16 v[244:247], a[180:183], v[108:111], v[244:247]
    ds_read_b64_tr_b16 a[164:165], v6 offset:18432
    v_mfma_f32_16x16x32_bf16 v[212:215], a[180:183], v[104:107], v[212:215]
    v_exp_f32 v81, v81
    v_mfma_f32_16x16x32_bf16 v[180:183], a[180:183], v[100:103], v[180:183]
    ds_read_b64_tr_b16 a[166:167], v6 offset:19456
    v_cvt_pk_bf16_f32 v120, v80, v81
    v_mfma_f32_16x16x32_bf16 v[148:151], a[180:183], v[96:99], v[148:151]
    v_exp_f32 v82, v82
    v_mfma_f32_16x16x32_bf16 v[152:155], a[184:187], v[96:99], v[152:155]
    ds_read_b64_tr_b16 a[168:169], v7 offset:18432
    v_mfma_f32_16x16x32_bf16 v[184:187], a[184:187], v[100:103], v[184:187]
    v_exp_f32 v83, v83
    v_mfma_f32_16x16x32_bf16 v[216:219], a[184:187], v[104:107], v[216:219]
    ds_read_b64_tr_b16 a[170:171], v7 offset:19456
    v_cvt_pk_bf16_f32 v121, v82, v83
    v_mfma_f32_16x16x32_bf16 v[248:251], a[184:187], v[108:111], v[248:251]
    v_exp_f32 v84, v84
    v_mfma_f32_16x16x32_bf16 v[252:255], a[188:191], v[108:111], v[252:255]
    ds_read_b64_tr_b16 a[172:173], v8 offset:18432
    v_mfma_f32_16x16x32_bf16 v[220:223], a[188:191], v[104:107], v[220:223]
    v_exp_f32 v85, v85
    v_mfma_f32_16x16x32_bf16 v[188:191], a[188:191], v[100:103], v[188:191]
    ds_read_b64_tr_b16 a[174:175], v8 offset:19456
    v_cvt_pk_bf16_f32 v122, v84, v85
    v_mfma_f32_16x16x32_bf16 v[156:159], a[188:191], v[96:99], v[156:159]
    v_exp_f32 v86, v86
    v_smfmac_f32_16x16x64_bf16 a[196:199], a[208:211], v[104:111], v15
    ds_read_b128 a[128:131], v1 offset:16384
    ds_read_b128 a[132:135], v2 offset:16384
    ds_read_b128 a[136:139], v3 offset:16384
    ds_read_b128 a[140:143], v4 offset:16384
    ds_read_b128 a[144:147], v1 offset:17408
    ds_read_b128 a[148:151], v2 offset:17408
    ds_read_b128 a[152:155], v3 offset:17408
    ds_read_b128 a[156:159], v4 offset:17408
    s_waitcnt lgkmcnt(3)
    v_mfma_f32_16x16x32_bf16 v[32:35], a[128:131], a[0:3], v[16:19]
    v_exp_f32 v87, v87
    v_mfma_f32_16x16x32_bf16 v[40:43], a[128:131], a[16:19], v[20:23]
    ds_read_b64_tr_b16 a[176:177], v9 offset:18432
    v_cvt_pk_bf16_f32 v123, v86, v87
    v_mfma_f32_16x16x32_bf16 v[44:47], a[144:147], a[16:19], v[20:23]
    v_exp_f32 v88, v88
    v_mfma_f32_16x16x32_bf16 v[36:39], a[144:147], a[0:3], v[16:19]
    ds_read_b64_tr_b16 a[178:179], v9 offset:19456
    s_waitcnt lgkmcnt(4)
    v_mfma_f32_16x16x32_bf16 v[44:47], a[148:151], a[20:23], v[44:47]
    v_exp_f32 v89, v89
    v_mfma_f32_16x16x32_bf16 v[36:39], a[148:151], a[4:7], v[36:39]
    ds_read_b64_tr_b16 a[180:181], v10 offset:18432
    v_cvt_pk_bf16_f32 v124, v88, v89
    v_mfma_f32_16x16x32_bf16 v[32:35], a[132:135], a[4:7], v[32:35]
    v_exp_f32 v90, v90
    v_mfma_f32_16x16x32_bf16 v[40:43], a[132:135], a[20:23], v[40:43]
    ds_read_b64_tr_b16 a[182:183], v10 offset:19456
    s_waitcnt lgkmcnt(5)
    v_mfma_f32_16x16x32_bf16 v[32:35], a[136:139], a[8:11], v[32:35]
    v_exp_f32 v91, v91
    v_mfma_f32_16x16x32_bf16 v[40:43], a[136:139], a[24:27], v[40:43]
    ds_read_b64_tr_b16 a[184:185], v11 offset:18432
    v_cvt_pk_bf16_f32 v125, v90, v91
    v_mfma_f32_16x16x32_bf16 v[44:47], a[152:155], a[24:27], v[44:47]
    v_exp_f32 v92, v92
    v_mfma_f32_16x16x32_bf16 v[36:39], a[152:155], a[8:11], v[36:39]
    ds_read_b64_tr_b16 a[186:187], v11 offset:19456
    s_waitcnt lgkmcnt(6)
    v_mfma_f32_16x16x32_bf16 v[44:47], a[156:159], a[28:31], v[44:47]
    v_exp_f32 v93, v93
    v_mfma_f32_16x16x32_bf16 v[36:39], a[156:159], a[12:15], v[36:39]
    ds_read_b64_tr_b16 a[188:189], v12 offset:18432
    v_cvt_pk_bf16_f32 v126, v92, v93
    v_mfma_f32_16x16x32_bf16 v[32:35], a[140:143], a[12:15], v[32:35]
    v_exp_f32 v94, v94
    v_mfma_f32_16x16x32_bf16 v[40:43], a[140:143], a[28:31], v[40:43]
    v_mfma_f32_16x16x32_bf16 v[48:51], a[128:131], a[32:35], v[24:27]
    v_exp_f32 v95, v95
    v_mfma_f32_16x16x32_bf16 v[56:59], a[128:131], a[48:51], v[28:31]
    v_cvt_pk_bf16_f32 v127, v94, v95
    v_mfma_f32_16x16x32_bf16 v[60:63], a[144:147], a[48:51], v[28:31]
    v_mfma_f32_16x16x32_bf16 v[52:55], a[144:147], a[32:35], v[24:27]
    v_mfma_f32_16x16x32_bf16 v[60:63], a[148:151], a[52:55], v[60:63]
    v_exp_f32 v32, v32
    v_mfma_f32_16x16x32_bf16 v[52:55], a[148:151], a[36:39], v[52:55]
    v_mfma_f32_16x16x32_bf16 v[48:51], a[132:135], a[36:39], v[48:51]
    v_exp_f32 v33, v33
    v_mfma_f32_16x16x32_bf16 v[56:59], a[132:135], a[52:55], v[56:59]
    v_cvt_pk_bf16_f32 v96, v32, v33
    v_mfma_f32_16x16x32_bf16 v[48:51], a[136:139], a[40:43], v[48:51]
    v_exp_f32 v34, v34
    v_mfma_f32_16x16x32_bf16 v[56:59], a[136:139], a[56:59], v[56:59]
    v_mfma_f32_16x16x32_bf16 v[60:63], a[152:155], a[56:59], v[60:63]
    v_exp_f32 v35, v35
    v_mfma_f32_16x16x32_bf16 v[52:55], a[152:155], a[40:43], v[52:55]
    v_cvt_pk_bf16_f32 v97, v34, v35
    v_mfma_f32_16x16x32_bf16 v[60:63], a[156:159], a[60:63], v[60:63]
    v_exp_f32 v36, v36
    v_mfma_f32_16x16x32_bf16 v[52:55], a[156:159], a[44:47], v[52:55]
    v_mfma_f32_16x16x32_bf16 v[48:51], a[140:143], a[44:47], v[48:51]
    v_exp_f32 v37, v37
    v_mfma_f32_16x16x32_bf16 v[56:59], a[140:143], a[60:63], v[56:59]
    ds_read_b64_tr_b16 a[190:191], v12 offset:19456
    v_cvt_pk_bf16_f32 v98, v36, v37
    s_sub_u32 s35, s35, 1
    s_branch L_loop_0
L_loop_1:
    s_waitcnt lgkmcnt(0)
    v_mfma_f32_16x16x32_bf16 v[128:131], a[160:163], v[112:115], v[128:131]
    v_exp_f32 v38, v38
    v_mfma_f32_16x16x32_bf16 v[160:163], a[160:163], v[116:119], v[160:163]
    ds_read_b128 a[128:131], v1 offset:18432
    v_mfma_f32_16x16x32_bf16 v[192:195], a[160:163], v[120:123], v[192:195]
    v_exp_f32 v39, v39
    v_mfma_f32_16x16x32_bf16 v[224:227], a[160:163], v[124:127], v[224:227]
    ds_read_b128 a[132:135], v2 offset:18432
    v_cvt_pk_bf16_f32 v99, v38, v39
    v_mfma_f32_16x16x32_bf16 v[228:231], a[164:167], v[124:127], v[228:231]
    v_exp_f32 v40, v40
    v_mfma_f32_16x16x32_bf16 v[196:199], a[164:167], v[120:123], v[196:199]
    ds_read_b128 a[136:139], v3 offset:18432
    v_mfma_f32_16x16x32_bf16 v[164:167], a[164:167], v[116:119], v[164:167]
    v_exp_f32 v41, v41
    v_mfma_f32_16x16x32_bf16 v[132:135], a[164:167], v[112:115], v[132:135]
    ds_read_b128 a[140:143], v4 offset:18432
    v_cvt_pk_bf16_f32 v100, v40, v41
    v_mfma_f32_16x16x32_bf16 v[136:139], a[168:171], v[112:115], v[136:139]
    v_exp_f32 v42, v42
    v_mfma_f32_16x16x32_bf16 v[168:171], a[168:171], v[116:119], v[168:171]
    ds_read_b128 a[144:147], v1 offset:19456
    v_mfma_f32_16x16x32_bf16 v[200:203], a[168:171], v[120:123], v[200:203]
    v_exp_f32 v43, v43
    v_mfma_f32_16x16x32_bf16 v[232:235], a[168:171], v[124:127], v[232:235]
    ds_read_b128 a[148:151], v2 offset:19456
    v_cvt_pk_bf16_f32 v101, v42, v43
    v_mfma_f32_16x16x32_bf16 v[236:239], a[172:175], v[124:127], v[236:239]
    v_exp_f32 v44, v44
    v_mfma_f32_16x16x32_bf16 v[204:207], a[172:175], v[120:123], v[204:207]
    ds_read_b128 a[152:155], v3 offset:19456
    v_mfma_f32_16x16x32_bf16 v[172:175], a[172:175], v[116:119], v[172:175]
    v_exp_f32 v45, v45
    v_mfma_f32_16x16x32_bf16 v[140:143], a[172:175], v[112:115], v[140:143]
    ds_read_b128 a[156:159], v4 offset:19456
    v_cvt_pk_bf16_f32 v102, v44, v45
    v_smfmac_f32_16x16x64_bf16 a[192:195], a[208:211], v[112:119], v15
    v_exp_f32 v46, v46
    v_mfma_f32_16x16x32_bf16 v[144:147], a[176:179], v[112:115], v[144:147]
    s_add_u32 m0, s29, 16384
    v_mfma_f32_16x16x32_bf16 v[176:179], a[176:179], v[116:119], v[176:179]
    v_exp_f32 v47, v47
    v_mfma_f32_16x16x32_bf16 v[208:211], a[176:179], v[120:123], v[208:211]
    v_cvt_pk_bf16_f32 v103, v46, v47
    s_waitcnt vmcnt(16) lgkmcnt(0)
    s_barrier
    v_mfma_f32_16x16x32_bf16 v[240:243], a[176:179], v[124:127], v[240:243]
    v_exp_f32 v48, v48
    v_mfma_f32_16x16x32_bf16 v[244:247], a[180:183], v[124:127], v[244:247]
    buffer_load_dwordx4 v13, s[16:19], s32 offen offset:0 nt lds
    v_mfma_f32_16x16x32_bf16 v[212:215], a[180:183], v[120:123], v[212:215]
    v_exp_f32 v49, v49
    v_mfma_f32_16x16x32_bf16 v[180:183], a[180:183], v[116:119], v[180:183]
    ds_read_b64_tr_b16 a[160:161], v5 offset:32768
    v_cvt_pk_bf16_f32 v104, v48, v49
    v_mfma_f32_16x16x32_bf16 v[148:151], a[180:183], v[112:115], v[148:151]
    v_exp_f32 v50, v50
    v_mfma_f32_16x16x32_bf16 v[152:155], a[184:187], v[112:115], v[152:155]
    ds_read_b64_tr_b16 a[162:163], v5 offset:33792
    v_mfma_f32_16x16x32_bf16 v[184:187], a[184:187], v[116:119], v[184:187]
    v_exp_f32 v51, v51
    v_mfma_f32_16x16x32_bf16 v[216:219], a[184:187], v[120:123], v[216:219]
    ds_read_b64_tr_b16 a[164:165], v6 offset:32768
    v_cvt_pk_bf16_f32 v105, v50, v51
    v_mfma_f32_16x16x32_bf16 v[248:251], a[184:187], v[124:127], v[248:251]
    v_exp_f32 v52, v52
    v_mfma_f32_16x16x32_bf16 v[252:255], a[188:191], v[124:127], v[252:255]
    buffer_load_dwordx4 v13, s[16:19], s32 offen offset:1024 nt lds
    v_mfma_f32_16x16x32_bf16 v[220:223], a[188:191], v[120:123], v[220:223]
    v_exp_f32 v53, v53
    v_mfma_f32_16x16x32_bf16 v[188:191], a[188:191], v[116:119], v[188:191]
    ds_read_b64_tr_b16 a[166:167], v6 offset:33792
    v_cvt_pk_bf16_f32 v106, v52, v53
    v_mfma_f32_16x16x32_bf16 v[156:159], a[188:191], v[112:115], v[156:159]
    v_exp_f32 v54, v54
    v_smfmac_f32_16x16x64_bf16 a[196:199], a[208:211], v[120:127], v15
    ds_read_b64_tr_b16 a[168:169], v7 offset:32768
    v_mfma_f32_16x16x32_bf16 v[64:67], a[128:131], a[0:3], v[16:19]
    v_exp_f32 v55, v55
    v_mfma_f32_16x16x32_bf16 v[72:75], a[128:131], a[16:19], v[20:23]
    ds_read_b64_tr_b16 a[170:171], v7 offset:33792
    v_cvt_pk_bf16_f32 v107, v54, v55
    v_mfma_f32_16x16x32_bf16 v[76:79], a[144:147], a[16:19], v[20:23]
    v_exp_f32 v56, v56
    v_mfma_f32_16x16x32_bf16 v[68:71], a[144:147], a[0:3], v[16:19]
    buffer_load_dwordx4 v13, s[16:19], s32 offen offset:2048 nt lds
    v_mfma_f32_16x16x32_bf16 v[76:79], a[148:151], a[20:23], v[76:79]
    v_exp_f32 v57, v57
    v_mfma_f32_16x16x32_bf16 v[68:71], a[148:151], a[4:7], v[68:71]
    ds_read_b64_tr_b16 a[172:173], v8 offset:32768
    v_cvt_pk_bf16_f32 v108, v56, v57
    v_mfma_f32_16x16x32_bf16 v[64:67], a[132:135], a[4:7], v[64:67]
    v_exp_f32 v58, v58
    v_mfma_f32_16x16x32_bf16 v[72:75], a[132:135], a[20:23], v[72:75]
    ds_read_b64_tr_b16 a[174:175], v8 offset:33792
    v_mfma_f32_16x16x32_bf16 v[64:67], a[136:139], a[8:11], v[64:67]
    v_exp_f32 v59, v59
    v_mfma_f32_16x16x32_bf16 v[72:75], a[136:139], a[24:27], v[72:75]
    ds_read_b64_tr_b16 a[176:177], v9 offset:32768
    v_cvt_pk_bf16_f32 v109, v58, v59
    v_mfma_f32_16x16x32_bf16 v[76:79], a[152:155], a[24:27], v[76:79]
    v_exp_f32 v60, v60
    v_mfma_f32_16x16x32_bf16 v[68:71], a[152:155], a[8:11], v[68:71]
    buffer_load_dwordx4 v13, s[16:19], s32 offen offset:3072 nt lds
    v_mfma_f32_16x16x32_bf16 v[76:79], a[156:159], a[28:31], v[76:79]
    v_exp_f32 v61, v61
    v_mfma_f32_16x16x32_bf16 v[68:71], a[156:159], a[12:15], v[68:71]
    ds_read_b64_tr_b16 a[178:179], v9 offset:33792
    v_cvt_pk_bf16_f32 v110, v60, v61
    v_mfma_f32_16x16x32_bf16 v[64:67], a[140:143], a[12:15], v[64:67]
    v_exp_f32 v62, v62
    v_mfma_f32_16x16x32_bf16 v[72:75], a[140:143], a[28:31], v[72:75]
    ds_read_b64_tr_b16 a[180:181], v10 offset:32768
    s_add_u32 m0, s30, 16384
    v_mfma_f32_16x16x32_bf16 v[80:83], a[128:131], a[32:35], v[24:27]
    v_exp_f32 v63, v63
    v_mfma_f32_16x16x32_bf16 v[88:91], a[128:131], a[48:51], v[28:31]
    ds_read_b64_tr_b16 a[182:183], v10 offset:33792
    v_cvt_pk_bf16_f32 v111, v62, v63
    v_mfma_f32_16x16x32_bf16 v[92:95], a[144:147], a[48:51], v[28:31]
    buffer_load_dwordx4 v13, s[20:23], s33 offen offset:0 nt lds
    v_mfma_f32_16x16x32_bf16 v[84:87], a[144:147], a[32:35], v[24:27]
    buffer_load_dwordx4 v13, s[20:23], s33 offen offset:1024 nt lds
    v_mfma_f32_16x16x32_bf16 v[92:95], a[148:151], a[52:55], v[92:95]
    v_exp_f32 v64, v64
    v_mfma_f32_16x16x32_bf16 v[84:87], a[148:151], a[36:39], v[84:87]
    buffer_load_dwordx4 v13, s[20:23], s33 offen offset:2048 nt lds
    v_mfma_f32_16x16x32_bf16 v[80:83], a[132:135], a[36:39], v[80:83]
    v_exp_f32 v65, v65
    v_mfma_f32_16x16x32_bf16 v[88:91], a[132:135], a[52:55], v[88:91]
    buffer_load_dwordx4 v13, s[20:23], s33 offen offset:3072 nt lds
    v_cvt_pk_bf16_f32 v112, v64, v65
    v_mfma_f32_16x16x32_bf16 v[80:83], a[136:139], a[40:43], v[80:83]
    v_exp_f32 v66, v66
    v_mfma_f32_16x16x32_bf16 v[88:91], a[136:139], a[56:59], v[88:91]
    s_add_u32 s32, s32, 0x4000
    s_add_u32 s33, s33, 0x4000
    v_mfma_f32_16x16x32_bf16 v[92:95], a[152:155], a[56:59], v[92:95]
    v_exp_f32 v67, v67
    v_mfma_f32_16x16x32_bf16 v[84:87], a[152:155], a[40:43], v[84:87]
    v_cvt_pk_bf16_f32 v113, v66, v67
    v_mfma_f32_16x16x32_bf16 v[92:95], a[156:159], a[60:63], v[92:95]
    v_exp_f32 v68, v68
    v_mfma_f32_16x16x32_bf16 v[84:87], a[156:159], a[44:47], v[84:87]
    v_mfma_f32_16x16x32_bf16 v[80:83], a[140:143], a[44:47], v[80:83]
    v_exp_f32 v69, v69
    v_mfma_f32_16x16x32_bf16 v[88:91], a[140:143], a[60:63], v[88:91]
    ds_read_b64_tr_b16 a[184:185], v11 offset:32768
    ds_read_b64_tr_b16 a[186:187], v11 offset:33792
    ds_read_b64_tr_b16 a[188:189], v12 offset:32768
    ds_read_b64_tr_b16 a[190:191], v12 offset:33792
    v_cvt_pk_bf16_f32 v114, v68, v69
    s_waitcnt lgkmcnt(0)
    v_mfma_f32_16x16x32_bf16 v[128:131], a[160:163], v[96:99], v[128:131]
    v_exp_f32 v70, v70
    v_mfma_f32_16x16x32_bf16 v[160:163], a[160:163], v[100:103], v[160:163]
    ds_read_b128 a[128:131], v1 offset:32768
    v_mfma_f32_16x16x32_bf16 v[192:195], a[160:163], v[104:107], v[192:195]
    v_exp_f32 v71, v71
    v_mfma_f32_16x16x32_bf16 v[224:227], a[160:163], v[108:111], v[224:227]
    ds_read_b128 a[132:135], v2 offset:32768
    v_cvt_pk_bf16_f32 v115, v70, v71
    v_mfma_f32_16x16x32_bf16 v[228:231], a[164:167], v[108:111], v[228:231]
    v_exp_f32 v72, v72
    v_mfma_f32_16x16x32_bf16 v[196:199], a[164:167], v[104:107], v[196:199]
    ds_read_b128 a[136:139], v3 offset:32768
    v_mfma_f32_16x16x32_bf16 v[164:167], a[164:167], v[100:103], v[164:167]
    v_exp_f32 v73, v73
    v_mfma_f32_16x16x32_bf16 v[132:135], a[164:167], v[96:99], v[132:135]
    ds_read_b128 a[140:143], v4 offset:32768
    v_cvt_pk_bf16_f32 v116, v72, v73
    v_mfma_f32_16x16x32_bf16 v[136:139], a[168:171], v[96:99], v[136:139]
    v_exp_f32 v74, v74
    v_mfma_f32_16x16x32_bf16 v[168:171], a[168:171], v[100:103], v[168:171]
    ds_read_b128 a[144:147], v1 offset:33792
    v_mfma_f32_16x16x32_bf16 v[200:203], a[168:171], v[104:107], v[200:203]
    v_exp_f32 v75, v75
    v_mfma_f32_16x16x32_bf16 v[232:235], a[168:171], v[108:111], v[232:235]
    ds_read_b128 a[148:151], v2 offset:33792
    v_cvt_pk_bf16_f32 v117, v74, v75
    v_mfma_f32_16x16x32_bf16 v[236:239], a[172:175], v[108:111], v[236:239]
    v_exp_f32 v76, v76
    v_mfma_f32_16x16x32_bf16 v[204:207], a[172:175], v[104:107], v[204:207]
    ds_read_b128 a[152:155], v3 offset:33792
    v_mfma_f32_16x16x32_bf16 v[172:175], a[172:175], v[100:103], v[172:175]
    v_exp_f32 v77, v77
    v_mfma_f32_16x16x32_bf16 v[140:143], a[172:175], v[96:99], v[140:143]
    ds_read_b128 a[156:159], v4 offset:33792
    v_cvt_pk_bf16_f32 v118, v76, v77
    v_smfmac_f32_16x16x64_bf16 a[192:195], a[208:211], v[96:103], v15
    v_exp_f32 v78, v78
    v_mfma_f32_16x16x32_bf16 v[144:147], a[176:179], v[96:99], v[144:147]
    ds_read_b64_tr_b16 a[160:161], v5 offset:34816
    v_mfma_f32_16x16x32_bf16 v[176:179], a[176:179], v[100:103], v[176:179]
    v_exp_f32 v79, v79
    v_mfma_f32_16x16x32_bf16 v[208:211], a[176:179], v[104:107], v[208:211]
    ds_read_b64_tr_b16 a[162:163], v5 offset:35840
    v_cvt_pk_bf16_f32 v119, v78, v79
    v_mfma_f32_16x16x32_bf16 v[240:243], a[176:179], v[108:111], v[240:243]
    v_exp_f32 v80, v80
    v_mfma_f32_16x16x32_bf16 v[244:247], a[180:183], v[108:111], v[244:247]
    ds_read_b64_tr_b16 a[164:165], v6 offset:34816
    v_mfma_f32_16x16x32_bf16 v[212:215], a[180:183], v[104:107], v[212:215]
    v_exp_f32 v81, v81
    v_mfma_f32_16x16x32_bf16 v[180:183], a[180:183], v[100:103], v[180:183]
    ds_read_b64_tr_b16 a[166:167], v6 offset:35840
    v_cvt_pk_bf16_f32 v120, v80, v81
    v_mfma_f32_16x16x32_bf16 v[148:151], a[180:183], v[96:99], v[148:151]
    v_exp_f32 v82, v82
    v_mfma_f32_16x16x32_bf16 v[152:155], a[184:187], v[96:99], v[152:155]
    ds_read_b64_tr_b16 a[168:169], v7 offset:34816
    s_waitcnt lgkmcnt(5)
    v_mfma_f32_16x16x32_bf16 v[184:187], a[184:187], v[100:103], v[184:187]
    v_exp_f32 v83, v83
    v_mfma_f32_16x16x32_bf16 v[216:219], a[184:187], v[104:107], v[216:219]
    ds_read_b64_tr_b16 a[170:171], v7 offset:35840
    v_cvt_pk_bf16_f32 v121, v82, v83
    v_mfma_f32_16x16x32_bf16 v[248:251], a[184:187], v[108:111], v[248:251]
    v_exp_f32 v84, v84
    v_mfma_f32_16x16x32_bf16 v[252:255], a[188:191], v[108:111], v[252:255]
    ds_read_b64_tr_b16 a[172:173], v8 offset:34816
    v_mfma_f32_16x16x32_bf16 v[220:223], a[188:191], v[104:107], v[220:223]
    v_exp_f32 v85, v85
    v_mfma_f32_16x16x32_bf16 v[188:191], a[188:191], v[100:103], v[188:191]
    ds_read_b64_tr_b16 a[174:175], v8 offset:35840
    v_cvt_pk_bf16_f32 v122, v84, v85
    v_mfma_f32_16x16x32_bf16 v[156:159], a[188:191], v[96:99], v[156:159]
    v_exp_f32 v86, v86
    v_smfmac_f32_16x16x64_bf16 a[196:199], a[208:211], v[104:111], v15
    ds_read_b64_tr_b16 a[176:177], v9 offset:34816
    v_mfma_f32_16x16x32_bf16 v[32:35], a[128:131], a[0:3], v[16:19]
    v_exp_f32 v87, v87
    v_mfma_f32_16x16x32_bf16 v[40:43], a[128:131], a[16:19], v[20:23]
    ds_read_b64_tr_b16 a[178:179], v9 offset:35840
    v_cvt_pk_bf16_f32 v123, v86, v87
    v_mfma_f32_16x16x32_bf16 v[44:47], a[144:147], a[16:19], v[20:23]
    v_exp_f32 v88, v88
    v_mfma_f32_16x16x32_bf16 v[36:39], a[144:147], a[0:3], v[16:19]
    ds_read_b64_tr_b16 a[180:181], v10 offset:34816
    v_mfma_f32_16x16x32_bf16 v[44:47], a[148:151], a[20:23], v[44:47]
    v_exp_f32 v89, v89
    v_mfma_f32_16x16x32_bf16 v[36:39], a[148:151], a[4:7], v[36:39]
    ds_read_b64_tr_b16 a[182:183], v10 offset:35840
    v_cvt_pk_bf16_f32 v124, v88, v89
    v_mfma_f32_16x16x32_bf16 v[32:35], a[132:135], a[4:7], v[32:35]
    v_exp_f32 v90, v90
    v_mfma_f32_16x16x32_bf16 v[40:43], a[132:135], a[20:23], v[40:43]
    v_mfma_f32_16x16x32_bf16 v[32:35], a[136:139], a[8:11], v[32:35]
    v_exp_f32 v91, v91
    v_mfma_f32_16x16x32_bf16 v[40:43], a[136:139], a[24:27], v[40:43]
    v_cvt_pk_bf16_f32 v125, v90, v91
    v_mfma_f32_16x16x32_bf16 v[44:47], a[152:155], a[24:27], v[44:47]
    v_exp_f32 v92, v92
    v_mfma_f32_16x16x32_bf16 v[36:39], a[152:155], a[8:11], v[36:39]
    v_mfma_f32_16x16x32_bf16 v[44:47], a[156:159], a[28:31], v[44:47]
    v_exp_f32 v93, v93
    v_mfma_f32_16x16x32_bf16 v[36:39], a[156:159], a[12:15], v[36:39]
    v_cvt_pk_bf16_f32 v126, v92, v93
    v_mfma_f32_16x16x32_bf16 v[32:35], a[140:143], a[12:15], v[32:35]
    v_exp_f32 v94, v94
    v_mfma_f32_16x16x32_bf16 v[40:43], a[140:143], a[28:31], v[40:43]
    v_mfma_f32_16x16x32_bf16 v[48:51], a[128:131], a[32:35], v[24:27]
    v_exp_f32 v95, v95
    v_mfma_f32_16x16x32_bf16 v[56:59], a[128:131], a[48:51], v[28:31]
    v_cvt_pk_bf16_f32 v127, v94, v95
    v_mfma_f32_16x16x32_bf16 v[60:63], a[144:147], a[48:51], v[28:31]
    v_mfma_f32_16x16x32_bf16 v[52:55], a[144:147], a[32:35], v[24:27]
    v_mfma_f32_16x16x32_bf16 v[60:63], a[148:151], a[52:55], v[60:63]
    v_exp_f32 v32, v32
    v_mfma_f32_16x16x32_bf16 v[52:55], a[148:151], a[36:39], v[52:55]
    v_mfma_f32_16x16x32_bf16 v[48:51], a[132:135], a[36:39], v[48:51]
    v_exp_f32 v33, v33
    v_mfma_f32_16x16x32_bf16 v[56:59], a[132:135], a[52:55], v[56:59]
    v_cvt_pk_bf16_f32 v96, v32, v33
    v_mfma_f32_16x16x32_bf16 v[48:51], a[136:139], a[40:43], v[48:51]
    v_exp_f32 v34, v34
    v_mfma_f32_16x16x32_bf16 v[56:59], a[136:139], a[56:59], v[56:59]
    v_mfma_f32_16x16x32_bf16 v[60:63], a[152:155], a[56:59], v[60:63]
    v_exp_f32 v35, v35
    v_mfma_f32_16x16x32_bf16 v[52:55], a[152:155], a[40:43], v[52:55]
    v_cvt_pk_bf16_f32 v97, v34, v35
    v_mfma_f32_16x16x32_bf16 v[60:63], a[156:159], a[60:63], v[60:63]
    v_exp_f32 v36, v36
    v_mfma_f32_16x16x32_bf16 v[52:55], a[156:159], a[44:47], v[52:55]
    v_mfma_f32_16x16x32_bf16 v[48:51], a[140:143], a[44:47], v[48:51]
    v_exp_f32 v37, v37
    v_mfma_f32_16x16x32_bf16 v[56:59], a[140:143], a[60:63], v[56:59]
    ds_read_b64_tr_b16 a[184:185], v11 offset:34816
    ds_read_b64_tr_b16 a[186:187], v11 offset:35840
    ds_read_b64_tr_b16 a[188:189], v12 offset:34816
    ds_read_b64_tr_b16 a[190:191], v12 offset:35840
    v_cvt_pk_bf16_f32 v98, v36, v37
    s_waitcnt lgkmcnt(0)
    v_mfma_f32_16x16x32_bf16 v[128:131], a[160:163], v[112:115], v[128:131]
    v_exp_f32 v38, v38
    v_mfma_f32_16x16x32_bf16 v[160:163], a[160:163], v[116:119], v[160:163]
    ds_read_b128 a[128:131], v1 offset:34816
    v_mfma_f32_16x16x32_bf16 v[192:195], a[160:163], v[120:123], v[192:195]
    v_exp_f32 v39, v39
    v_mfma_f32_16x16x32_bf16 v[224:227], a[160:163], v[124:127], v[224:227]
    ds_read_b128 a[132:135], v2 offset:34816
    v_cvt_pk_bf16_f32 v99, v38, v39
    v_mfma_f32_16x16x32_bf16 v[228:231], a[164:167], v[124:127], v[228:231]
    v_exp_f32 v40, v40
    v_mfma_f32_16x16x32_bf16 v[196:199], a[164:167], v[120:123], v[196:199]
    ds_read_b128 a[136:139], v3 offset:34816
    v_mfma_f32_16x16x32_bf16 v[164:167], a[164:167], v[116:119], v[164:167]
    v_exp_f32 v41, v41
    v_mfma_f32_16x16x32_bf16 v[132:135], a[164:167], v[112:115], v[132:135]
    ds_read_b128 a[140:143], v4 offset:34816
    v_cvt_pk_bf16_f32 v100, v40, v41
    v_mfma_f32_16x16x32_bf16 v[136:139], a[168:171], v[112:115], v[136:139]
    v_exp_f32 v42, v42
    v_mfma_f32_16x16x32_bf16 v[168:171], a[168:171], v[116:119], v[168:171]
    ds_read_b128 a[144:147], v1 offset:35840
    v_mfma_f32_16x16x32_bf16 v[200:203], a[168:171], v[120:123], v[200:203]
    v_exp_f32 v43, v43
    v_mfma_f32_16x16x32_bf16 v[232:235], a[168:171], v[124:127], v[232:235]
    ds_read_b128 a[148:151], v2 offset:35840
    v_cvt_pk_bf16_f32 v101, v42, v43
    v_mfma_f32_16x16x32_bf16 v[236:239], a[172:175], v[124:127], v[236:239]
    v_exp_f32 v44, v44
    v_mfma_f32_16x16x32_bf16 v[204:207], a[172:175], v[120:123], v[204:207]
    ds_read_b128 a[152:155], v3 offset:35840
    v_mfma_f32_16x16x32_bf16 v[172:175], a[172:175], v[116:119], v[172:175]
    v_exp_f32 v45, v45
    v_mfma_f32_16x16x32_bf16 v[140:143], a[172:175], v[112:115], v[140:143]
    ds_read_b128 a[156:159], v4 offset:35840
    v_cvt_pk_bf16_f32 v102, v44, v45
    v_smfmac_f32_16x16x64_bf16 a[192:195], a[208:211], v[112:119], v15
    v_exp_f32 v46, v46
    v_mfma_f32_16x16x32_bf16 v[144:147], a[176:179], v[112:115], v[144:147]
    s_add_u32 m0, s29, 32768
    v_mfma_f32_16x16x32_bf16 v[176:179], a[176:179], v[116:119], v[176:179]
    v_exp_f32 v47, v47
    v_mfma_f32_16x16x32_bf16 v[208:211], a[176:179], v[120:123], v[208:211]
    v_cvt_pk_bf16_f32 v103, v46, v47
    s_waitcnt vmcnt(16) lgkmcnt(0)
    s_barrier
    v_mfma_f32_16x16x32_bf16 v[240:243], a[176:179], v[124:127], v[240:243]
    v_exp_f32 v48, v48
    v_mfma_f32_16x16x32_bf16 v[244:247], a[180:183], v[124:127], v[244:247]
    buffer_load_dwordx4 v13, s[16:19], s32 offen offset:0 nt lds
    v_mfma_f32_16x16x32_bf16 v[212:215], a[180:183], v[120:123], v[212:215]
    v_exp_f32 v49, v49
    v_mfma_f32_16x16x32_bf16 v[180:183], a[180:183], v[116:119], v[180:183]
    ds_read_b64_tr_b16 a[160:161], v5 offset:49152
    v_cvt_pk_bf16_f32 v104, v48, v49
    v_mfma_f32_16x16x32_bf16 v[148:151], a[180:183], v[112:115], v[148:151]
    v_exp_f32 v50, v50
    v_mfma_f32_16x16x32_bf16 v[152:155], a[184:187], v[112:115], v[152:155]
    ds_read_b64_tr_b16 a[162:163], v5 offset:50176
    v_mfma_f32_16x16x32_bf16 v[184:187], a[184:187], v[116:119], v[184:187]
    v_exp_f32 v51, v51
    v_mfma_f32_16x16x32_bf16 v[216:219], a[184:187], v[120:123], v[216:219]
    ds_read_b64_tr_b16 a[164:165], v6 offset:49152
    v_cvt_pk_bf16_f32 v105, v50, v51
    v_mfma_f32_16x16x32_bf16 v[248:251], a[184:187], v[124:127], v[248:251]
    v_exp_f32 v52, v52
    v_mfma_f32_16x16x32_bf16 v[252:255], a[188:191], v[124:127], v[252:255]
    buffer_load_dwordx4 v13, s[16:19], s32 offen offset:1024 nt lds
    v_mfma_f32_16x16x32_bf16 v[220:223], a[188:191], v[120:123], v[220:223]
    v_exp_f32 v53, v53
    v_mfma_f32_16x16x32_bf16 v[188:191], a[188:191], v[116:119], v[188:191]
    ds_read_b64_tr_b16 a[166:167], v6 offset:50176
    v_cvt_pk_bf16_f32 v106, v52, v53
    v_mfma_f32_16x16x32_bf16 v[156:159], a[188:191], v[112:115], v[156:159]
    v_exp_f32 v54, v54
    v_smfmac_f32_16x16x64_bf16 a[196:199], a[208:211], v[120:127], v15
    ds_read_b64_tr_b16 a[168:169], v7 offset:49152
    v_mfma_f32_16x16x32_bf16 v[64:67], a[128:131], a[0:3], v[16:19]
    v_exp_f32 v55, v55
    v_mfma_f32_16x16x32_bf16 v[72:75], a[128:131], a[16:19], v[20:23]
    ds_read_b64_tr_b16 a[170:171], v7 offset:50176
    v_cvt_pk_bf16_f32 v107, v54, v55
    v_mfma_f32_16x16x32_bf16 v[76:79], a[144:147], a[16:19], v[20:23]
    v_exp_f32 v56, v56
    v_mfma_f32_16x16x32_bf16 v[68:71], a[144:147], a[0:3], v[16:19]
    buffer_load_dwordx4 v13, s[16:19], s32 offen offset:2048 nt lds
    v_mfma_f32_16x16x32_bf16 v[76:79], a[148:151], a[20:23], v[76:79]
    v_exp_f32 v57, v57
    v_mfma_f32_16x16x32_bf16 v[68:71], a[148:151], a[4:7], v[68:71]
    ds_read_b64_tr_b16 a[172:173], v8 offset:49152
    v_cvt_pk_bf16_f32 v108, v56, v57
    v_mfma_f32_16x16x32_bf16 v[64:67], a[132:135], a[4:7], v[64:67]
    v_exp_f32 v58, v58
    v_mfma_f32_16x16x32_bf16 v[72:75], a[132:135], a[20:23], v[72:75]
    ds_read_b64_tr_b16 a[174:175], v8 offset:50176
    v_mfma_f32_16x16x32_bf16 v[64:67], a[136:139], a[8:11], v[64:67]
    v_exp_f32 v59, v59
    v_mfma_f32_16x16x32_bf16 v[72:75], a[136:139], a[24:27], v[72:75]
    ds_read_b64_tr_b16 a[176:177], v9 offset:49152
    v_cvt_pk_bf16_f32 v109, v58, v59
    v_mfma_f32_16x16x32_bf16 v[76:79], a[152:155], a[24:27], v[76:79]
    v_exp_f32 v60, v60
    v_mfma_f32_16x16x32_bf16 v[68:71], a[152:155], a[8:11], v[68:71]
    buffer_load_dwordx4 v13, s[16:19], s32 offen offset:3072 nt lds
    v_mfma_f32_16x16x32_bf16 v[76:79], a[156:159], a[28:31], v[76:79]
    v_exp_f32 v61, v61
    v_mfma_f32_16x16x32_bf16 v[68:71], a[156:159], a[12:15], v[68:71]
    ds_read_b64_tr_b16 a[178:179], v9 offset:50176
    v_cvt_pk_bf16_f32 v110, v60, v61
    v_mfma_f32_16x16x32_bf16 v[64:67], a[140:143], a[12:15], v[64:67]
    v_exp_f32 v62, v62
    v_mfma_f32_16x16x32_bf16 v[72:75], a[140:143], a[28:31], v[72:75]
    ds_read_b64_tr_b16 a[180:181], v10 offset:49152
    s_add_u32 m0, s30, 32768
    v_mfma_f32_16x16x32_bf16 v[80:83], a[128:131], a[32:35], v[24:27]
    v_exp_f32 v63, v63
    v_mfma_f32_16x16x32_bf16 v[88:91], a[128:131], a[48:51], v[28:31]
    ds_read_b64_tr_b16 a[182:183], v10 offset:50176
    v_cvt_pk_bf16_f32 v111, v62, v63
    v_mfma_f32_16x16x32_bf16 v[92:95], a[144:147], a[48:51], v[28:31]
    buffer_load_dwordx4 v13, s[20:23], s33 offen offset:0 nt lds
    v_mfma_f32_16x16x32_bf16 v[84:87], a[144:147], a[32:35], v[24:27]
    buffer_load_dwordx4 v13, s[20:23], s33 offen offset:1024 nt lds
    v_mfma_f32_16x16x32_bf16 v[92:95], a[148:151], a[52:55], v[92:95]
    v_exp_f32 v64, v64
    v_mfma_f32_16x16x32_bf16 v[84:87], a[148:151], a[36:39], v[84:87]
    buffer_load_dwordx4 v13, s[20:23], s33 offen offset:2048 nt lds
    v_mfma_f32_16x16x32_bf16 v[80:83], a[132:135], a[36:39], v[80:83]
    v_exp_f32 v65, v65
    v_mfma_f32_16x16x32_bf16 v[88:91], a[132:135], a[52:55], v[88:91]
    buffer_load_dwordx4 v13, s[20:23], s33 offen offset:3072 nt lds
    v_cvt_pk_bf16_f32 v112, v64, v65
    v_mfma_f32_16x16x32_bf16 v[80:83], a[136:139], a[40:43], v[80:83]
    v_exp_f32 v66, v66
    v_mfma_f32_16x16x32_bf16 v[88:91], a[136:139], a[56:59], v[88:91]
    s_add_u32 s32, s32, 0x4000
    s_add_u32 s33, s33, 0x4000
    v_mfma_f32_16x16x32_bf16 v[92:95], a[152:155], a[56:59], v[92:95]
    v_exp_f32 v67, v67
    v_mfma_f32_16x16x32_bf16 v[84:87], a[152:155], a[40:43], v[84:87]
    v_cvt_pk_bf16_f32 v113, v66, v67
    v_mfma_f32_16x16x32_bf16 v[92:95], a[156:159], a[60:63], v[92:95]
    v_exp_f32 v68, v68
    v_mfma_f32_16x16x32_bf16 v[84:87], a[156:159], a[44:47], v[84:87]
    v_mfma_f32_16x16x32_bf16 v[80:83], a[140:143], a[44:47], v[80:83]
    v_exp_f32 v69, v69
    v_mfma_f32_16x16x32_bf16 v[88:91], a[140:143], a[60:63], v[88:91]
    ds_read_b64_tr_b16 a[184:185], v11 offset:49152
    ds_read_b64_tr_b16 a[186:187], v11 offset:50176
    ds_read_b64_tr_b16 a[188:189], v12 offset:49152
    ds_read_b64_tr_b16 a[190:191], v12 offset:50176
    v_cvt_pk_bf16_f32 v114, v68, v69
    s_waitcnt lgkmcnt(0)
    v_mfma_f32_16x16x32_bf16 v[128:131], a[160:163], v[96:99], v[128:131]
    v_exp_f32 v70, v70
    v_mfma_f32_16x16x32_bf16 v[160:163], a[160:163], v[100:103], v[160:163]
    ds_read_b128 a[128:131], v1 offset:49152
    v_mfma_f32_16x16x32_bf16 v[192:195], a[160:163], v[104:107], v[192:195]
    v_exp_f32 v71, v71
    v_mfma_f32_16x16x32_bf16 v[224:227], a[160:163], v[108:111], v[224:227]
    ds_read_b128 a[132:135], v2 offset:49152
    v_cvt_pk_bf16_f32 v115, v70, v71
    v_mfma_f32_16x16x32_bf16 v[228:231], a[164:167], v[108:111], v[228:231]
    v_exp_f32 v72, v72
    v_mfma_f32_16x16x32_bf16 v[196:199], a[164:167], v[104:107], v[196:199]
    ds_read_b128 a[136:139], v3 offset:49152
    v_mfma_f32_16x16x32_bf16 v[164:167], a[164:167], v[100:103], v[164:167]
    v_exp_f32 v73, v73
    v_mfma_f32_16x16x32_bf16 v[132:135], a[164:167], v[96:99], v[132:135]
    ds_read_b128 a[140:143], v4 offset:49152
    v_cvt_pk_bf16_f32 v116, v72, v73
    v_mfma_f32_16x16x32_bf16 v[136:139], a[168:171], v[96:99], v[136:139]
    v_exp_f32 v74, v74
    v_mfma_f32_16x16x32_bf16 v[168:171], a[168:171], v[100:103], v[168:171]
    ds_read_b128 a[144:147], v1 offset:50176
    v_mfma_f32_16x16x32_bf16 v[200:203], a[168:171], v[104:107], v[200:203]
    v_exp_f32 v75, v75
    v_mfma_f32_16x16x32_bf16 v[232:235], a[168:171], v[108:111], v[232:235]
    ds_read_b128 a[148:151], v2 offset:50176
    v_cvt_pk_bf16_f32 v117, v74, v75
    v_mfma_f32_16x16x32_bf16 v[236:239], a[172:175], v[108:111], v[236:239]
    v_exp_f32 v76, v76
    v_mfma_f32_16x16x32_bf16 v[204:207], a[172:175], v[104:107], v[204:207]
    ds_read_b128 a[152:155], v3 offset:50176
    v_mfma_f32_16x16x32_bf16 v[172:175], a[172:175], v[100:103], v[172:175]
    v_exp_f32 v77, v77
    v_mfma_f32_16x16x32_bf16 v[140:143], a[172:175], v[96:99], v[140:143]
    ds_read_b128 a[156:159], v4 offset:50176
    v_cvt_pk_bf16_f32 v118, v76, v77
    v_smfmac_f32_16x16x64_bf16 a[192:195], a[208:211], v[96:103], v15
    v_exp_f32 v78, v78
    v_mfma_f32_16x16x32_bf16 v[144:147], a[176:179], v[96:99], v[144:147]
    ds_read_b64_tr_b16 a[160:161], v5 offset:51200
    v_mfma_f32_16x16x32_bf16 v[176:179], a[176:179], v[100:103], v[176:179]
    v_exp_f32 v79, v79
    v_mfma_f32_16x16x32_bf16 v[208:211], a[176:179], v[104:107], v[208:211]
    ds_read_b64_tr_b16 a[162:163], v5 offset:52224
    v_cvt_pk_bf16_f32 v119, v78, v79
    v_mfma_f32_16x16x32_bf16 v[240:243], a[176:179], v[108:111], v[240:243]
    v_exp_f32 v80, v80
    v_mfma_f32_16x16x32_bf16 v[244:247], a[180:183], v[108:111], v[244:247]
    ds_read_b64_tr_b16 a[164:165], v6 offset:51200
    v_mfma_f32_16x16x32_bf16 v[212:215], a[180:183], v[104:107], v[212:215]
    v_exp_f32 v81, v81
    v_mfma_f32_16x16x32_bf16 v[180:183], a[180:183], v[100:103], v[180:183]
    ds_read_b64_tr_b16 a[166:167], v6 offset:52224
    v_cvt_pk_bf16_f32 v120, v80, v81
    v_mfma_f32_16x16x32_bf16 v[148:151], a[180:183], v[96:99], v[148:151]
    v_exp_f32 v82, v82
    v_mfma_f32_16x16x32_bf16 v[152:155], a[184:187], v[96:99], v[152:155]
    ds_read_b64_tr_b16 a[168:169], v7 offset:51200
    s_waitcnt lgkmcnt(5)
    v_mfma_f32_16x16x32_bf16 v[184:187], a[184:187], v[100:103], v[184:187]
    v_exp_f32 v83, v83
    v_mfma_f32_16x16x32_bf16 v[216:219], a[184:187], v[104:107], v[216:219]
    ds_read_b64_tr_b16 a[170:171], v7 offset:52224
    v_cvt_pk_bf16_f32 v121, v82, v83
    v_mfma_f32_16x16x32_bf16 v[248:251], a[184:187], v[108:111], v[248:251]
    v_exp_f32 v84, v84
    v_mfma_f32_16x16x32_bf16 v[252:255], a[188:191], v[108:111], v[252:255]
    ds_read_b64_tr_b16 a[172:173], v8 offset:51200
    v_mfma_f32_16x16x32_bf16 v[220:223], a[188:191], v[104:107], v[220:223]
    v_exp_f32 v85, v85
    v_mfma_f32_16x16x32_bf16 v[188:191], a[188:191], v[100:103], v[188:191]
    ds_read_b64_tr_b16 a[174:175], v8 offset:52224
    v_cvt_pk_bf16_f32 v122, v84, v85
    v_mfma_f32_16x16x32_bf16 v[156:159], a[188:191], v[96:99], v[156:159]
    v_exp_f32 v86, v86
    v_smfmac_f32_16x16x64_bf16 a[196:199], a[208:211], v[104:111], v15
    ds_read_b64_tr_b16 a[176:177], v9 offset:51200
    v_mfma_f32_16x16x32_bf16 v[32:35], a[128:131], a[0:3], v[16:19]
    v_exp_f32 v87, v87
    v_mfma_f32_16x16x32_bf16 v[40:43], a[128:131], a[16:19], v[20:23]
    ds_read_b64_tr_b16 a[178:179], v9 offset:52224
    v_cvt_pk_bf16_f32 v123, v86, v87
    v_mfma_f32_16x16x32_bf16 v[44:47], a[144:147], a[16:19], v[20:23]
    v_exp_f32 v88, v88
    v_mfma_f32_16x16x32_bf16 v[36:39], a[144:147], a[0:3], v[16:19]
    ds_read_b64_tr_b16 a[180:181], v10 offset:51200
    v_mfma_f32_16x16x32_bf16 v[44:47], a[148:151], a[20:23], v[44:47]
    v_exp_f32 v89, v89
    v_mfma_f32_16x16x32_bf16 v[36:39], a[148:151], a[4:7], v[36:39]
    ds_read_b64_tr_b16 a[182:183], v10 offset:52224
    v_cvt_pk_bf16_f32 v124, v88, v89
    v_mfma_f32_16x16x32_bf16 v[32:35], a[132:135], a[4:7], v[32:35]
    v_exp_f32 v90, v90
    v_mfma_f32_16x16x32_bf16 v[40:43], a[132:135], a[20:23], v[40:43]
    v_mfma_f32_16x16x32_bf16 v[32:35], a[136:139], a[8:11], v[32:35]
    v_exp_f32 v91, v91
    v_mfma_f32_16x16x32_bf16 v[40:43], a[136:139], a[24:27], v[40:43]
    v_cvt_pk_bf16_f32 v125, v90, v91
    v_mfma_f32_16x16x32_bf16 v[44:47], a[152:155], a[24:27], v[44:47]
    v_exp_f32 v92, v92
    v_mfma_f32_16x16x32_bf16 v[36:39], a[152:155], a[8:11], v[36:39]
    v_mfma_f32_16x16x32_bf16 v[44:47], a[156:159], a[28:31], v[44:47]
    v_exp_f32 v93, v93
    v_mfma_f32_16x16x32_bf16 v[36:39], a[156:159], a[12:15], v[36:39]
    v_cvt_pk_bf16_f32 v126, v92, v93
    v_mfma_f32_16x16x32_bf16 v[32:35], a[140:143], a[12:15], v[32:35]
    v_exp_f32 v94, v94
    v_mfma_f32_16x16x32_bf16 v[40:43], a[140:143], a[28:31], v[40:43]
    v_mfma_f32_16x16x32_bf16 v[48:51], a[128:131], a[32:35], v[24:27]
    v_exp_f32 v95, v95
    v_mfma_f32_16x16x32_bf16 v[56:59], a[128:131], a[48:51], v[28:31]
    v_cvt_pk_bf16_f32 v127, v94, v95
    v_mfma_f32_16x16x32_bf16 v[60:63], a[144:147], a[48:51], v[28:31]
    v_mfma_f32_16x16x32_bf16 v[52:55], a[144:147], a[32:35], v[24:27]
    v_mfma_f32_16x16x32_bf16 v[60:63], a[148:151], a[52:55], v[60:63]
    v_exp_f32 v32, v32
    v_mfma_f32_16x16x32_bf16 v[52:55], a[148:151], a[36:39], v[52:55]
    v_mfma_f32_16x16x32_bf16 v[48:51], a[132:135], a[36:39], v[48:51]
    v_exp_f32 v33, v33
    v_mfma_f32_16x16x32_bf16 v[56:59], a[132:135], a[52:55], v[56:59]
    v_cvt_pk_bf16_f32 v96, v32, v33
    v_mfma_f32_16x16x32_bf16 v[48:51], a[136:139], a[40:43], v[48:51]
    v_exp_f32 v34, v34
    v_mfma_f32_16x16x32_bf16 v[56:59], a[136:139], a[56:59], v[56:59]
    v_mfma_f32_16x16x32_bf16 v[60:63], a[152:155], a[56:59], v[60:63]
    v_exp_f32 v35, v35
    v_mfma_f32_16x16x32_bf16 v[52:55], a[152:155], a[40:43], v[52:55]
    v_cvt_pk_bf16_f32 v97, v34, v35
    v_mfma_f32_16x16x32_bf16 v[60:63], a[156:159], a[60:63], v[60:63]
    v_exp_f32 v36, v36
    v_mfma_f32_16x16x32_bf16 v[52:55], a[156:159], a[44:47], v[52:55]
    v_mfma_f32_16x16x32_bf16 v[48:51], a[140:143], a[44:47], v[48:51]
    v_exp_f32 v37, v37
    v_mfma_f32_16x16x32_bf16 v[56:59], a[140:143], a[60:63], v[56:59]
    ds_read_b64_tr_b16 a[184:185], v11 offset:51200
    ds_read_b64_tr_b16 a[186:187], v11 offset:52224
    ds_read_b64_tr_b16 a[188:189], v12 offset:51200
    ds_read_b64_tr_b16 a[190:191], v12 offset:52224
    v_cvt_pk_bf16_f32 v98, v36, v37
    s_waitcnt lgkmcnt(0)
    v_mfma_f32_16x16x32_bf16 v[128:131], a[160:163], v[112:115], v[128:131]
    v_exp_f32 v38, v38
    v_mfma_f32_16x16x32_bf16 v[160:163], a[160:163], v[116:119], v[160:163]
    ds_read_b128 a[128:131], v1 offset:51200
    v_mfma_f32_16x16x32_bf16 v[192:195], a[160:163], v[120:123], v[192:195]
    v_exp_f32 v39, v39
    v_mfma_f32_16x16x32_bf16 v[224:227], a[160:163], v[124:127], v[224:227]
    ds_read_b128 a[132:135], v2 offset:51200
    v_cvt_pk_bf16_f32 v99, v38, v39
    v_mfma_f32_16x16x32_bf16 v[228:231], a[164:167], v[124:127], v[228:231]
    v_exp_f32 v40, v40
    v_mfma_f32_16x16x32_bf16 v[196:199], a[164:167], v[120:123], v[196:199]
    ds_read_b128 a[136:139], v3 offset:51200
    v_mfma_f32_16x16x32_bf16 v[164:167], a[164:167], v[116:119], v[164:167]
    v_exp_f32 v41, v41
    v_mfma_f32_16x16x32_bf16 v[132:135], a[164:167], v[112:115], v[132:135]
    ds_read_b128 a[140:143], v4 offset:51200
    v_cvt_pk_bf16_f32 v100, v40, v41
    v_mfma_f32_16x16x32_bf16 v[136:139], a[168:171], v[112:115], v[136:139]
    v_exp_f32 v42, v42
    v_mfma_f32_16x16x32_bf16 v[168:171], a[168:171], v[116:119], v[168:171]
    ds_read_b128 a[144:147], v1 offset:52224
    v_mfma_f32_16x16x32_bf16 v[200:203], a[168:171], v[120:123], v[200:203]
    v_exp_f32 v43, v43
    v_mfma_f32_16x16x32_bf16 v[232:235], a[168:171], v[124:127], v[232:235]
    ds_read_b128 a[148:151], v2 offset:52224
    v_cvt_pk_bf16_f32 v101, v42, v43
    v_mfma_f32_16x16x32_bf16 v[236:239], a[172:175], v[124:127], v[236:239]
    v_exp_f32 v44, v44
    v_mfma_f32_16x16x32_bf16 v[204:207], a[172:175], v[120:123], v[204:207]
    ds_read_b128 a[152:155], v3 offset:52224
    v_mfma_f32_16x16x32_bf16 v[172:175], a[172:175], v[116:119], v[172:175]
    v_exp_f32 v45, v45
    v_mfma_f32_16x16x32_bf16 v[140:143], a[172:175], v[112:115], v[140:143]
    ds_read_b128 a[156:159], v4 offset:52224
    v_cvt_pk_bf16_f32 v102, v44, v45
    v_smfmac_f32_16x16x64_bf16 a[192:195], a[208:211], v[112:119], v15
    v_exp_f32 v46, v46
    v_mfma_f32_16x16x32_bf16 v[144:147], a[176:179], v[112:115], v[144:147]
    s_add_u32 m0, s29, 49152
    v_mfma_f32_16x16x32_bf16 v[176:179], a[176:179], v[116:119], v[176:179]
    v_exp_f32 v47, v47
    v_mfma_f32_16x16x32_bf16 v[208:211], a[176:179], v[120:123], v[208:211]
    v_cvt_pk_bf16_f32 v103, v46, v47
    s_waitcnt vmcnt(16) lgkmcnt(0)
    s_barrier
    v_mfma_f32_16x16x32_bf16 v[240:243], a[176:179], v[124:127], v[240:243]
    v_exp_f32 v48, v48
    v_mfma_f32_16x16x32_bf16 v[244:247], a[180:183], v[124:127], v[244:247]
    buffer_load_dwordx4 v13, s[16:19], s32 offen offset:0 nt lds
    v_mfma_f32_16x16x32_bf16 v[212:215], a[180:183], v[120:123], v[212:215]
    v_exp_f32 v49, v49
    v_mfma_f32_16x16x32_bf16 v[180:183], a[180:183], v[116:119], v[180:183]
    ds_read_b64_tr_b16 a[160:161], v5 offset:0
    v_cvt_pk_bf16_f32 v104, v48, v49
    v_mfma_f32_16x16x32_bf16 v[148:151], a[180:183], v[112:115], v[148:151]
    v_exp_f32 v50, v50
    v_mfma_f32_16x16x32_bf16 v[152:155], a[184:187], v[112:115], v[152:155]
    ds_read_b64_tr_b16 a[162:163], v5 offset:1024
    v_mfma_f32_16x16x32_bf16 v[184:187], a[184:187], v[116:119], v[184:187]
    v_exp_f32 v51, v51
    v_mfma_f32_16x16x32_bf16 v[216:219], a[184:187], v[120:123], v[216:219]
    ds_read_b64_tr_b16 a[164:165], v6 offset:0
    v_cvt_pk_bf16_f32 v105, v50, v51
    v_mfma_f32_16x16x32_bf16 v[248:251], a[184:187], v[124:127], v[248:251]
    v_exp_f32 v52, v52
    v_mfma_f32_16x16x32_bf16 v[252:255], a[188:191], v[124:127], v[252:255]
    buffer_load_dwordx4 v13, s[16:19], s32 offen offset:1024 nt lds
    v_mfma_f32_16x16x32_bf16 v[220:223], a[188:191], v[120:123], v[220:223]
    v_exp_f32 v53, v53
    v_mfma_f32_16x16x32_bf16 v[188:191], a[188:191], v[116:119], v[188:191]
    ds_read_b64_tr_b16 a[166:167], v6 offset:1024
    v_cvt_pk_bf16_f32 v106, v52, v53
    v_mfma_f32_16x16x32_bf16 v[156:159], a[188:191], v[112:115], v[156:159]
    v_exp_f32 v54, v54
    v_smfmac_f32_16x16x64_bf16 a[196:199], a[208:211], v[120:127], v15
    ds_read_b64_tr_b16 a[168:169], v7 offset:0
    v_mfma_f32_16x16x32_bf16 v[64:67], a[128:131], a[0:3], v[16:19]
    v_exp_f32 v55, v55
    v_mfma_f32_16x16x32_bf16 v[72:75], a[128:131], a[16:19], v[20:23]
    ds_read_b64_tr_b16 a[170:171], v7 offset:1024
    v_cvt_pk_bf16_f32 v107, v54, v55
    v_mfma_f32_16x16x32_bf16 v[76:79], a[144:147], a[16:19], v[20:23]
    v_exp_f32 v56, v56
    v_mfma_f32_16x16x32_bf16 v[68:71], a[144:147], a[0:3], v[16:19]
    buffer_load_dwordx4 v13, s[16:19], s32 offen offset:2048 nt lds
    v_mfma_f32_16x16x32_bf16 v[76:79], a[148:151], a[20:23], v[76:79]
    v_exp_f32 v57, v57
    v_mfma_f32_16x16x32_bf16 v[68:71], a[148:151], a[4:7], v[68:71]
    ds_read_b64_tr_b16 a[172:173], v8 offset:0
    v_cvt_pk_bf16_f32 v108, v56, v57
    v_mfma_f32_16x16x32_bf16 v[64:67], a[132:135], a[4:7], v[64:67]
    v_exp_f32 v58, v58
    v_mfma_f32_16x16x32_bf16 v[72:75], a[132:135], a[20:23], v[72:75]
    ds_read_b64_tr_b16 a[174:175], v8 offset:1024
    v_mfma_f32_16x16x32_bf16 v[64:67], a[136:139], a[8:11], v[64:67]
    v_exp_f32 v59, v59
    v_mfma_f32_16x16x32_bf16 v[72:75], a[136:139], a[24:27], v[72:75]
    ds_read_b64_tr_b16 a[176:177], v9 offset:0
    v_cvt_pk_bf16_f32 v109, v58, v59
    v_mfma_f32_16x16x32_bf16 v[76:79], a[152:155], a[24:27], v[76:79]
    v_exp_f32 v60, v60
    v_mfma_f32_16x16x32_bf16 v[68:71], a[152:155], a[8:11], v[68:71]
    buffer_load_dwordx4 v13, s[16:19], s32 offen offset:3072 nt lds
    v_mfma_f32_16x16x32_bf16 v[76:79], a[156:159], a[28:31], v[76:79]
    v_exp_f32 v61, v61
    v_mfma_f32_16x16x32_bf16 v[68:71], a[156:159], a[12:15], v[68:71]
    ds_read_b64_tr_b16 a[178:179], v9 offset:1024
    v_cvt_pk_bf16_f32 v110, v60, v61
    v_mfma_f32_16x16x32_bf16 v[64:67], a[140:143], a[12:15], v[64:67]
    v_exp_f32 v62, v62
    v_mfma_f32_16x16x32_bf16 v[72:75], a[140:143], a[28:31], v[72:75]
    ds_read_b64_tr_b16 a[180:181], v10 offset:0
    s_add_u32 m0, s30, 49152
    v_mfma_f32_16x16x32_bf16 v[80:83], a[128:131], a[32:35], v[24:27]
    v_exp_f32 v63, v63
    v_mfma_f32_16x16x32_bf16 v[88:91], a[128:131], a[48:51], v[28:31]
    ds_read_b64_tr_b16 a[182:183], v10 offset:1024
    v_cvt_pk_bf16_f32 v111, v62, v63
    v_mfma_f32_16x16x32_bf16 v[92:95], a[144:147], a[48:51], v[28:31]
    buffer_load_dwordx4 v13, s[20:23], s33 offen offset:0 nt lds
    v_mfma_f32_16x16x32_bf16 v[84:87], a[144:147], a[32:35], v[24:27]
    buffer_load_dwordx4 v13, s[20:23], s33 offen offset:1024 nt lds
    v_mfma_f32_16x16x32_bf16 v[92:95], a[148:151], a[52:55], v[92:95]
    v_exp_f32 v64, v64
    v_mfma_f32_16x16x32_bf16 v[84:87], a[148:151], a[36:39], v[84:87]
    buffer_load_dwordx4 v13, s[20:23], s33 offen offset:2048 nt lds
    v_mfma_f32_16x16x32_bf16 v[80:83], a[132:135], a[36:39], v[80:83]
    v_exp_f32 v65, v65
    v_mfma_f32_16x16x32_bf16 v[88:91], a[132:135], a[52:55], v[88:91]
    buffer_load_dwordx4 v13, s[20:23], s33 offen offset:3072 nt lds
    v_cvt_pk_bf16_f32 v112, v64, v65
    v_mfma_f32_16x16x32_bf16 v[80:83], a[136:139], a[40:43], v[80:83]
    v_exp_f32 v66, v66
    v_mfma_f32_16x16x32_bf16 v[88:91], a[136:139], a[56:59], v[88:91]
    s_add_u32 s32, s32, 0x4000
    s_add_u32 s33, s33, 0x4000
    v_mfma_f32_16x16x32_bf16 v[92:95], a[152:155], a[56:59], v[92:95]
    v_exp_f32 v67, v67
    v_mfma_f32_16x16x32_bf16 v[84:87], a[152:155], a[40:43], v[84:87]
    v_cvt_pk_bf16_f32 v113, v66, v67
    v_mfma_f32_16x16x32_bf16 v[92:95], a[156:159], a[60:63], v[92:95]
    v_exp_f32 v68, v68
    v_mfma_f32_16x16x32_bf16 v[84:87], a[156:159], a[44:47], v[84:87]
    v_mfma_f32_16x16x32_bf16 v[80:83], a[140:143], a[44:47], v[80:83]
    v_exp_f32 v69, v69
    v_mfma_f32_16x16x32_bf16 v[88:91], a[140:143], a[60:63], v[88:91]
    ds_read_b64_tr_b16 a[184:185], v11 offset:0
    ds_read_b64_tr_b16 a[186:187], v11 offset:1024
    ds_read_b64_tr_b16 a[188:189], v12 offset:0
    ds_read_b64_tr_b16 a[190:191], v12 offset:1024
    v_cvt_pk_bf16_f32 v114, v68, v69
    s_waitcnt lgkmcnt(0)
    v_mfma_f32_16x16x32_bf16 v[128:131], a[160:163], v[96:99], v[128:131]
    v_exp_f32 v70, v70
    v_mfma_f32_16x16x32_bf16 v[160:163], a[160:163], v[100:103], v[160:163]
    ds_read_b128 a[128:131], v1 offset:0
    v_mfma_f32_16x16x32_bf16 v[192:195], a[160:163], v[104:107], v[192:195]
    v_exp_f32 v71, v71
    v_mfma_f32_16x16x32_bf16 v[224:227], a[160:163], v[108:111], v[224:227]
    ds_read_b128 a[132:135], v2 offset:0
    v_cvt_pk_bf16_f32 v115, v70, v71
    v_mfma_f32_16x16x32_bf16 v[228:231], a[164:167], v[108:111], v[228:231]
    v_exp_f32 v72, v72
    v_mfma_f32_16x16x32_bf16 v[196:199], a[164:167], v[104:107], v[196:199]
    ds_read_b128 a[136:139], v3 offset:0
    v_mfma_f32_16x16x32_bf16 v[164:167], a[164:167], v[100:103], v[164:167]
    v_exp_f32 v73, v73
    v_mfma_f32_16x16x32_bf16 v[132:135], a[164:167], v[96:99], v[132:135]
    ds_read_b128 a[140:143], v4 offset:0
    v_cvt_pk_bf16_f32 v116, v72, v73
    v_mfma_f32_16x16x32_bf16 v[136:139], a[168:171], v[96:99], v[136:139]
    v_exp_f32 v74, v74
    v_mfma_f32_16x16x32_bf16 v[168:171], a[168:171], v[100:103], v[168:171]
    ds_read_b128 a[144:147], v1 offset:1024
    v_mfma_f32_16x16x32_bf16 v[200:203], a[168:171], v[104:107], v[200:203]
    v_exp_f32 v75, v75
    v_mfma_f32_16x16x32_bf16 v[232:235], a[168:171], v[108:111], v[232:235]
    ds_read_b128 a[148:151], v2 offset:1024
    v_cvt_pk_bf16_f32 v117, v74, v75
    v_mfma_f32_16x16x32_bf16 v[236:239], a[172:175], v[108:111], v[236:239]
    v_exp_f32 v76, v76
    v_mfma_f32_16x16x32_bf16 v[204:207], a[172:175], v[104:107], v[204:207]
    ds_read_b128 a[152:155], v3 offset:1024
    v_mfma_f32_16x16x32_bf16 v[172:175], a[172:175], v[100:103], v[172:175]
    v_exp_f32 v77, v77
    v_mfma_f32_16x16x32_bf16 v[140:143], a[172:175], v[96:99], v[140:143]
    ds_read_b128 a[156:159], v4 offset:1024
    v_cvt_pk_bf16_f32 v118, v76, v77
    v_smfmac_f32_16x16x64_bf16 a[192:195], a[208:211], v[96:103], v15
    v_exp_f32 v78, v78
    v_mfma_f32_16x16x32_bf16 v[144:147], a[176:179], v[96:99], v[144:147]
    ds_read_b64_tr_b16 a[160:161], v5 offset:2048
    v_mfma_f32_16x16x32_bf16 v[176:179], a[176:179], v[100:103], v[176:179]
    v_exp_f32 v79, v79
    v_mfma_f32_16x16x32_bf16 v[208:211], a[176:179], v[104:107], v[208:211]
    ds_read_b64_tr_b16 a[162:163], v5 offset:3072
    v_cvt_pk_bf16_f32 v119, v78, v79
    v_mfma_f32_16x16x32_bf16 v[240:243], a[176:179], v[108:111], v[240:243]
    v_exp_f32 v80, v80
    v_mfma_f32_16x16x32_bf16 v[244:247], a[180:183], v[108:111], v[244:247]
    ds_read_b64_tr_b16 a[164:165], v6 offset:2048
    v_mfma_f32_16x16x32_bf16 v[212:215], a[180:183], v[104:107], v[212:215]
    v_exp_f32 v81, v81
    v_mfma_f32_16x16x32_bf16 v[180:183], a[180:183], v[100:103], v[180:183]
    ds_read_b64_tr_b16 a[166:167], v6 offset:3072
    v_cvt_pk_bf16_f32 v120, v80, v81
    v_mfma_f32_16x16x32_bf16 v[148:151], a[180:183], v[96:99], v[148:151]
    v_exp_f32 v82, v82
    v_mfma_f32_16x16x32_bf16 v[152:155], a[184:187], v[96:99], v[152:155]
    ds_read_b64_tr_b16 a[168:169], v7 offset:2048
    s_waitcnt lgkmcnt(5)
    v_mfma_f32_16x16x32_bf16 v[184:187], a[184:187], v[100:103], v[184:187]
    v_exp_f32 v83, v83
    v_mfma_f32_16x16x32_bf16 v[216:219], a[184:187], v[104:107], v[216:219]
    ds_read_b64_tr_b16 a[170:171], v7 offset:3072
    v_cvt_pk_bf16_f32 v121, v82, v83
    v_mfma_f32_16x16x32_bf16 v[248:251], a[184:187], v[108:111], v[248:251]
    v_exp_f32 v84, v84
    v_mfma_f32_16x16x32_bf16 v[252:255], a[188:191], v[108:111], v[252:255]
    ds_read_b64_tr_b16 a[172:173], v8 offset:2048
    v_mfma_f32_16x16x32_bf16 v[220:223], a[188:191], v[104:107], v[220:223]
    v_exp_f32 v85, v85
    v_mfma_f32_16x16x32_bf16 v[188:191], a[188:191], v[100:103], v[188:191]
    ds_read_b64_tr_b16 a[174:175], v8 offset:3072
    v_cvt_pk_bf16_f32 v122, v84, v85
    v_mfma_f32_16x16x32_bf16 v[156:159], a[188:191], v[96:99], v[156:159]
    v_exp_f32 v86, v86
    v_smfmac_f32_16x16x64_bf16 a[196:199], a[208:211], v[104:111], v15
    ds_read_b64_tr_b16 a[176:177], v9 offset:2048
    v_mfma_f32_16x16x32_bf16 v[32:35], a[128:131], a[0:3], v[16:19]
    v_exp_f32 v87, v87
    v_mfma_f32_16x16x32_bf16 v[40:43], a[128:131], a[16:19], v[20:23]
    ds_read_b64_tr_b16 a[178:179], v9 offset:3072
    v_cvt_pk_bf16_f32 v123, v86, v87
    v_mfma_f32_16x16x32_bf16 v[44:47], a[144:147], a[16:19], v[20:23]
    v_exp_f32 v88, v88
    v_mfma_f32_16x16x32_bf16 v[36:39], a[144:147], a[0:3], v[16:19]
    ds_read_b64_tr_b16 a[180:181], v10 offset:2048
    v_mfma_f32_16x16x32_bf16 v[44:47], a[148:151], a[20:23], v[44:47]
    v_exp_f32 v89, v89
    v_mfma_f32_16x16x32_bf16 v[36:39], a[148:151], a[4:7], v[36:39]
    ds_read_b64_tr_b16 a[182:183], v10 offset:3072
    v_cvt_pk_bf16_f32 v124, v88, v89
    v_mfma_f32_16x16x32_bf16 v[32:35], a[132:135], a[4:7], v[32:35]
    v_exp_f32 v90, v90
    v_mfma_f32_16x16x32_bf16 v[40:43], a[132:135], a[20:23], v[40:43]
    v_mfma_f32_16x16x32_bf16 v[32:35], a[136:139], a[8:11], v[32:35]
    v_exp_f32 v91, v91
    v_mfma_f32_16x16x32_bf16 v[40:43], a[136:139], a[24:27], v[40:43]
    v_cvt_pk_bf16_f32 v125, v90, v91
    v_mfma_f32_16x16x32_bf16 v[44:47], a[152:155], a[24:27], v[44:47]
    v_exp_f32 v92, v92
    v_mfma_f32_16x16x32_bf16 v[36:39], a[152:155], a[8:11], v[36:39]
    v_mfma_f32_16x16x32_bf16 v[44:47], a[156:159], a[28:31], v[44:47]
    v_exp_f32 v93, v93
    v_mfma_f32_16x16x32_bf16 v[36:39], a[156:159], a[12:15], v[36:39]
    v_cvt_pk_bf16_f32 v126, v92, v93
    v_mfma_f32_16x16x32_bf16 v[32:35], a[140:143], a[12:15], v[32:35]
    v_exp_f32 v94, v94
    v_mfma_f32_16x16x32_bf16 v[40:43], a[140:143], a[28:31], v[40:43]
    v_mfma_f32_16x16x32_bf16 v[48:51], a[128:131], a[32:35], v[24:27]
    v_exp_f32 v95, v95
    v_mfma_f32_16x16x32_bf16 v[56:59], a[128:131], a[48:51], v[28:31]
    v_cvt_pk_bf16_f32 v127, v94, v95
    v_mfma_f32_16x16x32_bf16 v[60:63], a[144:147], a[48:51], v[28:31]
    v_mfma_f32_16x16x32_bf16 v[52:55], a[144:147], a[32:35], v[24:27]
    v_mfma_f32_16x16x32_bf16 v[60:63], a[148:151], a[52:55], v[60:63]
    v_exp_f32 v32, v32
    v_mfma_f32_16x16x32_bf16 v[52:55], a[148:151], a[36:39], v[52:55]
    v_mfma_f32_16x16x32_bf16 v[48:51], a[132:135], a[36:39], v[48:51]
    v_exp_f32 v33, v33
    v_mfma_f32_16x16x32_bf16 v[56:59], a[132:135], a[52:55], v[56:59]
    v_cvt_pk_bf16_f32 v96, v32, v33
    v_mfma_f32_16x16x32_bf16 v[48:51], a[136:139], a[40:43], v[48:51]
    v_exp_f32 v34, v34
    v_mfma_f32_16x16x32_bf16 v[56:59], a[136:139], a[56:59], v[56:59]
    v_mfma_f32_16x16x32_bf16 v[60:63], a[152:155], a[56:59], v[60:63]
    v_exp_f32 v35, v35
    v_mfma_f32_16x16x32_bf16 v[52:55], a[152:155], a[40:43], v[52:55]
    v_cvt_pk_bf16_f32 v97, v34, v35
    v_mfma_f32_16x16x32_bf16 v[60:63], a[156:159], a[60:63], v[60:63]
    v_exp_f32 v36, v36
    v_mfma_f32_16x16x32_bf16 v[52:55], a[156:159], a[44:47], v[52:55]
    v_mfma_f32_16x16x32_bf16 v[48:51], a[140:143], a[44:47], v[48:51]
    v_exp_f32 v37, v37
    v_mfma_f32_16x16x32_bf16 v[56:59], a[140:143], a[60:63], v[56:59]
    ds_read_b64_tr_b16 a[184:185], v11 offset:2048
    ds_read_b64_tr_b16 a[186:187], v11 offset:3072
    ds_read_b64_tr_b16 a[188:189], v12 offset:2048
    ds_read_b64_tr_b16 a[190:191], v12 offset:3072
    v_cvt_pk_bf16_f32 v98, v36, v37
    s_cmp_eq_u32 s35, s43
    s_cbranch_scc1 L_tail
    s_waitcnt lgkmcnt(0)
    v_mfma_f32_16x16x32_bf16 v[128:131], a[160:163], v[112:115], v[128:131]
    v_exp_f32 v38, v38
    v_mfma_f32_16x16x32_bf16 v[160:163], a[160:163], v[116:119], v[160:163]
    ds_read_b128 a[128:131], v1 offset:2048
    v_mfma_f32_16x16x32_bf16 v[192:195], a[160:163], v[120:123], v[192:195]
    v_exp_f32 v39, v39
    v_mfma_f32_16x16x32_bf16 v[224:227], a[160:163], v[124:127], v[224:227]
    ds_read_b128 a[132:135], v2 offset:2048
    v_cvt_pk_bf16_f32 v99, v38, v39
    v_mfma_f32_16x16x32_bf16 v[228:231], a[164:167], v[124:127], v[228:231]
    v_exp_f32 v40, v40
    v_mfma_f32_16x16x32_bf16 v[196:199], a[164:167], v[120:123], v[196:199]
    ds_read_b128 a[136:139], v3 offset:2048
    v_mfma_f32_16x16x32_bf16 v[164:167], a[164:167], v[116:119], v[164:167]
    v_exp_f32 v41, v41
    v_mfma_f32_16x16x32_bf16 v[132:135], a[164:167], v[112:115], v[132:135]
    ds_read_b128 a[140:143], v4 offset:2048
    v_cvt_pk_bf16_f32 v100, v40, v41
    v_mfma_f32_16x16x32_bf16 v[136:139], a[168:171], v[112:115], v[136:139]
    v_exp_f32 v42, v42
    v_mfma_f32_16x16x32_bf16 v[168:171], a[168:171], v[116:119], v[168:171]
    ds_read_b128 a[144:147], v1 offset:3072
    v_mfma_f32_16x16x32_bf16 v[200:203], a[168:171], v[120:123], v[200:203]
    v_exp_f32 v43, v43
    v_mfma_f32_16x16x32_bf16 v[232:235], a[168:171], v[124:127], v[232:235]
    ds_read_b128 a[148:151], v2 offset:3072
    v_cvt_pk_bf16_f32 v101, v42, v43
    v_mfma_f32_16x16x32_bf16 v[236:239], a[172:175], v[124:127], v[236:239]
    v_exp_f32 v44, v44
    v_mfma_f32_16x16x32_bf16 v[204:207], a[172:175], v[120:123], v[204:207]
    ds_read_b128 a[152:155], v3 offset:3072
    v_mfma_f32_16x16x32_bf16 v[172:175], a[172:175], v[116:119], v[172:175]
    v_exp_f32 v45, v45
    v_mfma_f32_16x16x32_bf16 v[140:143], a[172:175], v[112:115], v[140:143]
    ds_read_b128 a[156:159], v4 offset:3072
    v_cvt_pk_bf16_f32 v102, v44, v45
    v_smfmac_f32_16x16x64_bf16 a[192:195], a[208:211], v[112:119], v15
    v_exp_f32 v46, v46
    v_mfma_f32_16x16x32_bf16 v[144:147], a[176:179], v[112:115], v[144:147]
    s_add_u32 m0, s29, 0
    v_mfma_f32_16x16x32_bf16 v[176:179], a[176:179], v[116:119], v[176:179]
    v_exp_f32 v47, v47
    v_mfma_f32_16x16x32_bf16 v[208:211], a[176:179], v[120:123], v[208:211]
    v_cvt_pk_bf16_f32 v103, v46, v47
    s_waitcnt vmcnt(16) lgkmcnt(0)
    s_barrier
    v_mfma_f32_16x16x32_bf16 v[240:243], a[176:179], v[124:127], v[240:243]
    v_exp_f32 v48, v48
    v_mfma_f32_16x16x32_bf16 v[244:247], a[180:183], v[124:127], v[244:247]
    buffer_load_dwordx4 v13, s[16:19], s32 offen offset:0 nt lds
    v_mfma_f32_16x16x32_bf16 v[212:215], a[180:183], v[120:123], v[212:215]
    v_exp_f32 v49, v49
    v_mfma_f32_16x16x32_bf16 v[180:183], a[180:183], v[116:119], v[180:183]
    ds_read_b64_tr_b16 a[160:161], v5 offset:16384
    v_cvt_pk_bf16_f32 v104, v48, v49
    v_mfma_f32_16x16x32_bf16 v[148:151], a[180:183], v[112:115], v[148:151]
    v_exp_f32 v50, v50
    v_mfma_f32_16x16x32_bf16 v[152:155], a[184:187], v[112:115], v[152:155]
    ds_read_b64_tr_b16 a[162:163], v5 offset:17408
    v_mfma_f32_16x16x32_bf16 v[184:187], a[184:187], v[116:119], v[184:187]
    v_exp_f32 v51, v51
    v_mfma_f32_16x16x32_bf16 v[216:219], a[184:187], v[120:123], v[216:219]
    ds_read_b64_tr_b16 a[164:165], v6 offset:16384
    v_cvt_pk_bf16_f32 v105, v50, v51
    v_mfma_f32_16x16x32_bf16 v[248:251], a[184:187], v[124:127], v[248:251]
    v_exp_f32 v52, v52
    v_mfma_f32_16x16x32_bf16 v[252:255], a[188:191], v[124:127], v[252:255]
    buffer_load_dwordx4 v13, s[16:19], s32 offen offset:1024 nt lds
    v_mfma_f32_16x16x32_bf16 v[220:223], a[188:191], v[120:123], v[220:223]
    v_exp_f32 v53, v53
    v_mfma_f32_16x16x32_bf16 v[188:191], a[188:191], v[116:119], v[188:191]
    ds_read_b64_tr_b16 a[166:167], v6 offset:17408
    v_cvt_pk_bf16_f32 v106, v52, v53
    v_mfma_f32_16x16x32_bf16 v[156:159], a[188:191], v[112:115], v[156:159]
    v_exp_f32 v54, v54
    v_smfmac_f32_16x16x64_bf16 a[196:199], a[208:211], v[120:127], v15
    ds_read_b64_tr_b16 a[168:169], v7 offset:16384
    v_mfma_f32_16x16x32_bf16 v[64:67], a[128:131], a[0:3], v[16:19]
    v_exp_f32 v55, v55
    v_mfma_f32_16x16x32_bf16 v[72:75], a[128:131], a[16:19], v[20:23]
    ds_read_b64_tr_b16 a[170:171], v7 offset:17408
    v_cvt_pk_bf16_f32 v107, v54, v55
    v_mfma_f32_16x16x32_bf16 v[76:79], a[144:147], a[16:19], v[20:23]
    v_exp_f32 v56, v56
    v_mfma_f32_16x16x32_bf16 v[68:71], a[144:147], a[0:3], v[16:19]
    buffer_load_dwordx4 v13, s[16:19], s32 offen offset:2048 nt lds
    v_mfma_f32_16x16x32_bf16 v[76:79], a[148:151], a[20:23], v[76:79]
    v_exp_f32 v57, v57
    v_mfma_f32_16x16x32_bf16 v[68:71], a[148:151], a[4:7], v[68:71]
    ds_read_b64_tr_b16 a[172:173], v8 offset:16384
    v_cvt_pk_bf16_f32 v108, v56, v57
    v_mfma_f32_16x16x32_bf16 v[64:67], a[132:135], a[4:7], v[64:67]
    v_exp_f32 v58, v58
    v_mfma_f32_16x16x32_bf16 v[72:75], a[132:135], a[20:23], v[72:75]
    ds_read_b64_tr_b16 a[174:175], v8 offset:17408
    v_mfma_f32_16x16x32_bf16 v[64:67], a[136:139], a[8:11], v[64:67]
    v_exp_f32 v59, v59
    v_mfma_f32_16x16x32_bf16 v[72:75], a[136:139], a[24:27], v[72:75]
    ds_read_b64_tr_b16 a[176:177], v9 offset:16384
    v_cvt_pk_bf16_f32 v109, v58, v59
    v_mfma_f32_16x16x32_bf16 v[76:79], a[152:155], a[24:27], v[76:79]
    v_exp_f32 v60, v60
    v_mfma_f32_16x16x32_bf16 v[68:71], a[152:155], a[8:11], v[68:71]
    buffer_load_dwordx4 v13, s[16:19], s32 offen offset:3072 nt lds
    v_mfma_f32_16x16x32_bf16 v[76:79], a[156:159], a[28:31], v[76:79]
    v_exp_f32 v61, v61
    v_mfma_f32_16x16x32_bf16 v[68:71], a[156:159], a[12:15], v[68:71]
    ds_read_b64_tr_b16 a[178:179], v9 offset:17408
    v_cvt_pk_bf16_f32 v110, v60, v61
    v_mfma_f32_16x16x32_bf16 v[64:67], a[140:143], a[12:15], v[64:67]
    v_exp_f32 v62, v62
    v_mfma_f32_16x16x32_bf16 v[72:75], a[140:143], a[28:31], v[72:75]
    ds_read_b64_tr_b16 a[180:181], v10 offset:16384
    s_add_u32 m0, s30, 0
    v_mfma_f32_16x16x32_bf16 v[80:83], a[128:131], a[32:35], v[24:27]
    v_exp_f32 v63, v63
    v_mfma_f32_16x16x32_bf16 v[88:91], a[128:131], a[48:51], v[28:31]
    ds_read_b64_tr_b16 a[182:183], v10 offset:17408
    v_cvt_pk_bf16_f32 v111, v62, v63
    v_mfma_f32_16x16x32_bf16 v[92:95], a[144:147], a[48:51], v[28:31]
    buffer_load_dwordx4 v13, s[20:23], s33 offen offset:0 nt lds
    v_mfma_f32_16x16x32_bf16 v[84:87], a[144:147], a[32:35], v[24:27]
    buffer_load_dwordx4 v13, s[20:23], s33 offen offset:1024 nt lds
    v_mfma_f32_16x16x32_bf16 v[92:95], a[148:151], a[52:55], v[92:95]
    v_exp_f32 v64, v64
    v_mfma_f32_16x16x32_bf16 v[84:87], a[148:151], a[36:39], v[84:87]
    buffer_load_dwordx4 v13, s[20:23], s33 offen offset:2048 nt lds
    v_mfma_f32_16x16x32_bf16 v[80:83], a[132:135], a[36:39], v[80:83]
    v_exp_f32 v65, v65
    v_mfma_f32_16x16x32_bf16 v[88:91], a[132:135], a[52:55], v[88:91]
    buffer_load_dwordx4 v13, s[20:23], s33 offen offset:3072 nt lds
    v_cvt_pk_bf16_f32 v112, v64, v65
    v_mfma_f32_16x16x32_bf16 v[80:83], a[136:139], a[40:43], v[80:83]
    v_exp_f32 v66, v66
    v_mfma_f32_16x16x32_bf16 v[88:91], a[136:139], a[56:59], v[88:91]
    s_add_u32 s32, s32, 0x4000
    s_add_u32 s33, s33, 0x4000
    v_mfma_f32_16x16x32_bf16 v[92:95], a[152:155], a[56:59], v[92:95]
    v_exp_f32 v67, v67
    v_mfma_f32_16x16x32_bf16 v[84:87], a[152:155], a[40:43], v[84:87]
    v_cvt_pk_bf16_f32 v113, v66, v67
    v_mfma_f32_16x16x32_bf16 v[92:95], a[156:159], a[60:63], v[92:95]
    v_exp_f32 v68, v68
    v_mfma_f32_16x16x32_bf16 v[84:87], a[156:159], a[44:47], v[84:87]
    v_mfma_f32_16x16x32_bf16 v[80:83], a[140:143], a[44:47], v[80:83]
    v_exp_f32 v69, v69
    v_mfma_f32_16x16x32_bf16 v[88:91], a[140:143], a[60:63], v[88:91]
    ds_read_b64_tr_b16 a[184:185], v11 offset:16384
    ds_read_b64_tr_b16 a[186:187], v11 offset:17408
    ds_read_b64_tr_b16 a[188:189], v12 offset:16384
    ds_read_b64_tr_b16 a[190:191], v12 offset:17408
    v_cvt_pk_bf16_f32 v114, v68, v69
    s_waitcnt lgkmcnt(0)
    v_mfma_f32_16x16x32_bf16 v[128:131], a[160:163], v[96:99], v[128:131]
    v_exp_f32 v70, v70
    v_mfma_f32_16x16x32_bf16 v[160:163], a[160:163], v[100:103], v[160:163]
    ds_read_b128 a[128:131], v1 offset:16384
    v_mfma_f32_16x16x32_bf16 v[192:195], a[160:163], v[104:107], v[192:195]
    v_exp_f32 v71, v71
    v_mfma_f32_16x16x32_bf16 v[224:227], a[160:163], v[108:111], v[224:227]
    ds_read_b128 a[132:135], v2 offset:16384
    v_cvt_pk_bf16_f32 v115, v70, v71
    v_mfma_f32_16x16x32_bf16 v[228:231], a[164:167], v[108:111], v[228:231]
    v_exp_f32 v72, v72
    v_mfma_f32_16x16x32_bf16 v[196:199], a[164:167], v[104:107], v[196:199]
    ds_read_b128 a[136:139], v3 offset:16384
    v_mfma_f32_16x16x32_bf16 v[164:167], a[164:167], v[100:103], v[164:167]
    v_exp_f32 v73, v73
    v_mfma_f32_16x16x32_bf16 v[132:135], a[164:167], v[96:99], v[132:135]
    ds_read_b128 a[140:143], v4 offset:16384
    v_cvt_pk_bf16_f32 v116, v72, v73
    v_mfma_f32_16x16x32_bf16 v[136:139], a[168:171], v[96:99], v[136:139]
    v_exp_f32 v74, v74
    v_mfma_f32_16x16x32_bf16 v[168:171], a[168:171], v[100:103], v[168:171]
    ds_read_b128 a[144:147], v1 offset:17408
    v_mfma_f32_16x16x32_bf16 v[200:203], a[168:171], v[104:107], v[200:203]
    v_exp_f32 v75, v75
    v_mfma_f32_16x16x32_bf16 v[232:235], a[168:171], v[108:111], v[232:235]
    ds_read_b128 a[148:151], v2 offset:17408
    v_cvt_pk_bf16_f32 v117, v74, v75
    v_mfma_f32_16x16x32_bf16 v[236:239], a[172:175], v[108:111], v[236:239]
    v_exp_f32 v76, v76
    v_mfma_f32_16x16x32_bf16 v[204:207], a[172:175], v[104:107], v[204:207]
    ds_read_b128 a[152:155], v3 offset:17408
    v_mfma_f32_16x16x32_bf16 v[172:175], a[172:175], v[100:103], v[172:175]
    v_exp_f32 v77, v77
    v_mfma_f32_16x16x32_bf16 v[140:143], a[172:175], v[96:99], v[140:143]
    ds_read_b128 a[156:159], v4 offset:17408
    v_cvt_pk_bf16_f32 v118, v76, v77
    v_smfmac_f32_16x16x64_bf16 a[192:195], a[208:211], v[96:103], v15
    v_exp_f32 v78, v78
    v_mfma_f32_16x16x32_bf16 v[144:147], a[176:179], v[96:99], v[144:147]
    ds_read_b64_tr_b16 a[160:161], v5 offset:18432
    v_mfma_f32_16x16x32_bf16 v[176:179], a[176:179], v[100:103], v[176:179]
    v_exp_f32 v79, v79
    v_mfma_f32_16x16x32_bf16 v[208:211], a[176:179], v[104:107], v[208:211]
    ds_read_b64_tr_b16 a[162:163], v5 offset:19456
    v_cvt_pk_bf16_f32 v119, v78, v79
    v_mfma_f32_16x16x32_bf16 v[240:243], a[176:179], v[108:111], v[240:243]
    v_exp_f32 v80, v80
    v_mfma_f32_16x16x32_bf16 v[244:247], a[180:183], v[108:111], v[244:247]
    ds_read_b64_tr_b16 a[164:165], v6 offset:18432
    v_mfma_f32_16x16x32_bf16 v[212:215], a[180:183], v[104:107], v[212:215]
    v_exp_f32 v81, v81
    v_mfma_f32_16x16x32_bf16 v[180:183], a[180:183], v[100:103], v[180:183]
    ds_read_b64_tr_b16 a[166:167], v6 offset:19456
    v_cvt_pk_bf16_f32 v120, v80, v81
    v_mfma_f32_16x16x32_bf16 v[148:151], a[180:183], v[96:99], v[148:151]
    v_exp_f32 v82, v82
    v_mfma_f32_16x16x32_bf16 v[152:155], a[184:187], v[96:99], v[152:155]
    ds_read_b64_tr_b16 a[168:169], v7 offset:18432
    s_waitcnt lgkmcnt(5)
    v_mfma_f32_16x16x32_bf16 v[184:187], a[184:187], v[100:103], v[184:187]
    v_exp_f32 v83, v83
    v_mfma_f32_16x16x32_bf16 v[216:219], a[184:187], v[104:107], v[216:219]
    ds_read_b64_tr_b16 a[170:171], v7 offset:19456
    v_cvt_pk_bf16_f32 v121, v82, v83
    v_mfma_f32_16x16x32_bf16 v[248:251], a[184:187], v[108:111], v[248:251]
    v_exp_f32 v84, v84
    v_mfma_f32_16x16x32_bf16 v[252:255], a[188:191], v[108:111], v[252:255]
    ds_read_b64_tr_b16 a[172:173], v8 offset:18432
    v_mfma_f32_16x16x32_bf16 v[220:223], a[188:191], v[104:107], v[220:223]
    v_exp_f32 v85, v85
    v_mfma_f32_16x16x32_bf16 v[188:191], a[188:191], v[100:103], v[188:191]
    ds_read_b64_tr_b16 a[174:175], v8 offset:19456
    v_cvt_pk_bf16_f32 v122, v84, v85
    v_mfma_f32_16x16x32_bf16 v[156:159], a[188:191], v[96:99], v[156:159]
    v_exp_f32 v86, v86
    v_smfmac_f32_16x16x64_bf16 a[196:199], a[208:211], v[104:111], v15
    ds_read_b64_tr_b16 a[176:177], v9 offset:18432
    v_mfma_f32_16x16x32_bf16 v[32:35], a[128:131], a[0:3], v[16:19]
    v_exp_f32 v87, v87
    v_mfma_f32_16x16x32_bf16 v[40:43], a[128:131], a[16:19], v[20:23]
    ds_read_b64_tr_b16 a[178:179], v9 offset:19456
    v_cvt_pk_bf16_f32 v123, v86, v87
    v_mfma_f32_16x16x32_bf16 v[44:47], a[144:147], a[16:19], v[20:23]
    v_exp_f32 v88, v88
    v_mfma_f32_16x16x32_bf16 v[36:39], a[144:147], a[0:3], v[16:19]
    ds_read_b64_tr_b16 a[180:181], v10 offset:18432
    v_mfma_f32_16x16x32_bf16 v[44:47], a[148:151], a[20:23], v[44:47]
    v_exp_f32 v89, v89
    v_mfma_f32_16x16x32_bf16 v[36:39], a[148:151], a[4:7], v[36:39]
    ds_read_b64_tr_b16 a[182:183], v10 offset:19456
    v_cvt_pk_bf16_f32 v124, v88, v89
    v_mfma_f32_16x16x32_bf16 v[32:35], a[132:135], a[4:7], v[32:35]
    v_exp_f32 v90, v90
    v_mfma_f32_16x16x32_bf16 v[40:43], a[132:135], a[20:23], v[40:43]
    v_mfma_f32_16x16x32_bf16 v[32:35], a[136:139], a[8:11], v[32:35]
    v_exp_f32 v91, v91
    v_mfma_f32_16x16x32_bf16 v[40:43], a[136:139], a[24:27], v[40:43]
    v_cvt_pk_bf16_f32 v125, v90, v91
    v_mfma_f32_16x16x32_bf16 v[44:47], a[152:155], a[24:27], v[44:47]
    v_exp_f32 v92, v92
    v_mfma_f32_16x16x32_bf16 v[36:39], a[152:155], a[8:11], v[36:39]
    v_mfma_f32_16x16x32_bf16 v[44:47], a[156:159], a[28:31], v[44:47]
    v_exp_f32 v93, v93
    v_mfma_f32_16x16x32_bf16 v[36:39], a[156:159], a[12:15], v[36:39]
    v_cvt_pk_bf16_f32 v126, v92, v93
    v_mfma_f32_16x16x32_bf16 v[32:35], a[140:143], a[12:15], v[32:35]
    v_exp_f32 v94, v94
    v_mfma_f32_16x16x32_bf16 v[40:43], a[140:143], a[28:31], v[40:43]
    v_mfma_f32_16x16x32_bf16 v[48:51], a[128:131], a[32:35], v[24:27]
    v_exp_f32 v95, v95
    v_mfma_f32_16x16x32_bf16 v[56:59], a[128:131], a[48:51], v[28:31]
    v_cvt_pk_bf16_f32 v127, v94, v95
    v_mfma_f32_16x16x32_bf16 v[60:63], a[144:147], a[48:51], v[28:31]
    v_mfma_f32_16x16x32_bf16 v[52:55], a[144:147], a[32:35], v[24:27]
    v_mfma_f32_16x16x32_bf16 v[60:63], a[148:151], a[52:55], v[60:63]
    v_exp_f32 v32, v32
    v_mfma_f32_16x16x32_bf16 v[52:55], a[148:151], a[36:39], v[52:55]
    v_mfma_f32_16x16x32_bf16 v[48:51], a[132:135], a[36:39], v[48:51]
    v_exp_f32 v33, v33
    v_mfma_f32_16x16x32_bf16 v[56:59], a[132:135], a[52:55], v[56:59]
    v_cvt_pk_bf16_f32 v96, v32, v33
    v_mfma_f32_16x16x32_bf16 v[48:51], a[136:139], a[40:43], v[48:51]
    v_exp_f32 v34, v34
    v_mfma_f32_16x16x32_bf16 v[56:59], a[136:139], a[56:59], v[56:59]
    v_mfma_f32_16x16x32_bf16 v[60:63], a[152:155], a[56:59], v[60:63]
    v_exp_f32 v35, v35
    v_mfma_f32_16x16x32_bf16 v[52:55], a[152:155], a[40:43], v[52:55]
    v_cvt_pk_bf16_f32 v97, v34, v35
    v_mfma_f32_16x16x32_bf16 v[60:63], a[156:159], a[60:63], v[60:63]
    v_exp_f32 v36, v36
    v_mfma_f32_16x16x32_bf16 v[52:55], a[156:159], a[44:47], v[52:55]
    v_mfma_f32_16x16x32_bf16 v[48:51], a[140:143], a[44:47], v[48:51]
    v_exp_f32 v37, v37
    v_mfma_f32_16x16x32_bf16 v[56:59], a[140:143], a[60:63], v[56:59]
    ds_read_b64_tr_b16 a[184:185], v11 offset:18432
    ds_read_b64_tr_b16 a[186:187], v11 offset:19456
    ds_read_b64_tr_b16 a[188:189], v12 offset:18432
    ds_read_b64_tr_b16 a[190:191], v12 offset:19456
    v_cvt_pk_bf16_f32 v98, v36, v37
    s_sub_u32 s35, s35, 1
    s_branch L_loop_1
L_last:
    s_mov_b64 s[100:101], 0
    s_waitcnt lgkmcnt(12)
    v_mfma_f32_16x16x32_bf16 v[128:131], a[160:163], v[96:99], v[128:131]
    v_exp_f32 v70, v70
    v_mfma_f32_16x16x32_bf16 v[160:163], a[160:163], v[100:103], v[160:163]
    v_exp_f32 v71, v71
    v_mfma_f32_16x16x32_bf16 v[192:195], a[160:163], v[104:107], v[192:195]
    v_exp_f32 v72, v72
    v_cvt_pk_bf16_f32 v115, v70, v71
    v_mfma_f32_16x16x32_bf16 v[224:227], a[160:163], v[108:111], v[224:227]
    v_exp_f32 v73, v73
    v_mfma_f32_16x16x32_bf16 v[228:231], a[164:167], v[108:111], v[228:231]
    ds_read_b64_tr_b16 a[160:161], v5 offset:2048
    v_exp_f32 v74, v74
    v_mfma_f32_16x16x32_bf16 v[196:199], a[164:167], v[104:107], v[196:199]
    ds_read_b64_tr_b16 a[162:163], v5 offset:3072
    v_cvt_pk_bf16_f32 v116, v72, v73
    v_mfma_f32_16x16x32_bf16 v[164:167], a[164:167], v[100:103], v[164:167]
    v_exp_f32 v75, v75
    v_mfma_f32_16x16x32_bf16 v[132:135], a[164:167], v[96:99], v[132:135]
    v_exp_f32 v76, v76
    v_cvt_pk_bf16_f32 v117, v74, v75
    s_waitcnt lgkmcnt(10)
    v_mfma_f32_16x16x32_bf16 v[136:139], a[168:171], v[96:99], v[136:139]
    ds_read_b64_tr_b16 a[164:165], v6 offset:2048
    v_exp_f32 v77, v77
    v_mfma_f32_16x16x32_bf16 v[168:171], a[168:171], v[100:103], v[168:171]
    ds_read_b64_tr_b16 a[166:167], v6 offset:3072
    v_exp_f32 v78, v78
    v_mfma_f32_16x16x32_bf16 v[200:203], a[168:171], v[104:107], v[200:203]
    v_cvt_pk_bf16_f32 v118, v76, v77
    v_exp_f32 v79, v79
    v_mfma_f32_16x16x32_bf16 v[232:235], a[168:171], v[108:111], v[232:235]
    v_exp_f32 v80, v80
    v_cvt_pk_bf16_f32 v119, v78, v79
    v_mfma_f32_16x16x32_bf16 v[236:239], a[172:175], v[108:111], v[236:239]
    ds_read_b64_tr_b16 a[168:169], v7 offset:2048
    v_exp_f32 v81, v81
    v_mfma_f32_16x16x32_bf16 v[204:207], a[172:175], v[104:107], v[204:207]
    ds_read_b64_tr_b16 a[170:171], v7 offset:3072
    v_exp_f32 v82, v82
    v_mfma_f32_16x16x32_bf16 v[172:175], a[172:175], v[100:103], v[172:175]
    v_cvt_pk_bf16_f32 v120, v80, v81
    v_exp_f32 v83, v83
    v_mfma_f32_16x16x32_bf16 v[140:143], a[172:175], v[96:99], v[140:143]
    v_exp_f32 v84, v84
    v_cvt_pk_bf16_f32 v121, v82, v83
    v_smfmac_f32_16x16x64_bf16 a[192:195], a[208:211], v[96:103], v15
    ds_read_b64_tr_b16 a[172:173], v8 offset:2048
    v_exp_f32 v85, v85
    s_waitcnt lgkmcnt(11)
    v_mfma_f32_16x16x32_bf16 v[144:147], a[176:179], v[96:99], v[144:147]
    ds_read_b64_tr_b16 a[174:175], v8 offset:3072
    v_exp_f32 v86, v86
    v_mfma_f32_16x16x32_bf16 v[176:179], a[176:179], v[100:103], v[176:179]
    v_cvt_pk_bf16_f32 v122, v84, v85
    v_exp_f32 v87, v87
    v_mfma_f32_16x16x32_bf16 v[208:211], a[176:179], v[104:107], v[208:211]
    v_exp_f32 v88, v88
    v_cvt_pk_bf16_f32 v123, v86, v87
    v_mfma_f32_16x16x32_bf16 v[240:243], a[176:179], v[108:111], v[240:243]
    v_exp_f32 v89, v89
    v_mfma_f32_16x16x32_bf16 v[244:247], a[180:183], v[108:111], v[244:247]
    ds_read_b64_tr_b16 a[176:177], v9 offset:2048
    v_exp_f32 v90, v90
    v_mfma_f32_16x16x32_bf16 v[212:215], a[180:183], v[104:107], v[212:215]
    ds_read_b64_tr_b16 a[178:179], v9 offset:3072
    v_cvt_pk_bf16_f32 v124, v88, v89
    v_mfma_f32_16x16x32_bf16 v[180:183], a[180:183], v[100:103], v[180:183]
    v_exp_f32 v91, v91
    v_mfma_f32_16x16x32_bf16 v[148:151], a[180:183], v[96:99], v[148:151]
    v_exp_f32 v92, v92
    v_cvt_pk_bf16_f32 v125, v90, v91
    s_waitcnt lgkmcnt(10)
    v_mfma_f32_16x16x32_bf16 v[152:155], a[184:187], v[96:99], v[152:155]
    ds_read_b64_tr_b16 a[180:181], v10 offset:2048
    v_exp_f32 v93, v93
    v_mfma_f32_16x16x32_bf16 v[184:187], a[184:187], v[100:103], v[184:187]
    ds_read_b64_tr_b16 a[182:183], v10 offset:3072
    v_exp_f32 v94, v94
    v_mfma_f32_16x16x32_bf16 v[216:219], a[184:187], v[104:107], v[216:219]
    v_cvt_pk_bf16_f32 v126, v92, v93
    v_exp_f32 v95, v95
    v_mfma_f32_16x16x32_bf16 v[248:251], a[184:187], v[108:111], v[248:251]
    s_nop 0
    v_cvt_pk_bf16_f32 v127, v94, v95
    v_mfma_f32_16x16x32_bf16 v[252:255], a[188:191], v[108:111], v[252:255]
    ds_read_b64_tr_b16 a[184:185], v11 offset:2048
    s_nop 1
    v_mfma_f32_16x16x32_bf16 v[220:223], a[188:191], v[104:107], v[220:223]
    ds_read_b64_tr_b16 a[186:187], v11 offset:3072
    v_mfma_f32_16x16x32_bf16 v[188:191], a[188:191], v[100:103], v[188:191]
    v_mfma_f32_16x16x32_bf16 v[156:159], a[188:191], v[96:99], v[156:159]
    v_smfmac_f32_16x16x64_bf16 a[196:199], a[208:211], v[104:111], v15
    ds_read_b64_tr_b16 a[188:189], v12 offset:2048
    ds_read_b64_tr_b16 a[190:191], v12 offset:3072
    v_smfmac_f32_16x16x64_bf16 a[192:195], a[208:211], v[112:119], v15
    s_waitcnt lgkmcnt(12)
    v_mfma_f32_16x16x32_bf16 v[128:131], a[160:163], v[112:115], v[128:131]
    v_mfma_f32_16x16x32_bf16 v[132:135], a[164:167], v[112:115], v[132:135]
    s_waitcnt lgkmcnt(8)
    v_mfma_f32_16x16x32_bf16 v[136:139], a[168:171], v[112:115], v[136:139]
    v_mfma_f32_16x16x32_bf16 v[140:143], a[172:175], v[112:115], v[140:143]
    s_waitcnt lgkmcnt(4)
    v_mfma_f32_16x16x32_bf16 v[144:147], a[176:179], v[112:115], v[144:147]
    v_mfma_f32_16x16x32_bf16 v[148:151], a[180:183], v[112:115], v[148:151]
    s_waitcnt lgkmcnt(0)
    v_mfma_f32_16x16x32_bf16 v[152:155], a[184:187], v[112:115], v[152:155]
    v_mfma_f32_16x16x32_bf16 v[156:159], a[188:191], v[112:115], v[156:159]
    v_accvgpr_read_b32 v96, a192
    v_accvgpr_read_b32 v97, a193
    v_add_f32 v97, v96, v97
    v_mfma_f32_16x16x32_bf16 v[188:191], a[188:191], v[116:119], v[188:191]
    v_rcp_f32 v96, v97
    v_cmp_nle_f32 vcc, v97, s38
    v_mfma_f32_16x16x32_bf16 v[184:187], a[184:187], v[116:119], v[184:187]
    s_add_u32 s37, s42, 0
    s_or_b64 s[100:101], s[100:101], vcc
    v_mfma_f32_16x16x32_bf16 v[180:183], a[180:183], v[116:119], v[180:183]
    v_mfma_f32_16x16x32_bf16 v[176:179], a[176:179], v[116:119], v[176:179]
    v_mfma_f32_16x16x32_bf16 v[172:175], a[172:175], v[116:119], v[172:175]
    v_mul_f32 v128, v128, v96
    v_mul_f32 v129, v129, v96
    v_mul_f32 v130, v130, v96
    v_mfma_f32_16x16x32_bf16 v[168:171], a[168:171], v[116:119], v[168:171]
    v_mul_f32 v131, v131, v96
    v_mul_f32 v132, v132, v96
    v_mul_f32 v133, v133, v96
    v_mfma_f32_16x16x32_bf16 v[164:167], a[164:167], v[116:119], v[164:167]
    v_mul_f32 v134, v134, v96
    v_mul_f32 v135, v135, v96
    v_cvt_pk_bf16_f32 v32, v128, v129
    v_mfma_f32_16x16x32_bf16 v[160:163], a[160:163], v[116:119], v[160:163]
    v_cvt_pk_bf16_f32 v33, v130, v131
    v_cvt_pk_bf16_f32 v34, v132, v133
    v_smfmac_f32_16x16x64_bf16 a[196:199], a[208:211], v[120:127], v15
    v_cvt_pk_bf16_f32 v35, v134, v135
    buffer_store_dwordx4 v[32:35], v14, s[24:27], s37 offen offset:0 sc1
    v_mfma_f32_16x16x32_bf16 v[192:195], a[160:163], v[120:123], v[192:195]
    v_mul_f32 v136, v136, v96
    v_mul_f32 v137, v137, v96
    v_mul_f32 v138, v138, v96
    v_mfma_f32_16x16x32_bf16 v[196:199], a[164:167], v[120:123], v[196:199]
    v_mul_f32 v139, v139, v96
    v_mul_f32 v140, v140, v96
    v_mul_f32 v141, v141, v96
    v_mfma_f32_16x16x32_bf16 v[200:203], a[168:171], v[120:123], v[200:203]
    v_mul_f32 v142, v142, v96
    v_mul_f32 v143, v143, v96
    v_cvt_pk_bf16_f32 v36, v136, v137
    v_mfma_f32_16x16x32_bf16 v[204:207], a[172:175], v[120:123], v[204:207]
    v_cvt_pk_bf16_f32 v37, v138, v139
    v_cvt_pk_bf16_f32 v38, v140, v141
    v_mfma_f32_16x16x32_bf16 v[208:211], a[176:179], v[120:123], v[208:211]
    v_cvt_pk_bf16_f32 v39, v142, v143
    buffer_store_dwordx4 v[36:39], v14, s[24:27], s37 offen offset:1024 sc1
    v_mfma_f32_16x16x32_bf16 v[212:215], a[180:183], v[120:123], v[212:215]
    v_mul_f32 v144, v144, v96
    v_mul_f32 v145, v145, v96
    v_mul_f32 v146, v146, v96
    v_mfma_f32_16x16x32_bf16 v[216:219], a[184:187], v[120:123], v[216:219]
    v_mul_f32 v147, v147, v96
    v_mul_f32 v148, v148, v96
    v_mul_f32 v149, v149, v96
    v_mfma_f32_16x16x32_bf16 v[220:223], a[188:191], v[120:123], v[220:223]
    v_mul_f32 v150, v150, v96
    v_mul_f32 v151, v151, v96
    v_cvt_pk_bf16_f32 v40, v144, v145
    v_mfma_f32_16x16x32_bf16 v[252:255], a[188:191], v[124:127], v[252:255]
    v_cvt_pk_bf16_f32 v41, v146, v147
    v_cvt_pk_bf16_f32 v42, v148, v149
    v_mfma_f32_16x16x32_bf16 v[248:251], a[184:187], v[124:127], v[248:251]
    v_cvt_pk_bf16_f32 v43, v150, v151
    buffer_store_dwordx4 v[40:43], v14, s[24:27], s37 offen offset:2048 sc1
    v_mfma_f32_16x16x32_bf16 v[244:247], a[180:183], v[124:127], v[244:247]
    v_mul_f32 v152, v152, v96
    v_mul_f32 v153, v153, v96
    v_mul_f32 v154, v154, v96
    v_mfma_f32_16x16x32_bf16 v[240:243], a[176:179], v[124:127], v[240:243]
    v_mul_f32 v155, v155, v96
    v_mul_f32 v156, v156, v96
    v_mul_f32 v157, v157, v96
    v_mfma_f32_16x16x32_bf16 v[236:239], a[172:175], v[124:127], v[236:239]
    v_mul_f32 v158, v158, v96
    v_mul_f32 v159, v159, v96
    v_cvt_pk_bf16_f32 v44, v152, v153
    v_mfma_f32_16x16x32_bf16 v[232:235], a[168:171], v[124:127], v[232:235]
    v_cvt_pk_bf16_f32 v45, v154, v155
    v_cvt_pk_bf16_f32 v46, v156, v157
    v_mfma_f32_16x16x32_bf16 v[228:231], a[164:167], v[124:127], v[228:231]
    v_cvt_pk_bf16_f32 v47, v158, v159
    buffer_store_dwordx4 v[44:47], v14, s[24:27], s37 offen offset:3072 sc1
    v_mfma_f32_16x16x32_bf16 v[224:227], a[160:163], v[124:127], v[224:227]
    v_accvgpr_read_b32 v98, a194
    v_accvgpr_read_b32 v99, a195
    v_add_f32 v99, v98, v99
    v_rcp_f32 v98, v99
    v_cmp_nle_f32 vcc, v99, s38
    s_add_u32 s37, s42, 131072
    s_or_b64 s[100:101], s[100:101], vcc
    v_pk_mul_f32 v[160:161], v[160:161], v[98:99] op_sel_hi:[1,0]
    v_pk_mul_f32 v[162:163], v[162:163], v[98:99] op_sel_hi:[1,0]
    v_pk_mul_f32 v[164:165], v[164:165], v[98:99] op_sel_hi:[1,0]
    v_pk_mul_f32 v[166:167], v[166:167], v[98:99] op_sel_hi:[1,0]
    v_cvt_pk_bf16_f32 v48, v160, v161
    v_cvt_pk_bf16_f32 v49, v162, v163
    v_cvt_pk_bf16_f32 v50, v164, v165
    v_cvt_pk_bf16_f32 v51, v166, v167
    v_pk_mul_f32 v[168:169], v[168:169], v[98:99] op_sel_hi:[1,0]
    v_pk_mul_f32 v[170:171], v[170:171], v[98:99] op_sel_hi:[1,0]
    v_pk_mul_f32 v[172:173], v[172:173], v[98:99] op_sel_hi:[1,0]
    v_pk_mul_f32 v[174:175], v[174:175], v[98:99] op_sel_hi:[1,0]
    v_cvt_pk_bf16_f32 v52, v168, v169
    v_cvt_pk_bf16_f32 v53, v170, v171
    v_cvt_pk_bf16_f32 v54, v172, v173
    v_cvt_pk_bf16_f32 v55, v174, v175
    v_pk_mul_f32 v[176:177], v[176:177], v[98:99] op_sel_hi:[1,0]
    v_pk_mul_f32 v[178:179], v[178:179], v[98:99] op_sel_hi:[1,0]
    v_pk_mul_f32 v[180:181], v[180:181], v[98:99] op_sel_hi:[1,0]
    v_pk_mul_f32 v[182:183], v[182:183], v[98:99] op_sel_hi:[1,0]
    v_cvt_pk_bf16_f32 v56, v176, v177
    v_cvt_pk_bf16_f32 v57, v178, v179
    v_cvt_pk_bf16_f32 v58, v180, v181
    v_cvt_pk_bf16_f32 v59, v182, v183
    v_pk_mul_f32 v[184:185], v[184:185], v[98:99] op_sel_hi:[1,0]
    v_pk_mul_f32 v[186:187], v[186:187], v[98:99] op_sel_hi:[1,0]
    v_pk_mul_f32 v[188:189], v[188:189], v[98:99] op_sel_hi:[1,0]
    v_pk_mul_f32 v[190:191], v[190:191], v[98:99] op_sel_hi:[1,0]
    v_cvt_pk_bf16_f32 v60, v184, v185
    v_cvt_pk_bf16_f32 v61, v186, v187
    v_cvt_pk_bf16_f32 v62, v188, v189
    v_cvt_pk_bf16_f32 v63, v190, v191
    v_accvgpr_read_b32 v96, a196
    v_accvgpr_read_b32 v97, a197
    v_add_f32 v97, v96, v97
    v_rcp_f32 v96, v97
    v_cmp_nle_f32 vcc, v97, s38
    s_add_u32 s37, s42, 262144
    s_or_b64 s[100:101], s[100:101], vcc
    v_pk_mul_f32 v[192:193], v[192:193], v[96:97] op_sel_hi:[1,0]
    v_pk_mul_f32 v[194:195], v[194:195], v[96:97] op_sel_hi:[1,0]
    v_pk_mul_f32 v[196:197], v[196:197], v[96:97] op_sel_hi:[1,0]
    v_pk_mul_f32 v[198:199], v[198:199], v[96:97] op_sel_hi:[1,0]
    v_cvt_pk_bf16_f32 v64, v192, v193
    v_cvt_pk_bf16_f32 v65, v194, v195
    v_cvt_pk_bf16_f32 v66, v196, v197
    v_cvt_pk_bf16_f32 v67, v198, v199
    v_pk_mul_f32 v[200:201], v[200:201], v[96:97] op_sel_hi:[1,0]
    v_pk_mul_f32 v[202:203], v[202:203], v[96:97] op_sel_hi:[1,0]
    v_pk_mul_f32 v[204:205], v[204:205], v[96:97] op_sel_hi:[1,0]
    v_pk_mul_f32 v[206:207], v[206:207], v[96:97] op_sel_hi:[1,0]
    v_cvt_pk_bf16_f32 v68, v200, v201
    v_cvt_pk_bf16_f32 v69, v202, v203
    v_cvt_pk_bf16_f32 v70, v204, v205
    v_cvt_pk_bf16_f32 v71, v206, v207
    v_pk_mul_f32 v[208:209], v[208:209], v[96:97] op_sel_hi:[1,0]
    v_pk_mul_f32 v[210:211], v[210:211], v[96:97] op_sel_hi:[1,0]
    v_pk_mul_f32 v[212:213], v[212:213], v[96:97] op_sel_hi:[1,0]
    v_pk_mul_f32 v[214:215], v[214:215], v[96:97] op_sel_hi:[1,0]
    v_cvt_pk_bf16_f32 v72, v208, v209
    v_cvt_pk_bf16_f32 v73, v210, v211
    v_cvt_pk_bf16_f32 v74, v212, v213
    v_cvt_pk_bf16_f32 v75, v214, v215
    v_pk_mul_f32 v[216:217], v[216:217], v[96:97] op_sel_hi:[1,0]
    v_pk_mul_f32 v[218:219], v[218:219], v[96:97] op_sel_hi:[1,0]
    v_pk_mul_f32 v[220:221], v[220:221], v[96:97] op_sel_hi:[1,0]
    v_pk_mul_f32 v[222:223], v[222:223], v[96:97] op_sel_hi:[1,0]
    v_cvt_pk_bf16_f32 v76, v216, v217
    v_cvt_pk_bf16_f32 v77, v218, v219
    v_cvt_pk_bf16_f32 v78, v220, v221
    v_cvt_pk_bf16_f32 v79, v222, v223
    s_nop 7
    v_accvgpr_read_b32 v98, a198
    v_accvgpr_read_b32 v99, a199
    v_add_f32 v99, v98, v99
    v_rcp_f32 v98, v99
    v_cmp_nle_f32 vcc, v99, s38
    s_add_u32 s37, s42, 393216
    s_or_b64 s[100:101], s[100:101], vcc
    v_pk_mul_f32 v[224:225], v[224:225], v[98:99] op_sel_hi:[1,0]
    v_pk_mul_f32 v[226:227], v[226:227], v[98:99] op_sel_hi:[1,0]
    v_pk_mul_f32 v[228:229], v[228:229], v[98:99] op_sel_hi:[1,0]
    v_pk_mul_f32 v[230:231], v[230:231], v[98:99] op_sel_hi:[1,0]
    v_cvt_pk_bf16_f32 v80, v224, v225
    v_cvt_pk_bf16_f32 v81, v226, v227
    v_cvt_pk_bf16_f32 v82, v228, v229
    v_cvt_pk_bf16_f32 v83, v230, v231
    v_pk_mul_f32 v[232:233], v[232:233], v[98:99] op_sel_hi:[1,0]
    v_pk_mul_f32 v[234:235], v[234:235], v[98:99] op_sel_hi:[1,0]
    v_pk_mul_f32 v[236:237], v[236:237], v[98:99] op_sel_hi:[1,0]
    v_pk_mul_f32 v[238:239], v[238:239], v[98:99] op_sel_hi:[1,0]
    v_cvt_pk_bf16_f32 v84, v232, v233
    v_cvt_pk_bf16_f32 v85, v234, v235
    v_cvt_pk_bf16_f32 v86, v236, v237
    v_cvt_pk_bf16_f32 v87, v238, v239
    v_pk_mul_f32 v[240:241], v[240:241], v[98:99] op_sel_hi:[1,0]
    v_pk_mul_f32 v[242:243], v[242:243], v[98:99] op_sel_hi:[1,0]
    v_pk_mul_f32 v[244:245], v[244:245], v[98:99] op_sel_hi:[1,0]
    v_pk_mul_f32 v[246:247], v[246:247], v[98:99] op_sel_hi:[1,0]
    v_cvt_pk_bf16_f32 v88, v240, v241
    v_cvt_pk_bf16_f32 v89, v242, v243
    v_cvt_pk_bf16_f32 v90, v244, v245
    v_cvt_pk_bf16_f32 v91, v246, v247
    v_pk_mul_f32 v[248:249], v[248:249], v[98:99] op_sel_hi:[1,0]
    v_pk_mul_f32 v[250:251], v[250:251], v[98:99] op_sel_hi:[1,0]
    v_pk_mul_f32 v[252:253], v[252:253], v[98:99] op_sel_hi:[1,0]
    v_pk_mul_f32 v[254:255], v[254:255], v[98:99] op_sel_hi:[1,0]
    v_cvt_pk_bf16_f32 v92, v248, v249
    v_cvt_pk_bf16_f32 v93, v250, v251
    v_cvt_pk_bf16_f32 v94, v252, v253
    v_cvt_pk_bf16_f32 v95, v254, v255
    s_cmp_lg_u64 s[100:101], 0
    s_cbranch_scc1 L_fb
L_fbret0:
    s_mov_b32 s36, 1
    s_add_u32 s42, s42, 4096
    s_mov_b32 s43, 1
    s_branch L_unit
L_tail:
    s_waitcnt lgkmcnt(0)
    v_mfma_f32_16x16x32_bf16 v[128:131], a[160:163], v[112:115], v[128:131]
    v_exp_f32 v38, v38
    v_mfma_f32_16x16x32_bf16 v[160:163], a[160:163], v[116:119], v[160:163]
    ds_read_b128 a[128:131], v1 offset:2048
    v_mfma_f32_16x16x32_bf16 v[192:195], a[160:163], v[120:123], v[192:195]
    v_exp_f32 v39, v39
    v_mfma_f32_16x16x32_bf16 v[224:227], a[160:163], v[124:127], v[224:227]
    ds_read_b128 a[132:135], v2 offset:2048
    v_cvt_pk_bf16_f32 v99, v38, v39
    v_mfma_f32_16x16x32_bf16 v[228:231], a[164:167], v[124:127], v[228:231]
    v_exp_f32 v40, v40
    v_mfma_f32_16x16x32_bf16 v[196:199], a[164:167], v[120:123], v[196:199]
    ds_read_b128 a[136:139], v3 offset:2048
    v_mfma_f32_16x16x32_bf16 v[164:167], a[164:167], v[116:119], v[164:167]
    v_exp_f32 v41, v41
    v_mfma_f32_16x16x32_bf16 v[132:135], a[164:167], v[112:115], v[132:135]
    ds_read_b128 a[140:143], v4 offset:2048
    v_cvt_pk_bf16_f32 v100, v40, v41
    v_mfma_f32_16x16x32_bf16 v[136:139], a[168:171], v[112:115], v[136:139]
    v_exp_f32 v42, v42
    v_mfma_f32_16x16x32_bf16 v[168:171], a[168:171], v[116:119], v[168:171]
    ds_read_b128 a[144:147], v1 offset:3072
    v_mfma_f32_16x16x32_bf16 v[200:203], a[168:171], v[120:123], v[200:203]
    v_exp_f32 v43, v43
    v_mfma_f32_16x16x32_bf16 v[232:235], a[168:171], v[124:127], v[232:235]
    ds_read_b128 a[148:151], v2 offset:3072
    v_cvt_pk_bf16_f32 v101, v42, v43
    v_mfma_f32_16x16x32_bf16 v[236:239], a[172:175], v[124:127], v[236:239]
    v_exp_f32 v44, v44
    v_mfma_f32_16x16x32_bf16 v[204:207], a[172:175], v[120:123], v[204:207]
    ds_read_b128 a[152:155], v3 offset:3072
    v_mfma_f32_16x16x32_bf16 v[172:175], a[172:175], v[116:119], v[172:175]
    v_exp_f32 v45, v45
    v_mfma_f32_16x16x32_bf16 v[140:143], a[172:175], v[112:115], v[140:143]
    ds_read_b128 a[156:159], v4 offset:3072
    v_cvt_pk_bf16_f32 v102, v44, v45
    v_smfmac_f32_16x16x64_bf16 a[192:195], a[208:211], v[112:119], v15
    v_exp_f32 v46, v46
    v_mfma_f32_16x16x32_bf16 v[144:147], a[176:179], v[112:115], v[144:147]
    s_add_u32 m0, s30, 0
    v_mfma_f32_16x16x32_bf16 v[176:179], a[176:179], v[116:119], v[176:179]
    v_exp_f32 v47, v47
    v_mfma_f32_16x16x32_bf16 v[208:211], a[176:179], v[120:123], v[208:211]
    v_cvt_pk_bf16_f32 v103, v46, v47
    s_waitcnt vmcnt(16) lgkmcnt(0)
    s_barrier
    v_mfma_f32_16x16x32_bf16 v[240:243], a[176:179], v[124:127], v[240:243]
    v_exp_f32 v48, v48
    v_mfma_f32_16x16x32_bf16 v[244:247], a[180:183], v[124:127], v[244:247]
    buffer_load_dwordx4 v13, s[20:23], s33 offen offset:0 nt lds
    v_mfma_f32_16x16x32_bf16 v[212:215], a[180:183], v[120:123], v[212:215]
    v_exp_f32 v49, v49
    v_mfma_f32_16x16x32_bf16 v[180:183], a[180:183], v[116:119], v[180:183]
    ds_read_b64_tr_b16 a[160:161], v5 offset:16384
    v_cvt_pk_bf16_f32 v104, v48, v49
    v_mfma_f32_16x16x32_bf16 v[148:151], a[180:183], v[112:115], v[148:151]
    v_exp_f32 v50, v50
    v_mfma_f32_16x16x32_bf16 v[152:155], a[184:187], v[112:115], v[152:155]
    ds_read_b64_tr_b16 a[162:163], v5 offset:17408
    v_mfma_f32_16x16x32_bf16 v[184:187], a[184:187], v[116:119], v[184:187]
    v_exp_f32 v51, v51
    v_mfma_f32_16x16x32_bf16 v[216:219], a[184:187], v[120:123], v[216:219]
    ds_read_b64_tr_b16 a[164:165], v6 offset:16384
    v_cvt_pk_bf16_f32 v105, v50, v51
    v_mfma_f32_16x16x32_bf16 v[248:251], a[184:187], v[124:127], v[248:251]
    v_exp_f32 v52, v52
    v_mfma_f32_16x16x32_bf16 v[252:255], a[188:191], v[124:127], v[252:255]
    buffer_load_dwordx4 v13, s[20:23], s33 offen offset:1024 nt lds
    v_mfma_f32_16x16x32_bf16 v[220:223], a[188:191], v[120:123], v[220:223]
    v_exp_f32 v53, v53
    v_mfma_f32_16x16x32_bf16 v[188:191], a[188:191], v[116:119], v[188:191]
    ds_read_b64_tr_b16 a[166:167], v6 offset:17408
    v_cvt_pk_bf16_f32 v106, v52, v53
    v_mfma_f32_16x16x32_bf16 v[156:159], a[188:191], v[112:115], v[156:159]
    v_exp_f32 v54, v54
    v_smfmac_f32_16x16x64_bf16 a[196:199], a[208:211], v[120:127], v15
    ds_read_b64_tr_b16 a[168:169], v7 offset:16384
    v_mfma_f32_16x16x32_bf16 v[64:67], a[128:131], a[0:3], v[16:19]
    v_exp_f32 v55, v55
    v_mfma_f32_16x16x32_bf16 v[72:75], a[128:131], a[16:19], v[20:23]
    ds_read_b64_tr_b16 a[170:171], v7 offset:17408
    v_cvt_pk_bf16_f32 v107, v54, v55
    v_mfma_f32_16x16x32_bf16 v[76:79], a[144:147], a[16:19], v[20:23]
    v_exp_f32 v56, v56
    v_mfma_f32_16x16x32_bf16 v[68:71], a[144:147], a[0:3], v[16:19]
    buffer_load_dwordx4 v13, s[20:23], s33 offen offset:2048 nt lds
    v_mfma_f32_16x16x32_bf16 v[76:79], a[148:151], a[20:23], v[76:79]
    v_exp_f32 v57, v57
    v_mfma_f32_16x16x32_bf16 v[68:71], a[148:151], a[4:7], v[68:71]
    ds_read_b64_tr_b16 a[172:173], v8 offset:16384
    v_cvt_pk_bf16_f32 v108, v56, v57
    v_mfma_f32_16x16x32_bf16 v[64:67], a[132:135], a[4:7], v[64:67]
    v_exp_f32 v58, v58
    v_mfma_f32_16x16x32_bf16 v[72:75], a[132:135], a[20:23], v[72:75]
    ds_read_b64_tr_b16 a[174:175], v8 offset:17408
    v_mfma_f32_16x16x32_bf16 v[64:67], a[136:139], a[8:11], v[64:67]
    v_exp_f32 v59, v59
    v_mfma_f32_16x16x32_bf16 v[72:75], a[136:139], a[24:27], v[72:75]
    ds_read_b64_tr_b16 a[176:177], v9 offset:16384
    v_cvt_pk_bf16_f32 v109, v58, v59
    v_mfma_f32_16x16x32_bf16 v[76:79], a[152:155], a[24:27], v[76:79]
    v_exp_f32 v60, v60
    v_mfma_f32_16x16x32_bf16 v[68:71], a[152:155], a[8:11], v[68:71]
    buffer_load_dwordx4 v13, s[20:23], s33 offen offset:3072 nt lds
    v_mfma_f32_16x16x32_bf16 v[76:79], a[156:159], a[28:31], v[76:79]
    v_exp_f32 v61, v61
    v_mfma_f32_16x16x32_bf16 v[68:71], a[156:159], a[12:15], v[68:71]
    ds_read_b64_tr_b16 a[178:179], v9 offset:17408
    v_cvt_pk_bf16_f32 v110, v60, v61
    v_mfma_f32_16x16x32_bf16 v[64:67], a[140:143], a[12:15], v[64:67]
    v_exp_f32 v62, v62
    v_mfma_f32_16x16x32_bf16 v[72:75], a[140:143], a[28:31], v[72:75]
    ds_read_b64_tr_b16 a[180:181], v10 offset:16384
    s_add_u32 s37, s42, 126976
    v_mfma_f32_16x16x32_bf16 v[80:83], a[128:131], a[32:35], v[24:27]
    v_exp_f32 v63, v63
    v_mfma_f32_16x16x32_bf16 v[88:91], a[128:131], a[48:51], v[28:31]
    ds_read_b64_tr_b16 a[182:183], v10 offset:17408
    v_cvt_pk_bf16_f32 v111, v62, v63
    v_mfma_f32_16x16x32_bf16 v[92:95], a[144:147], a[48:51], v[28:31]
    buffer_store_dwordx4 a[80:83], v14, s[24:27], s37 offen offset:0 sc1
    v_mfma_f32_16x16x32_bf16 v[84:87], a[144:147], a[32:35], v[24:27]
    buffer_store_dwordx4 a[84:87], v14, s[24:27], s37 offen offset:1024 sc1
    v_mfma_f32_16x16x32_bf16 v[92:95], a[148:151], a[52:55], v[92:95]
    v_exp_f32 v64, v64
    v_mfma_f32_16x16x32_bf16 v[84:87], a[148:151], a[36:39], v[84:87]
    buffer_store_dwordx4 a[88:91], v14, s[24:27], s37 offen offset:2048 sc1
    v_mfma_f32_16x16x32_bf16 v[80:83], a[132:135], a[36:39], v[80:83]
    v_exp_f32 v65, v65
    v_mfma_f32_16x16x32_bf16 v[88:91], a[132:135], a[52:55], v[88:91]
    buffer_store_dwordx4 a[92:95], v14, s[24:27], s37 offen offset:3072 sc1
    v_cvt_pk_bf16_f32 v112, v64, v65
    v_mfma_f32_16x16x32_bf16 v[80:83], a[136:139], a[40:43], v[80:83]
    v_exp_f32 v66, v66
    v_mfma_f32_16x16x32_bf16 v[88:91], a[136:139], a[56:59], v[88:91]
    v_mfma_f32_16x16x32_bf16 v[92:95], a[152:155], a[56:59], v[92:95]
    v_exp_f32 v67, v67
    v_mfma_f32_16x16x32_bf16 v[84:87], a[152:155], a[40:43], v[84:87]
    v_cvt_pk_bf16_f32 v113, v66, v67
    v_mfma_f32_16x16x32_bf16 v[92:95], a[156:159], a[60:63], v[92:95]
    v_exp_f32 v68, v68
    v_mfma_f32_16x16x32_bf16 v[84:87], a[156:159], a[44:47], v[84:87]
    v_mfma_f32_16x16x32_bf16 v[80:83], a[140:143], a[44:47], v[80:83]
    v_exp_f32 v69, v69
    v_mfma_f32_16x16x32_bf16 v[88:91], a[140:143], a[60:63], v[88:91]
    ds_read_b64_tr_b16 a[184:185], v11 offset:16384
    ds_read_b64_tr_b16 a[186:187], v11 offset:17408
    ds_read_b64_tr_b16 a[188:189], v12 offset:16384
    ds_read_b64_tr_b16 a[190:191], v12 offset:17408
    v_cvt_pk_bf16_f32 v114, v68, v69
    s_waitcnt lgkmcnt(0)
    v_mfma_f32_16x16x32_bf16 v[128:131], a[160:163], v[96:99], v[128:131]
    v_exp_f32 v70, v70
    v_mfma_f32_16x16x32_bf16 v[160:163], a[160:163], v[100:103], v[160:163]
    ds_read_b128 a[128:131], v1 offset:16384
    v_mfma_f32_16x16x32_bf16 v[192:195], a[160:163], v[104:107], v[192:195]
    v_exp_f32 v71, v71
    v_mfma_f32_16x16x32_bf16 v[224:227], a[160:163], v[108:111], v[224:227]
    ds_read_b128 a[132:135], v2 offset:16384
    v_cvt_pk_bf16_f32 v115, v70, v71
    v_mfma_f32_16x16x32_bf16 v[228:231], a[164:167], v[108:111], v[228:231]
    v_exp_f32 v72, v72
    v_mfma_f32_16x16x32_bf16 v[196:199], a[164:167], v[104:107], v[196:199]
    ds_read_b128 a[136:139], v3 offset:16384
    v_mfma_f32_16x16x32_bf16 v[164:167], a[164:167], v[100:103], v[164:167]
    v_exp_f32 v73, v73
    v_mfma_f32_16x16x32_bf16 v[132:135], a[164:167], v[96:99], v[132:135]
    ds_read_b128 a[140:143], v4 offset:16384
    v_cvt_pk_bf16_f32 v116, v72, v73
    v_mfma_f32_16x16x32_bf16 v[136:139], a[168:171], v[96:99], v[136:139]
    v_exp_f32 v74, v74
    v_mfma_f32_16x16x32_bf16 v[168:171], a[168:171], v[100:103], v[168:171]
    ds_read_b128 a[144:147], v1 offset:17408
    v_mfma_f32_16x16x32_bf16 v[200:203], a[168:171], v[104:107], v[200:203]
    v_exp_f32 v75, v75
    v_mfma_f32_16x16x32_bf16 v[232:235], a[168:171], v[108:111], v[232:235]
    ds_read_b128 a[148:151], v2 offset:17408
    v_cvt_pk_bf16_f32 v117, v74, v75
    v_mfma_f32_16x16x32_bf16 v[236:239], a[172:175], v[108:111], v[236:239]
    v_exp_f32 v76, v76
    v_mfma_f32_16x16x32_bf16 v[204:207], a[172:175], v[104:107], v[204:207]
    ds_read_b128 a[152:155], v3 offset:17408
    v_mfma_f32_16x16x32_bf16 v[172:175], a[172:175], v[100:103], v[172:175]
    v_exp_f32 v77, v77
    v_mfma_f32_16x16x32_bf16 v[140:143], a[172:175], v[96:99], v[140:143]
    ds_read_b128 a[156:159], v4 offset:17408
    v_cvt_pk_bf16_f32 v118, v76, v77
    v_smfmac_f32_16x16x64_bf16 a[192:195], a[208:211], v[96:103], v15
    v_exp_f32 v78, v78
    s_add_u32 s37, s42, 258048
    v_mfma_f32_16x16x32_bf16 v[144:147], a[176:179], v[96:99], v[144:147]
    buffer_store_dwordx4 a[96:99], v14, s[24:27], s37 offen offset:0 sc1
    v_mfma_f32_16x16x32_bf16 v[176:179], a[176:179], v[100:103], v[176:179]
    v_exp_f32 v79, v79
    v_mfma_f32_16x16x32_bf16 v[208:211], a[176:179], v[104:107], v[208:211]
    ds_read_b64_tr_b16 a[160:161], v5 offset:18432
    v_cvt_pk_bf16_f32 v119, v78, v79
    v_mfma_f32_16x16x32_bf16 v[240:243], a[176:179], v[108:111], v[240:243]
    v_exp_f32 v80, v80
    v_mfma_f32_16x16x32_bf16 v[244:247], a[180:183], v[108:111], v[244:247]
    ds_read_b64_tr_b16 a[162:163], v5 offset:19456
    v_mfma_f32_16x16x32_bf16 v[212:215], a[180:183], v[104:107], v[212:215]
    v_exp_f32 v81, v81
    v_mfma_f32_16x16x32_bf16 v[180:183], a[180:183], v[100:103], v[180:183]
    ds_read_b64_tr_b16 a[164:165], v6 offset:18432
    v_cvt_pk_bf16_f32 v120, v80, v81
    v_mfma_f32_16x16x32_bf16 v[148:151], a[180:183], v[96:99], v[148:151]
    v_exp_f32 v82, v82
    v_mfma_f32_16x16x32_bf16 v[152:155], a[184:187], v[96:99], v[152:155]
    buffer_store_dwordx4 a[100:103], v14, s[24:27], s37 offen offset:1024 sc1
    v_mfma_f32_16x16x32_bf16 v[184:187], a[184:187], v[100:103], v[184:187]
    v_exp_f32 v83, v83
    v_mfma_f32_16x16x32_bf16 v[216:219], a[184:187], v[104:107], v[216:219]
    ds_read_b64_tr_b16 a[166:167], v6 offset:19456
    v_cvt_pk_bf16_f32 v121, v82, v83
    v_mfma_f32_16x16x32_bf16 v[248:251], a[184:187], v[108:111], v[248:251]
    v_exp_f32 v84, v84
    v_mfma_f32_16x16x32_bf16 v[252:255], a[188:191], v[108:111], v[252:255]
    ds_read_b64_tr_b16 a[168:169], v7 offset:18432
    s_waitcnt lgkmcnt(5)
    v_mfma_f32_16x16x32_bf16 v[220:223], a[188:191], v[104:107], v[220:223]
    v_exp_f32 v85, v85
    v_mfma_f32_16x16x32_bf16 v[188:191], a[188:191], v[100:103], v[188:191]
    ds_read_b64_tr_b16 a[170:171], v7 offset:19456
    v_cvt_pk_bf16_f32 v122, v84, v85
    v_mfma_f32_16x16x32_bf16 v[156:159], a[188:191], v[96:99], v[156:159]
    v_exp_f32 v86, v86
    v_smfmac_f32_16x16x64_bf16 a[196:199], a[208:211], v[104:111], v15
    buffer_store_dwordx4 a[104:107], v14, s[24:27], s37 offen offset:2048 sc1
    v_mfma_f32_16x16x32_bf16 v[32:35], a[128:131], a[0:3], v[16:19]
    v_exp_f32 v87, v87
    v_mfma_f32_16x16x32_bf16 v[40:43], a[128:131], a[16:19], v[20:23]
    ds_read_b64_tr_b16 a[172:173], v8 offset:18432
    v_cvt_pk_bf16_f32 v123, v86, v87
    v_mfma_f32_16x16x32_bf16 v[44:47], a[144:147], a[16:19], v[20:23]
    v_exp_f32 v88, v88
    v_mfma_f32_16x16x32_bf16 v[36:39], a[144:147], a[0:3], v[16:19]
    ds_read_b64_tr_b16 a[174:175], v8 offset:19456
    v_mfma_f32_16x16x32_bf16 v[44:47], a[148:151], a[20:23], v[44:47]
    v_exp_f32 v89, v89
    v_mfma_f32_16x16x32_bf16 v[36:39], a[148:151], a[4:7], v[36:39]
    ds_read_b64_tr_b16 a[176:177], v9 offset:18432
    v_cvt_pk_bf16_f32 v124, v88, v89
    v_mfma_f32_16x16x32_bf16 v[32:35], a[132:135], a[4:7], v[32:35]
    v_exp_f32 v90, v90
    v_mfma_f32_16x16x32_bf16 v[40:43], a[132:135], a[20:23], v[40:43]
    buffer_store_dwordx4 a[108:111], v14, s[24:27], s37 offen offset:3072 sc1
    v_mfma_f32_16x16x32_bf16 v[32:35], a[136:139], a[8:11], v[32:35]
    v_exp_f32 v91, v91
    v_mfma_f32_16x16x32_bf16 v[40:43], a[136:139], a[24:27], v[40:43]
    ds_read_b64_tr_b16 a[178:179], v9 offset:19456
    v_cvt_pk_bf16_f32 v125, v90, v91
    v_mfma_f32_16x16x32_bf16 v[44:47], a[152:155], a[24:27], v[44:47]
    v_exp_f32 v92, v92
    v_mfma_f32_16x16x32_bf16 v[36:39], a[152:155], a[8:11], v[36:39]
    ds_read_b64_tr_b16 a[180:181], v10 offset:18432
    v_mfma_f32_16x16x32_bf16 v[44:47], a[156:159], a[28:31], v[44:47]
    v_exp_f32 v93, v93
    v_mfma_f32_16x16x32_bf16 v[36:39], a[156:159], a[12:15], v[36:39]
    ds_read_b64_tr_b16 a[182:183], v10 offset:19456
    v_cvt_pk_bf16_f32 v126, v92, v93
    v_mfma_f32_16x16x32_bf16 v[32:35], a[140:143], a[12:15], v[32:35]
    v_exp_f32 v94, v94
    v_mfma_f32_16x16x32_bf16 v[40:43], a[140:143], a[28:31], v[40:43]
    v_mfma_f32_16x16x32_bf16 v[48:51], a[128:131], a[32:35], v[24:27]
    v_exp_f32 v95, v95
    v_mfma_f32_16x16x32_bf16 v[56:59], a[128:131], a[48:51], v[28:31]
    v_cvt_pk_bf16_f32 v127, v94, v95
    v_mfma_f32_16x16x32_bf16 v[60:63], a[144:147], a[48:51], v[28:31]
    v_mfma_f32_16x16x32_bf16 v[52:55], a[144:147], a[32:35], v[24:27]
    v_mfma_f32_16x16x32_bf16 v[60:63], a[148:151], a[52:55], v[60:63]
    v_exp_f32 v32, v32
    v_mfma_f32_16x16x32_bf16 v[52:55], a[148:151], a[36:39], v[52:55]
    v_mfma_f32_16x16x32_bf16 v[48:51], a[132:135], a[36:39], v[48:51]
    v_exp_f32 v33, v33
    v_mfma_f32_16x16x32_bf16 v[56:59], a[132:135], a[52:55], v[56:59]
    v_cvt_pk_bf16_f32 v96, v32, v33
    v_mfma_f32_16x16x32_bf16 v[48:51], a[136:139], a[40:43], v[48:51]
    v_exp_f32 v34, v34
    v_mfma_f32_16x16x32_bf16 v[56:59], a[136:139], a[56:59], v[56:59]
    v_mfma_f32_16x16x32_bf16 v[60:63], a[152:155], a[56:59], v[60:63]
    v_exp_f32 v35, v35
    v_mfma_f32_16x16x32_bf16 v[52:55], a[152:155], a[40:43], v[52:55]
    v_cvt_pk_bf16_f32 v97, v34, v35
    v_mfma_f32_16x16x32_bf16 v[60:63], a[156:159], a[60:63], v[60:63]
    v_exp_f32 v36, v36
    v_mfma_f32_16x16x32_bf16 v[52:55], a[156:159], a[44:47], v[52:55]
    v_mfma_f32_16x16x32_bf16 v[48:51], a[140:143], a[44:47], v[48:51]
    v_exp_f32 v37, v37
    v_mfma_f32_16x16x32_bf16 v[56:59], a[140:143], a[60:63], v[56:59]
    ds_read_b64_tr_b16 a[184:185], v11 offset:18432
    ds_read_b64_tr_b16 a[186:187], v11 offset:19456
    ds_read_b64_tr_b16 a[188:189], v12 offset:18432
    ds_read_b64_tr_b16 a[190:191], v12 offset:19456
    v_cvt_pk_bf16_f32 v98, v36, v37
    s_waitcnt lgkmcnt(0)
    v_mfma_f32_16x16x32_bf16 v[128:131], a[160:163], v[112:115], v[128:131]
    v_exp_f32 v38, v38
    v_mfma_f32_16x16x32_bf16 v[160:163], a[160:163], v[116:119], v[160:163]
    ds_read_b128 a[128:131], v1 offset:18432
    v_mfma_f32_16x16x32_bf16 v[192:195], a[160:163], v[120:123], v[192:195]
    v_exp_f32 v39, v39
    v_mfma_f32_16x16x32_bf16 v[224:227], a[160:163], v[124:127], v[224:227]
    ds_read_b128 a[132:135], v2 offset:18432
    v_cvt_pk_bf16_f32 v99, v38, v39
    v_mfma_f32_16x16x32_bf16 v[228:231], a[164:167], v[124:127], v[228:231]
    v_exp_f32 v40, v40
    v_mfma_f32_16x16x32_bf16 v[196:199], a[164:167], v[120:123], v[196:199]
    ds_read_b128 a[136:139], v3 offset:18432
    v_mfma_f32_16x16x32_bf16 v[164:167], a[164:167], v[116:119], v[164:167]
    v_exp_f32 v41, v41
    v_mfma_f32_16x16x32_bf16 v[132:135], a[164:167], v[112:115], v[132:135]
    ds_read_b128 a[140:143], v4 offset:18432
    v_cvt_pk_bf16_f32 v100, v40, v41
    v_mfma_f32_16x16x32_bf16 v[136:139], a[168:171], v[112:115], v[136:139]
    v_exp_f32 v42, v42
    v_mfma_f32_16x16x32_bf16 v[168:171], a[168:171], v[116:119], v[168:171]
    ds_read_b128 a[144:147], v1 offset:19456
    v_mfma_f32_16x16x32_bf16 v[200:203], a[168:171], v[120:123], v[200:203]
    v_exp_f32 v43, v43
    v_mfma_f32_16x16x32_bf16 v[232:235], a[168:171], v[124:127], v[232:235]
    ds_read_b128 a[148:151], v2 offset:19456
    v_cvt_pk_bf16_f32 v101, v42, v43
    v_mfma_f32_16x16x32_bf16 v[236:239], a[172:175], v[124:127], v[236:239]
    v_exp_f32 v44, v44
    v_mfma_f32_16x16x32_bf16 v[204:207], a[172:175], v[120:123], v[204:207]
    ds_read_b128 a[152:155], v3 offset:19456
    v_mfma_f32_16x16x32_bf16 v[172:175], a[172:175], v[116:119], v[172:175]
    v_exp_f32 v45, v45
    v_mfma_f32_16x16x32_bf16 v[140:143], a[172:175], v[112:115], v[140:143]
    ds_read_b128 a[156:159], v4 offset:19456
    v_cvt_pk_bf16_f32 v102, v44, v45
    v_smfmac_f32_16x16x64_bf16 a[192:195], a[208:211], v[112:119], v15
    v_exp_f32 v46, v46
    v_mfma_f32_16x16x32_bf16 v[144:147], a[176:179], v[112:115], v[144:147]
    s_add_u32 s37, s42, 389120
    v_mfma_f32_16x16x32_bf16 v[176:179], a[176:179], v[116:119], v[176:179]
    v_exp_f32 v47, v47
    v_mfma_f32_16x16x32_bf16 v[208:211], a[176:179], v[120:123], v[208:211]
    v_cvt_pk_bf16_f32 v103, v46, v47
    s_waitcnt vmcnt(20) lgkmcnt(0)
    s_barrier
    v_mfma_f32_16x16x32_bf16 v[240:243], a[176:179], v[124:127], v[240:243]
    v_exp_f32 v48, v48
    v_mfma_f32_16x16x32_bf16 v[244:247], a[180:183], v[124:127], v[244:247]
    buffer_store_dwordx4 a[112:115], v14, s[24:27], s37 offen offset:0 sc1
    v_mfma_f32_16x16x32_bf16 v[212:215], a[180:183], v[120:123], v[212:215]
    v_exp_f32 v49, v49
    v_mfma_f32_16x16x32_bf16 v[180:183], a[180:183], v[116:119], v[180:183]
    ds_read_b64_tr_b16 a[160:161], v5 offset:32768
    v_cvt_pk_bf16_f32 v104, v48, v49
    v_mfma_f32_16x16x32_bf16 v[148:151], a[180:183], v[112:115], v[148:151]
    v_exp_f32 v50, v50
    v_mfma_f32_16x16x32_bf16 v[152:155], a[184:187], v[112:115], v[152:155]
    ds_read_b64_tr_b16 a[162:163], v5 offset:33792
    v_mfma_f32_16x16x32_bf16 v[184:187], a[184:187], v[116:119], v[184:187]
    v_exp_f32 v51, v51
    v_mfma_f32_16x16x32_bf16 v[216:219], a[184:187], v[120:123], v[216:219]
    ds_read_b64_tr_b16 a[164:165], v6 offset:32768
    v_cvt_pk_bf16_f32 v105, v50, v51
    v_mfma_f32_16x16x32_bf16 v[248:251], a[184:187], v[124:127], v[248:251]
    v_exp_f32 v52, v52
    v_mfma_f32_16x16x32_bf16 v[252:255], a[188:191], v[124:127], v[252:255]
    buffer_store_dwordx4 a[116:119], v14, s[24:27], s37 offen offset:1024 sc1
    v_mfma_f32_16x16x32_bf16 v[220:223], a[188:191], v[120:123], v[220:223]
    v_exp_f32 v53, v53
    v_mfma_f32_16x16x32_bf16 v[188:191], a[188:191], v[116:119], v[188:191]
    ds_read_b64_tr_b16 a[166:167], v6 offset:33792
    v_cvt_pk_bf16_f32 v106, v52, v53
    v_mfma_f32_16x16x32_bf16 v[156:159], a[188:191], v[112:115], v[156:159]
    v_exp_f32 v54, v54
    v_smfmac_f32_16x16x64_bf16 a[196:199], a[208:211], v[120:127], v15
    ds_read_b64_tr_b16 a[168:169], v7 offset:32768
    v_mfma_f32_16x16x32_bf16 v[64:67], a[128:131], a[0:3], v[16:19]
    v_exp_f32 v55, v55
    v_mfma_f32_16x16x32_bf16 v[72:75], a[128:131], a[16:19], v[20:23]
    ds_read_b64_tr_b16 a[170:171], v7 offset:33792
    v_cvt_pk_bf16_f32 v107, v54, v55
    v_mfma_f32_16x16x32_bf16 v[76:79], a[144:147], a[16:19], v[20:23]
    v_exp_f32 v56, v56
    v_mfma_f32_16x16x32_bf16 v[68:71], a[144:147], a[0:3], v[16:19]
    buffer_store_dwordx4 a[120:123], v14, s[24:27], s37 offen offset:2048 sc1
    v_mfma_f32_16x16x32_bf16 v[76:79], a[148:151], a[20:23], v[76:79]
    v_exp_f32 v57, v57
    v_mfma_f32_16x16x32_bf16 v[68:71], a[148:151], a[4:7], v[68:71]
    ds_read_b64_tr_b16 a[172:173], v8 offset:32768
    v_cvt_pk_bf16_f32 v108, v56, v57
    v_mfma_f32_16x16x32_bf16 v[64:67], a[132:135], a[4:7], v[64:67]
    v_exp_f32 v58, v58
    v_mfma_f32_16x16x32_bf16 v[72:75], a[132:135], a[20:23], v[72:75]
    ds_read_b64_tr_b16 a[174:175], v8 offset:33792
    v_mfma_f32_16x16x32_bf16 v[64:67], a[136:139], a[8:11], v[64:67]
    v_exp_f32 v59, v59
    v_mfma_f32_16x16x32_bf16 v[72:75], a[136:139], a[24:27], v[72:75]
    ds_read_b64_tr_b16 a[176:177], v9 offset:32768
    v_cvt_pk_bf16_f32 v109, v58, v59
    v_mfma_f32_16x16x32_bf16 v[76:79], a[152:155], a[24:27], v[76:79]
    v_exp_f32 v60, v60
    v_mfma_f32_16x16x32_bf16 v[68:71], a[152:155], a[8:11], v[68:71]
    buffer_store_dwordx4 a[124:127], v14, s[24:27], s37 offen offset:3072 sc1
    v_mfma_f32_16x16x32_bf16 v[76:79], a[156:159], a[28:31], v[76:79]
    v_exp_f32 v61, v61
    v_mfma_f32_16x16x32_bf16 v[68:71], a[156:159], a[12:15], v[68:71]
    ds_read_b64_tr_b16 a[178:179], v9 offset:33792
    v_cvt_pk_bf16_f32 v110, v60, v61
    v_mfma_f32_16x16x32_bf16 v[64:67], a[140:143], a[12:15], v[64:67]
    v_exp_f32 v62, v62
    v_mfma_f32_16x16x32_bf16 v[72:75], a[140:143], a[28:31], v[72:75]
    ds_read_b64_tr_b16 a[180:181], v10 offset:32768
    s_add_u32 s44, s84, 0
    s_add_u32 m0, s92, 0
    v_mfma_f32_16x16x32_bf16 v[80:83], a[128:131], a[32:35], v[24:27]
    v_exp_f32 v63, v63
    v_accvgpr_read_b32 v13, a212
    v_mfma_f32_16x16x32_bf16 v[88:91], a[128:131], a[48:51], v[28:31]
    ds_read_b64_tr_b16 a[182:183], v10 offset:33792
    v_cvt_pk_bf16_f32 v111, v62, v63
    v_mfma_f32_16x16x32_bf16 v[92:95], a[144:147], a[48:51], v[28:31]
    buffer_load_dwordx4 v13, s[12:15], s44 offen offset:0 lds
    v_accvgpr_read_b32 v13, a213
    v_mfma_f32_16x16x32_bf16 v[84:87], a[144:147], a[32:35], v[24:27]
    buffer_load_dwordx4 v13, s[12:15], s44 offen offset:1024 lds
    v_accvgpr_read_b32 v13, a214
    v_mfma_f32_16x16x32_bf16 v[92:95], a[148:151], a[52:55], v[92:95]
    v_exp_f32 v64, v64
    v_mfma_f32_16x16x32_bf16 v[84:87], a[148:151], a[36:39], v[84:87]
    buffer_load_dwordx4 v13, s[12:15], s44 offen offset:2048 lds
    v_accvgpr_read_b32 v13, a215
    v_mfma_f32_16x16x32_bf16 v[80:83], a[132:135], a[36:39], v[80:83]
    v_exp_f32 v65, v65
    v_mfma_f32_16x16x32_bf16 v[88:91], a[132:135], a[52:55], v[88:91]
    buffer_load_dwordx4 v13, s[12:15], s44 offen offset:3072 lds
    v_cvt_pk_bf16_f32 v112, v64, v65
    v_mfma_f32_16x16x32_bf16 v[80:83], a[136:139], a[40:43], v[80:83]
    v_exp_f32 v66, v66
    v_accvgpr_read_b32 v13, a216
    s_add_u32 m0, s92, 8192
    v_mfma_f32_16x16x32_bf16 v[88:91], a[136:139], a[56:59], v[88:91]
    buffer_load_dwordx4 v13, s[12:15], s44 offen offset:0 lds
    v_mfma_f32_16x16x32_bf16 v[92:95], a[152:155], a[56:59], v[92:95]
    v_exp_f32 v67, v67
    v_mfma_f32_16x16x32_bf16 v[84:87], a[152:155], a[40:43], v[84:87]
    v_cvt_pk_bf16_f32 v113, v66, v67
    v_mfma_f32_16x16x32_bf16 v[92:95], a[156:159], a[60:63], v[92:95]
    v_exp_f32 v68, v68
    v_mfma_f32_16x16x32_bf16 v[84:87], a[156:159], a[44:47], v[84:87]
    v_mfma_f32_16x16x32_bf16 v[80:83], a[140:143], a[44:47], v[80:83]
    v_exp_f32 v69, v69
    v_mfma_f32_16x16x32_bf16 v[88:91], a[140:143], a[60:63], v[88:91]
    ds_read_b64_tr_b16 a[184:185], v11 offset:32768
    ds_read_b64_tr_b16 a[186:187], v11 offset:33792
    ds_read_b64_tr_b16 a[188:189], v12 offset:32768
    ds_read_b64_tr_b16 a[190:191], v12 offset:33792
    v_cvt_pk_bf16_f32 v114, v68, v69
    s_waitcnt lgkmcnt(0)
    v_mfma_f32_16x16x32_bf16 v[128:131], a[160:163], v[96:99], v[128:131]
    v_exp_f32 v70, v70
    v_mfma_f32_16x16x32_bf16 v[160:163], a[160:163], v[100:103], v[160:163]
    ds_read_b128 a[128:131], v1 offset:32768
    v_mfma_f32_16x16x32_bf16 v[192:195], a[160:163], v[104:107], v[192:195]
    v_exp_f32 v71, v71
    v_mfma_f32_16x16x32_bf16 v[224:227], a[160:163], v[108:111], v[224:227]
    ds_read_b128 a[132:135], v2 offset:32768
    v_cvt_pk_bf16_f32 v115, v70, v71
    v_mfma_f32_16x16x32_bf16 v[228:231], a[164:167], v[108:111], v[228:231]
    v_exp_f32 v72, v72
    v_mfma_f32_16x16x32_bf16 v[196:199], a[164:167], v[104:107], v[196:199]
    ds_read_b128 a[136:139], v3 offset:32768
    v_mfma_f32_16x16x32_bf16 v[164:167], a[164:167], v[100:103], v[164:167]
    v_exp_f32 v73, v73
    v_mfma_f32_16x16x32_bf16 v[132:135], a[164:167], v[96:99], v[132:135]
    ds_read_b128 a[140:143], v4 offset:32768
    v_cvt_pk_bf16_f32 v116, v72, v73
    v_mfma_f32_16x16x32_bf16 v[136:139], a[168:171], v[96:99], v[136:139]
    v_exp_f32 v74, v74
    v_mfma_f32_16x16x32_bf16 v[168:171], a[168:171], v[100:103], v[168:171]
    ds_read_b128 a[144:147], v1 offset:33792
    v_mfma_f32_16x16x32_bf16 v[200:203], a[168:171], v[104:107], v[200:203]
    v_exp_f32 v75, v75
    v_mfma_f32_16x16x32_bf16 v[232:235], a[168:171], v[108:111], v[232:235]
    ds_read_b128 a[148:151], v2 offset:33792
    v_cvt_pk_bf16_f32 v117, v74, v75
    v_mfma_f32_16x16x32_bf16 v[236:239], a[172:175], v[108:111], v[236:239]
    v_exp_f32 v76, v76
    v_mfma_f32_16x16x32_bf16 v[204:207], a[172:175], v[104:107], v[204:207]
    ds_read_b128 a[152:155], v3 offset:33792
    v_mfma_f32_16x16x32_bf16 v[172:175], a[172:175], v[100:103], v[172:175]
    v_exp_f32 v77, v77
    v_mfma_f32_16x16x32_bf16 v[140:143], a[172:175], v[96:99], v[140:143]
    ds_read_b128 a[156:159], v4 offset:33792
    v_cvt_pk_bf16_f32 v118, v76, v77
    v_smfmac_f32_16x16x64_bf16 a[192:195], a[208:211], v[96:103], v15
    v_exp_f32 v78, v78
    s_add_u32 s44, s84, 0
    s_add_u32 m0, s92, 4096
    v_accvgpr_read_b32 v13, a217
    v_mfma_f32_16x16x32_bf16 v[144:147], a[176:179], v[96:99], v[144:147]
    buffer_load_dwordx4 v13, s[12:15], s44 offen offset:0 lds
    v_mfma_f32_16x16x32_bf16 v[176:179], a[176:179], v[100:103], v[176:179]
    v_exp_f32 v79, v79
    v_mfma_f32_16x16x32_bf16 v[208:211], a[176:179], v[104:107], v[208:211]
    ds_read_b64_tr_b16 a[160:161], v5 offset:34816
    v_cvt_pk_bf16_f32 v119, v78, v79
    v_mfma_f32_16x16x32_bf16 v[240:243], a[176:179], v[108:111], v[240:243]
    v_exp_f32 v80, v80
    v_mfma_f32_16x16x32_bf16 v[244:247], a[180:183], v[108:111], v[244:247]
    ds_read_b64_tr_b16 a[162:163], v5 offset:35840
    v_accvgpr_read_b32 v13, a218
    v_mfma_f32_16x16x32_bf16 v[212:215], a[180:183], v[104:107], v[212:215]
    v_exp_f32 v81, v81
    v_mfma_f32_16x16x32_bf16 v[180:183], a[180:183], v[100:103], v[180:183]
    ds_read_b64_tr_b16 a[164:165], v6 offset:34816
    v_cvt_pk_bf16_f32 v120, v80, v81
    v_mfma_f32_16x16x32_bf16 v[148:151], a[180:183], v[96:99], v[148:151]
    v_exp_f32 v82, v82
    s_waitcnt lgkmcnt(3)
    v_mfma_f32_16x16x32_bf16 v[152:155], a[184:187], v[96:99], v[152:155]
    buffer_load_dwordx4 v13, s[12:15], s44 offen offset:1024 lds
    v_mfma_f32_16x16x32_bf16 v[184:187], a[184:187], v[100:103], v[184:187]
    v_exp_f32 v83, v83
    v_mfma_f32_16x16x32_bf16 v[216:219], a[184:187], v[104:107], v[216:219]
    ds_read_b64_tr_b16 a[166:167], v6 offset:35840
    v_cvt_pk_bf16_f32 v121, v82, v83
    v_mfma_f32_16x16x32_bf16 v[248:251], a[184:187], v[108:111], v[248:251]
    v_exp_f32 v84, v84
    v_mfma_f32_16x16x32_bf16 v[252:255], a[188:191], v[108:111], v[252:255]
    ds_read_b64_tr_b16 a[168:169], v7 offset:34816
    v_accvgpr_read_b32 v13, a219
    v_mfma_f32_16x16x32_bf16 v[220:223], a[188:191], v[104:107], v[220:223]
    v_exp_f32 v85, v85
    v_mfma_f32_16x16x32_bf16 v[188:191], a[188:191], v[100:103], v[188:191]
    ds_read_b64_tr_b16 a[170:171], v7 offset:35840
    v_cvt_pk_bf16_f32 v122, v84, v85
    v_mfma_f32_16x16x32_bf16 v[156:159], a[188:191], v[96:99], v[156:159]
    v_exp_f32 v86, v86
    v_smfmac_f32_16x16x64_bf16 a[196:199], a[208:211], v[104:111], v15
    buffer_load_dwordx4 v13, s[12:15], s44 offen offset:2048 lds
    v_mfma_f32_16x16x32_bf16 v[32:35], a[128:131], a[0:3], v[16:19]
    v_exp_f32 v87, v87
    v_mfma_f32_16x16x32_bf16 v[40:43], a[128:131], a[16:19], v[20:23]
    ds_read_b64_tr_b16 a[172:173], v8 offset:34816
    v_cvt_pk_bf16_f32 v123, v86, v87
    v_mfma_f32_16x16x32_bf16 v[44:47], a[144:147], a[16:19], v[20:23]
    v_exp_f32 v88, v88
    v_mfma_f32_16x16x32_bf16 v[36:39], a[144:147], a[0:3], v[16:19]
    ds_read_b64_tr_b16 a[174:175], v8 offset:35840
    v_accvgpr_read_b32 v13, a220
    v_mfma_f32_16x16x32_bf16 v[44:47], a[148:151], a[20:23], v[44:47]
    v_exp_f32 v89, v89
    v_mfma_f32_16x16x32_bf16 v[36:39], a[148:151], a[4:7], v[36:39]
    ds_read_b64_tr_b16 a[176:177], v9 offset:34816
    v_cvt_pk_bf16_f32 v124, v88, v89
    v_mfma_f32_16x16x32_bf16 v[32:35], a[132:135], a[4:7], v[32:35]
    v_exp_f32 v90, v90
    v_mfma_f32_16x16x32_bf16 v[40:43], a[132:135], a[20:23], v[40:43]
    buffer_load_dwordx4 v13, s[12:15], s44 offen offset:3072 lds
    v_mfma_f32_16x16x32_bf16 v[32:35], a[136:139], a[8:11], v[32:35]
    v_exp_f32 v91, v91
    v_mfma_f32_16x16x32_bf16 v[40:43], a[136:139], a[24:27], v[40:43]
    ds_read_b64_tr_b16 a[178:179], v9 offset:35840
    v_cvt_pk_bf16_f32 v125, v90, v91
    v_mfma_f32_16x16x32_bf16 v[44:47], a[152:155], a[24:27], v[44:47]
    v_exp_f32 v92, v92
    v_mfma_f32_16x16x32_bf16 v[36:39], a[152:155], a[8:11], v[36:39]
    ds_read_b64_tr_b16 a[180:181], v10 offset:34816
    v_accvgpr_read_b32 v13, a221
    s_add_u32 m0, s92, 8192
    v_mfma_f32_16x16x32_bf16 v[44:47], a[156:159], a[28:31], v[44:47]
    v_exp_f32 v93, v93
    v_mfma_f32_16x16x32_bf16 v[36:39], a[156:159], a[12:15], v[36:39]
    ds_read_b64_tr_b16 a[182:183], v10 offset:35840
    v_cvt_pk_bf16_f32 v126, v92, v93
    v_mfma_f32_16x16x32_bf16 v[32:35], a[140:143], a[12:15], v[32:35]
    v_exp_f32 v94, v94
    v_mfma_f32_16x16x32_bf16 v[40:43], a[140:143], a[28:31], v[40:43]
    buffer_load_dwordx4 v13, s[12:15], s44 offen offset:1024 lds
    s_add_u32 s37, s65, 0
    v_mfma_f32_16x16x32_bf16 v[48:51], a[128:131], a[32:35], v[24:27]
    v_exp_f32 v95, v95
    v_mfma_f32_16x16x32_bf16 v[56:59], a[128:131], a[48:51], v[28:31]
    buffer_load_dwordx4 a[224:227], v14, s[12:15], s37 offen offset:0
    v_cvt_pk_bf16_f32 v127, v94, v95
    v_mfma_f32_16x16x32_bf16 v[60:63], a[144:147], a[48:51], v[28:31]
    buffer_load_dwordx4 a[228:231], v14, s[12:15], s37 offen offset:1024
    v_mfma_f32_16x16x32_bf16 v[52:55], a[144:147], a[32:35], v[24:27]
    buffer_load_dwordx4 a[232:235], v14, s[12:15], s37 offen offset:2048
    v_mfma_f32_16x16x32_bf16 v[60:63], a[148:151], a[52:55], v[60:63]
    v_exp_f32 v32, v32
    v_mfma_f32_16x16x32_bf16 v[52:55], a[148:151], a[36:39], v[52:55]
    buffer_load_dwordx4 a[236:239], v14, s[12:15], s37 offen offset:3072
    s_add_u32 s37, s65, 4096
    v_mfma_f32_16x16x32_bf16 v[48:51], a[132:135], a[36:39], v[48:51]
    v_exp_f32 v33, v33
    v_mfma_f32_16x16x32_bf16 v[56:59], a[132:135], a[52:55], v[56:59]
    buffer_load_dwordx4 a[240:243], v14, s[12:15], s37 offen offset:0
    v_cvt_pk_bf16_f32 v96, v32, v33
    v_mfma_f32_16x16x32_bf16 v[48:51], a[136:139], a[40:43], v[48:51]
    v_exp_f32 v34, v34
    v_mfma_f32_16x16x32_bf16 v[56:59], a[136:139], a[56:59], v[56:59]
    v_mfma_f32_16x16x32_bf16 v[60:63], a[152:155], a[56:59], v[60:63]
    v_exp_f32 v35, v35
    v_mfma_f32_16x16x32_bf16 v[52:55], a[152:155], a[40:43], v[52:55]
    v_cvt_pk_bf16_f32 v97, v34, v35
    v_mfma_f32_16x16x32_bf16 v[60:63], a[156:159], a[60:63], v[60:63]
    v_exp_f32 v36, v36
    v_mfma_f32_16x16x32_bf16 v[52:55], a[156:159], a[44:47], v[52:55]
    v_mfma_f32_16x16x32_bf16 v[48:51], a[140:143], a[44:47], v[48:51]
    v_exp_f32 v37, v37
    v_mfma_f32_16x16x32_bf16 v[56:59], a[140:143], a[60:63], v[56:59]
    ds_read_b64_tr_b16 a[184:185], v11 offset:34816
    ds_read_b64_tr_b16 a[186:187], v11 offset:35840
    ds_read_b64_tr_b16 a[188:189], v12 offset:34816
    ds_read_b64_tr_b16 a[190:191], v12 offset:35840
    v_cvt_pk_bf16_f32 v98, v36, v37
    s_waitcnt lgkmcnt(0)
    v_mfma_f32_16x16x32_bf16 v[128:131], a[160:163], v[112:115], v[128:131]
    v_exp_f32 v38, v38
    v_mfma_f32_16x16x32_bf16 v[160:163], a[160:163], v[116:119], v[160:163]
    ds_read_b128 a[128:131], v1 offset:34816
    v_mfma_f32_16x16x32_bf16 v[192:195], a[160:163], v[120:123], v[192:195]
    v_exp_f32 v39, v39
    v_mfma_f32_16x16x32_bf16 v[224:227], a[160:163], v[124:127], v[224:227]
    ds_read_b128 a[132:135], v2 offset:34816
    v_cvt_pk_bf16_f32 v99, v38, v39
    v_mfma_f32_16x16x32_bf16 v[228:231], a[164:167], v[124:127], v[228:231]
    v_exp_f32 v40, v40
    v_mfma_f32_16x16x32_bf16 v[196:199], a[164:167], v[120:123], v[196:199]
    ds_read_b128 a[136:139], v3 offset:34816
    v_mfma_f32_16x16x32_bf16 v[164:167], a[164:167], v[116:119], v[164:167]
    v_exp_f32 v41, v41
    v_mfma_f32_16x16x32_bf16 v[132:135], a[164:167], v[112:115], v[132:135]
    ds_read_b128 a[140:143], v4 offset:34816
    v_cvt_pk_bf16_f32 v100, v40, v41
    v_mfma_f32_16x16x32_bf16 v[136:139], a[168:171], v[112:115], v[136:139]
    v_exp_f32 v42, v42
    v_mfma_f32_16x16x32_bf16 v[168:171], a[168:171], v[116:119], v[168:171]
    ds_read_b128 a[144:147], v1 offset:35840
    v_mfma_f32_16x16x32_bf16 v[200:203], a[168:171], v[120:123], v[200:203]
    v_exp_f32 v43, v43
    v_mfma_f32_16x16x32_bf16 v[232:235], a[168:171], v[124:127], v[232:235]
    ds_read_b128 a[148:151], v2 offset:35840
    v_cvt_pk_bf16_f32 v101, v42, v43
    v_mfma_f32_16x16x32_bf16 v[236:239], a[172:175], v[124:127], v[236:239]
    v_exp_f32 v44, v44
    v_mfma_f32_16x16x32_bf16 v[204:207], a[172:175], v[120:123], v[204:207]
    ds_read_b128 a[152:155], v3 offset:35840
    v_mfma_f32_16x16x32_bf16 v[172:175], a[172:175], v[116:119], v[172:175]
    v_exp_f32 v45, v45
    v_mfma_f32_16x16x32_bf16 v[140:143], a[172:175], v[112:115], v[140:143]
    ds_read_b128 a[156:159], v4 offset:35840
    v_cvt_pk_bf16_f32 v102, v44, v45
    v_smfmac_f32_16x16x64_bf16 a[192:195], a[208:211], v[112:119], v15
    v_exp_f32 v46, v46
    v_mfma_f32_16x16x32_bf16 v[144:147], a[176:179], v[112:115], v[144:147]
    s_add_u32 s44, s85, 0
    s_add_u32 m0, s93, 0
    v_accvgpr_read_b32 v13, a212
    v_mfma_f32_16x16x32_bf16 v[176:179], a[176:179], v[116:119], v[176:179]
    v_exp_f32 v47, v47
    v_mfma_f32_16x16x32_bf16 v[208:211], a[176:179], v[120:123], v[208:211]
    v_cvt_pk_bf16_f32 v103, v46, v47
    s_waitcnt vmcnt(15) lgkmcnt(0)
    s_barrier
    v_mfma_f32_16x16x32_bf16 v[240:243], a[176:179], v[124:127], v[240:243]
    v_exp_f32 v48, v48
    s_cmp_lg_u32 s28, 0
    s_cbranch_scc1 L_np_f1
    v_mov_b32 v0, 1
    s_mov_b64 exec, 1
    buffer_store_byte v0, off, s[80:83], s45 sc1
    s_mov_b64 exec, -1
L_np_f1:
    v_mfma_f32_16x16x32_bf16 v[244:247], a[180:183], v[124:127], v[244:247]
    buffer_load_dwordx4 v13, s[12:15], s44 offen offset:0 lds
    v_mfma_f32_16x16x32_bf16 v[212:215], a[180:183], v[120:123], v[212:215]
    v_exp_f32 v49, v49
    v_mfma_f32_16x16x32_bf16 v[180:183], a[180:183], v[116:119], v[180:183]
    ds_read_b64_tr_b16 a[160:161], v5 offset:49152
    v_cvt_pk_bf16_f32 v104, v48, v49
    v_mfma_f32_16x16x32_bf16 v[148:151], a[180:183], v[112:115], v[148:151]
    v_exp_f32 v50, v50
    v_mfma_f32_16x16x32_bf16 v[152:155], a[184:187], v[112:115], v[152:155]
    ds_read_b64_tr_b16 a[162:163], v5 offset:50176
    v_accvgpr_read_b32 v13, a213
    v_mfma_f32_16x16x32_bf16 v[184:187], a[184:187], v[116:119], v[184:187]
    v_exp_f32 v51, v51
    v_mfma_f32_16x16x32_bf16 v[216:219], a[184:187], v[120:123], v[216:219]
    ds_read_b64_tr_b16 a[164:165], v6 offset:49152
    v_cvt_pk_bf16_f32 v105, v50, v51
    v_mfma_f32_16x16x32_bf16 v[248:251], a[184:187], v[124:127], v[248:251]
    v_exp_f32 v52, v52
    v_mfma_f32_16x16x32_bf16 v[252:255], a[188:191], v[124:127], v[252:255]
    buffer_load_dwordx4 v13, s[12:15], s44 offen offset:1024 lds
    v_mfma_f32_16x16x32_bf16 v[220:223], a[188:191], v[120:123], v[220:223]
    v_exp_f32 v53, v53
    v_mfma_f32_16x16x32_bf16 v[188:191], a[188:191], v[116:119], v[188:191]
    ds_read_b64_tr_b16 a[166:167], v6 offset:50176
    v_cvt_pk_bf16_f32 v106, v52, v53
    v_mfma_f32_16x16x32_bf16 v[156:159], a[188:191], v[112:115], v[156:159]
    v_exp_f32 v54, v54
    v_smfmac_f32_16x16x64_bf16 a[196:199], a[208:211], v[120:127], v15
    ds_read_b64_tr_b16 a[168:169], v7 offset:49152
    v_accvgpr_read_b32 v13, a214
    v_mfma_f32_16x16x32_bf16 v[64:67], a[128:131], a[0:3], v[16:19]
    v_exp_f32 v55, v55
    v_mfma_f32_16x16x32_bf16 v[72:75], a[128:131], a[16:19], v[20:23]
    ds_read_b64_tr_b16 a[170:171], v7 offset:50176
    v_cvt_pk_bf16_f32 v107, v54, v55
    v_mfma_f32_16x16x32_bf16 v[76:79], a[144:147], a[16:19], v[20:23]
    v_exp_f32 v56, v56
    v_mfma_f32_16x16x32_bf16 v[68:71], a[144:147], a[0:3], v[16:19]
    buffer_load_dwordx4 v13, s[12:15], s44 offen offset:2048 lds
    v_mfma_f32_16x16x32_bf16 v[76:79], a[148:151], a[20:23], v[76:79]
    v_exp_f32 v57, v57
    v_mfma_f32_16x16x32_bf16 v[68:71], a[148:151], a[4:7], v[68:71]
    ds_read_b64_tr_b16 a[172:173], v8 offset:49152
    v_cvt_pk_bf16_f32 v108, v56, v57
    v_mfma_f32_16x16x32_bf16 v[64:67], a[132:135], a[4:7], v[64:67]
    v_exp_f32 v58, v58
    v_mfma_f32_16x16x32_bf16 v[72:75], a[132:135], a[20:23], v[72:75]
    ds_read_b64_tr_b16 a[174:175], v8 offset:50176
    v_accvgpr_read_b32 v13, a215
    v_mfma_f32_16x16x32_bf16 v[64:67], a[136:139], a[8:11], v[64:67]
    v_exp_f32 v59, v59
    v_mfma_f32_16x16x32_bf16 v[72:75], a[136:139], a[24:27], v[72:75]
    ds_read_b64_tr_b16 a[176:177], v9 offset:49152
    v_cvt_pk_bf16_f32 v109, v58, v59
    v_mfma_f32_16x16x32_bf16 v[76:79], a[152:155], a[24:27], v[76:79]
    v_exp_f32 v60, v60
    v_mfma_f32_16x16x32_bf16 v[68:71], a[152:155], a[8:11], v[68:71]
    buffer_load_dwordx4 v13, s[12:15], s44 offen offset:3072 lds
    v_mfma_f32_16x16x32_bf16 v[76:79], a[156:159], a[28:31], v[76:79]
    v_exp_f32 v61, v61
    v_mfma_f32_16x16x32_bf16 v[68:71], a[156:159], a[12:15], v[68:71]
    ds_read_b64_tr_b16 a[178:179], v9 offset:50176
    v_cvt_pk_bf16_f32 v110, v60, v61
    v_mfma_f32_16x16x32_bf16 v[64:67], a[140:143], a[12:15], v[64:67]
    v_exp_f32 v62, v62
    v_mfma_f32_16x16x32_bf16 v[72:75], a[140:143], a[28:31], v[72:75]
    ds_read_b64_tr_b16 a[180:181], v10 offset:49152
    v_accvgpr_read_b32 v13, a216
    s_add_u32 m0, s93, 8192
    v_mfma_f32_16x16x32_bf16 v[80:83], a[128:131], a[32:35], v[24:27]
    v_exp_f32 v63, v63
    v_mfma_f32_16x16x32_bf16 v[88:91], a[128:131], a[48:51], v[28:31]
    ds_read_b64_tr_b16 a[182:183], v10 offset:50176
    v_cvt_pk_bf16_f32 v111, v62, v63
    v_mfma_f32_16x16x32_bf16 v[92:95], a[144:147], a[48:51], v[28:31]
    buffer_load_dwordx4 v13, s[12:15], s44 offen offset:0 lds
    v_mfma_f32_16x16x32_bf16 v[84:87], a[144:147], a[32:35], v[24:27]
    v_mfma_f32_16x16x32_bf16 v[92:95], a[148:151], a[52:55], v[92:95]
    v_exp_f32 v64, v64
    v_mfma_f32_16x16x32_bf16 v[84:87], a[148:151], a[36:39], v[84:87]
    v_mfma_f32_16x16x32_bf16 v[80:83], a[132:135], a[36:39], v[80:83]
    v_exp_f32 v65, v65
    v_mfma_f32_16x16x32_bf16 v[88:91], a[132:135], a[52:55], v[88:91]
    v_cvt_pk_bf16_f32 v112, v64, v65
    v_mfma_f32_16x16x32_bf16 v[80:83], a[136:139], a[40:43], v[80:83]
    v_exp_f32 v66, v66
    v_mfma_f32_16x16x32_bf16 v[88:91], a[136:139], a[56:59], v[88:91]
    v_mfma_f32_16x16x32_bf16 v[92:95], a[152:155], a[56:59], v[92:95]
    v_exp_f32 v67, v67
    v_mfma_f32_16x16x32_bf16 v[84:87], a[152:155], a[40:43], v[84:87]
    v_cvt_pk_bf16_f32 v113, v66, v67
    v_mfma_f32_16x16x32_bf16 v[92:95], a[156:159], a[60:63], v[92:95]
    v_exp_f32 v68, v68
    v_mfma_f32_16x16x32_bf16 v[84:87], a[156:159], a[44:47], v[84:87]
    v_mfma_f32_16x16x32_bf16 v[80:83], a[140:143], a[44:47], v[80:83]
    v_exp_f32 v69, v69
    v_mfma_f32_16x16x32_bf16 v[88:91], a[140:143], a[60:63], v[88:91]
    ds_read_b64_tr_b16 a[184:185], v11 offset:49152
    ds_read_b64_tr_b16 a[186:187], v11 offset:50176
    ds_read_b64_tr_b16 a[188:189], v12 offset:49152
    ds_read_b64_tr_b16 a[190:191], v12 offset:50176
    v_cvt_pk_bf16_f32 v114, v68, v69
    s_waitcnt lgkmcnt(0)
    v_mfma_f32_16x16x32_bf16 v[128:131], a[160:163], v[96:99], v[128:131]
    v_exp_f32 v70, v70
    v_mfma_f32_16x16x32_bf16 v[160:163], a[160:163], v[100:103], v[160:163]
    ds_read_b128 a[128:131], v1 offset:49152
    v_mfma_f32_16x16x32_bf16 v[192:195], a[160:163], v[104:107], v[192:195]
    v_exp_f32 v71, v71
    v_mfma_f32_16x16x32_bf16 v[224:227], a[160:163], v[108:111], v[224:227]
    ds_read_b128 a[132:135], v2 offset:49152
    v_cvt_pk_bf16_f32 v115, v70, v71
    v_mfma_f32_16x16x32_bf16 v[228:231], a[164:167], v[108:111], v[228:231]
    v_exp_f32 v72, v72
    v_mfma_f32_16x16x32_bf16 v[196:199], a[164:167], v[104:107], v[196:199]
    ds_read_b128 a[136:139], v3 offset:49152
    v_mfma_f32_16x16x32_bf16 v[164:167], a[164:167], v[100:103], v[164:167]
    v_exp_f32 v73, v73
    v_mfma_f32_16x16x32_bf16 v[132:135], a[164:167], v[96:99], v[132:135]
    ds_read_b128 a[140:143], v4 offset:49152
    v_cvt_pk_bf16_f32 v116, v72, v73
    v_mfma_f32_16x16x32_bf16 v[136:139], a[168:171], v[96:99], v[136:139]
    v_exp_f32 v74, v74
    v_mfma_f32_16x16x32_bf16 v[168:171], a[168:171], v[100:103], v[168:171]
    ds_read_b128 a[144:147], v1 offset:50176
    v_mfma_f32_16x16x32_bf16 v[200:203], a[168:171], v[104:107], v[200:203]
    v_exp_f32 v75, v75
    v_mfma_f32_16x16x32_bf16 v[232:235], a[168:171], v[108:111], v[232:235]
    ds_read_b128 a[148:151], v2 offset:50176
    v_cvt_pk_bf16_f32 v117, v74, v75
    v_mfma_f32_16x16x32_bf16 v[236:239], a[172:175], v[108:111], v[236:239]
    v_exp_f32 v76, v76
    v_mfma_f32_16x16x32_bf16 v[204:207], a[172:175], v[104:107], v[204:207]
    ds_read_b128 a[152:155], v3 offset:50176
    v_mfma_f32_16x16x32_bf16 v[172:175], a[172:175], v[100:103], v[172:175]
    v_exp_f32 v77, v77
    v_mfma_f32_16x16x32_bf16 v[140:143], a[172:175], v[96:99], v[140:143]
    ds_read_b128 a[156:159], v4 offset:50176
    v_cvt_pk_bf16_f32 v118, v76, v77
    v_smfmac_f32_16x16x64_bf16 a[192:195], a[208:211], v[96:103], v15
    v_exp_f32 v78, v78
    s_add_u32 s37, s65, 4096
    v_mfma_f32_16x16x32_bf16 v[144:147], a[176:179], v[96:99], v[144:147]
    buffer_load_dwordx4 a[244:247], v14, s[12:15], s37 offen offset:1024
    v_mfma_f32_16x16x32_bf16 v[176:179], a[176:179], v[100:103], v[176:179]
    v_exp_f32 v79, v79
    v_mfma_f32_16x16x32_bf16 v[208:211], a[176:179], v[104:107], v[208:211]
    ds_read_b64_tr_b16 a[160:161], v5 offset:51200
    v_cvt_pk_bf16_f32 v119, v78, v79
    v_mfma_f32_16x16x32_bf16 v[240:243], a[176:179], v[108:111], v[240:243]
    v_exp_f32 v80, v80
    v_mfma_f32_16x16x32_bf16 v[244:247], a[180:183], v[108:111], v[244:247]
    ds_read_b64_tr_b16 a[162:163], v5 offset:52224
    v_mfma_f32_16x16x32_bf16 v[212:215], a[180:183], v[104:107], v[212:215]
    v_exp_f32 v81, v81
    v_mfma_f32_16x16x32_bf16 v[180:183], a[180:183], v[100:103], v[180:183]
    ds_read_b64_tr_b16 a[164:165], v6 offset:51200
    v_cvt_pk_bf16_f32 v120, v80, v81
    v_mfma_f32_16x16x32_bf16 v[148:151], a[180:183], v[96:99], v[148:151]
    v_exp_f32 v82, v82
    v_mfma_f32_16x16x32_bf16 v[152:155], a[184:187], v[96:99], v[152:155]
    buffer_load_dwordx4 a[248:251], v14, s[12:15], s37 offen offset:2048
    v_mfma_f32_16x16x32_bf16 v[184:187], a[184:187], v[100:103], v[184:187]
    v_exp_f32 v83, v83
    v_mfma_f32_16x16x32_bf16 v[216:219], a[184:187], v[104:107], v[216:219]
    ds_read_b64_tr_b16 a[166:167], v6 offset:52224
    v_cvt_pk_bf16_f32 v121, v82, v83
    v_mfma_f32_16x16x32_bf16 v[248:251], a[184:187], v[108:111], v[248:251]
    v_exp_f32 v84, v84
    v_mfma_f32_16x16x32_bf16 v[252:255], a[188:191], v[108:111], v[252:255]
    ds_read_b64_tr_b16 a[168:169], v7 offset:51200
    s_waitcnt lgkmcnt(5)
    v_mfma_f32_16x16x32_bf16 v[220:223], a[188:191], v[104:107], v[220:223]
    v_exp_f32 v85, v85
    v_mfma_f32_16x16x32_bf16 v[188:191], a[188:191], v[100:103], v[188:191]
    ds_read_b64_tr_b16 a[170:171], v7 offset:52224
    v_cvt_pk_bf16_f32 v122, v84, v85
    v_mfma_f32_16x16x32_bf16 v[156:159], a[188:191], v[96:99], v[156:159]
    v_exp_f32 v86, v86
    v_smfmac_f32_16x16x64_bf16 a[196:199], a[208:211], v[104:111], v15
    buffer_load_dwordx4 a[252:255], v14, s[12:15], s37 offen offset:3072
    v_mfma_f32_16x16x32_bf16 v[32:35], a[128:131], a[0:3], v[16:19]
    v_exp_f32 v87, v87
    v_mfma_f32_16x16x32_bf16 v[40:43], a[128:131], a[16:19], v[20:23]
    ds_read_b64_tr_b16 a[172:173], v8 offset:51200
    v_cvt_pk_bf16_f32 v123, v86, v87
    v_mfma_f32_16x16x32_bf16 v[44:47], a[144:147], a[16:19], v[20:23]
    v_exp_f32 v88, v88
    v_mfma_f32_16x16x32_bf16 v[36:39], a[144:147], a[0:3], v[16:19]
    ds_read_b64_tr_b16 a[174:175], v8 offset:52224
    s_add_u32 s37, s65, 8192
    v_mfma_f32_16x16x32_bf16 v[44:47], a[148:151], a[20:23], v[44:47]
    v_exp_f32 v89, v89
    v_mfma_f32_16x16x32_bf16 v[36:39], a[148:151], a[4:7], v[36:39]
    ds_read_b64_tr_b16 a[176:177], v9 offset:51200
    v_cvt_pk_bf16_f32 v124, v88, v89
    v_mfma_f32_16x16x32_bf16 v[32:35], a[132:135], a[4:7], v[32:35]
    v_exp_f32 v90, v90
    v_mfma_f32_16x16x32_bf16 v[40:43], a[132:135], a[20:23], v[40:43]
    buffer_load_dwordx4 a[224:227], v14, s[12:15], s37 offen offset:0
    v_mfma_f32_16x16x32_bf16 v[32:35], a[136:139], a[8:11], v[32:35]
    v_exp_f32 v91, v91
    v_mfma_f32_16x16x32_bf16 v[40:43], a[136:139], a[24:27], v[40:43]
    ds_read_b64_tr_b16 a[178:179], v9 offset:52224
    v_cvt_pk_bf16_f32 v125, v90, v91
    v_mfma_f32_16x16x32_bf16 v[44:47], a[152:155], a[24:27], v[44:47]
    v_exp_f32 v92, v92
    v_mfma_f32_16x16x32_bf16 v[36:39], a[152:155], a[8:11], v[36:39]
    ds_read_b64_tr_b16 a[180:181], v10 offset:51200
    v_mfma_f32_16x16x32_bf16 v[44:47], a[156:159], a[28:31], v[44:47]
    v_exp_f32 v93, v93
    v_mfma_f32_16x16x32_bf16 v[36:39], a[156:159], a[12:15], v[36:39]
    ds_read_b64_tr_b16 a[182:183], v10 offset:52224
    v_cvt_pk_bf16_f32 v126, v92, v93
    v_mfma_f32_16x16x32_bf16 v[32:35], a[140:143], a[12:15], v[32:35]
    v_exp_f32 v94, v94
    v_mfma_f32_16x16x32_bf16 v[40:43], a[140:143], a[28:31], v[40:43]
    buffer_load_dwordx4 a[228:231], v14, s[12:15], s37 offen offset:1024
    s_add_u32 s44, s85, 0
    v_mfma_f32_16x16x32_bf16 v[48:51], a[128:131], a[32:35], v[24:27]
    v_exp_f32 v95, v95
    s_add_u32 m0, s93, 4096
    v_accvgpr_read_b32 v13, a217
    v_mfma_f32_16x16x32_bf16 v[56:59], a[128:131], a[48:51], v[28:31]
    buffer_load_dwordx4 v13, s[12:15], s44 offen offset:0 lds
    v_cvt_pk_bf16_f32 v127, v94, v95
    v_accvgpr_read_b32 v13, a218
    v_mfma_f32_16x16x32_bf16 v[60:63], a[144:147], a[48:51], v[28:31]
    buffer_load_dwordx4 v13, s[12:15], s44 offen offset:1024 lds
    v_accvgpr_read_b32 v13, a219
    v_mfma_f32_16x16x32_bf16 v[52:55], a[144:147], a[32:35], v[24:27]
    buffer_load_dwordx4 v13, s[12:15], s44 offen offset:2048 lds
    v_accvgpr_read_b32 v13, a220
    v_mfma_f32_16x16x32_bf16 v[60:63], a[148:151], a[52:55], v[60:63]
    v_exp_f32 v32, v32
    v_mfma_f32_16x16x32_bf16 v[52:55], a[148:151], a[36:39], v[52:55]
    buffer_load_dwordx4 v13, s[12:15], s44 offen offset:3072 lds
    v_accvgpr_read_b32 v13, a221
    v_mfma_f32_16x16x32_bf16 v[48:51], a[132:135], a[36:39], v[48:51]
    v_exp_f32 v33, v33
    s_add_u32 m0, s93, 8192
    v_mfma_f32_16x16x32_bf16 v[56:59], a[132:135], a[52:55], v[56:59]
    buffer_load_dwordx4 v13, s[12:15], s44 offen offset:1024 lds
    v_cvt_pk_bf16_f32 v96, v32, v33
    v_mfma_f32_16x16x32_bf16 v[48:51], a[136:139], a[40:43], v[48:51]
    v_exp_f32 v34, v34
    v_mfma_f32_16x16x32_bf16 v[56:59], a[136:139], a[56:59], v[56:59]
    v_mfma_f32_16x16x32_bf16 v[60:63], a[152:155], a[56:59], v[60:63]
    v_exp_f32 v35, v35
    v_mfma_f32_16x16x32_bf16 v[52:55], a[152:155], a[40:43], v[52:55]
    v_cvt_pk_bf16_f32 v97, v34, v35
    v_mfma_f32_16x16x32_bf16 v[60:63], a[156:159], a[60:63], v[60:63]
    v_exp_f32 v36, v36
    v_mfma_f32_16x16x32_bf16 v[52:55], a[156:159], a[44:47], v[52:55]
    v_mfma_f32_16x16x32_bf16 v[48:51], a[140:143], a[44:47], v[48:51]
    v_exp_f32 v37, v37
    v_mfma_f32_16x16x32_bf16 v[56:59], a[140:143], a[60:63], v[56:59]
    ds_read_b64_tr_b16 a[184:185], v11 offset:51200
    ds_read_b64_tr_b16 a[186:187], v11 offset:52224
    ds_read_b64_tr_b16 a[188:189], v12 offset:51200
    ds_read_b64_tr_b16 a[190:191], v12 offset:52224
    v_cvt_pk_bf16_f32 v98, v36, v37
    s_waitcnt lgkmcnt(0)
    v_mfma_f32_16x16x32_bf16 v[128:131], a[160:163], v[112:115], v[128:131]
    v_exp_f32 v38, v38
    v_mfma_f32_16x16x32_bf16 v[160:163], a[160:163], v[116:119], v[160:163]
    ds_read_b128 a[128:131], v1 offset:51200
    v_mfma_f32_16x16x32_bf16 v[192:195], a[160:163], v[120:123], v[192:195]
    v_exp_f32 v39, v39
    v_mfma_f32_16x16x32_bf16 v[224:227], a[160:163], v[124:127], v[224:227]
    ds_read_b128 a[132:135], v2 offset:51200
    v_cvt_pk_bf16_f32 v99, v38, v39
    v_mfma_f32_16x16x32_bf16 v[228:231], a[164:167], v[124:127], v[228:231]
    v_exp_f32 v40, v40
    v_mfma_f32_16x16x32_bf16 v[196:199], a[164:167], v[120:123], v[196:199]
    ds_read_b128 a[136:139], v3 offset:51200
    v_mfma_f32_16x16x32_bf16 v[164:167], a[164:167], v[116:119], v[164:167]
    v_exp_f32 v41, v41
    v_mfma_f32_16x16x32_bf16 v[132:135], a[164:167], v[112:115], v[132:135]
    ds_read_b128 a[140:143], v4 offset:51200
    v_cvt_pk_bf16_f32 v100, v40, v41
    v_mfma_f32_16x16x32_bf16 v[136:139], a[168:171], v[112:115], v[136:139]
    v_exp_f32 v42, v42
    v_mfma_f32_16x16x32_bf16 v[168:171], a[168:171], v[116:119], v[168:171]
    ds_read_b128 a[144:147], v1 offset:52224
    v_mfma_f32_16x16x32_bf16 v[200:203], a[168:171], v[120:123], v[200:203]
    v_exp_f32 v43, v43
    v_mfma_f32_16x16x32_bf16 v[232:235], a[168:171], v[124:127], v[232:235]
    ds_read_b128 a[148:151], v2 offset:52224
    v_cvt_pk_bf16_f32 v101, v42, v43
    v_mfma_f32_16x16x32_bf16 v[236:239], a[172:175], v[124:127], v[236:239]
    v_exp_f32 v44, v44
    v_mfma_f32_16x16x32_bf16 v[204:207], a[172:175], v[120:123], v[204:207]
    ds_read_b128 a[152:155], v3 offset:52224
    v_mfma_f32_16x16x32_bf16 v[172:175], a[172:175], v[116:119], v[172:175]
    v_exp_f32 v45, v45
    v_mfma_f32_16x16x32_bf16 v[140:143], a[172:175], v[112:115], v[140:143]
    ds_read_b128 a[156:159], v4 offset:52224
    v_cvt_pk_bf16_f32 v102, v44, v45
    v_smfmac_f32_16x16x64_bf16 a[192:195], a[208:211], v[112:119], v15
    v_exp_f32 v46, v46
    v_mfma_f32_16x16x32_bf16 v[144:147], a[176:179], v[112:115], v[144:147]
    s_add_u32 s44, s86, 0
    s_add_u32 m0, s94, 0
    v_accvgpr_read_b32 v13, a212
    v_mfma_f32_16x16x32_bf16 v[176:179], a[176:179], v[116:119], v[176:179]
    v_exp_f32 v47, v47
    v_mfma_f32_16x16x32_bf16 v[208:211], a[176:179], v[120:123], v[208:211]
    v_cvt_pk_bf16_f32 v103, v46, v47
    s_waitcnt lgkmcnt(0)
    s_barrier
    v_mfma_f32_16x16x32_bf16 v[240:243], a[176:179], v[124:127], v[240:243]
    v_exp_f32 v48, v48
    v_mfma_f32_16x16x32_bf16 v[244:247], a[180:183], v[124:127], v[244:247]
    buffer_load_dwordx4 v13, s[12:15], s44 offen offset:0 lds
    v_mfma_f32_16x16x32_bf16 v[212:215], a[180:183], v[120:123], v[212:215]
    v_exp_f32 v49, v49
    v_mfma_f32_16x16x32_bf16 v[180:183], a[180:183], v[116:119], v[180:183]
    ds_read_b64_tr_b16 a[160:161], v5 offset:0
    v_cvt_pk_bf16_f32 v104, v48, v49
    v_mfma_f32_16x16x32_bf16 v[148:151], a[180:183], v[112:115], v[148:151]
    v_exp_f32 v50, v50
    v_mfma_f32_16x16x32_bf16 v[152:155], a[184:187], v[112:115], v[152:155]
    ds_read_b64_tr_b16 a[162:163], v5 offset:1024
    v_accvgpr_read_b32 v13, a213
    v_mfma_f32_16x16x32_bf16 v[184:187], a[184:187], v[116:119], v[184:187]
    v_exp_f32 v51, v51
    v_mfma_f32_16x16x32_bf16 v[216:219], a[184:187], v[120:123], v[216:219]
    ds_read_b64_tr_b16 a[164:165], v6 offset:0
    v_cvt_pk_bf16_f32 v105, v50, v51
    v_mfma_f32_16x16x32_bf16 v[248:251], a[184:187], v[124:127], v[248:251]
    v_exp_f32 v52, v52
    v_mfma_f32_16x16x32_bf16 v[252:255], a[188:191], v[124:127], v[252:255]
    buffer_load_dwordx4 v13, s[12:15], s44 offen offset:1024 lds
    v_mfma_f32_16x16x32_bf16 v[220:223], a[188:191], v[120:123], v[220:223]
    v_exp_f32 v53, v53
    v_mfma_f32_16x16x32_bf16 v[188:191], a[188:191], v[116:119], v[188:191]
    ds_read_b64_tr_b16 a[166:167], v6 offset:1024
    v_cvt_pk_bf16_f32 v106, v52, v53
    v_mfma_f32_16x16x32_bf16 v[156:159], a[188:191], v[112:115], v[156:159]
    v_exp_f32 v54, v54
    v_smfmac_f32_16x16x64_bf16 a[196:199], a[208:211], v[120:127], v15
    ds_read_b64_tr_b16 a[168:169], v7 offset:0
    v_accvgpr_read_b32 v13, a214
    v_mfma_f32_16x16x32_bf16 v[64:67], a[128:131], a[0:3], v[16:19]
    v_exp_f32 v55, v55
    v_mfma_f32_16x16x32_bf16 v[72:75], a[128:131], a[16:19], v[20:23]
    ds_read_b64_tr_b16 a[170:171], v7 offset:1024
    v_cvt_pk_bf16_f32 v107, v54, v55
    v_mfma_f32_16x16x32_bf16 v[76:79], a[144:147], a[16:19], v[20:23]
    v_exp_f32 v56, v56
    v_mfma_f32_16x16x32_bf16 v[68:71], a[144:147], a[0:3], v[16:19]
    buffer_load_dwordx4 v13, s[12:15], s44 offen offset:2048 lds
    v_mfma_f32_16x16x32_bf16 v[76:79], a[148:151], a[20:23], v[76:79]
    v_exp_f32 v57, v57
    v_mfma_f32_16x16x32_bf16 v[68:71], a[148:151], a[4:7], v[68:71]
    ds_read_b64_tr_b16 a[172:173], v8 offset:0
    v_cvt_pk_bf16_f32 v108, v56, v57
    v_mfma_f32_16x16x32_bf16 v[64:67], a[132:135], a[4:7], v[64:67]
    v_exp_f32 v58, v58
    v_mfma_f32_16x16x32_bf16 v[72:75], a[132:135], a[20:23], v[72:75]
    ds_read_b64_tr_b16 a[174:175], v8 offset:1024
    v_accvgpr_read_b32 v13, a215
    v_mfma_f32_16x16x32_bf16 v[64:67], a[136:139], a[8:11], v[64:67]
    v_exp_f32 v59, v59
    v_mfma_f32_16x16x32_bf16 v[72:75], a[136:139], a[24:27], v[72:75]
    ds_read_b64_tr_b16 a[176:177], v9 offset:0
    v_cvt_pk_bf16_f32 v109, v58, v59
    v_mfma_f32_16x16x32_bf16 v[76:79], a[152:155], a[24:27], v[76:79]
    v_exp_f32 v60, v60
    v_mfma_f32_16x16x32_bf16 v[68:71], a[152:155], a[8:11], v[68:71]
    buffer_load_dwordx4 v13, s[12:15], s44 offen offset:3072 lds
    v_mfma_f32_16x16x32_bf16 v[76:79], a[156:159], a[28:31], v[76:79]
    v_exp_f32 v61, v61
    v_mfma_f32_16x16x32_bf16 v[68:71], a[156:159], a[12:15], v[68:71]
    ds_read_b64_tr_b16 a[178:179], v9 offset:1024
    v_cvt_pk_bf16_f32 v110, v60, v61
    v_mfma_f32_16x16x32_bf16 v[64:67], a[140:143], a[12:15], v[64:67]
    v_exp_f32 v62, v62
    v_mfma_f32_16x16x32_bf16 v[72:75], a[140:143], a[28:31], v[72:75]
    ds_read_b64_tr_b16 a[180:181], v10 offset:0
    v_accvgpr_read_b32 v13, a216
    s_add_u32 m0, s94, 8192
    v_mfma_f32_16x16x32_bf16 v[80:83], a[128:131], a[32:35], v[24:27]
    v_exp_f32 v63, v63
    v_mfma_f32_16x16x32_bf16 v[88:91], a[128:131], a[48:51], v[28:31]
    ds_read_b64_tr_b16 a[182:183], v10 offset:1024
    v_cvt_pk_bf16_f32 v111, v62, v63
    v_mfma_f32_16x16x32_bf16 v[92:95], a[144:147], a[48:51], v[28:31]
    buffer_load_dwordx4 v13, s[12:15], s44 offen offset:0 lds
    v_mfma_f32_16x16x32_bf16 v[84:87], a[144:147], a[32:35], v[24:27]
    v_mfma_f32_16x16x32_bf16 v[92:95], a[148:151], a[52:55], v[92:95]
    v_exp_f32 v64, v64
    v_mfma_f32_16x16x32_bf16 v[84:87], a[148:151], a[36:39], v[84:87]
    v_mfma_f32_16x16x32_bf16 v[80:83], a[132:135], a[36:39], v[80:83]
    v_exp_f32 v65, v65
    v_mfma_f32_16x16x32_bf16 v[88:91], a[132:135], a[52:55], v[88:91]
    v_cvt_pk_bf16_f32 v112, v64, v65
    v_mfma_f32_16x16x32_bf16 v[80:83], a[136:139], a[40:43], v[80:83]
    v_exp_f32 v66, v66
    v_mfma_f32_16x16x32_bf16 v[88:91], a[136:139], a[56:59], v[88:91]
    v_mfma_f32_16x16x32_bf16 v[92:95], a[152:155], a[56:59], v[92:95]
    v_exp_f32 v67, v67
    v_mfma_f32_16x16x32_bf16 v[84:87], a[152:155], a[40:43], v[84:87]
    v_cvt_pk_bf16_f32 v113, v66, v67
    v_mfma_f32_16x16x32_bf16 v[92:95], a[156:159], a[60:63], v[92:95]
    v_exp_f32 v68, v68
    v_mfma_f32_16x16x32_bf16 v[84:87], a[156:159], a[44:47], v[84:87]
    v_mfma_f32_16x16x32_bf16 v[80:83], a[140:143], a[44:47], v[80:83]
    v_exp_f32 v69, v69
    v_mfma_f32_16x16x32_bf16 v[88:91], a[140:143], a[60:63], v[88:91]
    ds_read_b64_tr_b16 a[184:185], v11 offset:0
    ds_read_b64_tr_b16 a[186:187], v11 offset:1024
    ds_read_b64_tr_b16 a[188:189], v12 offset:0
    ds_read_b64_tr_b16 a[190:191], v12 offset:1024
    v_cvt_pk_bf16_f32 v114, v68, v69
    v_accvgpr_read_b32 v30, a222
    s_cmp_lg_u32 s28, 0
    s_cbranch_scc1 L_np_p1
    buffer_load_dword v0, v30, s[80:83], 0 offen sc1
L_np_p1:
    v_accvgpr_read_b32 v30, a222
    s_lshl_b32 s37, s28, 18
    v_and_b32 v16, 0x3ff, v14
    v_add_u32 v16, s37, v16
    v_add_u32 v17, 0x20000, v16
    v_accvgpr_read_b32 v18, a212
    v_accvgpr_read_b32 v19, a213
    v_accvgpr_read_b32 v20, a214
    v_accvgpr_read_b32 v21, a215
    v_accvgpr_read_b32 v22, a216
    v_accvgpr_read_b32 v23, a217
    v_accvgpr_read_b32 v24, a218
    v_accvgpr_read_b32 v25, a219
    v_accvgpr_read_b32 v26, a220
    v_accvgpr_read_b32 v27, a221
    s_and_b32 s37, s45, 0xfc
    s_and_b32 s3, s45, 3
    s_lshl_b32 s3, s3, 3
    s_lshl_b32 s3, 0xff, s3
    v_cmp_eq_u32 vcc, s37, v30
    v_mov_b32 v28, s3
    s_xor_b32 s37, s37, 8
    v_cndmask_b32 v28, 0, v28, vcc
    v_cmp_eq_u32 vcc, s37, v30
    s_not_b32 s3, s3
    v_mov_b32 v29, s3
    v_cndmask_b32 v29, -1, v29, vcc
    v_xor_b32 v31, s45, v30
    v_bfe_i32 v31, v31, 3, 1
    v_and_or_b32 v29, v29, v31, v28
    v_or_b32 v28, v28, v31
    s_mov_b64 s[100:101], 0
    s_waitcnt lgkmcnt(12)
    v_mfma_f32_16x16x32_bf16 v[128:131], a[160:163], v[96:99], v[128:131]
    s_add_u32 s44, s86, 0
    s_add_u32 m0, s94, 4096
    v_mfma_f32_16x16x32_bf16 v[160:163], a[160:163], v[100:103], v[160:163]
    buffer_load_dwordx4 v23, s[12:15], s44 offen offset:0 lds
    v_mfma_f32_16x16x32_bf16 v[192:195], a[160:163], v[104:107], v[192:195]
    buffer_load_dwordx4 v24, s[12:15], s44 offen offset:1024 lds
    v_mfma_f32_16x16x32_bf16 v[224:227], a[160:163], v[108:111], v[224:227]
    buffer_load_dwordx4 v25, s[12:15], s44 offen offset:2048 lds
    v_mfma_f32_16x16x32_bf16 v[228:231], a[164:167], v[108:111], v[228:231]
    ds_read_b64_tr_b16 a[160:161], v5 offset:2048
    v_exp_f32 v70, v70
    v_mfma_f32_16x16x32_bf16 v[196:199], a[164:167], v[104:107], v[196:199]
    ds_read_b64_tr_b16 a[162:163], v5 offset:3072
    v_exp_f32 v71, v71
    v_mfma_f32_16x16x32_bf16 v[164:167], a[164:167], v[100:103], v[164:167]
    buffer_load_dwordx4 v26, s[12:15], s44 offen offset:3072 lds
    s_add_u32 m0, s94, 8192
    v_mfma_f32_16x16x32_bf16 v[132:135], a[164:167], v[96:99], v[132:135]
    buffer_load_dwordx4 v27, s[12:15], s44 offen offset:1024 lds
    s_waitcnt lgkmcnt(10)
    v_mfma_f32_16x16x32_bf16 v[136:139], a[168:171], v[96:99], v[136:139]
    ds_read_b64_tr_b16 a[164:165], v6 offset:2048
    v_exp_f32 v72, v72
    v_mfma_f32_16x16x32_bf16 v[168:171], a[168:171], v[100:103], v[168:171]
    ds_read_b64_tr_b16 a[166:167], v6 offset:3072
    v_cvt_pk_bf16_f32 v115, v70, v71
    v_mfma_f32_16x16x32_bf16 v[200:203], a[168:171], v[104:107], v[200:203]
    s_xor_b32 s4, s34, 0
    buffer_load_dwordx4 a[64:67], v16, s[8:11], s4 offen offset:0 sc1
    v_mfma_f32_16x16x32_bf16 v[232:235], a[168:171], v[108:111], v[232:235]
    buffer_load_dwordx4 a[68:71], v17, s[8:11], s4 offen offset:0 sc1
    v_mfma_f32_16x16x32_bf16 v[236:239], a[172:175], v[108:111], v[236:239]
    ds_read_b64_tr_b16 a[168:169], v7 offset:2048
    v_exp_f32 v73, v73
    v_mfma_f32_16x16x32_bf16 v[204:207], a[172:175], v[104:107], v[204:207]
    ds_read_b64_tr_b16 a[170:171], v7 offset:3072
    v_exp_f32 v74, v74
    v_mfma_f32_16x16x32_bf16 v[172:175], a[172:175], v[100:103], v[172:175]
    buffer_load_dwordx4 a[72:75], v16, s[8:11], s4 offen offset:1024 sc1
    v_cvt_pk_bf16_f32 v116, v72, v73
    v_mfma_f32_16x16x32_bf16 v[140:143], a[172:175], v[96:99], v[140:143]
    buffer_load_dwordx4 a[76:79], v17, s[8:11], s4 offen offset:1024 sc1
    v_smfmac_f32_16x16x64_bf16 a[192:195], a[208:211], v[96:103], v15
    ds_read_b64_tr_b16 a[172:173], v8 offset:2048
    v_exp_f32 v75, v75
    s_waitcnt lgkmcnt(11)
    v_mfma_f32_16x16x32_bf16 v[144:147], a[176:179], v[96:99], v[144:147]
    ds_read_b64_tr_b16 a[174:175], v8 offset:3072
    v_exp_f32 v76, v76
    v_mfma_f32_16x16x32_bf16 v[176:179], a[176:179], v[100:103], v[176:179]
    buffer_load_dwordx4 a[80:83], v16, s[8:11], s4 offen offset:2048 sc1
    v_cvt_pk_bf16_f32 v117, v74, v75
    v_mfma_f32_16x16x32_bf16 v[208:211], a[176:179], v[104:107], v[208:211]
    buffer_load_dwordx4 a[84:87], v17, s[8:11], s4 offen offset:2048 sc1
    v_mfma_f32_16x16x32_bf16 v[240:243], a[176:179], v[108:111], v[240:243]
    buffer_load_dwordx4 a[88:91], v16, s[8:11], s4 offen offset:3072 sc1
    v_mfma_f32_16x16x32_bf16 v[244:247], a[180:183], v[108:111], v[244:247]
    ds_read_b64_tr_b16 a[176:177], v9 offset:2048
    v_exp_f32 v77, v77
    v_mfma_f32_16x16x32_bf16 v[212:215], a[180:183], v[104:107], v[212:215]
    ds_read_b64_tr_b16 a[178:179], v9 offset:3072
    v_exp_f32 v78, v78
    v_mfma_f32_16x16x32_bf16 v[180:183], a[180:183], v[100:103], v[180:183]
    buffer_load_dwordx4 a[92:95], v17, s[8:11], s4 offen offset:3072 sc1
    v_cvt_pk_bf16_f32 v118, v76, v77
    v_mfma_f32_16x16x32_bf16 v[148:151], a[180:183], v[96:99], v[148:151]
    v_exp_f32 v79, v79
    s_waitcnt lgkmcnt(10)
    v_mfma_f32_16x16x32_bf16 v[152:155], a[184:187], v[96:99], v[152:155]
    ds_read_b64_tr_b16 a[180:181], v10 offset:2048
    v_exp_f32 v80, v80
    v_mfma_f32_16x16x32_bf16 v[184:187], a[184:187], v[100:103], v[184:187]
    ds_read_b64_tr_b16 a[182:183], v10 offset:3072
    v_cvt_pk_bf16_f32 v119, v78, v79
    v_mfma_f32_16x16x32_bf16 v[216:219], a[184:187], v[104:107], v[216:219]
    v_exp_f32 v81, v81
    v_mfma_f32_16x16x32_bf16 v[248:251], a[184:187], v[108:111], v[248:251]
    v_exp_f32 v82, v82
    v_cvt_pk_bf16_f32 v120, v80, v81
    v_mfma_f32_16x16x32_bf16 v[252:255], a[188:191], v[108:111], v[252:255]
    ds_read_b64_tr_b16 a[184:185], v11 offset:2048
    v_exp_f32 v83, v83
    v_mfma_f32_16x16x32_bf16 v[220:223], a[188:191], v[104:107], v[220:223]
    ds_read_b64_tr_b16 a[186:187], v11 offset:3072
    v_exp_f32 v84, v84
    v_mfma_f32_16x16x32_bf16 v[188:191], a[188:191], v[100:103], v[188:191]
    v_cvt_pk_bf16_f32 v121, v82, v83
    v_exp_f32 v85, v85
    v_mfma_f32_16x16x32_bf16 v[156:159], a[188:191], v[96:99], v[156:159]
    v_exp_f32 v86, v86
    v_cvt_pk_bf16_f32 v122, v84, v85
    v_smfmac_f32_16x16x64_bf16 a[196:199], a[208:211], v[104:111], v15
    ds_read_b64_tr_b16 a[188:189], v12 offset:2048
    ds_read_b64_tr_b16 a[190:191], v12 offset:3072
    v_exp_f32 v87, v87
    v_exp_f32 v88, v88
    v_cvt_pk_bf16_f32 v123, v86, v87
    v_exp_f32 v89, v89
    v_exp_f32 v90, v90
    v_cvt_pk_bf16_f32 v124, v88, v89
    v_exp_f32 v91, v91
    v_exp_f32 v92, v92
    v_cvt_pk_bf16_f32 v125, v90, v91
    v_exp_f32 v93, v93
    v_exp_f32 v94, v94
    v_cvt_pk_bf16_f32 v126, v92, v93
    v_exp_f32 v95, v95
    s_nop 0
    v_cvt_pk_bf16_f32 v127, v94, v95
    s_nop 1
    s_waitcnt lgkmcnt(0)
    s_cmp_lg_u32 s28, 0
    s_cbranch_scc1 L_spun_u1
    s_waitcnt vmcnt(13)
    v_or_b32 v0, v0, v29
    v_and_b32 v0, 0x1010101, v0
    v_cmp_ne_u32 vcc, 0x1010101, v0
    s_cbranch_vccnz L_spin_u1
L_spun_u1:
    s_barrier
    v_smfmac_f32_16x16x64_bf16 a[192:195], a[208:211], v[112:119], v15
    s_xor_b32 s4, s34, 8192
    buffer_load_dwordx4 a[96:99], v16, s[8:11], s4 offen offset:0 sc1
    v_mfma_f32_16x16x32_bf16 v[128:131], a[160:163], v[112:115], v[128:131]
    buffer_load_dwordx4 a[100:103], v17, s[8:11], s4 offen offset:0 sc1
    v_mfma_f32_16x16x32_bf16 v[132:135], a[164:167], v[112:115], v[132:135]
    buffer_load_dwordx4 a[104:107], v16, s[8:11], s4 offen offset:1024 sc1
    v_mfma_f32_16x16x32_bf16 v[136:139], a[168:171], v[112:115], v[136:139]
    buffer_load_dwordx4 a[108:111], v17, s[8:11], s4 offen offset:1024 sc1
    v_mfma_f32_16x16x32_bf16 v[140:143], a[172:175], v[112:115], v[140:143]
    buffer_load_dwordx4 a[112:115], v16, s[8:11], s4 offen offset:2048 sc1
    v_mfma_f32_16x16x32_bf16 v[144:147], a[176:179], v[112:115], v[144:147]
    buffer_load_dwordx4 a[116:119], v17, s[8:11], s4 offen offset:2048 sc1
    v_mfma_f32_16x16x32_bf16 v[148:151], a[180:183], v[112:115], v[148:151]
    buffer_load_dwordx4 a[120:123], v16, s[8:11], s4 offen offset:3072 sc1
    v_mfma_f32_16x16x32_bf16 v[152:155], a[184:187], v[112:115], v[152:155]
    buffer_load_dwordx4 a[124:127], v17, s[8:11], s4 offen offset:3072 sc1
    v_mfma_f32_16x16x32_bf16 v[156:159], a[188:191], v[112:115], v[156:159]
    s_xor_b32 s4, s34, 16384
    buffer_load_dwordx4 a[224:227], v16, s[8:11], s4 offen offset:0 sc1
    v_mfma_f32_16x16x32_bf16 v[188:191], a[188:191], v[116:119], v[188:191]
    buffer_load_dwordx4 a[228:231], v17, s[8:11], s4 offen offset:0 sc1
    v_accvgpr_read_b32 v96, a192
    v_mfma_f32_16x16x32_bf16 v[184:187], a[184:187], v[116:119], v[184:187]
    buffer_load_dwordx4 a[232:235], v16, s[8:11], s4 offen offset:1024 sc1
    v_accvgpr_read_b32 v97, a193
    v_mfma_f32_16x16x32_bf16 v[180:183], a[180:183], v[116:119], v[180:183]
    buffer_load_dwordx4 a[236:239], v17, s[8:11], s4 offen offset:1024 sc1
    v_add_f32 v97, v96, v97
    v_mfma_f32_16x16x32_bf16 v[176:179], a[176:179], v[116:119], v[176:179]
    buffer_load_dwordx4 a[240:243], v16, s[8:11], s4 offen offset:2048 sc1
    v_mfma_f32_16x16x32_bf16 v[172:175], a[172:175], v[116:119], v[172:175]
    buffer_load_dwordx4 a[244:247], v17, s[8:11], s4 offen offset:2048 sc1
    v_mfma_f32_16x16x32_bf16 v[168:171], a[168:171], v[116:119], v[168:171]
    buffer_load_dwordx4 a[248:251], v16, s[8:11], s4 offen offset:3072 sc1
    v_mfma_f32_16x16x32_bf16 v[164:167], a[164:167], v[116:119], v[164:167]
    buffer_load_dwordx4 a[252:255], v17, s[8:11], s4 offen offset:3072 sc1
    v_mfma_f32_16x16x32_bf16 v[160:163], a[160:163], v[116:119], v[160:163]
    v_rcp_f32 v96, v97
    v_cmp_nle_f32 vcc, v97, s38
    v_smfmac_f32_16x16x64_bf16 a[196:199], a[208:211], v[120:127], v15
    s_add_u32 s37, s42, 0
    s_or_b64 s[100:101], s[100:101], vcc
    v_mul_f32 v128, v128, v96
    v_mfma_f32_16x16x32_bf16 v[192:195], a[160:163], v[120:123], v[192:195]
    v_mul_f32 v129, v129, v96
    v_mul_f32 v130, v130, v96
    v_mul_f32 v131, v131, v96
    v_mfma_f32_16x16x32_bf16 v[196:199], a[164:167], v[120:123], v[196:199]
    v_mul_f32 v132, v132, v96
    v_mul_f32 v133, v133, v96
    v_mul_f32 v134, v134, v96
    v_mfma_f32_16x16x32_bf16 v[200:203], a[168:171], v[120:123], v[200:203]
    v_mul_f32 v135, v135, v96
    v_cvt_pk_bf16_f32 v32, v128, v129
    v_mfma_f32_16x16x32_bf16 v[204:207], a[172:175], v[120:123], v[204:207]
    v_cvt_pk_bf16_f32 v33, v130, v131
    v_cvt_pk_bf16_f32 v34, v132, v133
    v_mfma_f32_16x16x32_bf16 v[208:211], a[176:179], v[120:123], v[208:211]
    v_cvt_pk_bf16_f32 v35, v134, v135
    buffer_store_dwordx4 v[32:35], v14, s[24:27], s37 offen offset:0 sc1
    v_mfma_f32_16x16x32_bf16 v[212:215], a[180:183], v[120:123], v[212:215]
    v_mul_f32 v136, v136, v96
    v_mul_f32 v137, v137, v96
    v_mul_f32 v138, v138, v96
    v_mfma_f32_16x16x32_bf16 v[216:219], a[184:187], v[120:123], v[216:219]
    v_mul_f32 v139, v139, v96
    v_mul_f32 v140, v140, v96
    v_mul_f32 v141, v141, v96
    v_mfma_f32_16x16x32_bf16 v[220:223], a[188:191], v[120:123], v[220:223]
    v_mul_f32 v142, v142, v96
    v_mul_f32 v143, v143, v96
    v_cvt_pk_bf16_f32 v36, v136, v137
    v_mfma_f32_16x16x32_bf16 v[252:255], a[188:191], v[124:127], v[252:255]
    v_cvt_pk_bf16_f32 v37, v138, v139
    v_cvt_pk_bf16_f32 v38, v140, v141
    v_mfma_f32_16x16x32_bf16 v[248:251], a[184:187], v[124:127], v[248:251]
    v_cvt_pk_bf16_f32 v39, v142, v143
    buffer_store_dwordx4 v[36:39], v14, s[24:27], s37 offen offset:1024 sc1
    v_mfma_f32_16x16x32_bf16 v[244:247], a[180:183], v[124:127], v[244:247]
    v_mul_f32 v144, v144, v96
    v_mul_f32 v145, v145, v96
    v_mul_f32 v146, v146, v96
    v_mfma_f32_16x16x32_bf16 v[240:243], a[176:179], v[124:127], v[240:243]
    v_mul_f32 v147, v147, v96
    v_mul_f32 v148, v148, v96
    v_mul_f32 v149, v149, v96
    v_mfma_f32_16x16x32_bf16 v[236:239], a[172:175], v[124:127], v[236:239]
    v_mul_f32 v150, v150, v96
    v_mul_f32 v151, v151, v96
    v_cvt_pk_bf16_f32 v40, v144, v145
    v_mfma_f32_16x16x32_bf16 v[232:235], a[168:171], v[124:127], v[232:235]
    v_cvt_pk_bf16_f32 v41, v146, v147
    v_cvt_pk_bf16_f32 v42, v148, v149
    v_mfma_f32_16x16x32_bf16 v[228:231], a[164:167], v[124:127], v[228:231]
    v_cvt_pk_bf16_f32 v43, v150, v151
    buffer_store_dwordx4 v[40:43], v14, s[24:27], s37 offen offset:2048 sc1
    v_mfma_f32_16x16x32_bf16 v[224:227], a[160:163], v[124:127], v[224:227]
    v_mul_f32 v152, v152, v96
    v_mul_f32 v153, v153, v96
    v_mul_f32 v154, v154, v96
    v_mul_f32 v155, v155, v96
    v_mul_f32 v156, v156, v96
    v_mul_f32 v157, v157, v96
    v_mul_f32 v158, v158, v96
    v_mul_f32 v159, v159, v96
    v_cvt_pk_bf16_f32 v44, v152, v153
    v_cvt_pk_bf16_f32 v45, v154, v155
    v_cvt_pk_bf16_f32 v46, v156, v157
    v_cvt_pk_bf16_f32 v47, v158, v159
    buffer_store_dwordx4 v[44:47], v14, s[24:27], s37 offen offset:3072 sc1
    v_accvgpr_read_b32 v98, a194
    v_accvgpr_read_b32 v99, a195
    v_add_f32 v99, v98, v99
    v_rcp_f32 v98, v99
    v_cmp_nle_f32 vcc, v99, s38
    s_add_u32 s37, s42, 131072
    s_or_b64 s[100:101], s[100:101], vcc
    v_pk_mul_f32 v[160:161], v[160:161], v[98:99] op_sel_hi:[1,0]
    v_pk_mul_f32 v[162:163], v[162:163], v[98:99] op_sel_hi:[1,0]
    v_pk_mul_f32 v[164:165], v[164:165], v[98:99] op_sel_hi:[1,0]
    v_pk_mul_f32 v[166:167], v[166:167], v[98:99] op_sel_hi:[1,0]
    v_cvt_pk_bf16_f32 v48, v160, v161
    v_cvt_pk_bf16_f32 v49, v162, v163
    v_cvt_pk_bf16_f32 v50, v164, v165
    v_cvt_pk_bf16_f32 v51, v166, v167
    buffer_store_dwordx4 v[48:51], v14, s[24:27], s37 offen offset:0 sc1
    v_pk_mul_f32 v[168:169], v[168:169], v[98:99] op_sel_hi:[1,0]
    v_pk_mul_f32 v[170:171], v[170:171], v[98:99] op_sel_hi:[1,0]
    v_pk_mul_f32 v[172:173], v[172:173], v[98:99] op_sel_hi:[1,0]
    v_pk_mul_f32 v[174:175], v[174:175], v[98:99] op_sel_hi:[1,0]
    v_cvt_pk_bf16_f32 v52, v168, v169
    v_cvt_pk_bf16_f32 v53, v170, v171
    v_cvt_pk_bf16_f32 v54, v172, v173
    v_cvt_pk_bf16_f32 v55, v174, v175
    buffer_store_dwordx4 v[52:55], v14, s[24:27], s37 offen offset:1024 sc1
    v_pk_mul_f32 v[176:177], v[176:177], v[98:99] op_sel_hi:[1,0]
    v_pk_mul_f32 v[178:179], v[178:179], v[98:99] op_sel_hi:[1,0]
    v_pk_mul_f32 v[180:181], v[180:181], v[98:99] op_sel_hi:[1,0]
    v_pk_mul_f32 v[182:183], v[182:183], v[98:99] op_sel_hi:[1,0]
    v_cvt_pk_bf16_f32 v56, v176, v177
    v_cvt_pk_bf16_f32 v57, v178, v179
    v_cvt_pk_bf16_f32 v58, v180, v181
    v_cvt_pk_bf16_f32 v59, v182, v183
    buffer_store_dwordx4 v[56:59], v14, s[24:27], s37 offen offset:2048 sc1
    v_pk_mul_f32 v[184:185], v[184:185], v[98:99] op_sel_hi:[1,0]
    v_pk_mul_f32 v[186:187], v[186:187], v[98:99] op_sel_hi:[1,0]
    v_pk_mul_f32 v[188:189], v[188:189], v[98:99] op_sel_hi:[1,0]
    v_pk_mul_f32 v[190:191], v[190:191], v[98:99] op_sel_hi:[1,0]
    v_cvt_pk_bf16_f32 v60, v184, v185
    v_cvt_pk_bf16_f32 v61, v186, v187
    v_cvt_pk_bf16_f32 v62, v188, v189
    v_cvt_pk_bf16_f32 v63, v190, v191
    buffer_store_dwordx4 v[60:63], v14, s[24:27], s37 offen offset:3072 sc1
    v_accvgpr_read_b32 v96, a196
    v_accvgpr_read_b32 v97, a197
    v_add_f32 v97, v96, v97
    v_rcp_f32 v96, v97
    v_cmp_nle_f32 vcc, v97, s38
    s_add_u32 s37, s42, 262144
    s_or_b64 s[100:101], s[100:101], vcc
    v_pk_mul_f32 v[192:193], v[192:193], v[96:97] op_sel_hi:[1,0]
    v_pk_mul_f32 v[194:195], v[194:195], v[96:97] op_sel_hi:[1,0]
    v_pk_mul_f32 v[196:197], v[196:197], v[96:97] op_sel_hi:[1,0]
    v_pk_mul_f32 v[198:199], v[198:199], v[96:97] op_sel_hi:[1,0]
    v_cvt_pk_bf16_f32 v64, v192, v193
    v_cvt_pk_bf16_f32 v65, v194, v195
    v_cvt_pk_bf16_f32 v66, v196, v197
    v_cvt_pk_bf16_f32 v67, v198, v199
    buffer_store_dwordx4 v[64:67], v14, s[24:27], s37 offen offset:0 sc1
    v_pk_mul_f32 v[200:201], v[200:201], v[96:97] op_sel_hi:[1,0]
    v_pk_mul_f32 v[202:203], v[202:203], v[96:97] op_sel_hi:[1,0]
    v_pk_mul_f32 v[204:205], v[204:205], v[96:97] op_sel_hi:[1,0]
    v_pk_mul_f32 v[206:207], v[206:207], v[96:97] op_sel_hi:[1,0]
    v_cvt_pk_bf16_f32 v68, v200, v201
    v_cvt_pk_bf16_f32 v69, v202, v203
    v_cvt_pk_bf16_f32 v70, v204, v205
    v_cvt_pk_bf16_f32 v71, v206, v207
    buffer_store_dwordx4 v[68:71], v14, s[24:27], s37 offen offset:1024 sc1
    v_pk_mul_f32 v[208:209], v[208:209], v[96:97] op_sel_hi:[1,0]
    v_pk_mul_f32 v[210:211], v[210:211], v[96:97] op_sel_hi:[1,0]
    v_pk_mul_f32 v[212:213], v[212:213], v[96:97] op_sel_hi:[1,0]
    v_pk_mul_f32 v[214:215], v[214:215], v[96:97] op_sel_hi:[1,0]
    v_cvt_pk_bf16_f32 v72, v208, v209
    v_cvt_pk_bf16_f32 v73, v210, v211
    v_cvt_pk_bf16_f32 v74, v212, v213
    v_cvt_pk_bf16_f32 v75, v214, v215
    buffer_store_dwordx4 v[72:75], v14, s[24:27], s37 offen offset:2048 sc1
    v_pk_mul_f32 v[216:217], v[216:217], v[96:97] op_sel_hi:[1,0]
    v_pk_mul_f32 v[218:219], v[218:219], v[96:97] op_sel_hi:[1,0]
    v_pk_mul_f32 v[220:221], v[220:221], v[96:97] op_sel_hi:[1,0]
    v_pk_mul_f32 v[222:223], v[222:223], v[96:97] op_sel_hi:[1,0]
    v_cvt_pk_bf16_f32 v76, v216, v217
    v_cvt_pk_bf16_f32 v77, v218, v219
    v_cvt_pk_bf16_f32 v78, v220, v221
    v_cvt_pk_bf16_f32 v79, v222, v223
    buffer_store_dwordx4 v[76:79], v14, s[24:27], s37 offen offset:3072 sc1
    s_nop 7
    v_accvgpr_read_b32 v98, a198
    v_accvgpr_read_b32 v99, a199
    v_add_f32 v99, v98, v99
    v_rcp_f32 v98, v99
    v_cmp_nle_f32 vcc, v99, s38
    s_add_u32 s37, s42, 393216
    s_or_b64 s[100:101], s[100:101], vcc
    v_pk_mul_f32 v[224:225], v[224:225], v[98:99] op_sel_hi:[1,0]
    v_pk_mul_f32 v[226:227], v[226:227], v[98:99] op_sel_hi:[1,0]
    v_pk_mul_f32 v[228:229], v[228:229], v[98:99] op_sel_hi:[1,0]
    v_pk_mul_f32 v[230:231], v[230:231], v[98:99] op_sel_hi:[1,0]
    v_cvt_pk_bf16_f32 v80, v224, v225
    v_cvt_pk_bf16_f32 v81, v226, v227
    v_cvt_pk_bf16_f32 v82, v228, v229
    v_cvt_pk_bf16_f32 v83, v230, v231
    buffer_store_dwordx4 v[80:83], v14, s[24:27], s37 offen offset:0 sc1
    v_pk_mul_f32 v[232:233], v[232:233], v[98:99] op_sel_hi:[1,0]
    v_pk_mul_f32 v[234:235], v[234:235], v[98:99] op_sel_hi:[1,0]
    v_pk_mul_f32 v[236:237], v[236:237], v[98:99] op_sel_hi:[1,0]
    v_pk_mul_f32 v[238:239], v[238:239], v[98:99] op_sel_hi:[1,0]
    v_cvt_pk_bf16_f32 v84, v232, v233
    v_cvt_pk_bf16_f32 v85, v234, v235
    v_cvt_pk_bf16_f32 v86, v236, v237
    v_cvt_pk_bf16_f32 v87, v238, v239
    buffer_store_dwordx4 v[84:87], v14, s[24:27], s37 offen offset:1024 sc1
    v_pk_mul_f32 v[240:241], v[240:241], v[98:99] op_sel_hi:[1,0]
    v_pk_mul_f32 v[242:243], v[242:243], v[98:99] op_sel_hi:[1,0]
    v_pk_mul_f32 v[244:245], v[244:245], v[98:99] op_sel_hi:[1,0]
    v_pk_mul_f32 v[246:247], v[246:247], v[98:99] op_sel_hi:[1,0]
    v_cvt_pk_bf16_f32 v88, v240, v241
    v_cvt_pk_bf16_f32 v89, v242, v243
    v_cvt_pk_bf16_f32 v90, v244, v245
    v_cvt_pk_bf16_f32 v91, v246, v247
    buffer_store_dwordx4 v[88:91], v14, s[24:27], s37 offen offset:2048 sc1
    v_pk_mul_f32 v[248:249], v[248:249], v[98:99] op_sel_hi:[1,0]
    v_pk_mul_f32 v[250:251], v[250:251], v[98:99] op_sel_hi:[1,0]
    v_pk_mul_f32 v[252:253], v[252:253], v[98:99] op_sel_hi:[1,0]
    v_pk_mul_f32 v[254:255], v[254:255], v[98:99] op_sel_hi:[1,0]
    v_cvt_pk_bf16_f32 v92, v248, v249
    v_cvt_pk_bf16_f32 v93, v250, v251
    v_cvt_pk_bf16_f32 v94, v252, v253
    v_cvt_pk_bf16_f32 v95, v254, v255
    buffer_store_dwordx4 v[92:95], v14, s[24:27], s37 offen offset:3072 sc1
    s_cmp_lg_u64 s[100:101], 0
    s_cbranch_scc1 L_fb
L_fbret1:
    v_bfe_u32 v38, v14, 4, 6
    v_lshrrev_b32 v39, 5, v38
    v_lshlrev_b32 v39, 10, v39
    v_bfe_u32 v37, v38, 2, 3
    v_lshl_add_u32 v39, v37, 7, v39
    v_and_b32 v37, 3, v38
    v_lshl_add_u32 v39, v37, 3, v39
    v_bfe_u32 v37, v38, 3, 2
    v_lshl_add_u32 v200, v37, 5, v39
    v_xor_b32 v203, 32, v200
    v_xor_b32 v206, 64, v200
    v_xor_b32 v209, 96, v200
    v_lshrrev_b32 v39, 2, v38
    v_lshlrev_b32 v39, 6, v39
    v_and_b32 v37, 3, v38
    v_lshl_add_u32 v39, v37, 3, v39
    v_bfe_u32 v37, v38, 4, 1
    v_lshl_add_u32 v212, v37, 5, v39
    v_xor_b32 v215, 32, v212
    v_add_u32 v202, 102400, v200
    v_add_u32 v201, 51200, v200
    v_add_u32 v205, 102400, v203
    v_add_u32 v204, 51200, v203
    v_add_u32 v208, 102400, v206
    v_add_u32 v207, 51200, v206
    v_add_u32 v211, 102400, v209
    v_add_u32 v210, 51200, v209
    v_add_u32 v214, 102400, v212
    v_add_u32 v213, 51200, v212
    v_add_u32 v217, 102400, v215
    v_add_u32 v216, 51200, v215
    s_xor_b32 s4, s34, 24576
    buffer_load_dwordx4 a[0:3], v16, s[8:11], s4 offen offset:0 sc1
    buffer_load_dwordx4 a[4:7], v17, s[8:11], s4 offen offset:0 sc1
    buffer_load_dwordx4 a[8:11], v16, s[8:11], s4 offen offset:1024 sc1
    buffer_load_dwordx4 a[12:15], v17, s[8:11], s4 offen offset:1024 sc1
    buffer_load_dwordx4 a[16:19], v16, s[8:11], s4 offen offset:2048 sc1
    buffer_load_dwordx4 a[20:23], v17, s[8:11], s4 offen offset:2048 sc1
    buffer_load_dwordx4 a[24:27], v16, s[8:11], s4 offen offset:3072 sc1
    buffer_load_dwordx4 a[28:31], v17, s[8:11], s4 offen offset:3072 sc1
    s_waitcnt vmcnt(40)
    s_barrier
    ds_read_b64_tr_b16 v[120:121], v202 offset:30720
    ds_read_b64_tr_b16 v[122:123], v202 offset:32768
    ds_read_b64_tr_b16 v[124:125], v205 offset:30720
    ds_read_b64_tr_b16 v[126:127], v205 offset:32768
    ds_read_b64_tr_b16 v[128:129], v208 offset:30720
    ds_read_b64_tr_b16 v[130:131], v208 offset:32768
    ds_read_b64_tr_b16 v[132:133], v211 offset:30720
    ds_read_b64_tr_b16 v[134:135], v211 offset:32768
    ds_read_b64_tr_b16 v[136:137], v214 offset:38912
    ds_read_b64_tr_b16 v[138:139], v214 offset:39936
    ds_read_b64_tr_b16 v[140:141], v202 offset:34816
    ds_read_b64_tr_b16 v[142:143], v202 offset:36864
    ds_read_b64_tr_b16 v[144:145], v205 offset:34816
    ds_read_b64_tr_b16 v[146:147], v205 offset:36864
    ds_read_b64_tr_b16 v[148:149], v208 offset:34816
    ds_read_b64_tr_b16 v[150:151], v208 offset:36864
    ds_read_b64_tr_b16 v[152:153], v211 offset:34816
    ds_read_b64_tr_b16 v[154:155], v211 offset:36864
    ds_read_b64_tr_b16 v[156:157], v217 offset:38912
    ds_read_b64_tr_b16 v[158:159], v217 offset:39936
    s_waitcnt lgkmcnt(15)
    v_mfma_f32_16x16x32_bf16 v[40:43], v[120:123], a[64:67], 0
    ds_read_b64_tr_b16 v[160:161], v202 offset:40960
    ds_read_b64_tr_b16 v[162:163], v202 offset:43008
    v_mfma_f32_16x16x32_bf16 v[60:63], v[120:123], a[68:71], 0
    s_add_u32 s44, s87, 0
    s_add_u32 m0, s95, 0
    v_mfma_f32_16x16x32_bf16 v[64:67], v[124:127], a[68:71], 0
    ds_read_b64_tr_b16 v[164:165], v205 offset:40960
    ds_read_b64_tr_b16 v[166:167], v205 offset:43008
    v_mfma_f32_16x16x32_bf16 v[44:47], v[124:127], a[64:67], 0
    s_waitcnt lgkmcnt(14)
    v_mfma_f32_16x16x32_bf16 v[48:51], v[128:131], a[64:67], 0
    ds_read_b64_tr_b16 v[168:169], v208 offset:40960
    ds_read_b64_tr_b16 v[170:171], v208 offset:43008
    v_mfma_f32_16x16x32_bf16 v[68:71], v[128:131], a[68:71], 0
    buffer_load_dwordx4 v18, s[12:15], s44 offen offset:0 lds
    v_mfma_f32_16x16x32_bf16 v[72:75], v[132:135], a[68:71], 0
    ds_read_b64_tr_b16 v[172:173], v211 offset:40960
    ds_read_b64_tr_b16 v[174:175], v211 offset:43008
    v_mfma_f32_16x16x32_bf16 v[52:55], v[132:135], a[64:67], 0
    buffer_load_dwordx4 v19, s[12:15], s44 offen offset:1024 lds
    v_mfma_f32_16x16x32_bf16 v[56:59], v[136:139], a[64:67], 0
    ds_read_b64_tr_b16 v[176:177], v214 offset:49152
    ds_read_b64_tr_b16 v[178:179], v214 offset:50176
    v_mfma_f32_16x16x32_bf16 v[76:79], v[136:139], a[68:71], 0
    s_waitcnt lgkmcnt(15)
    v_mfma_f32_16x16x32_bf16 v[100:103], v[140:143], a[68:71], 0
    ds_read_b64_tr_b16 v[180:181], v202 offset:45056
    ds_read_b64_tr_b16 v[182:183], v202 offset:47104
    v_mfma_f32_16x16x32_bf16 v[80:83], v[140:143], a[64:67], 0
    buffer_load_dwordx4 v20, s[12:15], s44 offen offset:2048 lds
    v_mfma_f32_16x16x32_bf16 v[84:87], v[144:147], a[64:67], 0
    ds_read_b64_tr_b16 v[184:185], v205 offset:45056
    ds_read_b64_tr_b16 v[186:187], v205 offset:47104
    v_mfma_f32_16x16x32_bf16 v[104:107], v[144:147], a[68:71], 0
    s_waitcnt lgkmcnt(14)
    v_mfma_f32_16x16x32_bf16 v[108:111], v[148:151], a[68:71], 0
    ds_read_b64_tr_b16 v[188:189], v208 offset:45056
    ds_read_b64_tr_b16 v[190:191], v208 offset:47104
    v_mfma_f32_16x16x32_bf16 v[88:91], v[148:151], a[64:67], 0
    buffer_load_dwordx4 v21, s[12:15], s44 offen offset:3072 lds
    s_add_u32 m0, s95, 8192
    v_mfma_f32_16x16x32_bf16 v[92:95], v[152:155], a[64:67], 0
    ds_read_b64_tr_b16 v[192:193], v211 offset:45056
    ds_read_b64_tr_b16 v[194:195], v211 offset:47104
    v_mfma_f32_16x16x32_bf16 v[112:115], v[152:155], a[68:71], 0
    buffer_load_dwordx4 v22, s[12:15], s44 offen offset:0 lds
    v_mfma_f32_16x16x32_bf16 v[116:119], v[156:159], a[68:71], 0
    ds_read_b64_tr_b16 v[196:197], v217 offset:49152
    ds_read_b64_tr_b16 v[198:199], v217 offset:50176
    v_mfma_f32_16x16x32_bf16 v[96:99], v[156:159], a[64:67], 0
    s_waitcnt lgkmcnt(15)
    v_mfma_f32_16x16x32_bf16 v[40:43], v[160:163], a[72:75], v[40:43]
    ds_read_b64_tr_b16 v[120:121], v202 offset:51200
    ds_read_b64_tr_b16 v[122:123], v202 offset:53248
    v_mfma_f32_16x16x32_bf16 v[60:63], v[160:163], a[76:79], v[60:63]
    s_add_u32 s44, s87, 0
    s_add_u32 m0, s95, 4096
    v_mfma_f32_16x16x32_bf16 v[64:67], v[164:167], a[76:79], v[64:67]
    ds_read_b64_tr_b16 v[124:125], v205 offset:51200
    ds_read_b64_tr_b16 v[126:127], v205 offset:53248
    v_mfma_f32_16x16x32_bf16 v[44:47], v[164:167], a[72:75], v[44:47]
    s_waitcnt lgkmcnt(14)
    v_mfma_f32_16x16x32_bf16 v[48:51], v[168:171], a[72:75], v[48:51]
    ds_read_b64_tr_b16 v[128:129], v208 offset:51200
    ds_read_b64_tr_b16 v[130:131], v208 offset:53248
    v_mfma_f32_16x16x32_bf16 v[68:71], v[168:171], a[76:79], v[68:71]
    buffer_load_dwordx4 v23, s[12:15], s44 offen offset:0 lds
    v_mfma_f32_16x16x32_bf16 v[72:75], v[172:175], a[76:79], v[72:75]
    ds_read_b64_tr_b16 v[132:133], v211 offset:51200
    ds_read_b64_tr_b16 v[134:135], v211 offset:53248
    v_mfma_f32_16x16x32_bf16 v[52:55], v[172:175], a[72:75], v[52:55]
    buffer_load_dwordx4 v24, s[12:15], s44 offen offset:1024 lds
    v_mfma_f32_16x16x32_bf16 v[56:59], v[176:179], a[72:75], v[56:59]
    ds_read_b64_tr_b16 v[136:137], v214 offset:59392
    ds_read_b64_tr_b16 v[138:139], v214 offset:60416
    v_mfma_f32_16x16x32_bf16 v[76:79], v[176:179], a[76:79], v[76:79]
    s_waitcnt lgkmcnt(15)
    v_mfma_f32_16x16x32_bf16 v[100:103], v[180:183], a[76:79], v[100:103]
    ds_read_b64_tr_b16 v[140:141], v202 offset:55296
    ds_read_b64_tr_b16 v[142:143], v202 offset:57344
    v_mfma_f32_16x16x32_bf16 v[80:83], v[180:183], a[72:75], v[80:83]
    buffer_load_dwordx4 v25, s[12:15], s44 offen offset:2048 lds
    v_mfma_f32_16x16x32_bf16 v[84:87], v[184:187], a[72:75], v[84:87]
    ds_read_b64_tr_b16 v[144:145], v205 offset:55296
    ds_read_b64_tr_b16 v[146:147], v205 offset:57344
    v_mfma_f32_16x16x32_bf16 v[104:107], v[184:187], a[76:79], v[104:107]
    s_waitcnt lgkmcnt(14)
    v_mfma_f32_16x16x32_bf16 v[108:111], v[188:191], a[76:79], v[108:111]
    ds_read_b64_tr_b16 v[148:149], v208 offset:55296
    ds_read_b64_tr_b16 v[150:151], v208 offset:57344
    v_mfma_f32_16x16x32_bf16 v[88:91], v[188:191], a[72:75], v[88:91]
    buffer_load_dwordx4 v26, s[12:15], s44 offen offset:3072 lds
    s_add_u32 m0, s95, 8192
    v_mfma_f32_16x16x32_bf16 v[92:95], v[192:195], a[72:75], v[92:95]
    ds_read_b64_tr_b16 v[152:153], v211 offset:55296
    ds_read_b64_tr_b16 v[154:155], v211 offset:57344
    v_mfma_f32_16x16x32_bf16 v[112:115], v[192:195], a[76:79], v[112:115]
    buffer_load_dwordx4 v27, s[12:15], s44 offen offset:1024 lds
    v_mfma_f32_16x16x32_bf16 v[116:119], v[196:199], a[76:79], v[116:119]
    ds_read_b64_tr_b16 v[156:157], v217 offset:59392
    ds_read_b64_tr_b16 v[158:159], v217 offset:60416
    v_mfma_f32_16x16x32_bf16 v[96:99], v[196:199], a[72:75], v[96:99]
    s_waitcnt lgkmcnt(15)
    v_mfma_f32_16x16x32_bf16 v[40:43], v[120:123], a[80:83], v[40:43]
    ds_read_b64_tr_b16 v[160:161], v200 offset:0
    ds_read_b64_tr_b16 v[162:163], v200 offset:2048
    v_mfma_f32_16x16x32_bf16 v[60:63], v[120:123], a[84:87], v[60:63]
    v_mfma_f32_16x16x32_bf16 v[64:67], v[124:127], a[84:87], v[64:67]
    ds_read_b64_tr_b16 v[164:165], v203 offset:0
    ds_read_b64_tr_b16 v[166:167], v203 offset:2048
    v_mfma_f32_16x16x32_bf16 v[44:47], v[124:127], a[80:83], v[44:47]
    s_waitcnt lgkmcnt(14)
    v_mfma_f32_16x16x32_bf16 v[48:51], v[128:131], a[80:83], v[48:51]
    ds_read_b64_tr_b16 v[168:169], v206 offset:0
    ds_read_b64_tr_b16 v[170:171], v206 offset:2048
    v_mfma_f32_16x16x32_bf16 v[68:71], v[128:131], a[84:87], v[68:71]
    v_mfma_f32_16x16x32_bf16 v[72:75], v[132:135], a[84:87], v[72:75]
    ds_read_b64_tr_b16 v[172:173], v209 offset:0
    ds_read_b64_tr_b16 v[174:175], v209 offset:2048
    v_mfma_f32_16x16x32_bf16 v[52:55], v[132:135], a[80:83], v[52:55]
    v_mfma_f32_16x16x32_bf16 v[56:59], v[136:139], a[80:83], v[56:59]
    ds_read_b64_tr_b16 v[176:177], v212 offset:8192
    ds_read_b64_tr_b16 v[178:179], v212 offset:9216
    v_mfma_f32_16x16x32_bf16 v[76:79], v[136:139], a[84:87], v[76:79]
    s_waitcnt lgkmcnt(15)
    v_mfma_f32_16x16x32_bf16 v[100:103], v[140:143], a[84:87], v[100:103]
    ds_read_b64_tr_b16 v[180:181], v200 offset:4096
    ds_read_b64_tr_b16 v[182:183], v200 offset:6144
    v_mfma_f32_16x16x32_bf16 v[80:83], v[140:143], a[80:83], v[80:83]
    v_mfma_f32_16x16x32_bf16 v[84:87], v[144:147], a[80:83], v[84:87]
    ds_read_b64_tr_b16 v[184:185], v203 offset:4096
    ds_read_b64_tr_b16 v[186:187], v203 offset:6144
    v_mfma_f32_16x16x32_bf16 v[104:107], v[144:147], a[84:87], v[104:107]
    s_waitcnt lgkmcnt(14)
    v_mfma_f32_16x16x32_bf16 v[108:111], v[148:151], a[84:87], v[108:111]
    ds_read_b64_tr_b16 v[188:189], v206 offset:4096
    ds_read_b64_tr_b16 v[190:191], v206 offset:6144
    v_mfma_f32_16x16x32_bf16 v[88:91], v[148:151], a[80:83], v[88:91]
    v_mfma_f32_16x16x32_bf16 v[92:95], v[152:155], a[80:83], v[92:95]
    ds_read_b64_tr_b16 v[192:193], v209 offset:4096
    ds_read_b64_tr_b16 v[194:195], v209 offset:6144
    v_mfma_f32_16x16x32_bf16 v[112:115], v[152:155], a[84:87], v[112:115]
    v_mfma_f32_16x16x32_bf16 v[116:119], v[156:159], a[84:87], v[116:119]
    ds_read_b64_tr_b16 v[196:197], v215 offset:8192
    ds_read_b64_tr_b16 v[198:199], v215 offset:9216
    v_mfma_f32_16x16x32_bf16 v[96:99], v[156:159], a[80:83], v[96:99]
    s_waitcnt lgkmcnt(15)
    v_mfma_f32_16x16x32_bf16 v[40:43], v[160:163], a[88:91], v[40:43]
    v_mfma_f32_16x16x32_bf16 v[60:63], v[160:163], a[92:95], v[60:63]
    v_mfma_f32_16x16x32_bf16 v[64:67], v[164:167], a[92:95], v[64:67]
    v_mfma_f32_16x16x32_bf16 v[44:47], v[164:167], a[88:91], v[44:47]
    s_waitcnt vmcnt(42) lgkmcnt(0)
    s_barrier
    v_mfma_f32_16x16x32_bf16 v[48:51], v[168:171], a[88:91], v[48:51]
    ds_read_b64_tr_b16 v[120:121], v200 offset:10240
    ds_read_b64_tr_b16 v[122:123], v200 offset:12288
    v_mfma_f32_16x16x32_bf16 v[68:71], v[168:171], a[92:95], v[68:71]
    ds_read_b64_tr_b16 v[124:125], v203 offset:10240
    ds_read_b64_tr_b16 v[126:127], v203 offset:12288
    v_mfma_f32_16x16x32_bf16 v[72:75], v[172:175], a[92:95], v[72:75]
    s_add_u32 s44, s88, 0
    s_add_u32 m0, s92, 0
    v_mfma_f32_16x16x32_bf16 v[52:55], v[172:175], a[88:91], v[52:55]
    ds_read_b64_tr_b16 v[128:129], v206 offset:10240
    ds_read_b64_tr_b16 v[130:131], v206 offset:12288
    v_mfma_f32_16x16x32_bf16 v[56:59], v[176:179], a[88:91], v[56:59]
    ds_read_b64_tr_b16 v[132:133], v209 offset:10240
    ds_read_b64_tr_b16 v[134:135], v209 offset:12288
    v_mfma_f32_16x16x32_bf16 v[76:79], v[176:179], a[92:95], v[76:79]
    v_mfma_f32_16x16x32_bf16 v[100:103], v[180:183], a[92:95], v[100:103]
    ds_read_b64_tr_b16 v[136:137], v212 offset:18432
    ds_read_b64_tr_b16 v[138:139], v212 offset:19456
    v_mfma_f32_16x16x32_bf16 v[80:83], v[180:183], a[88:91], v[80:83]
    ds_read_b64_tr_b16 v[140:141], v200 offset:14336
    ds_read_b64_tr_b16 v[142:143], v200 offset:16384
    v_mfma_f32_16x16x32_bf16 v[84:87], v[184:187], a[88:91], v[84:87]
    buffer_load_dwordx4 v18, s[12:15], s44 offen offset:0 lds
    v_mfma_f32_16x16x32_bf16 v[104:107], v[184:187], a[92:95], v[104:107]
    ds_read_b64_tr_b16 v[144:145], v203 offset:14336
    ds_read_b64_tr_b16 v[146:147], v203 offset:16384
    v_mfma_f32_16x16x32_bf16 v[108:111], v[188:191], a[92:95], v[108:111]
    ds_read_b64_tr_b16 v[148:149], v206 offset:14336
    ds_read_b64_tr_b16 v[150:151], v206 offset:16384
    v_mfma_f32_16x16x32_bf16 v[88:91], v[188:191], a[88:91], v[88:91]
    buffer_load_dwordx4 v19, s[12:15], s44 offen offset:1024 lds
    v_mfma_f32_16x16x32_bf16 v[92:95], v[192:195], a[88:91], v[92:95]
    ds_read_b64_tr_b16 v[152:153], v209 offset:14336
    ds_read_b64_tr_b16 v[154:155], v209 offset:16384
    v_mfma_f32_16x16x32_bf16 v[112:115], v[192:195], a[92:95], v[112:115]
    ds_read_b64_tr_b16 v[156:157], v215 offset:18432
    ds_read_b64_tr_b16 v[158:159], v215 offset:19456
    v_mfma_f32_16x16x32_bf16 v[116:119], v[196:199], a[92:95], v[116:119]
    buffer_load_dwordx4 v20, s[12:15], s44 offen offset:2048 lds
    v_mfma_f32_16x16x32_bf16 v[96:99], v[196:199], a[88:91], v[96:99]
    s_waitcnt lgkmcnt(15)
    v_mfma_f32_16x16x32_bf16 v[40:43], v[120:123], a[96:99], v[40:43]
    ds_read_b64_tr_b16 v[160:161], v200 offset:20480
    ds_read_b64_tr_b16 v[162:163], v200 offset:22528
    v_mfma_f32_16x16x32_bf16 v[60:63], v[120:123], a[100:103], v[60:63]
    buffer_load_dwordx4 v21, s[12:15], s44 offen offset:3072 lds
    s_add_u32 m0, s92, 8192
    v_mfma_f32_16x16x32_bf16 v[64:67], v[124:127], a[100:103], v[64:67]
    ds_read_b64_tr_b16 v[164:165], v203 offset:20480
    ds_read_b64_tr_b16 v[166:167], v203 offset:22528
    v_mfma_f32_16x16x32_bf16 v[44:47], v[124:127], a[96:99], v[44:47]
    s_waitcnt lgkmcnt(14)
    v_mfma_f32_16x16x32_bf16 v[48:51], v[128:131], a[96:99], v[48:51]
    ds_read_b64_tr_b16 v[168:169], v206 offset:20480
    ds_read_b64_tr_b16 v[170:171], v206 offset:22528
    v_mfma_f32_16x16x32_bf16 v[68:71], v[128:131], a[100:103], v[68:71]
    buffer_load_dwordx4 v22, s[12:15], s44 offen offset:0 lds
    v_mfma_f32_16x16x32_bf16 v[72:75], v[132:135], a[100:103], v[72:75]
    ds_read_b64_tr_b16 v[172:173], v209 offset:20480
    ds_read_b64_tr_b16 v[174:175], v209 offset:22528
    v_mfma_f32_16x16x32_bf16 v[52:55], v[132:135], a[96:99], v[52:55]
    s_add_u32 s44, s88, 0
    s_add_u32 m0, s92, 4096
    v_mfma_f32_16x16x32_bf16 v[56:59], v[136:139], a[96:99], v[56:59]
    ds_read_b64_tr_b16 v[176:177], v212 offset:28672
    ds_read_b64_tr_b16 v[178:179], v212 offset:29696
    v_mfma_f32_16x16x32_bf16 v[76:79], v[136:139], a[100:103], v[76:79]
    s_waitcnt lgkmcnt(15)
    v_mfma_f32_16x16x32_bf16 v[100:103], v[140:143], a[100:103], v[100:103]
    ds_read_b64_tr_b16 v[180:181], v200 offset:24576
    ds_read_b64_tr_b16 v[182:183], v200 offset:26624
    v_mfma_f32_16x16x32_bf16 v[80:83], v[140:143], a[96:99], v[80:83]
    buffer_load_dwordx4 v23, s[12:15], s44 offen offset:0 lds
    v_mfma_f32_16x16x32_bf16 v[84:87], v[144:147], a[96:99], v[84:87]
    ds_read_b64_tr_b16 v[184:185], v203 offset:24576
    ds_read_b64_tr_b16 v[186:187], v203 offset:26624
    v_mfma_f32_16x16x32_bf16 v[104:107], v[144:147], a[100:103], v[104:107]
    s_waitcnt lgkmcnt(14)
    v_mfma_f32_16x16x32_bf16 v[108:111], v[148:151], a[100:103], v[108:111]
    ds_read_b64_tr_b16 v[188:189], v206 offset:24576
    ds_read_b64_tr_b16 v[190:191], v206 offset:26624
    v_mfma_f32_16x16x32_bf16 v[88:91], v[148:151], a[96:99], v[88:91]
    buffer_load_dwordx4 v24, s[12:15], s44 offen offset:1024 lds
    v_mfma_f32_16x16x32_bf16 v[92:95], v[152:155], a[96:99], v[92:95]
    ds_read_b64_tr_b16 v[192:193], v209 offset:24576
    ds_read_b64_tr_b16 v[194:195], v209 offset:26624
    v_mfma_f32_16x16x32_bf16 v[112:115], v[152:155], a[100:103], v[112:115]
    buffer_load_dwordx4 v25, s[12:15], s44 offen offset:2048 lds
    v_mfma_f32_16x16x32_bf16 v[116:119], v[156:159], a[100:103], v[116:119]
    ds_read_b64_tr_b16 v[196:197], v215 offset:28672
    ds_read_b64_tr_b16 v[198:199], v215 offset:29696
    v_mfma_f32_16x16x32_bf16 v[96:99], v[156:159], a[96:99], v[96:99]
    s_waitcnt lgkmcnt(15)
    v_mfma_f32_16x16x32_bf16 v[40:43], v[160:163], a[104:107], v[40:43]
    ds_read_b64_tr_b16 v[120:121], v201 offset:30720
    ds_read_b64_tr_b16 v[122:123], v201 offset:32768
    v_mfma_f32_16x16x32_bf16 v[60:63], v[160:163], a[108:111], v[60:63]
    buffer_load_dwordx4 v26, s[12:15], s44 offen offset:3072 lds
    s_add_u32 m0, s92, 8192
    v_mfma_f32_16x16x32_bf16 v[64:67], v[164:167], a[108:111], v[64:67]
    ds_read_b64_tr_b16 v[124:125], v204 offset:30720
    ds_read_b64_tr_b16 v[126:127], v204 offset:32768
    v_mfma_f32_16x16x32_bf16 v[44:47], v[164:167], a[104:107], v[44:47]
    s_waitcnt lgkmcnt(14)
    v_mfma_f32_16x16x32_bf16 v[48:51], v[168:171], a[104:107], v[48:51]
    ds_read_b64_tr_b16 v[128:129], v207 offset:30720
    ds_read_b64_tr_b16 v[130:131], v207 offset:32768
    v_mfma_f32_16x16x32_bf16 v[68:71], v[168:171], a[108:111], v[68:71]
    buffer_load_dwordx4 v27, s[12:15], s44 offen offset:1024 lds
    v_mfma_f32_16x16x32_bf16 v[72:75], v[172:175], a[108:111], v[72:75]
    ds_read_b64_tr_b16 v[132:133], v210 offset:30720
    ds_read_b64_tr_b16 v[134:135], v210 offset:32768
    v_mfma_f32_16x16x32_bf16 v[52:55], v[172:175], a[104:107], v[52:55]
    s_xor_b32 s4, s34, 32768
    buffer_load_dwordx4 a[32:35], v16, s[8:11], s4 offen offset:0 sc1
    v_mfma_f32_16x16x32_bf16 v[56:59], v[176:179], a[104:107], v[56:59]
    ds_read_b64_tr_b16 v[136:137], v213 offset:38912
    ds_read_b64_tr_b16 v[138:139], v213 offset:39936
    v_mfma_f32_16x16x32_bf16 v[76:79], v[176:179], a[108:111], v[76:79]
    s_waitcnt lgkmcnt(15)
    v_mfma_f32_16x16x32_bf16 v[100:103], v[180:183], a[108:111], v[100:103]
    ds_read_b64_tr_b16 v[140:141], v201 offset:34816
    ds_read_b64_tr_b16 v[142:143], v201 offset:36864
    v_mfma_f32_16x16x32_bf16 v[80:83], v[180:183], a[104:107], v[80:83]
    buffer_load_dwordx4 a[36:39], v17, s[8:11], s4 offen offset:0 sc1
    v_mfma_f32_16x16x32_bf16 v[84:87], v[184:187], a[104:107], v[84:87]
    ds_read_b64_tr_b16 v[144:145], v204 offset:34816
    ds_read_b64_tr_b16 v[146:147], v204 offset:36864
    v_mfma_f32_16x16x32_bf16 v[104:107], v[184:187], a[108:111], v[104:107]
    s_waitcnt lgkmcnt(14)
    v_mfma_f32_16x16x32_bf16 v[108:111], v[188:191], a[108:111], v[108:111]
    ds_read_b64_tr_b16 v[148:149], v207 offset:34816
    ds_read_b64_tr_b16 v[150:151], v207 offset:36864
    v_mfma_f32_16x16x32_bf16 v[88:91], v[188:191], a[104:107], v[88:91]
    buffer_load_dwordx4 a[40:43], v16, s[8:11], s4 offen offset:1024 sc1
    v_mfma_f32_16x16x32_bf16 v[92:95], v[192:195], a[104:107], v[92:95]
    ds_read_b64_tr_b16 v[152:153], v210 offset:34816
    ds_read_b64_tr_b16 v[154:155], v210 offset:36864
    v_mfma_f32_16x16x32_bf16 v[112:115], v[192:195], a[108:111], v[112:115]
    buffer_load_dwordx4 a[44:47], v17, s[8:11], s4 offen offset:1024 sc1
    v_mfma_f32_16x16x32_bf16 v[116:119], v[196:199], a[108:111], v[116:119]
    ds_read_b64_tr_b16 v[156:157], v216 offset:38912
    ds_read_b64_tr_b16 v[158:159], v216 offset:39936
    v_mfma_f32_16x16x32_bf16 v[96:99], v[196:199], a[104:107], v[96:99]
    s_waitcnt lgkmcnt(15)
    v_mfma_f32_16x16x32_bf16 v[40:43], v[120:123], a[112:115], v[40:43]
    ds_read_b64_tr_b16 v[160:161], v201 offset:40960
    ds_read_b64_tr_b16 v[162:163], v201 offset:43008
    v_mfma_f32_16x16x32_bf16 v[60:63], v[120:123], a[116:119], v[60:63]
    buffer_load_dwordx4 a[48:51], v16, s[8:11], s4 offen offset:2048 sc1
    v_mfma_f32_16x16x32_bf16 v[64:67], v[124:127], a[116:119], v[64:67]
    ds_read_b64_tr_b16 v[164:165], v204 offset:40960
    ds_read_b64_tr_b16 v[166:167], v204 offset:43008
    v_mfma_f32_16x16x32_bf16 v[44:47], v[124:127], a[112:115], v[44:47]
    s_waitcnt lgkmcnt(14)
    v_mfma_f32_16x16x32_bf16 v[48:51], v[128:131], a[112:115], v[48:51]
    ds_read_b64_tr_b16 v[168:169], v207 offset:40960
    ds_read_b64_tr_b16 v[170:171], v207 offset:43008
    v_mfma_f32_16x16x32_bf16 v[68:71], v[128:131], a[116:119], v[68:71]
    buffer_load_dwordx4 a[52:55], v17, s[8:11], s4 offen offset:2048 sc1
    v_mfma_f32_16x16x32_bf16 v[72:75], v[132:135], a[116:119], v[72:75]
    ds_read_b64_tr_b16 v[172:173], v210 offset:40960
    ds_read_b64_tr_b16 v[174:175], v210 offset:43008
    v_mfma_f32_16x16x32_bf16 v[52:55], v[132:135], a[112:115], v[52:55]
    buffer_load_dwordx4 a[56:59], v16, s[8:11], s4 offen offset:3072 sc1
    v_mfma_f32_16x16x32_bf16 v[56:59], v[136:139], a[112:115], v[56:59]
    ds_read_b64_tr_b16 v[176:177], v213 offset:49152
    ds_read_b64_tr_b16 v[178:179], v213 offset:50176
    v_mfma_f32_16x16x32_bf16 v[76:79], v[136:139], a[116:119], v[76:79]
    s_waitcnt lgkmcnt(15)
    v_mfma_f32_16x16x32_bf16 v[100:103], v[140:143], a[116:119], v[100:103]
    ds_read_b64_tr_b16 v[180:181], v201 offset:45056
    ds_read_b64_tr_b16 v[182:183], v201 offset:47104
    v_mfma_f32_16x16x32_bf16 v[80:83], v[140:143], a[112:115], v[80:83]
    buffer_load_dwordx4 a[60:63], v17, s[8:11], s4 offen offset:3072 sc1
    v_mfma_f32_16x16x32_bf16 v[84:87], v[144:147], a[112:115], v[84:87]
    ds_read_b64_tr_b16 v[184:185], v204 offset:45056
    ds_read_b64_tr_b16 v[186:187], v204 offset:47104
    v_mfma_f32_16x16x32_bf16 v[104:107], v[144:147], a[116:119], v[104:107]
    s_waitcnt lgkmcnt(14)
    v_mfma_f32_16x16x32_bf16 v[108:111], v[148:151], a[116:119], v[108:111]
    ds_read_b64_tr_b16 v[188:189], v207 offset:45056
    ds_read_b64_tr_b16 v[190:191], v207 offset:47104
    v_mfma_f32_16x16x32_bf16 v[88:91], v[148:151], a[112:115], v[88:91]
    v_mfma_f32_16x16x32_bf16 v[92:95], v[152:155], a[112:115], v[92:95]
    ds_read_b64_tr_b16 v[192:193], v210 offset:45056
    ds_read_b64_tr_b16 v[194:195], v210 offset:47104
    v_mfma_f32_16x16x32_bf16 v[112:115], v[152:155], a[116:119], v[112:115]
    v_mfma_f32_16x16x32_bf16 v[116:119], v[156:159], a[116:119], v[116:119]
    ds_read_b64_tr_b16 v[196:197], v216 offset:49152
    ds_read_b64_tr_b16 v[198:199], v216 offset:50176
    v_mfma_f32_16x16x32_bf16 v[96:99], v[156:159], a[112:115], v[96:99]
    s_waitcnt lgkmcnt(15)
    v_mfma_f32_16x16x32_bf16 v[40:43], v[160:163], a[120:123], v[40:43]
    v_mfma_f32_16x16x32_bf16 v[60:63], v[160:163], a[124:127], v[60:63]
    v_mfma_f32_16x16x32_bf16 v[64:67], v[164:167], a[124:127], v[64:67]
    v_mfma_f32_16x16x32_bf16 v[44:47], v[164:167], a[120:123], v[44:47]
    s_waitcnt vmcnt(36) lgkmcnt(0)
    s_barrier
    s_cmp_lg_u32 s28, 0
    s_cbranch_scc1 L_np_f2
    v_mov_b32 v0, 3
    s_mov_b64 exec, 1
    buffer_store_byte v0, off, s[80:83], s45 sc1
    s_mov_b64 exec, -1
L_np_f2:
    v_mfma_f32_16x16x32_bf16 v[48:51], v[168:171], a[120:123], v[48:51]
    ds_read_b64_tr_b16 v[120:121], v200 offset:30720
    ds_read_b64_tr_b16 v[122:123], v200 offset:32768
    v_mfma_f32_16x16x32_bf16 v[68:71], v[168:171], a[124:127], v[68:71]
    ds_read_b64_tr_b16 v[124:125], v203 offset:30720
    ds_read_b64_tr_b16 v[126:127], v203 offset:32768
    v_mfma_f32_16x16x32_bf16 v[72:75], v[172:175], a[124:127], v[72:75]
    s_add_u32 s44, s89, 0
    s_add_u32 m0, s93, 0
    v_mfma_f32_16x16x32_bf16 v[52:55], v[172:175], a[120:123], v[52:55]
    ds_read_b64_tr_b16 v[128:129], v206 offset:30720
    ds_read_b64_tr_b16 v[130:131], v206 offset:32768
    v_mfma_f32_16x16x32_bf16 v[56:59], v[176:179], a[120:123], v[56:59]
    ds_read_b64_tr_b16 v[132:133], v209 offset:30720
    ds_read_b64_tr_b16 v[134:135], v209 offset:32768
    v_mfma_f32_16x16x32_bf16 v[76:79], v[176:179], a[124:127], v[76:79]
    v_mfma_f32_16x16x32_bf16 v[100:103], v[180:183], a[124:127], v[100:103]
    ds_read_b64_tr_b16 v[136:137], v212 offset:38912
    ds_read_b64_tr_b16 v[138:139], v212 offset:39936
    v_mfma_f32_16x16x32_bf16 v[80:83], v[180:183], a[120:123], v[80:83]
    ds_read_b64_tr_b16 v[140:141], v200 offset:34816
    ds_read_b64_tr_b16 v[142:143], v200 offset:36864
    v_mfma_f32_16x16x32_bf16 v[84:87], v[184:187], a[120:123], v[84:87]
    buffer_load_dwordx4 v18, s[12:15], s44 offen offset:0 lds
    v_mfma_f32_16x16x32_bf16 v[104:107], v[184:187], a[124:127], v[104:107]
    ds_read_b64_tr_b16 v[144:145], v203 offset:34816
    ds_read_b64_tr_b16 v[146:147], v203 offset:36864
    v_mfma_f32_16x16x32_bf16 v[108:111], v[188:191], a[124:127], v[108:111]
    ds_read_b64_tr_b16 v[148:149], v206 offset:34816
    ds_read_b64_tr_b16 v[150:151], v206 offset:36864
    v_mfma_f32_16x16x32_bf16 v[88:91], v[188:191], a[120:123], v[88:91]
    buffer_load_dwordx4 v19, s[12:15], s44 offen offset:1024 lds
    v_mfma_f32_16x16x32_bf16 v[92:95], v[192:195], a[120:123], v[92:95]
    ds_read_b64_tr_b16 v[152:153], v209 offset:34816
    ds_read_b64_tr_b16 v[154:155], v209 offset:36864
    v_mfma_f32_16x16x32_bf16 v[112:115], v[192:195], a[124:127], v[112:115]
    ds_read_b64_tr_b16 v[156:157], v215 offset:38912
    ds_read_b64_tr_b16 v[158:159], v215 offset:39936
    v_mfma_f32_16x16x32_bf16 v[116:119], v[196:199], a[124:127], v[116:119]
    buffer_load_dwordx4 v20, s[12:15], s44 offen offset:2048 lds
    v_mfma_f32_16x16x32_bf16 v[96:99], v[196:199], a[120:123], v[96:99]
    s_waitcnt lgkmcnt(15)
    v_mfma_f32_16x16x32_bf16 v[40:43], v[120:123], a[224:227], v[40:43]
    ds_read_b64_tr_b16 v[160:161], v202 offset:0
    ds_read_b64_tr_b16 v[162:163], v202 offset:2048
    v_mfma_f32_16x16x32_bf16 v[60:63], v[120:123], a[228:231], v[60:63]
    buffer_load_dwordx4 v21, s[12:15], s44 offen offset:3072 lds
    s_add_u32 m0, s93, 8192
    v_mfma_f32_16x16x32_bf16 v[64:67], v[124:127], a[228:231], v[64:67]
    ds_read_b64_tr_b16 v[164:165], v205 offset:0
    ds_read_b64_tr_b16 v[166:167], v205 offset:2048
    v_mfma_f32_16x16x32_bf16 v[44:47], v[124:127], a[224:227], v[44:47]
    s_waitcnt lgkmcnt(14)
    v_mfma_f32_16x16x32_bf16 v[48:51], v[128:131], a[224:227], v[48:51]
    ds_read_b64_tr_b16 v[168:169], v208 offset:0
    ds_read_b64_tr_b16 v[170:171], v208 offset:2048
    v_mfma_f32_16x16x32_bf16 v[68:71], v[128:131], a[228:231], v[68:71]
    buffer_load_dwordx4 v22, s[12:15], s44 offen offset:0 lds
    v_mfma_f32_16x16x32_bf16 v[72:75], v[132:135], a[228:231], v[72:75]
    ds_read_b64_tr_b16 v[172:173], v211 offset:0
    ds_read_b64_tr_b16 v[174:175], v211 offset:2048
    v_mfma_f32_16x16x32_bf16 v[52:55], v[132:135], a[224:227], v[52:55]
    s_add_u32 s44, s89, 0
    s_add_u32 m0, s93, 4096
    v_mfma_f32_16x16x32_bf16 v[56:59], v[136:139], a[224:227], v[56:59]
    ds_read_b64_tr_b16 v[176:177], v214 offset:8192
    ds_read_b64_tr_b16 v[178:179], v214 offset:9216
    v_mfma_f32_16x16x32_bf16 v[76:79], v[136:139], a[228:231], v[76:79]
    s_waitcnt lgkmcnt(15)
    v_mfma_f32_16x16x32_bf16 v[100:103], v[140:143], a[228:231], v[100:103]
    ds_read_b64_tr_b16 v[180:181], v202 offset:4096
    ds_read_b64_tr_b16 v[182:183], v202 offset:6144
    v_mfma_f32_16x16x32_bf16 v[80:83], v[140:143], a[224:227], v[80:83]
    buffer_load_dwordx4 v23, s[12:15], s44 offen offset:0 lds
    v_mfma_f32_16x16x32_bf16 v[84:87], v[144:147], a[224:227], v[84:87]
    ds_read_b64_tr_b16 v[184:185], v205 offset:4096
    ds_read_b64_tr_b16 v[186:187], v205 offset:6144
    v_mfma_f32_16x16x32_bf16 v[104:107], v[144:147], a[228:231], v[104:107]
    s_waitcnt lgkmcnt(14)
    v_mfma_f32_16x16x32_bf16 v[108:111], v[148:151], a[228:231], v[108:111]
    ds_read_b64_tr_b16 v[188:189], v208 offset:4096
    ds_read_b64_tr_b16 v[190:191], v208 offset:6144
    v_mfma_f32_16x16x32_bf16 v[88:91], v[148:151], a[224:227], v[88:91]
    buffer_load_dwordx4 v24, s[12:15], s44 offen offset:1024 lds
    v_mfma_f32_16x16x32_bf16 v[92:95], v[152:155], a[224:227], v[92:95]
    ds_read_b64_tr_b16 v[192:193], v211 offset:4096
    ds_read_b64_tr_b16 v[194:195], v211 offset:6144
    v_mfma_f32_16x16x32_bf16 v[112:115], v[152:155], a[228:231], v[112:115]
    buffer_load_dwordx4 v25, s[12:15], s44 offen offset:2048 lds
    v_mfma_f32_16x16x32_bf16 v[116:119], v[156:159], a[228:231], v[116:119]
    ds_read_b64_tr_b16 v[196:197], v217 offset:8192
    ds_read_b64_tr_b16 v[198:199], v217 offset:9216
    v_mfma_f32_16x16x32_bf16 v[96:99], v[156:159], a[224:227], v[96:99]
    s_waitcnt lgkmcnt(15)
    v_mfma_f32_16x16x32_bf16 v[40:43], v[160:163], a[232:235], v[40:43]
    ds_read_b64_tr_b16 v[120:121], v200 offset:40960
    ds_read_b64_tr_b16 v[122:123], v200 offset:43008
    v_mfma_f32_16x16x32_bf16 v[60:63], v[160:163], a[236:239], v[60:63]
    buffer_load_dwordx4 v26, s[12:15], s44 offen offset:3072 lds
    s_add_u32 m0, s93, 8192
    v_mfma_f32_16x16x32_bf16 v[64:67], v[164:167], a[236:239], v[64:67]
    ds_read_b64_tr_b16 v[124:125], v203 offset:40960
    ds_read_b64_tr_b16 v[126:127], v203 offset:43008
    v_mfma_f32_16x16x32_bf16 v[44:47], v[164:167], a[232:235], v[44:47]
    s_waitcnt lgkmcnt(14)
    v_mfma_f32_16x16x32_bf16 v[48:51], v[168:171], a[232:235], v[48:51]
    ds_read_b64_tr_b16 v[128:129], v206 offset:40960
    ds_read_b64_tr_b16 v[130:131], v206 offset:43008
    v_mfma_f32_16x16x32_bf16 v[68:71], v[168:171], a[236:239], v[68:71]
    buffer_load_dwordx4 v27, s[12:15], s44 offen offset:1024 lds
    v_mfma_f32_16x16x32_bf16 v[72:75], v[172:175], a[236:239], v[72:75]
    ds_read_b64_tr_b16 v[132:133], v209 offset:40960
    ds_read_b64_tr_b16 v[134:135], v209 offset:43008
    v_mfma_f32_16x16x32_bf16 v[52:55], v[172:175], a[232:235], v[52:55]
    s_xor_b32 s4, s34, 40960
    buffer_load_dwordx4 a[128:131], v16, s[8:11], s4 offen offset:0 sc1
    v_mfma_f32_16x16x32_bf16 v[56:59], v[176:179], a[232:235], v[56:59]
    ds_read_b64_tr_b16 v[136:137], v212 offset:49152
    ds_read_b64_tr_b16 v[138:139], v212 offset:50176
    v_mfma_f32_16x16x32_bf16 v[76:79], v[176:179], a[236:239], v[76:79]
    s_waitcnt lgkmcnt(15)
    v_mfma_f32_16x16x32_bf16 v[100:103], v[180:183], a[236:239], v[100:103]
    ds_read_b64_tr_b16 v[140:141], v200 offset:45056
    ds_read_b64_tr_b16 v[142:143], v200 offset:47104
    v_mfma_f32_16x16x32_bf16 v[80:83], v[180:183], a[232:235], v[80:83]
    buffer_load_dwordx4 a[132:135], v17, s[8:11], s4 offen offset:0 sc1
    v_mfma_f32_16x16x32_bf16 v[84:87], v[184:187], a[232:235], v[84:87]
    ds_read_b64_tr_b16 v[144:145], v203 offset:45056
    ds_read_b64_tr_b16 v[146:147], v203 offset:47104
    v_mfma_f32_16x16x32_bf16 v[104:107], v[184:187], a[236:239], v[104:107]
    s_waitcnt lgkmcnt(14)
    v_mfma_f32_16x16x32_bf16 v[108:111], v[188:191], a[236:239], v[108:111]
    ds_read_b64_tr_b16 v[148:149], v206 offset:45056
    ds_read_b64_tr_b16 v[150:151], v206 offset:47104
    v_mfma_f32_16x16x32_bf16 v[88:91], v[188:191], a[232:235], v[88:91]
    buffer_load_dwordx4 a[136:139], v16, s[8:11], s4 offen offset:1024 sc1
    v_mfma_f32_16x16x32_bf16 v[92:95], v[192:195], a[232:235], v[92:95]
    ds_read_b64_tr_b16 v[152:153], v209 offset:45056
    ds_read_b64_tr_b16 v[154:155], v209 offset:47104
    v_mfma_f32_16x16x32_bf16 v[112:115], v[192:195], a[236:239], v[112:115]
    buffer_load_dwordx4 a[140:143], v17, s[8:11], s4 offen offset:1024 sc1
    v_mfma_f32_16x16x32_bf16 v[116:119], v[196:199], a[236:239], v[116:119]
    ds_read_b64_tr_b16 v[156:157], v215 offset:49152
    ds_read_b64_tr_b16 v[158:159], v215 offset:50176
    v_mfma_f32_16x16x32_bf16 v[96:99], v[196:199], a[232:235], v[96:99]
    s_waitcnt lgkmcnt(15)
    v_mfma_f32_16x16x32_bf16 v[40:43], v[120:123], a[240:243], v[40:43]
    ds_read_b64_tr_b16 v[160:161], v201 offset:0
    ds_read_b64_tr_b16 v[162:163], v201 offset:2048
    v_mfma_f32_16x16x32_bf16 v[60:63], v[120:123], a[244:247], v[60:63]
    buffer_load_dwordx4 a[144:147], v16, s[8:11], s4 offen offset:2048 sc1
    v_mfma_f32_16x16x32_bf16 v[64:67], v[124:127], a[244:247], v[64:67]
    ds_read_b64_tr_b16 v[164:165], v204 offset:0
    ds_read_b64_tr_b16 v[166:167], v204 offset:2048
    v_mfma_f32_16x16x32_bf16 v[44:47], v[124:127], a[240:243], v[44:47]
    s_waitcnt lgkmcnt(14)
    v_mfma_f32_16x16x32_bf16 v[48:51], v[128:131], a[240:243], v[48:51]
    ds_read_b64_tr_b16 v[168:169], v207 offset:0
    ds_read_b64_tr_b16 v[170:171], v207 offset:2048
    v_mfma_f32_16x16x32_bf16 v[68:71], v[128:131], a[244:247], v[68:71]
    buffer_load_dwordx4 a[148:151], v17, s[8:11], s4 offen offset:2048 sc1
    v_mfma_f32_16x16x32_bf16 v[72:75], v[132:135], a[244:247], v[72:75]
    ds_read_b64_tr_b16 v[172:173], v210 offset:0
    ds_read_b64_tr_b16 v[174:175], v210 offset:2048
    v_mfma_f32_16x16x32_bf16 v[52:55], v[132:135], a[240:243], v[52:55]
    buffer_load_dwordx4 a[152:155], v16, s[8:11], s4 offen offset:3072 sc1
    v_mfma_f32_16x16x32_bf16 v[56:59], v[136:139], a[240:243], v[56:59]
    ds_read_b64_tr_b16 v[176:177], v213 offset:8192
    ds_read_b64_tr_b16 v[178:179], v213 offset:9216
    v_mfma_f32_16x16x32_bf16 v[76:79], v[136:139], a[244:247], v[76:79]
    s_waitcnt lgkmcnt(15)
    v_mfma_f32_16x16x32_bf16 v[100:103], v[140:143], a[244:247], v[100:103]
    ds_read_b64_tr_b16 v[180:181], v201 offset:4096
    ds_read_b64_tr_b16 v[182:183], v201 offset:6144
    v_mfma_f32_16x16x32_bf16 v[80:83], v[140:143], a[240:243], v[80:83]
    buffer_load_dwordx4 a[156:159], v17, s[8:11], s4 offen offset:3072 sc1
    v_mfma_f32_16x16x32_bf16 v[84:87], v[144:147], a[240:243], v[84:87]
    ds_read_b64_tr_b16 v[184:185], v204 offset:4096
    ds_read_b64_tr_b16 v[186:187], v204 offset:6144
    v_mfma_f32_16x16x32_bf16 v[104:107], v[144:147], a[244:247], v[104:107]
    s_waitcnt lgkmcnt(14)
    v_mfma_f32_16x16x32_bf16 v[108:111], v[148:151], a[244:247], v[108:111]
    ds_read_b64_tr_b16 v[188:189], v207 offset:4096
    ds_read_b64_tr_b16 v[190:191], v207 offset:6144
    v_mfma_f32_16x16x32_bf16 v[88:91], v[148:151], a[240:243], v[88:91]
    v_mfma_f32_16x16x32_bf16 v[92:95], v[152:155], a[240:243], v[92:95]
    ds_read_b64_tr_b16 v[192:193], v210 offset:4096
    ds_read_b64_tr_b16 v[194:195], v210 offset:6144
    v_mfma_f32_16x16x32_bf16 v[112:115], v[152:155], a[244:247], v[112:115]
    v_mfma_f32_16x16x32_bf16 v[116:119], v[156:159], a[244:247], v[116:119]
    ds_read_b64_tr_b16 v[196:197], v216 offset:8192
    ds_read_b64_tr_b16 v[198:199], v216 offset:9216
    v_mfma_f32_16x16x32_bf16 v[96:99], v[156:159], a[240:243], v[96:99]
    s_waitcnt lgkmcnt(15)
    v_mfma_f32_16x16x32_bf16 v[40:43], v[160:163], a[248:251], v[40:43]
    v_mfma_f32_16x16x32_bf16 v[60:63], v[160:163], a[252:255], v[60:63]
    v_mfma_f32_16x16x32_bf16 v[64:67], v[164:167], a[252:255], v[64:67]
    v_mfma_f32_16x16x32_bf16 v[44:47], v[164:167], a[248:251], v[44:47]
    s_waitcnt vmcnt(36) lgkmcnt(0)
    s_barrier
    v_mfma_f32_16x16x32_bf16 v[48:51], v[168:171], a[248:251], v[48:51]
    ds_read_b64_tr_b16 v[120:121], v201 offset:10240
    ds_read_b64_tr_b16 v[122:123], v201 offset:12288
    v_mfma_f32_16x16x32_bf16 v[68:71], v[168:171], a[252:255], v[68:71]
    ds_read_b64_tr_b16 v[124:125], v204 offset:10240
    ds_read_b64_tr_b16 v[126:127], v204 offset:12288
    v_mfma_f32_16x16x32_bf16 v[72:75], v[172:175], a[252:255], v[72:75]
    s_add_u32 s44, s90, 0
    s_add_u32 m0, s94, 0
    v_mfma_f32_16x16x32_bf16 v[52:55], v[172:175], a[248:251], v[52:55]
    ds_read_b64_tr_b16 v[128:129], v207 offset:10240
    ds_read_b64_tr_b16 v[130:131], v207 offset:12288
    v_mfma_f32_16x16x32_bf16 v[56:59], v[176:179], a[248:251], v[56:59]
    ds_read_b64_tr_b16 v[132:133], v210 offset:10240
    ds_read_b64_tr_b16 v[134:135], v210 offset:12288
    v_mfma_f32_16x16x32_bf16 v[76:79], v[176:179], a[252:255], v[76:79]
    v_mfma_f32_16x16x32_bf16 v[100:103], v[180:183], a[252:255], v[100:103]
    ds_read_b64_tr_b16 v[136:137], v213 offset:18432
    ds_read_b64_tr_b16 v[138:139], v213 offset:19456
    v_mfma_f32_16x16x32_bf16 v[80:83], v[180:183], a[248:251], v[80:83]
    ds_read_b64_tr_b16 v[140:141], v201 offset:14336
    ds_read_b64_tr_b16 v[142:143], v201 offset:16384
    v_mfma_f32_16x16x32_bf16 v[84:87], v[184:187], a[248:251], v[84:87]
    buffer_load_dwordx4 v18, s[12:15], s44 offen offset:0 lds
    v_mfma_f32_16x16x32_bf16 v[104:107], v[184:187], a[252:255], v[104:107]
    ds_read_b64_tr_b16 v[144:145], v204 offset:14336
    ds_read_b64_tr_b16 v[146:147], v204 offset:16384
    v_mfma_f32_16x16x32_bf16 v[108:111], v[188:191], a[252:255], v[108:111]
    ds_read_b64_tr_b16 v[148:149], v207 offset:14336
    ds_read_b64_tr_b16 v[150:151], v207 offset:16384
    v_mfma_f32_16x16x32_bf16 v[88:91], v[188:191], a[248:251], v[88:91]
    buffer_load_dwordx4 v19, s[12:15], s44 offen offset:1024 lds
    v_mfma_f32_16x16x32_bf16 v[92:95], v[192:195], a[248:251], v[92:95]
    ds_read_b64_tr_b16 v[152:153], v210 offset:14336
    ds_read_b64_tr_b16 v[154:155], v210 offset:16384
    v_mfma_f32_16x16x32_bf16 v[112:115], v[192:195], a[252:255], v[112:115]
    ds_read_b64_tr_b16 v[156:157], v216 offset:18432
    ds_read_b64_tr_b16 v[158:159], v216 offset:19456
    v_mfma_f32_16x16x32_bf16 v[116:119], v[196:199], a[252:255], v[116:119]
    buffer_load_dwordx4 v20, s[12:15], s44 offen offset:2048 lds
    v_mfma_f32_16x16x32_bf16 v[96:99], v[196:199], a[248:251], v[96:99]
    s_waitcnt lgkmcnt(15)
    v_mfma_f32_16x16x32_bf16 v[40:43], v[120:123], a[0:3], v[40:43]
    ds_read_b64_tr_b16 v[160:161], v201 offset:20480
    ds_read_b64_tr_b16 v[162:163], v201 offset:22528
    v_mfma_f32_16x16x32_bf16 v[60:63], v[120:123], a[4:7], v[60:63]
    buffer_load_dwordx4 v21, s[12:15], s44 offen offset:3072 lds
    s_add_u32 m0, s94, 8192
    v_mfma_f32_16x16x32_bf16 v[64:67], v[124:127], a[4:7], v[64:67]
    ds_read_b64_tr_b16 v[164:165], v204 offset:20480
    ds_read_b64_tr_b16 v[166:167], v204 offset:22528
    v_mfma_f32_16x16x32_bf16 v[44:47], v[124:127], a[0:3], v[44:47]
    s_waitcnt lgkmcnt(14)
    v_mfma_f32_16x16x32_bf16 v[48:51], v[128:131], a[0:3], v[48:51]
    ds_read_b64_tr_b16 v[168:169], v207 offset:20480
    ds_read_b64_tr_b16 v[170:171], v207 offset:22528
    v_mfma_f32_16x16x32_bf16 v[68:71], v[128:131], a[4:7], v[68:71]
    buffer_load_dwordx4 v22, s[12:15], s44 offen offset:0 lds
    v_mfma_f32_16x16x32_bf16 v[72:75], v[132:135], a[4:7], v[72:75]
    ds_read_b64_tr_b16 v[172:173], v210 offset:20480
    ds_read_b64_tr_b16 v[174:175], v210 offset:22528
    v_mfma_f32_16x16x32_bf16 v[52:55], v[132:135], a[0:3], v[52:55]
    s_add_u32 s44, s90, 0
    s_add_u32 m0, s94, 4096
    v_mfma_f32_16x16x32_bf16 v[56:59], v[136:139], a[0:3], v[56:59]
    ds_read_b64_tr_b16 v[176:177], v213 offset:28672
    ds_read_b64_tr_b16 v[178:179], v213 offset:29696
    v_mfma_f32_16x16x32_bf16 v[76:79], v[136:139], a[4:7], v[76:79]
    s_waitcnt lgkmcnt(15)
    v_mfma_f32_16x16x32_bf16 v[100:103], v[140:143], a[4:7], v[100:103]
    ds_read_b64_tr_b16 v[180:181], v201 offset:24576
    ds_read_b64_tr_b16 v[182:183], v201 offset:26624
    v_mfma_f32_16x16x32_bf16 v[80:83], v[140:143], a[0:3], v[80:83]
    buffer_load_dwordx4 v23, s[12:15], s44 offen offset:0 lds
    v_mfma_f32_16x16x32_bf16 v[84:87], v[144:147], a[0:3], v[84:87]
    ds_read_b64_tr_b16 v[184:185], v204 offset:24576
    ds_read_b64_tr_b16 v[186:187], v204 offset:26624
    v_mfma_f32_16x16x32_bf16 v[104:107], v[144:147], a[4:7], v[104:107]
    s_waitcnt lgkmcnt(14)
    v_mfma_f32_16x16x32_bf16 v[108:111], v[148:151], a[4:7], v[108:111]
    ds_read_b64_tr_b16 v[188:189], v207 offset:24576
    ds_read_b64_tr_b16 v[190:191], v207 offset:26624
    v_mfma_f32_16x16x32_bf16 v[88:91], v[148:151], a[0:3], v[88:91]
    buffer_load_dwordx4 v24, s[12:15], s44 offen offset:1024 lds
    v_mfma_f32_16x16x32_bf16 v[92:95], v[152:155], a[0:3], v[92:95]
    ds_read_b64_tr_b16 v[192:193], v210 offset:24576
    ds_read_b64_tr_b16 v[194:195], v210 offset:26624
    v_mfma_f32_16x16x32_bf16 v[112:115], v[152:155], a[4:7], v[112:115]
    buffer_load_dwordx4 v25, s[12:15], s44 offen offset:2048 lds
    v_mfma_f32_16x16x32_bf16 v[116:119], v[156:159], a[4:7], v[116:119]
    ds_read_b64_tr_b16 v[196:197], v216 offset:28672
    ds_read_b64_tr_b16 v[198:199], v216 offset:29696
    v_mfma_f32_16x16x32_bf16 v[96:99], v[156:159], a[0:3], v[96:99]
    s_waitcnt lgkmcnt(15)
    v_mfma_f32_16x16x32_bf16 v[40:43], v[160:163], a[8:11], v[40:43]
    ds_read_b64_tr_b16 v[120:121], v202 offset:10240
    ds_read_b64_tr_b16 v[122:123], v202 offset:12288
    v_mfma_f32_16x16x32_bf16 v[60:63], v[160:163], a[12:15], v[60:63]
    buffer_load_dwordx4 v26, s[12:15], s44 offen offset:3072 lds
    s_add_u32 m0, s94, 8192
    v_mfma_f32_16x16x32_bf16 v[64:67], v[164:167], a[12:15], v[64:67]
    ds_read_b64_tr_b16 v[124:125], v205 offset:10240
    ds_read_b64_tr_b16 v[126:127], v205 offset:12288
    v_mfma_f32_16x16x32_bf16 v[44:47], v[164:167], a[8:11], v[44:47]
    s_waitcnt lgkmcnt(14)
    v_mfma_f32_16x16x32_bf16 v[48:51], v[168:171], a[8:11], v[48:51]
    ds_read_b64_tr_b16 v[128:129], v208 offset:10240
    ds_read_b64_tr_b16 v[130:131], v208 offset:12288
    v_mfma_f32_16x16x32_bf16 v[68:71], v[168:171], a[12:15], v[68:71]
    buffer_load_dwordx4 v27, s[12:15], s44 offen offset:1024 lds
    v_mfma_f32_16x16x32_bf16 v[72:75], v[172:175], a[12:15], v[72:75]
    ds_read_b64_tr_b16 v[132:133], v211 offset:10240
    ds_read_b64_tr_b16 v[134:135], v211 offset:12288
    v_mfma_f32_16x16x32_bf16 v[52:55], v[172:175], a[8:11], v[52:55]
    s_xor_b32 s4, s34, 49152
    buffer_load_dwordx4 a[160:163], v16, s[8:11], s4 offen offset:0 sc1
    v_mfma_f32_16x16x32_bf16 v[56:59], v[176:179], a[8:11], v[56:59]
    ds_read_b64_tr_b16 v[136:137], v214 offset:18432
    ds_read_b64_tr_b16 v[138:139], v214 offset:19456
    v_mfma_f32_16x16x32_bf16 v[76:79], v[176:179], a[12:15], v[76:79]
    s_waitcnt lgkmcnt(15)
    v_mfma_f32_16x16x32_bf16 v[100:103], v[180:183], a[12:15], v[100:103]
    ds_read_b64_tr_b16 v[140:141], v202 offset:14336
    ds_read_b64_tr_b16 v[142:143], v202 offset:16384
    v_mfma_f32_16x16x32_bf16 v[80:83], v[180:183], a[8:11], v[80:83]
    buffer_load_dwordx4 a[164:167], v17, s[8:11], s4 offen offset:0 sc1
    v_mfma_f32_16x16x32_bf16 v[84:87], v[184:187], a[8:11], v[84:87]
    ds_read_b64_tr_b16 v[144:145], v205 offset:14336
    ds_read_b64_tr_b16 v[146:147], v205 offset:16384
    v_mfma_f32_16x16x32_bf16 v[104:107], v[184:187], a[12:15], v[104:107]
    s_waitcnt lgkmcnt(14)
    v_mfma_f32_16x16x32_bf16 v[108:111], v[188:191], a[12:15], v[108:111]
    ds_read_b64_tr_b16 v[148:149], v208 offset:14336
    ds_read_b64_tr_b16 v[150:151], v208 offset:16384
    v_mfma_f32_16x16x32_bf16 v[88:91], v[188:191], a[8:11], v[88:91]
    buffer_load_dwordx4 a[168:171], v16, s[8:11], s4 offen offset:1024 sc1
    v_mfma_f32_16x16x32_bf16 v[92:95], v[192:195], a[8:11], v[92:95]
    ds_read_b64_tr_b16 v[152:153], v211 offset:14336
    ds_read_b64_tr_b16 v[154:155], v211 offset:16384
    v_mfma_f32_16x16x32_bf16 v[112:115], v[192:195], a[12:15], v[112:115]
    buffer_load_dwordx4 a[172:175], v17, s[8:11], s4 offen offset:1024 sc1
    v_mfma_f32_16x16x32_bf16 v[116:119], v[196:199], a[12:15], v[116:119]
    ds_read_b64_tr_b16 v[156:157], v217 offset:18432
    ds_read_b64_tr_b16 v[158:159], v217 offset:19456
    v_mfma_f32_16x16x32_bf16 v[96:99], v[196:199], a[8:11], v[96:99]
    s_waitcnt lgkmcnt(15)
    v_mfma_f32_16x16x32_bf16 v[40:43], v[120:123], a[16:19], v[40:43]
    ds_read_b64_tr_b16 v[160:161], v202 offset:20480
    ds_read_b64_tr_b16 v[162:163], v202 offset:22528
    v_mfma_f32_16x16x32_bf16 v[60:63], v[120:123], a[20:23], v[60:63]
    buffer_load_dwordx4 a[176:179], v16, s[8:11], s4 offen offset:2048 sc1
    v_mfma_f32_16x16x32_bf16 v[64:67], v[124:127], a[20:23], v[64:67]
    ds_read_b64_tr_b16 v[164:165], v205 offset:20480
    ds_read_b64_tr_b16 v[166:167], v205 offset:22528
    v_mfma_f32_16x16x32_bf16 v[44:47], v[124:127], a[16:19], v[44:47]
    s_waitcnt lgkmcnt(14)
    v_mfma_f32_16x16x32_bf16 v[48:51], v[128:131], a[16:19], v[48:51]
    ds_read_b64_tr_b16 v[168:169], v208 offset:20480
    ds_read_b64_tr_b16 v[170:171], v208 offset:22528
    v_mfma_f32_16x16x32_bf16 v[68:71], v[128:131], a[20:23], v[68:71]
    buffer_load_dwordx4 a[180:183], v17, s[8:11], s4 offen offset:2048 sc1
    v_mfma_f32_16x16x32_bf16 v[72:75], v[132:135], a[20:23], v[72:75]
    ds_read_b64_tr_b16 v[172:173], v211 offset:20480
    ds_read_b64_tr_b16 v[174:175], v211 offset:22528
    v_mfma_f32_16x16x32_bf16 v[52:55], v[132:135], a[16:19], v[52:55]
    buffer_load_dwordx4 a[184:187], v16, s[8:11], s4 offen offset:3072 sc1
    v_mfma_f32_16x16x32_bf16 v[56:59], v[136:139], a[16:19], v[56:59]
    ds_read_b64_tr_b16 v[176:177], v214 offset:28672
    ds_read_b64_tr_b16 v[178:179], v214 offset:29696
    v_mfma_f32_16x16x32_bf16 v[76:79], v[136:139], a[20:23], v[76:79]
    s_waitcnt lgkmcnt(15)
    v_mfma_f32_16x16x32_bf16 v[100:103], v[140:143], a[20:23], v[100:103]
    ds_read_b64_tr_b16 v[180:181], v202 offset:24576
    ds_read_b64_tr_b16 v[182:183], v202 offset:26624
    v_mfma_f32_16x16x32_bf16 v[80:83], v[140:143], a[16:19], v[80:83]
    buffer_load_dwordx4 a[188:191], v17, s[8:11], s4 offen offset:3072 sc1
    v_mfma_f32_16x16x32_bf16 v[84:87], v[144:147], a[16:19], v[84:87]
    ds_read_b64_tr_b16 v[184:185], v205 offset:24576
    ds_read_b64_tr_b16 v[186:187], v205 offset:26624
    v_mfma_f32_16x16x32_bf16 v[104:107], v[144:147], a[20:23], v[104:107]
    s_waitcnt lgkmcnt(14)
    v_mfma_f32_16x16x32_bf16 v[108:111], v[148:151], a[20:23], v[108:111]
    ds_read_b64_tr_b16 v[188:189], v208 offset:24576
    ds_read_b64_tr_b16 v[190:191], v208 offset:26624
    v_mfma_f32_16x16x32_bf16 v[88:91], v[148:151], a[16:19], v[88:91]
    v_mfma_f32_16x16x32_bf16 v[92:95], v[152:155], a[16:19], v[92:95]
    ds_read_b64_tr_b16 v[192:193], v211 offset:24576
    ds_read_b64_tr_b16 v[194:195], v211 offset:26624
    v_mfma_f32_16x16x32_bf16 v[112:115], v[152:155], a[20:23], v[112:115]
    v_mfma_f32_16x16x32_bf16 v[116:119], v[156:159], a[20:23], v[116:119]
    ds_read_b64_tr_b16 v[196:197], v217 offset:28672
    ds_read_b64_tr_b16 v[198:199], v217 offset:29696
    v_mfma_f32_16x16x32_bf16 v[96:99], v[156:159], a[16:19], v[96:99]
    s_waitcnt lgkmcnt(15)
    v_mfma_f32_16x16x32_bf16 v[40:43], v[160:163], a[24:27], v[40:43]
    v_mfma_f32_16x16x32_bf16 v[60:63], v[160:163], a[28:31], v[60:63]
    v_mfma_f32_16x16x32_bf16 v[64:67], v[164:167], a[28:31], v[64:67]
    v_mfma_f32_16x16x32_bf16 v[44:47], v[164:167], a[24:27], v[44:47]
    s_waitcnt vmcnt(36) lgkmcnt(0)
    s_barrier
    s_cmp_lg_u32 s28, 0
    s_cbranch_scc1 L_np_p2
    buffer_load_dword v0, v30, s[80:83], 0 offen sc1
L_np_p2:
    v_mfma_f32_16x16x32_bf16 v[48:51], v[168:171], a[24:27], v[48:51]
    ds_read_b64_tr_b16 v[120:121], v202 offset:30720
    ds_read_b64_tr_b16 v[122:123], v202 offset:32768
    v_mfma_f32_16x16x32_bf16 v[68:71], v[168:171], a[28:31], v[68:71]
    ds_read_b64_tr_b16 v[124:125], v205 offset:30720
    ds_read_b64_tr_b16 v[126:127], v205 offset:32768
    v_mfma_f32_16x16x32_bf16 v[72:75], v[172:175], a[28:31], v[72:75]
    s_add_u32 s44, s91, 0
    s_add_u32 m0, s95, 0
    v_mfma_f32_16x16x32_bf16 v[52:55], v[172:175], a[24:27], v[52:55]
    ds_read_b64_tr_b16 v[128:129], v208 offset:30720
    ds_read_b64_tr_b16 v[130:131], v208 offset:32768
    v_mfma_f32_16x16x32_bf16 v[56:59], v[176:179], a[24:27], v[56:59]
    ds_read_b64_tr_b16 v[132:133], v211 offset:30720
    ds_read_b64_tr_b16 v[134:135], v211 offset:32768
    v_mfma_f32_16x16x32_bf16 v[76:79], v[176:179], a[28:31], v[76:79]
    v_mfma_f32_16x16x32_bf16 v[100:103], v[180:183], a[28:31], v[100:103]
    ds_read_b64_tr_b16 v[136:137], v214 offset:38912
    ds_read_b64_tr_b16 v[138:139], v214 offset:39936
    v_mfma_f32_16x16x32_bf16 v[80:83], v[180:183], a[24:27], v[80:83]
    ds_read_b64_tr_b16 v[140:141], v202 offset:34816
    ds_read_b64_tr_b16 v[142:143], v202 offset:36864
    v_mfma_f32_16x16x32_bf16 v[84:87], v[184:187], a[24:27], v[84:87]
    buffer_load_dwordx4 v18, s[12:15], s44 offen offset:0 lds
    v_mfma_f32_16x16x32_bf16 v[104:107], v[184:187], a[28:31], v[104:107]
    ds_read_b64_tr_b16 v[144:145], v205 offset:34816
    ds_read_b64_tr_b16 v[146:147], v205 offset:36864
    v_mfma_f32_16x16x32_bf16 v[108:111], v[188:191], a[28:31], v[108:111]
    ds_read_b64_tr_b16 v[148:149], v208 offset:34816
    ds_read_b64_tr_b16 v[150:151], v208 offset:36864
    v_mfma_f32_16x16x32_bf16 v[88:91], v[188:191], a[24:27], v[88:91]
    buffer_load_dwordx4 v19, s[12:15], s44 offen offset:1024 lds
    v_mfma_f32_16x16x32_bf16 v[92:95], v[192:195], a[24:27], v[92:95]
    ds_read_b64_tr_b16 v[152:153], v211 offset:34816
    ds_read_b64_tr_b16 v[154:155], v211 offset:36864
    v_mfma_f32_16x16x32_bf16 v[112:115], v[192:195], a[28:31], v[112:115]
    ds_read_b64_tr_b16 v[156:157], v217 offset:38912
    ds_read_b64_tr_b16 v[158:159], v217 offset:39936
    v_mfma_f32_16x16x32_bf16 v[116:119], v[196:199], a[28:31], v[116:119]
    buffer_load_dwordx4 v20, s[12:15], s44 offen offset:2048 lds
    v_mfma_f32_16x16x32_bf16 v[96:99], v[196:199], a[24:27], v[96:99]
    s_waitcnt lgkmcnt(15)
    v_mfma_f32_16x16x32_bf16 v[40:43], v[120:123], a[32:35], v[40:43]
    ds_read_b64_tr_b16 v[160:161], v202 offset:40960
    ds_read_b64_tr_b16 v[162:163], v202 offset:43008
    v_mfma_f32_16x16x32_bf16 v[60:63], v[120:123], a[36:39], v[60:63]
    buffer_load_dwordx4 v21, s[12:15], s44 offen offset:3072 lds
    s_add_u32 m0, s95, 8192
    v_mfma_f32_16x16x32_bf16 v[64:67], v[124:127], a[36:39], v[64:67]
    ds_read_b64_tr_b16 v[164:165], v205 offset:40960
    ds_read_b64_tr_b16 v[166:167], v205 offset:43008
    v_mfma_f32_16x16x32_bf16 v[44:47], v[124:127], a[32:35], v[44:47]
    s_waitcnt lgkmcnt(14)
    v_mfma_f32_16x16x32_bf16 v[48:51], v[128:131], a[32:35], v[48:51]
    ds_read_b64_tr_b16 v[168:169], v208 offset:40960
    ds_read_b64_tr_b16 v[170:171], v208 offset:43008
    v_mfma_f32_16x16x32_bf16 v[68:71], v[128:131], a[36:39], v[68:71]
    buffer_load_dwordx4 v22, s[12:15], s44 offen offset:0 lds
    v_mfma_f32_16x16x32_bf16 v[72:75], v[132:135], a[36:39], v[72:75]
    ds_read_b64_tr_b16 v[172:173], v211 offset:40960
    ds_read_b64_tr_b16 v[174:175], v211 offset:43008
    v_mfma_f32_16x16x32_bf16 v[52:55], v[132:135], a[32:35], v[52:55]
    s_add_u32 s44, s91, 0
    s_add_u32 m0, s95, 4096
    v_mfma_f32_16x16x32_bf16 v[56:59], v[136:139], a[32:35], v[56:59]
    ds_read_b64_tr_b16 v[176:177], v214 offset:49152
    ds_read_b64_tr_b16 v[178:179], v214 offset:50176
    v_mfma_f32_16x16x32_bf16 v[76:79], v[136:139], a[36:39], v[76:79]
    s_waitcnt lgkmcnt(15)
    v_mfma_f32_16x16x32_bf16 v[100:103], v[140:143], a[36:39], v[100:103]
    ds_read_b64_tr_b16 v[180:181], v202 offset:45056
    ds_read_b64_tr_b16 v[182:183], v202 offset:47104
    v_mfma_f32_16x16x32_bf16 v[80:83], v[140:143], a[32:35], v[80:83]
    buffer_load_dwordx4 v23, s[12:15], s44 offen offset:0 lds
    v_mfma_f32_16x16x32_bf16 v[84:87], v[144:147], a[32:35], v[84:87]
    ds_read_b64_tr_b16 v[184:185], v205 offset:45056
    ds_read_b64_tr_b16 v[186:187], v205 offset:47104
    v_mfma_f32_16x16x32_bf16 v[104:107], v[144:147], a[36:39], v[104:107]
    s_waitcnt lgkmcnt(14)
    v_mfma_f32_16x16x32_bf16 v[108:111], v[148:151], a[36:39], v[108:111]
    ds_read_b64_tr_b16 v[188:189], v208 offset:45056
    ds_read_b64_tr_b16 v[190:191], v208 offset:47104
    v_mfma_f32_16x16x32_bf16 v[88:91], v[148:151], a[32:35], v[88:91]
    buffer_load_dwordx4 v24, s[12:15], s44 offen offset:1024 lds
    v_mfma_f32_16x16x32_bf16 v[92:95], v[152:155], a[32:35], v[92:95]
    ds_read_b64_tr_b16 v[192:193], v211 offset:45056
    ds_read_b64_tr_b16 v[194:195], v211 offset:47104
    v_mfma_f32_16x16x32_bf16 v[112:115], v[152:155], a[36:39], v[112:115]
    buffer_load_dwordx4 v25, s[12:15], s44 offen offset:2048 lds
    v_mfma_f32_16x16x32_bf16 v[116:119], v[156:159], a[36:39], v[116:119]
    ds_read_b64_tr_b16 v[196:197], v217 offset:49152
    ds_read_b64_tr_b16 v[198:199], v217 offset:50176
    v_mfma_f32_16x16x32_bf16 v[96:99], v[156:159], a[32:35], v[96:99]
    s_waitcnt lgkmcnt(15)
    v_mfma_f32_16x16x32_bf16 v[40:43], v[160:163], a[40:43], v[40:43]
    ds_read_b64_tr_b16 v[120:121], v202 offset:51200
    ds_read_b64_tr_b16 v[122:123], v202 offset:53248
    v_mfma_f32_16x16x32_bf16 v[60:63], v[160:163], a[44:47], v[60:63]
    buffer_load_dwordx4 v26, s[12:15], s44 offen offset:3072 lds
    s_add_u32 m0, s95, 8192
    v_mfma_f32_16x16x32_bf16 v[64:67], v[164:167], a[44:47], v[64:67]
    ds_read_b64_tr_b16 v[124:125], v205 offset:51200
    ds_read_b64_tr_b16 v[126:127], v205 offset:53248
    v_mfma_f32_16x16x32_bf16 v[44:47], v[164:167], a[40:43], v[44:47]
    s_waitcnt lgkmcnt(14)
    v_mfma_f32_16x16x32_bf16 v[48:51], v[168:171], a[40:43], v[48:51]
    ds_read_b64_tr_b16 v[128:129], v208 offset:51200
    ds_read_b64_tr_b16 v[130:131], v208 offset:53248
    v_mfma_f32_16x16x32_bf16 v[68:71], v[168:171], a[44:47], v[68:71]
    buffer_load_dwordx4 v27, s[12:15], s44 offen offset:1024 lds
    v_mfma_f32_16x16x32_bf16 v[72:75], v[172:175], a[44:47], v[72:75]
    ds_read_b64_tr_b16 v[132:133], v211 offset:51200
    ds_read_b64_tr_b16 v[134:135], v211 offset:53248
    v_mfma_f32_16x16x32_bf16 v[52:55], v[172:175], a[40:43], v[52:55]
    s_xor_b32 s4, s34, 57344
    buffer_load_dwordx4 a[192:195], v16, s[8:11], s4 offen offset:0 sc1
    v_mfma_f32_16x16x32_bf16 v[56:59], v[176:179], a[40:43], v[56:59]
    ds_read_b64_tr_b16 v[136:137], v214 offset:59392
    ds_read_b64_tr_b16 v[138:139], v214 offset:60416
    v_mfma_f32_16x16x32_bf16 v[76:79], v[176:179], a[44:47], v[76:79]
    s_waitcnt lgkmcnt(15)
    v_mfma_f32_16x16x32_bf16 v[100:103], v[180:183], a[44:47], v[100:103]
    ds_read_b64_tr_b16 v[140:141], v202 offset:55296
    ds_read_b64_tr_b16 v[142:143], v202 offset:57344
    v_mfma_f32_16x16x32_bf16 v[80:83], v[180:183], a[40:43], v[80:83]
    buffer_load_dwordx4 a[196:199], v17, s[8:11], s4 offen offset:0 sc1
    v_mfma_f32_16x16x32_bf16 v[84:87], v[184:187], a[40:43], v[84:87]
    ds_read_b64_tr_b16 v[144:145], v205 offset:55296
    ds_read_b64_tr_b16 v[146:147], v205 offset:57344
    v_mfma_f32_16x16x32_bf16 v[104:107], v[184:187], a[44:47], v[104:107]
    s_waitcnt lgkmcnt(14)
    v_mfma_f32_16x16x32_bf16 v[108:111], v[188:191], a[44:47], v[108:111]
    ds_read_b64_tr_b16 v[148:149], v208 offset:55296
    ds_read_b64_tr_b16 v[150:151], v208 offset:57344
    v_mfma_f32_16x16x32_bf16 v[88:91], v[188:191], a[40:43], v[88:91]
    buffer_load_dwordx4 a[200:203], v16, s[8:11], s4 offen offset:1024 sc1
    v_mfma_f32_16x16x32_bf16 v[92:95], v[192:195], a[40:43], v[92:95]
    ds_read_b64_tr_b16 v[152:153], v211 offset:55296
    ds_read_b64_tr_b16 v[154:155], v211 offset:57344
    v_mfma_f32_16x16x32_bf16 v[112:115], v[192:195], a[44:47], v[112:115]
    buffer_load_dwordx4 a[204:207], v17, s[8:11], s4 offen offset:1024 sc1
    v_mfma_f32_16x16x32_bf16 v[116:119], v[196:199], a[44:47], v[116:119]
    ds_read_b64_tr_b16 v[156:157], v217 offset:59392
    ds_read_b64_tr_b16 v[158:159], v217 offset:60416
    v_mfma_f32_16x16x32_bf16 v[96:99], v[196:199], a[40:43], v[96:99]
    s_waitcnt lgkmcnt(15)
    v_mfma_f32_16x16x32_bf16 v[40:43], v[120:123], a[48:51], v[40:43]
    ds_read_b64_tr_b16 v[160:161], v200 offset:0
    ds_read_b64_tr_b16 v[162:163], v200 offset:2048
    v_mfma_f32_16x16x32_bf16 v[60:63], v[120:123], a[52:55], v[60:63]
    buffer_load_dwordx4 a[208:211], v16, s[8:11], s4 offen offset:2048 sc1
    v_mfma_f32_16x16x32_bf16 v[64:67], v[124:127], a[52:55], v[64:67]
    ds_read_b64_tr_b16 v[164:165], v203 offset:0
    ds_read_b64_tr_b16 v[166:167], v203 offset:2048
    v_mfma_f32_16x16x32_bf16 v[44:47], v[124:127], a[48:51], v[44:47]
    s_waitcnt lgkmcnt(14)
    v_mfma_f32_16x16x32_bf16 v[48:51], v[128:131], a[48:51], v[48:51]
    ds_read_b64_tr_b16 v[168:169], v206 offset:0
    ds_read_b64_tr_b16 v[170:171], v206 offset:2048
    v_mfma_f32_16x16x32_bf16 v[68:71], v[128:131], a[52:55], v[68:71]
    buffer_load_dwordx4 a[212:215], v17, s[8:11], s4 offen offset:2048 sc1
    v_mfma_f32_16x16x32_bf16 v[72:75], v[132:135], a[52:55], v[72:75]
    ds_read_b64_tr_b16 v[172:173], v209 offset:0
    ds_read_b64_tr_b16 v[174:175], v209 offset:2048
    v_mfma_f32_16x16x32_bf16 v[52:55], v[132:135], a[48:51], v[52:55]
    buffer_load_dwordx4 a[216:219], v16, s[8:11], s4 offen offset:3072 sc1
    v_mfma_f32_16x16x32_bf16 v[56:59], v[136:139], a[48:51], v[56:59]
    ds_read_b64_tr_b16 v[176:177], v212 offset:8192
    ds_read_b64_tr_b16 v[178:179], v212 offset:9216
    v_mfma_f32_16x16x32_bf16 v[76:79], v[136:139], a[52:55], v[76:79]
    s_waitcnt lgkmcnt(15)
    v_mfma_f32_16x16x32_bf16 v[100:103], v[140:143], a[52:55], v[100:103]
    ds_read_b64_tr_b16 v[180:181], v200 offset:4096
    ds_read_b64_tr_b16 v[182:183], v200 offset:6144
    v_mfma_f32_16x16x32_bf16 v[80:83], v[140:143], a[48:51], v[80:83]
    buffer_load_dwordx4 a[220:223], v17, s[8:11], s4 offen offset:3072 sc1
    v_mfma_f32_16x16x32_bf16 v[84:87], v[144:147], a[48:51], v[84:87]
    ds_read_b64_tr_b16 v[184:185], v203 offset:4096
    ds_read_b64_tr_b16 v[186:187], v203 offset:6144
    v_mfma_f32_16x16x32_bf16 v[104:107], v[144:147], a[52:55], v[104:107]
    s_waitcnt lgkmcnt(14)
    v_mfma_f32_16x16x32_bf16 v[108:111], v[148:151], a[52:55], v[108:111]
    ds_read_b64_tr_b16 v[188:189], v206 offset:4096
    ds_read_b64_tr_b16 v[190:191], v206 offset:6144
    v_mfma_f32_16x16x32_bf16 v[88:91], v[148:151], a[48:51], v[88:91]
    v_mfma_f32_16x16x32_bf16 v[92:95], v[152:155], a[48:51], v[92:95]
    ds_read_b64_tr_b16 v[192:193], v209 offset:4096
    ds_read_b64_tr_b16 v[194:195], v209 offset:6144
    v_mfma_f32_16x16x32_bf16 v[112:115], v[152:155], a[52:55], v[112:115]
    v_mfma_f32_16x16x32_bf16 v[116:119], v[156:159], a[52:55], v[116:119]
    ds_read_b64_tr_b16 v[196:197], v215 offset:8192
    ds_read_b64_tr_b16 v[198:199], v215 offset:9216
    v_mfma_f32_16x16x32_bf16 v[96:99], v[156:159], a[48:51], v[96:99]
    s_waitcnt lgkmcnt(15)
    v_mfma_f32_16x16x32_bf16 v[40:43], v[160:163], a[56:59], v[40:43]
    v_mfma_f32_16x16x32_bf16 v[60:63], v[160:163], a[60:63], v[60:63]
    v_mfma_f32_16x16x32_bf16 v[64:67], v[164:167], a[60:63], v[64:67]
    v_mfma_f32_16x16x32_bf16 v[44:47], v[164:167], a[56:59], v[44:47]
    s_waitcnt vmcnt(36) lgkmcnt(0)
    s_cmp_lg_u32 s28, 0
    s_cbranch_scc1 L_spun_u2
    s_waitcnt vmcnt(18)
    v_or_b32 v0, v0, v28
    v_and_b32 v0, 0x3030303, v0
    v_cmp_ne_u32 vcc, 0x3030303, v0
    s_cbranch_vccnz L_spin_u2
L_spun_u2:
    s_barrier
    v_mfma_f32_16x16x32_bf16 v[48:51], v[168:171], a[56:59], v[48:51]
    ds_read_b64_tr_b16 v[120:121], v200 offset:10240
    ds_read_b64_tr_b16 v[122:123], v200 offset:12288
    v_mfma_f32_16x16x32_bf16 v[68:71], v[168:171], a[60:63], v[68:71]
    ds_read_b64_tr_b16 v[124:125], v203 offset:10240
    ds_read_b64_tr_b16 v[126:127], v203 offset:12288
    v_mfma_f32_16x16x32_bf16 v[72:75], v[172:175], a[60:63], v[72:75]
    s_add_u32 s44, s84, 163840
    s_add_u32 m0, s92, 0
    v_mfma_f32_16x16x32_bf16 v[52:55], v[172:175], a[56:59], v[52:55]
    ds_read_b64_tr_b16 v[128:129], v206 offset:10240
    ds_read_b64_tr_b16 v[130:131], v206 offset:12288
    v_mfma_f32_16x16x32_bf16 v[56:59], v[176:179], a[56:59], v[56:59]
    ds_read_b64_tr_b16 v[132:133], v209 offset:10240
    ds_read_b64_tr_b16 v[134:135], v209 offset:12288
    v_mfma_f32_16x16x32_bf16 v[76:79], v[176:179], a[60:63], v[76:79]
    v_mfma_f32_16x16x32_bf16 v[100:103], v[180:183], a[60:63], v[100:103]
    ds_read_b64_tr_b16 v[136:137], v212 offset:18432
    ds_read_b64_tr_b16 v[138:139], v212 offset:19456
    v_mfma_f32_16x16x32_bf16 v[80:83], v[180:183], a[56:59], v[80:83]
    ds_read_b64_tr_b16 v[140:141], v200 offset:14336
    ds_read_b64_tr_b16 v[142:143], v200 offset:16384
    v_mfma_f32_16x16x32_bf16 v[84:87], v[184:187], a[56:59], v[84:87]
    buffer_load_dwordx4 v18, s[12:15], s44 offen offset:0 lds
    v_mfma_f32_16x16x32_bf16 v[104:107], v[184:187], a[60:63], v[104:107]
    ds_read_b64_tr_b16 v[144:145], v203 offset:14336
    ds_read_b64_tr_b16 v[146:147], v203 offset:16384
    v_mfma_f32_16x16x32_bf16 v[108:111], v[188:191], a[60:63], v[108:111]
    ds_read_b64_tr_b16 v[148:149], v206 offset:14336
    ds_read_b64_tr_b16 v[150:151], v206 offset:16384
    v_mfma_f32_16x16x32_bf16 v[88:91], v[188:191], a[56:59], v[88:91]
    buffer_load_dwordx4 v19, s[12:15], s44 offen offset:1024 lds
    v_mfma_f32_16x16x32_bf16 v[92:95], v[192:195], a[56:59], v[92:95]
    ds_read_b64_tr_b16 v[152:153], v209 offset:14336
    ds_read_b64_tr_b16 v[154:155], v209 offset:16384
    v_mfma_f32_16x16x32_bf16 v[112:115], v[192:195], a[60:63], v[112:115]
    ds_read_b64_tr_b16 v[156:157], v215 offset:18432
    ds_read_b64_tr_b16 v[158:159], v215 offset:19456
    v_mfma_f32_16x16x32_bf16 v[116:119], v[196:199], a[60:63], v[116:119]
    buffer_load_dwordx4 v20, s[12:15], s44 offen offset:2048 lds
    v_mfma_f32_16x16x32_bf16 v[96:99], v[196:199], a[56:59], v[96:99]
    s_waitcnt lgkmcnt(15)
    v_mfma_f32_16x16x32_bf16 v[40:43], v[120:123], a[128:131], v[40:43]
    ds_read_b64_tr_b16 v[160:161], v200 offset:20480
    ds_read_b64_tr_b16 v[162:163], v200 offset:22528
    v_mfma_f32_16x16x32_bf16 v[60:63], v[120:123], a[132:135], v[60:63]
    buffer_load_dwordx4 v21, s[12:15], s44 offen offset:3072 lds
    s_add_u32 m0, s92, 8192
    v_mfma_f32_16x16x32_bf16 v[64:67], v[124:127], a[132:135], v[64:67]
    ds_read_b64_tr_b16 v[164:165], v203 offset:20480
    ds_read_b64_tr_b16 v[166:167], v203 offset:22528
    v_mfma_f32_16x16x32_bf16 v[44:47], v[124:127], a[128:131], v[44:47]
    s_waitcnt lgkmcnt(14)
    v_mfma_f32_16x16x32_bf16 v[48:51], v[128:131], a[128:131], v[48:51]
    ds_read_b64_tr_b16 v[168:169], v206 offset:20480
    ds_read_b64_tr_b16 v[170:171], v206 offset:22528
    v_mfma_f32_16x16x32_bf16 v[68:71], v[128:131], a[132:135], v[68:71]
    buffer_load_dwordx4 v22, s[12:15], s44 offen offset:0 lds
    v_mfma_f32_16x16x32_bf16 v[72:75], v[132:135], a[132:135], v[72:75]
    ds_read_b64_tr_b16 v[172:173], v209 offset:20480
    ds_read_b64_tr_b16 v[174:175], v209 offset:22528
    v_mfma_f32_16x16x32_bf16 v[52:55], v[132:135], a[128:131], v[52:55]
    s_add_u32 s44, s84, 163840
    s_add_u32 m0, s92, 4096
    v_mfma_f32_16x16x32_bf16 v[56:59], v[136:139], a[128:131], v[56:59]
    ds_read_b64_tr_b16 v[176:177], v212 offset:28672
    ds_read_b64_tr_b16 v[178:179], v212 offset:29696
    v_mfma_f32_16x16x32_bf16 v[76:79], v[136:139], a[132:135], v[76:79]
    s_waitcnt lgkmcnt(15)
    v_mfma_f32_16x16x32_bf16 v[100:103], v[140:143], a[132:135], v[100:103]
    ds_read_b64_tr_b16 v[180:181], v200 offset:24576
    ds_read_b64_tr_b16 v[182:183], v200 offset:26624
    v_mfma_f32_16x16x32_bf16 v[80:83], v[140:143], a[128:131], v[80:83]
    buffer_load_dwordx4 v23, s[12:15], s44 offen offset:0 lds
    v_mfma_f32_16x16x32_bf16 v[84:87], v[144:147], a[128:131], v[84:87]
    ds_read_b64_tr_b16 v[184:185], v203 offset:24576
    ds_read_b64_tr_b16 v[186:187], v203 offset:26624
    v_mfma_f32_16x16x32_bf16 v[104:107], v[144:147], a[132:135], v[104:107]
    s_waitcnt lgkmcnt(14)
    v_mfma_f32_16x16x32_bf16 v[108:111], v[148:151], a[132:135], v[108:111]
    ds_read_b64_tr_b16 v[188:189], v206 offset:24576
    ds_read_b64_tr_b16 v[190:191], v206 offset:26624
    v_mfma_f32_16x16x32_bf16 v[88:91], v[148:151], a[128:131], v[88:91]
    buffer_load_dwordx4 v24, s[12:15], s44 offen offset:1024 lds
    v_mfma_f32_16x16x32_bf16 v[92:95], v[152:155], a[128:131], v[92:95]
    ds_read_b64_tr_b16 v[192:193], v209 offset:24576
    ds_read_b64_tr_b16 v[194:195], v209 offset:26624
    v_mfma_f32_16x16x32_bf16 v[112:115], v[152:155], a[132:135], v[112:115]
    buffer_load_dwordx4 v25, s[12:15], s44 offen offset:2048 lds
    v_mfma_f32_16x16x32_bf16 v[116:119], v[156:159], a[132:135], v[116:119]
    ds_read_b64_tr_b16 v[196:197], v215 offset:28672
    ds_read_b64_tr_b16 v[198:199], v215 offset:29696
    v_mfma_f32_16x16x32_bf16 v[96:99], v[156:159], a[128:131], v[96:99]
    s_waitcnt lgkmcnt(15)
    v_mfma_f32_16x16x32_bf16 v[40:43], v[160:163], a[136:139], v[40:43]
    ds_read_b64_tr_b16 v[120:121], v201 offset:30720
    ds_read_b64_tr_b16 v[122:123], v201 offset:32768
    v_mfma_f32_16x16x32_bf16 v[60:63], v[160:163], a[140:143], v[60:63]
    buffer_load_dwordx4 v26, s[12:15], s44 offen offset:3072 lds
    s_add_u32 m0, s92, 8192
    v_mfma_f32_16x16x32_bf16 v[64:67], v[164:167], a[140:143], v[64:67]
    ds_read_b64_tr_b16 v[124:125], v204 offset:30720
    ds_read_b64_tr_b16 v[126:127], v204 offset:32768
    v_mfma_f32_16x16x32_bf16 v[44:47], v[164:167], a[136:139], v[44:47]
    s_waitcnt lgkmcnt(14)
    v_mfma_f32_16x16x32_bf16 v[48:51], v[168:171], a[136:139], v[48:51]
    ds_read_b64_tr_b16 v[128:129], v207 offset:30720
    ds_read_b64_tr_b16 v[130:131], v207 offset:32768
    v_mfma_f32_16x16x32_bf16 v[68:71], v[168:171], a[140:143], v[68:71]
    buffer_load_dwordx4 v27, s[12:15], s44 offen offset:1024 lds
    v_mfma_f32_16x16x32_bf16 v[72:75], v[172:175], a[140:143], v[72:75]
    ds_read_b64_tr_b16 v[132:133], v210 offset:30720
    ds_read_b64_tr_b16 v[134:135], v210 offset:32768
    v_mfma_f32_16x16x32_bf16 v[52:55], v[172:175], a[136:139], v[52:55]
    s_xor_b32 s4, s34, 4096
    buffer_load_dwordx4 a[64:67], v16, s[8:11], s4 offen offset:0 sc1
    v_mfma_f32_16x16x32_bf16 v[56:59], v[176:179], a[136:139], v[56:59]
    ds_read_b64_tr_b16 v[136:137], v213 offset:38912
    ds_read_b64_tr_b16 v[138:139], v213 offset:39936
    v_mfma_f32_16x16x32_bf16 v[76:79], v[176:179], a[140:143], v[76:79]
    s_waitcnt lgkmcnt(15)
    v_mfma_f32_16x16x32_bf16 v[100:103], v[180:183], a[140:143], v[100:103]
    ds_read_b64_tr_b16 v[140:141], v201 offset:34816
    ds_read_b64_tr_b16 v[142:143], v201 offset:36864
    v_mfma_f32_16x16x32_bf16 v[80:83], v[180:183], a[136:139], v[80:83]
    buffer_load_dwordx4 a[68:71], v17, s[8:11], s4 offen offset:0 sc1
    v_mfma_f32_16x16x32_bf16 v[84:87], v[184:187], a[136:139], v[84:87]
    ds_read_b64_tr_b16 v[144:145], v204 offset:34816
    ds_read_b64_tr_b16 v[146:147], v204 offset:36864
    v_mfma_f32_16x16x32_bf16 v[104:107], v[184:187], a[140:143], v[104:107]
    s_waitcnt lgkmcnt(14)
    v_mfma_f32_16x16x32_bf16 v[108:111], v[188:191], a[140:143], v[108:111]
    ds_read_b64_tr_b16 v[148:149], v207 offset:34816
    ds_read_b64_tr_b16 v[150:151], v207 offset:36864
    v_mfma_f32_16x16x32_bf16 v[88:91], v[188:191], a[136:139], v[88:91]
    buffer_load_dwordx4 a[72:75], v16, s[8:11], s4 offen offset:1024 sc1
    v_mfma_f32_16x16x32_bf16 v[92:95], v[192:195], a[136:139], v[92:95]
    ds_read_b64_tr_b16 v[152:153], v210 offset:34816
    ds_read_b64_tr_b16 v[154:155], v210 offset:36864
    v_mfma_f32_16x16x32_bf16 v[112:115], v[192:195], a[140:143], v[112:115]
    buffer_load_dwordx4 a[76:79], v17, s[8:11], s4 offen offset:1024 sc1
    v_mfma_f32_16x16x32_bf16 v[116:119], v[196:199], a[140:143], v[116:119]
    ds_read_b64_tr_b16 v[156:157], v216 offset:38912
    ds_read_b64_tr_b16 v[158:159], v216 offset:39936
    v_mfma_f32_16x16x32_bf16 v[96:99], v[196:199], a[136:139], v[96:99]
    s_waitcnt lgkmcnt(15)
    v_mfma_f32_16x16x32_bf16 v[40:43], v[120:123], a[144:147], v[40:43]
    ds_read_b64_tr_b16 v[160:161], v201 offset:40960
    ds_read_b64_tr_b16 v[162:163], v201 offset:43008
    v_mfma_f32_16x16x32_bf16 v[60:63], v[120:123], a[148:151], v[60:63]
    buffer_load_dwordx4 a[80:83], v16, s[8:11], s4 offen offset:2048 sc1
    v_mfma_f32_16x16x32_bf16 v[64:67], v[124:127], a[148:151], v[64:67]
    ds_read_b64_tr_b16 v[164:165], v204 offset:40960
    ds_read_b64_tr_b16 v[166:167], v204 offset:43008
    v_mfma_f32_16x16x32_bf16 v[44:47], v[124:127], a[144:147], v[44:47]
    s_waitcnt lgkmcnt(14)
    v_mfma_f32_16x16x32_bf16 v[48:51], v[128:131], a[144:147], v[48:51]
    ds_read_b64_tr_b16 v[168:169], v207 offset:40960
    ds_read_b64_tr_b16 v[170:171], v207 offset:43008
    v_mfma_f32_16x16x32_bf16 v[68:71], v[128:131], a[148:151], v[68:71]
    buffer_load_dwordx4 a[84:87], v17, s[8:11], s4 offen offset:2048 sc1
    v_mfma_f32_16x16x32_bf16 v[72:75], v[132:135], a[148:151], v[72:75]
    ds_read_b64_tr_b16 v[172:173], v210 offset:40960
    ds_read_b64_tr_b16 v[174:175], v210 offset:43008
    v_mfma_f32_16x16x32_bf16 v[52:55], v[132:135], a[144:147], v[52:55]
    buffer_load_dwordx4 a[88:91], v16, s[8:11], s4 offen offset:3072 sc1
    v_mfma_f32_16x16x32_bf16 v[56:59], v[136:139], a[144:147], v[56:59]
    ds_read_b64_tr_b16 v[176:177], v213 offset:49152
    ds_read_b64_tr_b16 v[178:179], v213 offset:50176
    v_mfma_f32_16x16x32_bf16 v[76:79], v[136:139], a[148:151], v[76:79]
    s_waitcnt lgkmcnt(15)
    v_mfma_f32_16x16x32_bf16 v[100:103], v[140:143], a[148:151], v[100:103]
    ds_read_b64_tr_b16 v[180:181], v201 offset:45056
    ds_read_b64_tr_b16 v[182:183], v201 offset:47104
    v_mfma_f32_16x16x32_bf16 v[80:83], v[140:143], a[144:147], v[80:83]
    buffer_load_dwordx4 a[92:95], v17, s[8:11], s4 offen offset:3072 sc1
    v_mfma_f32_16x16x32_bf16 v[84:87], v[144:147], a[144:147], v[84:87]
    ds_read_b64_tr_b16 v[184:185], v204 offset:45056
    ds_read_b64_tr_b16 v[186:187], v204 offset:47104
    v_mfma_f32_16x16x32_bf16 v[104:107], v[144:147], a[148:151], v[104:107]
    s_waitcnt lgkmcnt(14)
    v_mfma_f32_16x16x32_bf16 v[108:111], v[148:151], a[148:151], v[108:111]
    ds_read_b64_tr_b16 v[188:189], v207 offset:45056
    ds_read_b64_tr_b16 v[190:191], v207 offset:47104
    v_mfma_f32_16x16x32_bf16 v[88:91], v[148:151], a[144:147], v[88:91]
    v_mfma_f32_16x16x32_bf16 v[92:95], v[152:155], a[144:147], v[92:95]
    ds_read_b64_tr_b16 v[192:193], v210 offset:45056
    ds_read_b64_tr_b16 v[194:195], v210 offset:47104
    v_mfma_f32_16x16x32_bf16 v[112:115], v[152:155], a[148:151], v[112:115]
    v_mfma_f32_16x16x32_bf16 v[116:119], v[156:159], a[148:151], v[116:119]
    ds_read_b64_tr_b16 v[196:197], v216 offset:49152
    ds_read_b64_tr_b16 v[198:199], v216 offset:50176
    v_mfma_f32_16x16x32_bf16 v[96:99], v[156:159], a[144:147], v[96:99]
    s_waitcnt lgkmcnt(15)
    v_mfma_f32_16x16x32_bf16 v[40:43], v[160:163], a[152:155], v[40:43]
    v_mfma_f32_16x16x32_bf16 v[60:63], v[160:163], a[156:159], v[60:63]
    v_mfma_f32_16x16x32_bf16 v[64:67], v[164:167], a[156:159], v[64:67]
    v_mfma_f32_16x16x32_bf16 v[44:47], v[164:167], a[152:155], v[44:47]
    s_waitcnt vmcnt(36) lgkmcnt(0)
    s_barrier
    v_mfma_f32_16x16x32_bf16 v[48:51], v[168:171], a[152:155], v[48:51]
    ds_read_b64_tr_b16 v[120:121], v200 offset:30720
    ds_read_b64_tr_b16 v[122:123], v200 offset:32768
    v_mfma_f32_16x16x32_bf16 v[68:71], v[168:171], a[156:159], v[68:71]
    ds_read_b64_tr_b16 v[124:125], v203 offset:30720
    ds_read_b64_tr_b16 v[126:127], v203 offset:32768
    v_mfma_f32_16x16x32_bf16 v[72:75], v[172:175], a[156:159], v[72:75]
    s_add_u32 s44, s85, 163840
    s_add_u32 m0, s93, 0
    v_mfma_f32_16x16x32_bf16 v[52:55], v[172:175], a[152:155], v[52:55]
    ds_read_b64_tr_b16 v[128:129], v206 offset:30720
    ds_read_b64_tr_b16 v[130:131], v206 offset:32768
    v_mfma_f32_16x16x32_bf16 v[56:59], v[176:179], a[152:155], v[56:59]
    ds_read_b64_tr_b16 v[132:133], v209 offset:30720
    ds_read_b64_tr_b16 v[134:135], v209 offset:32768
    v_mfma_f32_16x16x32_bf16 v[76:79], v[176:179], a[156:159], v[76:79]
    v_mfma_f32_16x16x32_bf16 v[100:103], v[180:183], a[156:159], v[100:103]
    ds_read_b64_tr_b16 v[136:137], v212 offset:38912
    ds_read_b64_tr_b16 v[138:139], v212 offset:39936
    v_mfma_f32_16x16x32_bf16 v[80:83], v[180:183], a[152:155], v[80:83]
    ds_read_b64_tr_b16 v[140:141], v200 offset:34816
    ds_read_b64_tr_b16 v[142:143], v200 offset:36864
    v_mfma_f32_16x16x32_bf16 v[84:87], v[184:187], a[152:155], v[84:87]
    buffer_load_dwordx4 v18, s[12:15], s44 offen offset:0 lds
    v_mfma_f32_16x16x32_bf16 v[104:107], v[184:187], a[156:159], v[104:107]
    ds_read_b64_tr_b16 v[144:145], v203 offset:34816
    ds_read_b64_tr_b16 v[146:147], v203 offset:36864
    v_mfma_f32_16x16x32_bf16 v[108:111], v[188:191], a[156:159], v[108:111]
    ds_read_b64_tr_b16 v[148:149], v206 offset:34816
    ds_read_b64_tr_b16 v[150:151], v206 offset:36864
    v_mfma_f32_16x16x32_bf16 v[88:91], v[188:191], a[152:155], v[88:91]
    buffer_load_dwordx4 v19, s[12:15], s44 offen offset:1024 lds
    v_mfma_f32_16x16x32_bf16 v[92:95], v[192:195], a[152:155], v[92:95]
    ds_read_b64_tr_b16 v[152:153], v209 offset:34816
    ds_read_b64_tr_b16 v[154:155], v209 offset:36864
    v_mfma_f32_16x16x32_bf16 v[112:115], v[192:195], a[156:159], v[112:115]
    ds_read_b64_tr_b16 v[156:157], v215 offset:38912
    ds_read_b64_tr_b16 v[158:159], v215 offset:39936
    v_mfma_f32_16x16x32_bf16 v[116:119], v[196:199], a[156:159], v[116:119]
    buffer_load_dwordx4 v20, s[12:15], s44 offen offset:2048 lds
    v_mfma_f32_16x16x32_bf16 v[96:99], v[196:199], a[152:155], v[96:99]
    s_waitcnt lgkmcnt(15)
    v_mfma_f32_16x16x32_bf16 v[40:43], v[120:123], a[160:163], v[40:43]
    ds_read_b64_tr_b16 v[160:161], v202 offset:0
    ds_read_b64_tr_b16 v[162:163], v202 offset:2048
    v_mfma_f32_16x16x32_bf16 v[60:63], v[120:123], a[164:167], v[60:63]
    buffer_load_dwordx4 v21, s[12:15], s44 offen offset:3072 lds
    s_add_u32 m0, s93, 8192
    v_mfma_f32_16x16x32_bf16 v[64:67], v[124:127], a[164:167], v[64:67]
    ds_read_b64_tr_b16 v[164:165], v205 offset:0
    ds_read_b64_tr_b16 v[166:167], v205 offset:2048
    v_mfma_f32_16x16x32_bf16 v[44:47], v[124:127], a[160:163], v[44:47]
    s_waitcnt lgkmcnt(14)
    v_mfma_f32_16x16x32_bf16 v[48:51], v[128:131], a[160:163], v[48:51]
    ds_read_b64_tr_b16 v[168:169], v208 offset:0
    ds_read_b64_tr_b16 v[170:171], v208 offset:2048
    v_mfma_f32_16x16x32_bf16 v[68:71], v[128:131], a[164:167], v[68:71]
    buffer_load_dwordx4 v22, s[12:15], s44 offen offset:0 lds
    v_mfma_f32_16x16x32_bf16 v[72:75], v[132:135], a[164:167], v[72:75]
    ds_read_b64_tr_b16 v[172:173], v211 offset:0
    ds_read_b64_tr_b16 v[174:175], v211 offset:2048
    v_mfma_f32_16x16x32_bf16 v[52:55], v[132:135], a[160:163], v[52:55]
    s_add_u32 s44, s85, 163840
    s_add_u32 m0, s93, 4096
    v_mfma_f32_16x16x32_bf16 v[56:59], v[136:139], a[160:163], v[56:59]
    ds_read_b64_tr_b16 v[176:177], v214 offset:8192
    ds_read_b64_tr_b16 v[178:179], v214 offset:9216
    v_mfma_f32_16x16x32_bf16 v[76:79], v[136:139], a[164:167], v[76:79]
    s_waitcnt lgkmcnt(15)
    v_mfma_f32_16x16x32_bf16 v[100:103], v[140:143], a[164:167], v[100:103]
    ds_read_b64_tr_b16 v[180:181], v202 offset:4096
    ds_read_b64_tr_b16 v[182:183], v202 offset:6144
    v_mfma_f32_16x16x32_bf16 v[80:83], v[140:143], a[160:163], v[80:83]
    buffer_load_dwordx4 v23, s[12:15], s44 offen offset:0 lds
    v_mfma_f32_16x16x32_bf16 v[84:87], v[144:147], a[160:163], v[84:87]
    ds_read_b64_tr_b16 v[184:185], v205 offset:4096
    ds_read_b64_tr_b16 v[186:187], v205 offset:6144
    v_mfma_f32_16x16x32_bf16 v[104:107], v[144:147], a[164:167], v[104:107]
    s_waitcnt lgkmcnt(14)
    v_mfma_f32_16x16x32_bf16 v[108:111], v[148:151], a[164:167], v[108:111]
    ds_read_b64_tr_b16 v[188:189], v208 offset:4096
    ds_read_b64_tr_b16 v[190:191], v208 offset:6144
    v_mfma_f32_16x16x32_bf16 v[88:91], v[148:151], a[160:163], v[88:91]
    buffer_load_dwordx4 v24, s[12:15], s44 offen offset:1024 lds
    v_mfma_f32_16x16x32_bf16 v[92:95], v[152:155], a[160:163], v[92:95]
    ds_read_b64_tr_b16 v[192:193], v211 offset:4096
    ds_read_b64_tr_b16 v[194:195], v211 offset:6144
    v_mfma_f32_16x16x32_bf16 v[112:115], v[152:155], a[164:167], v[112:115]
    buffer_load_dwordx4 v25, s[12:15], s44 offen offset:2048 lds
    v_mfma_f32_16x16x32_bf16 v[116:119], v[156:159], a[164:167], v[116:119]
    ds_read_b64_tr_b16 v[196:197], v217 offset:8192
    ds_read_b64_tr_b16 v[198:199], v217 offset:9216
    v_mfma_f32_16x16x32_bf16 v[96:99], v[156:159], a[160:163], v[96:99]
    s_waitcnt lgkmcnt(15)
    v_mfma_f32_16x16x32_bf16 v[40:43], v[160:163], a[168:171], v[40:43]
    ds_read_b64_tr_b16 v[120:121], v200 offset:40960
    ds_read_b64_tr_b16 v[122:123], v200 offset:43008
    v_mfma_f32_16x16x32_bf16 v[60:63], v[160:163], a[172:175], v[60:63]
    buffer_load_dwordx4 v26, s[12:15], s44 offen offset:3072 lds
    s_add_u32 m0, s93, 8192
    v_mfma_f32_16x16x32_bf16 v[64:67], v[164:167], a[172:175], v[64:67]
    ds_read_b64_tr_b16 v[124:125], v203 offset:40960
    ds_read_b64_tr_b16 v[126:127], v203 offset:43008
    v_mfma_f32_16x16x32_bf16 v[44:47], v[164:167], a[168:171], v[44:47]
    s_waitcnt lgkmcnt(14)
    v_mfma_f32_16x16x32_bf16 v[48:51], v[168:171], a[168:171], v[48:51]
    ds_read_b64_tr_b16 v[128:129], v206 offset:40960
    ds_read_b64_tr_b16 v[130:131], v206 offset:43008
    v_mfma_f32_16x16x32_bf16 v[68:71], v[168:171], a[172:175], v[68:71]
    buffer_load_dwordx4 v27, s[12:15], s44 offen offset:1024 lds
    v_mfma_f32_16x16x32_bf16 v[72:75], v[172:175], a[172:175], v[72:75]
    ds_read_b64_tr_b16 v[132:133], v209 offset:40960
    ds_read_b64_tr_b16 v[134:135], v209 offset:43008
    v_mfma_f32_16x16x32_bf16 v[52:55], v[172:175], a[168:171], v[52:55]
    s_xor_b32 s4, s34, 12288
    buffer_load_dwordx4 a[96:99], v16, s[8:11], s4 offen offset:0 sc1
    v_mfma_f32_16x16x32_bf16 v[56:59], v[176:179], a[168:171], v[56:59]
    ds_read_b64_tr_b16 v[136:137], v212 offset:49152
    ds_read_b64_tr_b16 v[138:139], v212 offset:50176
    v_mfma_f32_16x16x32_bf16 v[76:79], v[176:179], a[172:175], v[76:79]
    s_waitcnt lgkmcnt(15)
    v_mfma_f32_16x16x32_bf16 v[100:103], v[180:183], a[172:175], v[100:103]
    ds_read_b64_tr_b16 v[140:141], v200 offset:45056
    ds_read_b64_tr_b16 v[142:143], v200 offset:47104
    v_mfma_f32_16x16x32_bf16 v[80:83], v[180:183], a[168:171], v[80:83]
    buffer_load_dwordx4 a[100:103], v17, s[8:11], s4 offen offset:0 sc1
    v_mfma_f32_16x16x32_bf16 v[84:87], v[184:187], a[168:171], v[84:87]
    ds_read_b64_tr_b16 v[144:145], v203 offset:45056
    ds_read_b64_tr_b16 v[146:147], v203 offset:47104
    v_mfma_f32_16x16x32_bf16 v[104:107], v[184:187], a[172:175], v[104:107]
    s_waitcnt lgkmcnt(14)
    v_mfma_f32_16x16x32_bf16 v[108:111], v[188:191], a[172:175], v[108:111]
    ds_read_b64_tr_b16 v[148:149], v206 offset:45056
    ds_read_b64_tr_b16 v[150:151], v206 offset:47104
    v_mfma_f32_16x16x32_bf16 v[88:91], v[188:191], a[168:171], v[88:91]
    buffer_load_dwordx4 a[104:107], v16, s[8:11], s4 offen offset:1024 sc1
    v_mfma_f32_16x16x32_bf16 v[92:95], v[192:195], a[168:171], v[92:95]
    ds_read_b64_tr_b16 v[152:153], v209 offset:45056
    ds_read_b64_tr_b16 v[154:155], v209 offset:47104
    v_mfma_f32_16x16x32_bf16 v[112:115], v[192:195], a[172:175], v[112:115]
    buffer_load_dwordx4 a[108:111], v17, s[8:11], s4 offen offset:1024 sc1
    v_mfma_f32_16x16x32_bf16 v[116:119], v[196:199], a[172:175], v[116:119]
    ds_read_b64_tr_b16 v[156:157], v215 offset:49152
    ds_read_b64_tr_b16 v[158:159], v215 offset:50176
    v_mfma_f32_16x16x32_bf16 v[96:99], v[196:199], a[168:171], v[96:99]
    s_waitcnt lgkmcnt(15)
    v_mfma_f32_16x16x32_bf16 v[40:43], v[120:123], a[176:179], v[40:43]
    ds_read_b64_tr_b16 v[160:161], v201 offset:0
    ds_read_b64_tr_b16 v[162:163], v201 offset:2048
    v_mfma_f32_16x16x32_bf16 v[60:63], v[120:123], a[180:183], v[60:63]
    buffer_load_dwordx4 a[112:115], v16, s[8:11], s4 offen offset:2048 sc1
    v_mfma_f32_16x16x32_bf16 v[64:67], v[124:127], a[180:183], v[64:67]
    ds_read_b64_tr_b16 v[164:165], v204 offset:0
    ds_read_b64_tr_b16 v[166:167], v204 offset:2048
    v_mfma_f32_16x16x32_bf16 v[44:47], v[124:127], a[176:179], v[44:47]
    s_waitcnt lgkmcnt(14)
    v_mfma_f32_16x16x32_bf16 v[48:51], v[128:131], a[176:179], v[48:51]
    ds_read_b64_tr_b16 v[168:169], v207 offset:0
    ds_read_b64_tr_b16 v[170:171], v207 offset:2048
    v_mfma_f32_16x16x32_bf16 v[68:71], v[128:131], a[180:183], v[68:71]
    buffer_load_dwordx4 a[116:119], v17, s[8:11], s4 offen offset:2048 sc1
    v_mfma_f32_16x16x32_bf16 v[72:75], v[132:135], a[180:183], v[72:75]
    ds_read_b64_tr_b16 v[172:173], v210 offset:0
    ds_read_b64_tr_b16 v[174:175], v210 offset:2048
    v_mfma_f32_16x16x32_bf16 v[52:55], v[132:135], a[176:179], v[52:55]
    buffer_load_dwordx4 a[120:123], v16, s[8:11], s4 offen offset:3072 sc1
    v_mfma_f32_16x16x32_bf16 v[56:59], v[136:139], a[176:179], v[56:59]
    ds_read_b64_tr_b16 v[176:177], v213 offset:8192
    ds_read_b64_tr_b16 v[178:179], v213 offset:9216
    v_mfma_f32_16x16x32_bf16 v[76:79], v[136:139], a[180:183], v[76:79]
    s_waitcnt lgkmcnt(15)
    v_mfma_f32_16x16x32_bf16 v[100:103], v[140:143], a[180:183], v[100:103]
    ds_read_b64_tr_b16 v[180:181], v201 offset:4096
    ds_read_b64_tr_b16 v[182:183], v201 offset:6144
    v_mfma_f32_16x16x32_bf16 v[80:83], v[140:143], a[176:179], v[80:83]
    buffer_load_dwordx4 a[124:127], v17, s[8:11], s4 offen offset:3072 sc1
    v_mfma_f32_16x16x32_bf16 v[84:87], v[144:147], a[176:179], v[84:87]
    ds_read_b64_tr_b16 v[184:185], v204 offset:4096
    ds_read_b64_tr_b16 v[186:187], v204 offset:6144
    v_mfma_f32_16x16x32_bf16 v[104:107], v[144:147], a[180:183], v[104:107]
    s_waitcnt lgkmcnt(14)
    v_mfma_f32_16x16x32_bf16 v[108:111], v[148:151], a[180:183], v[108:111]
    ds_read_b64_tr_b16 v[188:189], v207 offset:4096
    ds_read_b64_tr_b16 v[190:191], v207 offset:6144
    v_mfma_f32_16x16x32_bf16 v[88:91], v[148:151], a[176:179], v[88:91]
    v_mfma_f32_16x16x32_bf16 v[92:95], v[152:155], a[176:179], v[92:95]
    ds_read_b64_tr_b16 v[192:193], v210 offset:4096
    ds_read_b64_tr_b16 v[194:195], v210 offset:6144
    v_mfma_f32_16x16x32_bf16 v[112:115], v[152:155], a[180:183], v[112:115]
    v_mfma_f32_16x16x32_bf16 v[116:119], v[156:159], a[180:183], v[116:119]
    ds_read_b64_tr_b16 v[196:197], v216 offset:8192
    ds_read_b64_tr_b16 v[198:199], v216 offset:9216
    v_mfma_f32_16x16x32_bf16 v[96:99], v[156:159], a[176:179], v[96:99]
    s_waitcnt lgkmcnt(15)
    v_mfma_f32_16x16x32_bf16 v[40:43], v[160:163], a[184:187], v[40:43]
    v_mfma_f32_16x16x32_bf16 v[60:63], v[160:163], a[188:191], v[60:63]
    v_mfma_f32_16x16x32_bf16 v[64:67], v[164:167], a[188:191], v[64:67]
    v_mfma_f32_16x16x32_bf16 v[44:47], v[164:167], a[184:187], v[44:47]
    s_waitcnt vmcnt(36) lgkmcnt(0)
    s_barrier
    v_mfma_f32_16x16x32_bf16 v[48:51], v[168:171], a[184:187], v[48:51]
    ds_read_b64_tr_b16 v[120:121], v201 offset:10240
    ds_read_b64_tr_b16 v[122:123], v201 offset:12288
    v_mfma_f32_16x16x32_bf16 v[68:71], v[168:171], a[188:191], v[68:71]
    ds_read_b64_tr_b16 v[124:125], v204 offset:10240
    ds_read_b64_tr_b16 v[126:127], v204 offset:12288
    v_mfma_f32_16x16x32_bf16 v[72:75], v[172:175], a[188:191], v[72:75]
    s_add_u32 s44, s86, 163840
    s_add_u32 m0, s94, 0
    v_mfma_f32_16x16x32_bf16 v[52:55], v[172:175], a[184:187], v[52:55]
    ds_read_b64_tr_b16 v[128:129], v207 offset:10240
    ds_read_b64_tr_b16 v[130:131], v207 offset:12288
    v_mfma_f32_16x16x32_bf16 v[56:59], v[176:179], a[184:187], v[56:59]
    ds_read_b64_tr_b16 v[132:133], v210 offset:10240
    ds_read_b64_tr_b16 v[134:135], v210 offset:12288
    v_mfma_f32_16x16x32_bf16 v[76:79], v[176:179], a[188:191], v[76:79]
    v_mfma_f32_16x16x32_bf16 v[100:103], v[180:183], a[188:191], v[100:103]
    ds_read_b64_tr_b16 v[136:137], v213 offset:18432
    ds_read_b64_tr_b16 v[138:139], v213 offset:19456
    v_mfma_f32_16x16x32_bf16 v[80:83], v[180:183], a[184:187], v[80:83]
    ds_read_b64_tr_b16 v[140:141], v201 offset:14336
    ds_read_b64_tr_b16 v[142:143], v201 offset:16384
    v_mfma_f32_16x16x32_bf16 v[84:87], v[184:187], a[184:187], v[84:87]
    buffer_load_dwordx4 v18, s[12:15], s44 offen offset:0 lds
    v_mfma_f32_16x16x32_bf16 v[104:107], v[184:187], a[188:191], v[104:107]
    ds_read_b64_tr_b16 v[144:145], v204 offset:14336
    ds_read_b64_tr_b16 v[146:147], v204 offset:16384
    v_mfma_f32_16x16x32_bf16 v[108:111], v[188:191], a[188:191], v[108:111]
    ds_read_b64_tr_b16 v[148:149], v207 offset:14336
    ds_read_b64_tr_b16 v[150:151], v207 offset:16384
    v_mfma_f32_16x16x32_bf16 v[88:91], v[188:191], a[184:187], v[88:91]
    buffer_load_dwordx4 v19, s[12:15], s44 offen offset:1024 lds
    v_mfma_f32_16x16x32_bf16 v[92:95], v[192:195], a[184:187], v[92:95]
    ds_read_b64_tr_b16 v[152:153], v210 offset:14336
    ds_read_b64_tr_b16 v[154:155], v210 offset:16384
    v_mfma_f32_16x16x32_bf16 v[112:115], v[192:195], a[188:191], v[112:115]
    ds_read_b64_tr_b16 v[156:157], v216 offset:18432
    ds_read_b64_tr_b16 v[158:159], v216 offset:19456
    v_mfma_f32_16x16x32_bf16 v[116:119], v[196:199], a[188:191], v[116:119]
    buffer_load_dwordx4 v20, s[12:15], s44 offen offset:2048 lds
    v_mfma_f32_16x16x32_bf16 v[96:99], v[196:199], a[184:187], v[96:99]
    s_waitcnt lgkmcnt(15)
    v_mfma_f32_16x16x32_bf16 v[40:43], v[120:123], a[192:195], v[40:43]
    ds_read_b64_tr_b16 v[160:161], v201 offset:20480
    ds_read_b64_tr_b16 v[162:163], v201 offset:22528
    v_mfma_f32_16x16x32_bf16 v[60:63], v[120:123], a[196:199], v[60:63]
    buffer_load_dwordx4 v21, s[12:15], s44 offen offset:3072 lds
    s_add_u32 m0, s94, 8192
    v_mfma_f32_16x16x32_bf16 v[64:67], v[124:127], a[196:199], v[64:67]
    ds_read_b64_tr_b16 v[164:165], v204 offset:20480
    ds_read_b64_tr_b16 v[166:167], v204 offset:22528
    v_mfma_f32_16x16x32_bf16 v[44:47], v[124:127], a[192:195], v[44:47]
    s_waitcnt lgkmcnt(14)
    v_mfma_f32_16x16x32_bf16 v[48:51], v[128:131], a[192:195], v[48:51]
    ds_read_b64_tr_b16 v[168:169], v207 offset:20480
    ds_read_b64_tr_b16 v[170:171], v207 offset:22528
    v_mfma_f32_16x16x32_bf16 v[68:71], v[128:131], a[196:199], v[68:71]
    buffer_load_dwordx4 v22, s[12:15], s44 offen offset:0 lds
    v_mfma_f32_16x16x32_bf16 v[72:75], v[132:135], a[196:199], v[72:75]
    ds_read_b64_tr_b16 v[172:173], v210 offset:20480
    ds_read_b64_tr_b16 v[174:175], v210 offset:22528
    v_mfma_f32_16x16x32_bf16 v[52:55], v[132:135], a[192:195], v[52:55]
    s_add_u32 s44, s86, 163840
    s_add_u32 m0, s94, 4096
    v_mfma_f32_16x16x32_bf16 v[56:59], v[136:139], a[192:195], v[56:59]
    ds_read_b64_tr_b16 v[176:177], v213 offset:28672
    ds_read_b64_tr_b16 v[178:179], v213 offset:29696
    v_mfma_f32_16x16x32_bf16 v[76:79], v[136:139], a[196:199], v[76:79]
    s_waitcnt lgkmcnt(15)
    v_mfma_f32_16x16x32_bf16 v[100:103], v[140:143], a[196:199], v[100:103]
    ds_read_b64_tr_b16 v[180:181], v201 offset:24576
    ds_read_b64_tr_b16 v[182:183], v201 offset:26624
    v_mfma_f32_16x16x32_bf16 v[80:83], v[140:143], a[192:195], v[80:83]
    buffer_load_dwordx4 v23, s[12:15], s44 offen offset:0 lds
    v_mfma_f32_16x16x32_bf16 v[84:87], v[144:147], a[192:195], v[84:87]
    ds_read_b64_tr_b16 v[184:185], v204 offset:24576
    ds_read_b64_tr_b16 v[186:187], v204 offset:26624
    v_mfma_f32_16x16x32_bf16 v[104:107], v[144:147], a[196:199], v[104:107]
    s_waitcnt lgkmcnt(14)
    v_mfma_f32_16x16x32_bf16 v[108:111], v[148:151], a[196:199], v[108:111]
    ds_read_b64_tr_b16 v[188:189], v207 offset:24576
    ds_read_b64_tr_b16 v[190:191], v207 offset:26624
    v_mfma_f32_16x16x32_bf16 v[88:91], v[148:151], a[192:195], v[88:91]
    buffer_load_dwordx4 v24, s[12:15], s44 offen offset:1024 lds
    v_mfma_f32_16x16x32_bf16 v[92:95], v[152:155], a[192:195], v[92:95]
    ds_read_b64_tr_b16 v[192:193], v210 offset:24576
    ds_read_b64_tr_b16 v[194:195], v210 offset:26624
    v_mfma_f32_16x16x32_bf16 v[112:115], v[152:155], a[196:199], v[112:115]
    buffer_load_dwordx4 v25, s[12:15], s44 offen offset:2048 lds
    v_mfma_f32_16x16x32_bf16 v[116:119], v[156:159], a[196:199], v[116:119]
    ds_read_b64_tr_b16 v[196:197], v216 offset:28672
    ds_read_b64_tr_b16 v[198:199], v216 offset:29696
    v_mfma_f32_16x16x32_bf16 v[96:99], v[156:159], a[192:195], v[96:99]
    s_waitcnt lgkmcnt(15)
    v_mfma_f32_16x16x32_bf16 v[40:43], v[160:163], a[200:203], v[40:43]
    ds_read_b64_tr_b16 v[120:121], v202 offset:10240
    ds_read_b64_tr_b16 v[122:123], v202 offset:12288
    v_mfma_f32_16x16x32_bf16 v[60:63], v[160:163], a[204:207], v[60:63]
    buffer_load_dwordx4 v26, s[12:15], s44 offen offset:3072 lds
    s_add_u32 m0, s94, 8192
    v_mfma_f32_16x16x32_bf16 v[64:67], v[164:167], a[204:207], v[64:67]
    ds_read_b64_tr_b16 v[124:125], v205 offset:10240
    ds_read_b64_tr_b16 v[126:127], v205 offset:12288
    v_mfma_f32_16x16x32_bf16 v[44:47], v[164:167], a[200:203], v[44:47]
    s_waitcnt lgkmcnt(14)
    v_mfma_f32_16x16x32_bf16 v[48:51], v[168:171], a[200:203], v[48:51]
    ds_read_b64_tr_b16 v[128:129], v208 offset:10240
    ds_read_b64_tr_b16 v[130:131], v208 offset:12288
    v_mfma_f32_16x16x32_bf16 v[68:71], v[168:171], a[204:207], v[68:71]
    buffer_load_dwordx4 v27, s[12:15], s44 offen offset:1024 lds
    v_mfma_f32_16x16x32_bf16 v[72:75], v[172:175], a[204:207], v[72:75]
    ds_read_b64_tr_b16 v[132:133], v211 offset:10240
    ds_read_b64_tr_b16 v[134:135], v211 offset:12288
    v_mfma_f32_16x16x32_bf16 v[52:55], v[172:175], a[200:203], v[52:55]
    s_xor_b32 s4, s34, 20480
    buffer_load_dwordx4 a[224:227], v16, s[8:11], s4 offen offset:0 sc1
    v_mfma_f32_16x16x32_bf16 v[56:59], v[176:179], a[200:203], v[56:59]
    ds_read_b64_tr_b16 v[136:137], v214 offset:18432
    ds_read_b64_tr_b16 v[138:139], v214 offset:19456
    v_mfma_f32_16x16x32_bf16 v[76:79], v[176:179], a[204:207], v[76:79]
    s_waitcnt lgkmcnt(15)
    v_mfma_f32_16x16x32_bf16 v[100:103], v[180:183], a[204:207], v[100:103]
    ds_read_b64_tr_b16 v[140:141], v202 offset:14336
    ds_read_b64_tr_b16 v[142:143], v202 offset:16384
    v_mfma_f32_16x16x32_bf16 v[80:83], v[180:183], a[200:203], v[80:83]
    buffer_load_dwordx4 a[228:231], v17, s[8:11], s4 offen offset:0 sc1
    v_mfma_f32_16x16x32_bf16 v[84:87], v[184:187], a[200:203], v[84:87]
    ds_read_b64_tr_b16 v[144:145], v205 offset:14336
    ds_read_b64_tr_b16 v[146:147], v205 offset:16384
    v_mfma_f32_16x16x32_bf16 v[104:107], v[184:187], a[204:207], v[104:107]
    s_waitcnt lgkmcnt(14)
    v_mfma_f32_16x16x32_bf16 v[108:111], v[188:191], a[204:207], v[108:111]
    ds_read_b64_tr_b16 v[148:149], v208 offset:14336
    ds_read_b64_tr_b16 v[150:151], v208 offset:16384
    v_mfma_f32_16x16x32_bf16 v[88:91], v[188:191], a[200:203], v[88:91]
    buffer_load_dwordx4 a[232:235], v16, s[8:11], s4 offen offset:1024 sc1
    v_mfma_f32_16x16x32_bf16 v[92:95], v[192:195], a[200:203], v[92:95]
    ds_read_b64_tr_b16 v[152:153], v211 offset:14336
    ds_read_b64_tr_b16 v[154:155], v211 offset:16384
    v_mfma_f32_16x16x32_bf16 v[112:115], v[192:195], a[204:207], v[112:115]
    buffer_load_dwordx4 a[236:239], v17, s[8:11], s4 offen offset:1024 sc1
    v_mfma_f32_16x16x32_bf16 v[116:119], v[196:199], a[204:207], v[116:119]
    ds_read_b64_tr_b16 v[156:157], v217 offset:18432
    ds_read_b64_tr_b16 v[158:159], v217 offset:19456
    v_mfma_f32_16x16x32_bf16 v[96:99], v[196:199], a[200:203], v[96:99]
    s_waitcnt lgkmcnt(15)
    v_mfma_f32_16x16x32_bf16 v[40:43], v[120:123], a[208:211], v[40:43]
    ds_read_b64_tr_b16 v[160:161], v202 offset:20480
    ds_read_b64_tr_b16 v[162:163], v202 offset:22528
    v_mfma_f32_16x16x32_bf16 v[60:63], v[120:123], a[212:215], v[60:63]
    buffer_load_dwordx4 a[240:243], v16, s[8:11], s4 offen offset:2048 sc1
    v_mfma_f32_16x16x32_bf16 v[64:67], v[124:127], a[212:215], v[64:67]
    ds_read_b64_tr_b16 v[164:165], v205 offset:20480
    ds_read_b64_tr_b16 v[166:167], v205 offset:22528
    v_mfma_f32_16x16x32_bf16 v[44:47], v[124:127], a[208:211], v[44:47]
    s_waitcnt lgkmcnt(14)
    v_mfma_f32_16x16x32_bf16 v[48:51], v[128:131], a[208:211], v[48:51]
    ds_read_b64_tr_b16 v[168:169], v208 offset:20480
    ds_read_b64_tr_b16 v[170:171], v208 offset:22528
    v_mfma_f32_16x16x32_bf16 v[68:71], v[128:131], a[212:215], v[68:71]
    buffer_load_dwordx4 a[244:247], v17, s[8:11], s4 offen offset:2048 sc1
    v_mfma_f32_16x16x32_bf16 v[72:75], v[132:135], a[212:215], v[72:75]
    ds_read_b64_tr_b16 v[172:173], v211 offset:20480
    ds_read_b64_tr_b16 v[174:175], v211 offset:22528
    v_mfma_f32_16x16x32_bf16 v[52:55], v[132:135], a[208:211], v[52:55]
    buffer_load_dwordx4 a[248:251], v16, s[8:11], s4 offen offset:3072 sc1
    v_mfma_f32_16x16x32_bf16 v[56:59], v[136:139], a[208:211], v[56:59]
    ds_read_b64_tr_b16 v[176:177], v214 offset:28672
    ds_read_b64_tr_b16 v[178:179], v214 offset:29696
    v_mfma_f32_16x16x32_bf16 v[76:79], v[136:139], a[212:215], v[76:79]
    s_waitcnt lgkmcnt(15)
    v_mfma_f32_16x16x32_bf16 v[100:103], v[140:143], a[212:215], v[100:103]
    ds_read_b64_tr_b16 v[180:181], v202 offset:24576
    ds_read_b64_tr_b16 v[182:183], v202 offset:26624
    v_mfma_f32_16x16x32_bf16 v[80:83], v[140:143], a[208:211], v[80:83]
    buffer_load_dwordx4 a[252:255], v17, s[8:11], s4 offen offset:3072 sc1
    v_mfma_f32_16x16x32_bf16 v[84:87], v[144:147], a[208:211], v[84:87]
    ds_read_b64_tr_b16 v[184:185], v205 offset:24576
    ds_read_b64_tr_b16 v[186:187], v205 offset:26624
    v_mfma_f32_16x16x32_bf16 v[104:107], v[144:147], a[212:215], v[104:107]
    s_waitcnt lgkmcnt(14)
    v_mfma_f32_16x16x32_bf16 v[108:111], v[148:151], a[212:215], v[108:111]
    ds_read_b64_tr_b16 v[188:189], v208 offset:24576
    ds_read_b64_tr_b16 v[190:191], v208 offset:26624
    v_mfma_f32_16x16x32_bf16 v[88:91], v[148:151], a[208:211], v[88:91]
    v_mfma_f32_16x16x32_bf16 v[92:95], v[152:155], a[208:211], v[92:95]
    ds_read_b64_tr_b16 v[192:193], v211 offset:24576
    ds_read_b64_tr_b16 v[194:195], v211 offset:26624
    v_mfma_f32_16x16x32_bf16 v[112:115], v[152:155], a[212:215], v[112:115]
    v_mfma_f32_16x16x32_bf16 v[116:119], v[156:159], a[212:215], v[116:119]
    ds_read_b64_tr_b16 v[196:197], v217 offset:28672
    ds_read_b64_tr_b16 v[198:199], v217 offset:29696
    v_mfma_f32_16x16x32_bf16 v[96:99], v[156:159], a[208:211], v[96:99]
    s_waitcnt lgkmcnt(15)
    v_mfma_f32_16x16x32_bf16 v[40:43], v[160:163], a[216:219], v[40:43]
    v_mfma_f32_16x16x32_bf16 v[60:63], v[160:163], a[220:223], v[60:63]
    v_mfma_f32_16x16x32_bf16 v[64:67], v[164:167], a[220:223], v[64:67]
    v_mfma_f32_16x16x32_bf16 v[44:47], v[164:167], a[216:219], v[44:47]
    s_waitcnt vmcnt(36) lgkmcnt(0)
    s_barrier
    v_mfma_f32_16x16x32_bf16 v[48:51], v[168:171], a[216:219], v[48:51]
    ds_read_b64_tr_b16 v[120:121], v202 offset:30720
    ds_read_b64_tr_b16 v[122:123], v202 offset:32768
    v_mfma_f32_16x16x32_bf16 v[68:71], v[168:171], a[220:223], v[68:71]
    ds_read_b64_tr_b16 v[124:125], v205 offset:30720
    ds_read_b64_tr_b16 v[126:127], v205 offset:32768
    v_mfma_f32_16x16x32_bf16 v[72:75], v[172:175], a[220:223], v[72:75]
    s_add_u32 s44, s87, 163840
    s_add_u32 m0, s95, 0
    v_mfma_f32_16x16x32_bf16 v[52:55], v[172:175], a[216:219], v[52:55]
    ds_read_b64_tr_b16 v[128:129], v208 offset:30720
    ds_read_b64_tr_b16 v[130:131], v208 offset:32768
    v_mfma_f32_16x16x32_bf16 v[56:59], v[176:179], a[216:219], v[56:59]
    ds_read_b64_tr_b16 v[132:133], v211 offset:30720
    ds_read_b64_tr_b16 v[134:135], v211 offset:32768
    v_mfma_f32_16x16x32_bf16 v[76:79], v[176:179], a[220:223], v[76:79]
    v_mfma_f32_16x16x32_bf16 v[100:103], v[180:183], a[220:223], v[100:103]
    ds_read_b64_tr_b16 v[136:137], v214 offset:38912
    ds_read_b64_tr_b16 v[138:139], v214 offset:39936
    v_mfma_f32_16x16x32_bf16 v[80:83], v[180:183], a[216:219], v[80:83]
    ds_read_b64_tr_b16 v[140:141], v202 offset:34816
    ds_read_b64_tr_b16 v[142:143], v202 offset:36864
    v_mfma_f32_16x16x32_bf16 v[84:87], v[184:187], a[216:219], v[84:87]
    buffer_load_dwordx4 v18, s[12:15], s44 offen offset:0 lds
    v_mfma_f32_16x16x32_bf16 v[104:107], v[184:187], a[220:223], v[104:107]
    ds_read_b64_tr_b16 v[144:145], v205 offset:34816
    ds_read_b64_tr_b16 v[146:147], v205 offset:36864
    v_mfma_f32_16x16x32_bf16 v[108:111], v[188:191], a[220:223], v[108:111]
    ds_read_b64_tr_b16 v[148:149], v208 offset:34816
    ds_read_b64_tr_b16 v[150:151], v208 offset:36864
    v_mfma_f32_16x16x32_bf16 v[88:91], v[188:191], a[216:219], v[88:91]
    buffer_load_dwordx4 v19, s[12:15], s44 offen offset:1024 lds
    v_mfma_f32_16x16x32_bf16 v[92:95], v[192:195], a[216:219], v[92:95]
    ds_read_b64_tr_b16 v[152:153], v211 offset:34816
    ds_read_b64_tr_b16 v[154:155], v211 offset:36864
    v_mfma_f32_16x16x32_bf16 v[112:115], v[192:195], a[220:223], v[112:115]
    ds_read_b64_tr_b16 v[156:157], v217 offset:38912
    ds_read_b64_tr_b16 v[158:159], v217 offset:39936
    v_mfma_f32_16x16x32_bf16 v[116:119], v[196:199], a[220:223], v[116:119]
    buffer_load_dwordx4 v20, s[12:15], s44 offen offset:2048 lds
    v_mfma_f32_16x16x32_bf16 v[96:99], v[196:199], a[216:219], v[96:99]
    s_waitcnt lgkmcnt(15)
    v_mfma_f32_16x16x32_bf16 v[40:43], v[120:123], a[64:67], v[40:43]
    ds_read_b64_tr_b16 v[160:161], v202 offset:40960
    ds_read_b64_tr_b16 v[162:163], v202 offset:43008
    v_mfma_f32_16x16x32_bf16 v[60:63], v[120:123], a[68:71], v[60:63]
    buffer_load_dwordx4 v21, s[12:15], s44 offen offset:3072 lds
    s_add_u32 m0, s95, 8192
    v_mfma_f32_16x16x32_bf16 v[64:67], v[124:127], a[68:71], v[64:67]
    ds_read_b64_tr_b16 v[164:165], v205 offset:40960
    ds_read_b64_tr_b16 v[166:167], v205 offset:43008
    v_mfma_f32_16x16x32_bf16 v[44:47], v[124:127], a[64:67], v[44:47]
    s_waitcnt lgkmcnt(14)
    v_mfma_f32_16x16x32_bf16 v[48:51], v[128:131], a[64:67], v[48:51]
    ds_read_b64_tr_b16 v[168:169], v208 offset:40960
    ds_read_b64_tr_b16 v[170:171], v208 offset:43008
    v_mfma_f32_16x16x32_bf16 v[68:71], v[128:131], a[68:71], v[68:71]
    buffer_load_dwordx4 v22, s[12:15], s44 offen offset:0 lds
    v_mfma_f32_16x16x32_bf16 v[72:75], v[132:135], a[68:71], v[72:75]
    ds_read_b64_tr_b16 v[172:173], v211 offset:40960
    ds_read_b64_tr_b16 v[174:175], v211 offset:43008
    v_mfma_f32_16x16x32_bf16 v[52:55], v[132:135], a[64:67], v[52:55]
    s_add_u32 s44, s87, 163840
    s_add_u32 m0, s95, 4096
    v_mfma_f32_16x16x32_bf16 v[56:59], v[136:139], a[64:67], v[56:59]
    ds_read_b64_tr_b16 v[176:177], v214 offset:49152
    ds_read_b64_tr_b16 v[178:179], v214 offset:50176
    v_mfma_f32_16x16x32_bf16 v[76:79], v[136:139], a[68:71], v[76:79]
    s_waitcnt lgkmcnt(15)
    v_mfma_f32_16x16x32_bf16 v[100:103], v[140:143], a[68:71], v[100:103]
    ds_read_b64_tr_b16 v[180:181], v202 offset:45056
    ds_read_b64_tr_b16 v[182:183], v202 offset:47104
    v_mfma_f32_16x16x32_bf16 v[80:83], v[140:143], a[64:67], v[80:83]
    buffer_load_dwordx4 v23, s[12:15], s44 offen offset:0 lds
    v_mfma_f32_16x16x32_bf16 v[84:87], v[144:147], a[64:67], v[84:87]
    ds_read_b64_tr_b16 v[184:185], v205 offset:45056
    ds_read_b64_tr_b16 v[186:187], v205 offset:47104
    v_mfma_f32_16x16x32_bf16 v[104:107], v[144:147], a[68:71], v[104:107]
    s_waitcnt lgkmcnt(14)
    v_mfma_f32_16x16x32_bf16 v[108:111], v[148:151], a[68:71], v[108:111]
    ds_read_b64_tr_b16 v[188:189], v208 offset:45056
    ds_read_b64_tr_b16 v[190:191], v208 offset:47104
    v_mfma_f32_16x16x32_bf16 v[88:91], v[148:151], a[64:67], v[88:91]
    buffer_load_dwordx4 v24, s[12:15], s44 offen offset:1024 lds
    v_mfma_f32_16x16x32_bf16 v[92:95], v[152:155], a[64:67], v[92:95]
    ds_read_b64_tr_b16 v[192:193], v211 offset:45056
    ds_read_b64_tr_b16 v[194:195], v211 offset:47104
    v_mfma_f32_16x16x32_bf16 v[112:115], v[152:155], a[68:71], v[112:115]
    buffer_load_dwordx4 v25, s[12:15], s44 offen offset:2048 lds
    v_mfma_f32_16x16x32_bf16 v[116:119], v[156:159], a[68:71], v[116:119]
    ds_read_b64_tr_b16 v[196:197], v217 offset:49152
    ds_read_b64_tr_b16 v[198:199], v217 offset:50176
    v_mfma_f32_16x16x32_bf16 v[96:99], v[156:159], a[64:67], v[96:99]
    s_waitcnt lgkmcnt(15)
    v_mfma_f32_16x16x32_bf16 v[40:43], v[160:163], a[72:75], v[40:43]
    ds_read_b64_tr_b16 v[120:121], v202 offset:51200
    ds_read_b64_tr_b16 v[122:123], v202 offset:53248
    v_mfma_f32_16x16x32_bf16 v[60:63], v[160:163], a[76:79], v[60:63]
    buffer_load_dwordx4 v26, s[12:15], s44 offen offset:3072 lds
    s_add_u32 m0, s95, 8192
    v_mfma_f32_16x16x32_bf16 v[64:67], v[164:167], a[76:79], v[64:67]
    ds_read_b64_tr_b16 v[124:125], v205 offset:51200
    ds_read_b64_tr_b16 v[126:127], v205 offset:53248
    v_mfma_f32_16x16x32_bf16 v[44:47], v[164:167], a[72:75], v[44:47]
    s_waitcnt lgkmcnt(14)
    v_mfma_f32_16x16x32_bf16 v[48:51], v[168:171], a[72:75], v[48:51]
    ds_read_b64_tr_b16 v[128:129], v208 offset:51200
    ds_read_b64_tr_b16 v[130:131], v208 offset:53248
    v_mfma_f32_16x16x32_bf16 v[68:71], v[168:171], a[76:79], v[68:71]
    buffer_load_dwordx4 v27, s[12:15], s44 offen offset:1024 lds
    v_mfma_f32_16x16x32_bf16 v[72:75], v[172:175], a[76:79], v[72:75]
    ds_read_b64_tr_b16 v[132:133], v211 offset:51200
    ds_read_b64_tr_b16 v[134:135], v211 offset:53248
    v_mfma_f32_16x16x32_bf16 v[52:55], v[172:175], a[72:75], v[52:55]
    s_xor_b32 s4, s34, 28672
    buffer_load_dwordx4 a[0:3], v16, s[8:11], s4 offen offset:0 sc1
    v_mfma_f32_16x16x32_bf16 v[56:59], v[176:179], a[72:75], v[56:59]
    ds_read_b64_tr_b16 v[136:137], v214 offset:59392
    ds_read_b64_tr_b16 v[138:139], v214 offset:60416
    v_mfma_f32_16x16x32_bf16 v[76:79], v[176:179], a[76:79], v[76:79]
    s_waitcnt lgkmcnt(15)
    v_mfma_f32_16x16x32_bf16 v[100:103], v[180:183], a[76:79], v[100:103]
    ds_read_b64_tr_b16 v[140:141], v202 offset:55296
    ds_read_b64_tr_b16 v[142:143], v202 offset:57344
    v_mfma_f32_16x16x32_bf16 v[80:83], v[180:183], a[72:75], v[80:83]
    buffer_load_dwordx4 a[4:7], v17, s[8:11], s4 offen offset:0 sc1
    v_mfma_f32_16x16x32_bf16 v[84:87], v[184:187], a[72:75], v[84:87]
    ds_read_b64_tr_b16 v[144:145], v205 offset:55296
    ds_read_b64_tr_b16 v[146:147], v205 offset:57344
    v_mfma_f32_16x16x32_bf16 v[104:107], v[184:187], a[76:79], v[104:107]
    s_waitcnt lgkmcnt(14)
    v_mfma_f32_16x16x32_bf16 v[108:111], v[188:191], a[76:79], v[108:111]
    ds_read_b64_tr_b16 v[148:149], v208 offset:55296
    ds_read_b64_tr_b16 v[150:151], v208 offset:57344
    v_mfma_f32_16x16x32_bf16 v[88:91], v[188:191], a[72:75], v[88:91]
    buffer_load_dwordx4 a[8:11], v16, s[8:11], s4 offen offset:1024 sc1
    v_mfma_f32_16x16x32_bf16 v[92:95], v[192:195], a[72:75], v[92:95]
    ds_read_b64_tr_b16 v[152:153], v211 offset:55296
    ds_read_b64_tr_b16 v[154:155], v211 offset:57344
    v_mfma_f32_16x16x32_bf16 v[112:115], v[192:195], a[76:79], v[112:115]
    buffer_load_dwordx4 a[12:15], v17, s[8:11], s4 offen offset:1024 sc1
    v_mfma_f32_16x16x32_bf16 v[116:119], v[196:199], a[76:79], v[116:119]
    ds_read_b64_tr_b16 v[156:157], v217 offset:59392
    ds_read_b64_tr_b16 v[158:159], v217 offset:60416
    v_mfma_f32_16x16x32_bf16 v[96:99], v[196:199], a[72:75], v[96:99]
    s_waitcnt lgkmcnt(15)
    v_mfma_f32_16x16x32_bf16 v[40:43], v[120:123], a[80:83], v[40:43]
    ds_read_b64_tr_b16 v[160:161], v200 offset:0
    ds_read_b64_tr_b16 v[162:163], v200 offset:2048
    v_mfma_f32_16x16x32_bf16 v[60:63], v[120:123], a[84:87], v[60:63]
    buffer_load_dwordx4 a[16:19], v16, s[8:11], s4 offen offset:2048 sc1
    v_mfma_f32_16x16x32_bf16 v[64:67], v[124:127], a[84:87], v[64:67]
    ds_read_b64_tr_b16 v[164:165], v203 offset:0
    ds_read_b64_tr_b16 v[166:167], v203 offset:2048
    v_mfma_f32_16x16x32_bf16 v[44:47], v[124:127], a[80:83], v[44:47]
    s_waitcnt lgkmcnt(14)
    v_mfma_f32_16x16x32_bf16 v[48:51], v[128:131], a[80:83], v[48:51]
    ds_read_b64_tr_b16 v[168:169], v206 offset:0
    ds_read_b64_tr_b16 v[170:171], v206 offset:2048
    v_mfma_f32_16x16x32_bf16 v[68:71], v[128:131], a[84:87], v[68:71]
    buffer_load_dwordx4 a[20:23], v17, s[8:11], s4 offen offset:2048 sc1
    v_mfma_f32_16x16x32_bf16 v[72:75], v[132:135], a[84:87], v[72:75]
    ds_read_b64_tr_b16 v[172:173], v209 offset:0
    ds_read_b64_tr_b16 v[174:175], v209 offset:2048
    v_mfma_f32_16x16x32_bf16 v[52:55], v[132:135], a[80:83], v[52:55]
    buffer_load_dwordx4 a[24:27], v16, s[8:11], s4 offen offset:3072 sc1
    v_mfma_f32_16x16x32_bf16 v[56:59], v[136:139], a[80:83], v[56:59]
    ds_read_b64_tr_b16 v[176:177], v212 offset:8192
    ds_read_b64_tr_b16 v[178:179], v212 offset:9216
    v_mfma_f32_16x16x32_bf16 v[76:79], v[136:139], a[84:87], v[76:79]
    s_waitcnt lgkmcnt(15)
    v_mfma_f32_16x16x32_bf16 v[100:103], v[140:143], a[84:87], v[100:103]
    ds_read_b64_tr_b16 v[180:181], v200 offset:4096
    ds_read_b64_tr_b16 v[182:183], v200 offset:6144
    v_mfma_f32_16x16x32_bf16 v[80:83], v[140:143], a[80:83], v[80:83]
    buffer_load_dwordx4 a[28:31], v17, s[8:11], s4 offen offset:3072 sc1
    v_mfma_f32_16x16x32_bf16 v[84:87], v[144:147], a[80:83], v[84:87]
    ds_read_b64_tr_b16 v[184:185], v203 offset:4096
    ds_read_b64_tr_b16 v[186:187], v203 offset:6144
    v_mfma_f32_16x16x32_bf16 v[104:107], v[144:147], a[84:87], v[104:107]
    s_waitcnt lgkmcnt(14)
    v_mfma_f32_16x16x32_bf16 v[108:111], v[148:151], a[84:87], v[108:111]
    ds_read_b64_tr_b16 v[188:189], v206 offset:4096
    ds_read_b64_tr_b16 v[190:191], v206 offset:6144
    v_mfma_f32_16x16x32_bf16 v[88:91], v[148:151], a[80:83], v[88:91]
    v_mfma_f32_16x16x32_bf16 v[92:95], v[152:155], a[80:83], v[92:95]
    ds_read_b64_tr_b16 v[192:193], v209 offset:4096
    ds_read_b64_tr_b16 v[194:195], v209 offset:6144
    v_mfma_f32_16x16x32_bf16 v[112:115], v[152:155], a[84:87], v[112:115]
    v_mfma_f32_16x16x32_bf16 v[116:119], v[156:159], a[84:87], v[116:119]
    ds_read_b64_tr_b16 v[196:197], v215 offset:8192
    ds_read_b64_tr_b16 v[198:199], v215 offset:9216
    v_mfma_f32_16x16x32_bf16 v[96:99], v[156:159], a[80:83], v[96:99]
    s_waitcnt lgkmcnt(15)
    v_mfma_f32_16x16x32_bf16 v[40:43], v[160:163], a[88:91], v[40:43]
    v_mfma_f32_16x16x32_bf16 v[60:63], v[160:163], a[92:95], v[60:63]
    v_mfma_f32_16x16x32_bf16 v[64:67], v[164:167], a[92:95], v[64:67]
    v_mfma_f32_16x16x32_bf16 v[44:47], v[164:167], a[88:91], v[44:47]
    s_waitcnt vmcnt(36) lgkmcnt(0)
    s_barrier
    v_mfma_f32_16x16x32_bf16 v[48:51], v[168:171], a[88:91], v[48:51]
    ds_read_b64_tr_b16 v[120:121], v200 offset:10240
    ds_read_b64_tr_b16 v[122:123], v200 offset:12288
    v_mfma_f32_16x16x32_bf16 v[68:71], v[168:171], a[92:95], v[68:71]
    ds_read_b64_tr_b16 v[124:125], v203 offset:10240
    ds_read_b64_tr_b16 v[126:127], v203 offset:12288
    v_mfma_f32_16x16x32_bf16 v[72:75], v[172:175], a[92:95], v[72:75]
    s_add_u32 s44, s88, 163840
    s_add_u32 m0, s92, 0
    v_mfma_f32_16x16x32_bf16 v[52:55], v[172:175], a[88:91], v[52:55]
    ds_read_b64_tr_b16 v[128:129], v206 offset:10240
    ds_read_b64_tr_b16 v[130:131], v206 offset:12288
    v_mfma_f32_16x16x32_bf16 v[56:59], v[176:179], a[88:91], v[56:59]
    ds_read_b64_tr_b16 v[132:133], v209 offset:10240
    ds_read_b64_tr_b16 v[134:135], v209 offset:12288
    v_mfma_f32_16x16x32_bf16 v[76:79], v[176:179], a[92:95], v[76:79]
    v_mfma_f32_16x16x32_bf16 v[100:103], v[180:183], a[92:95], v[100:103]
    ds_read_b64_tr_b16 v[136:137], v212 offset:18432
    ds_read_b64_tr_b16 v[138:139], v212 offset:19456
    v_mfma_f32_16x16x32_bf16 v[80:83], v[180:183], a[88:91], v[80:83]
    ds_read_b64_tr_b16 v[140:141], v200 offset:14336
    ds_read_b64_tr_b16 v[142:143], v200 offset:16384
    v_mfma_f32_16x16x32_bf16 v[84:87], v[184:187], a[88:91], v[84:87]
    buffer_load_dwordx4 v18, s[12:15], s44 offen offset:0 lds
    v_mfma_f32_16x16x32_bf16 v[104:107], v[184:187], a[92:95], v[104:107]
    ds_read_b64_tr_b16 v[144:145], v203 offset:14336
    ds_read_b64_tr_b16 v[146:147], v203 offset:16384
    v_mfma_f32_16x16x32_bf16 v[108:111], v[188:191], a[92:95], v[108:111]
    ds_read_b64_tr_b16 v[148:149], v206 offset:14336
    ds_read_b64_tr_b16 v[150:151], v206 offset:16384
    v_mfma_f32_16x16x32_bf16 v[88:91], v[188:191], a[88:91], v[88:91]
    buffer_load_dwordx4 v19, s[12:15], s44 offen offset:1024 lds
    v_mfma_f32_16x16x32_bf16 v[92:95], v[192:195], a[88:91], v[92:95]
    ds_read_b64_tr_b16 v[152:153], v209 offset:14336
    ds_read_b64_tr_b16 v[154:155], v209 offset:16384
    v_mfma_f32_16x16x32_bf16 v[112:115], v[192:195], a[92:95], v[112:115]
    ds_read_b64_tr_b16 v[156:157], v215 offset:18432
    ds_read_b64_tr_b16 v[158:159], v215 offset:19456
    v_mfma_f32_16x16x32_bf16 v[116:119], v[196:199], a[92:95], v[116:119]
    buffer_load_dwordx4 v20, s[12:15], s44 offen offset:2048 lds
    v_mfma_f32_16x16x32_bf16 v[96:99], v[196:199], a[88:91], v[96:99]
    s_waitcnt lgkmcnt(15)
    v_mfma_f32_16x16x32_bf16 v[40:43], v[120:123], a[96:99], v[40:43]
    ds_read_b64_tr_b16 v[160:161], v200 offset:20480
    ds_read_b64_tr_b16 v[162:163], v200 offset:22528
    v_mfma_f32_16x16x32_bf16 v[60:63], v[120:123], a[100:103], v[60:63]
    buffer_load_dwordx4 v21, s[12:15], s44 offen offset:3072 lds
    s_add_u32 m0, s92, 8192
    v_mfma_f32_16x16x32_bf16 v[64:67], v[124:127], a[100:103], v[64:67]
    ds_read_b64_tr_b16 v[164:165], v203 offset:20480
    ds_read_b64_tr_b16 v[166:167], v203 offset:22528
    v_mfma_f32_16x16x32_bf16 v[44:47], v[124:127], a[96:99], v[44:47]
    s_waitcnt lgkmcnt(14)
    v_mfma_f32_16x16x32_bf16 v[48:51], v[128:131], a[96:99], v[48:51]
    ds_read_b64_tr_b16 v[168:169], v206 offset:20480
    ds_read_b64_tr_b16 v[170:171], v206 offset:22528
    v_mfma_f32_16x16x32_bf16 v[68:71], v[128:131], a[100:103], v[68:71]
    buffer_load_dwordx4 v22, s[12:15], s44 offen offset:0 lds
    v_mfma_f32_16x16x32_bf16 v[72:75], v[132:135], a[100:103], v[72:75]
    ds_read_b64_tr_b16 v[172:173], v209 offset:20480
    ds_read_b64_tr_b16 v[174:175], v209 offset:22528
    v_mfma_f32_16x16x32_bf16 v[52:55], v[132:135], a[96:99], v[52:55]
    s_add_u32 s44, s88, 163840
    s_add_u32 m0, s92, 4096
    v_mfma_f32_16x16x32_bf16 v[56:59], v[136:139], a[96:99], v[56:59]
    ds_read_b64_tr_b16 v[176:177], v212 offset:28672
    ds_read_b64_tr_b16 v[178:179], v212 offset:29696
    v_mfma_f32_16x16x32_bf16 v[76:79], v[136:139], a[100:103], v[76:79]
    s_waitcnt lgkmcnt(15)
    v_mfma_f32_16x16x32_bf16 v[100:103], v[140:143], a[100:103], v[100:103]
    ds_read_b64_tr_b16 v[180:181], v200 offset:24576
    ds_read_b64_tr_b16 v[182:183], v200 offset:26624
    v_mfma_f32_16x16x32_bf16 v[80:83], v[140:143], a[96:99], v[80:83]
    buffer_load_dwordx4 v23, s[12:15], s44 offen offset:0 lds
    v_mfma_f32_16x16x32_bf16 v[84:87], v[144:147], a[96:99], v[84:87]
    ds_read_b64_tr_b16 v[184:185], v203 offset:24576
    ds_read_b64_tr_b16 v[186:187], v203 offset:26624
    v_mfma_f32_16x16x32_bf16 v[104:107], v[144:147], a[100:103], v[104:107]
    s_waitcnt lgkmcnt(14)
    v_mfma_f32_16x16x32_bf16 v[108:111], v[148:151], a[100:103], v[108:111]
    ds_read_b64_tr_b16 v[188:189], v206 offset:24576
    ds_read_b64_tr_b16 v[190:191], v206 offset:26624
    v_mfma_f32_16x16x32_bf16 v[88:91], v[148:151], a[96:99], v[88:91]
    buffer_load_dwordx4 v24, s[12:15], s44 offen offset:1024 lds
    v_mfma_f32_16x16x32_bf16 v[92:95], v[152:155], a[96:99], v[92:95]
    ds_read_b64_tr_b16 v[192:193], v209 offset:24576
    ds_read_b64_tr_b16 v[194:195], v209 offset:26624
    v_mfma_f32_16x16x32_bf16 v[112:115], v[152:155], a[100:103], v[112:115]
    buffer_load_dwordx4 v25, s[12:15], s44 offen offset:2048 lds
    v_mfma_f32_16x16x32_bf16 v[116:119], v[156:159], a[100:103], v[116:119]
    ds_read_b64_tr_b16 v[196:197], v215 offset:28672
    ds_read_b64_tr_b16 v[198:199], v215 offset:29696
    v_mfma_f32_16x16x32_bf16 v[96:99], v[156:159], a[96:99], v[96:99]
    s_waitcnt lgkmcnt(15)
    v_mfma_f32_16x16x32_bf16 v[40:43], v[160:163], a[104:107], v[40:43]
    ds_read_b64_tr_b16 v[120:121], v201 offset:30720
    ds_read_b64_tr_b16 v[122:123], v201 offset:32768
    v_mfma_f32_16x16x32_bf16 v[60:63], v[160:163], a[108:111], v[60:63]
    buffer_load_dwordx4 v26, s[12:15], s44 offen offset:3072 lds
    s_add_u32 m0, s92, 8192
    v_mfma_f32_16x16x32_bf16 v[64:67], v[164:167], a[108:111], v[64:67]
    ds_read_b64_tr_b16 v[124:125], v204 offset:30720
    ds_read_b64_tr_b16 v[126:127], v204 offset:32768
    v_mfma_f32_16x16x32_bf16 v[44:47], v[164:167], a[104:107], v[44:47]
    s_waitcnt lgkmcnt(14)
    v_mfma_f32_16x16x32_bf16 v[48:51], v[168:171], a[104:107], v[48:51]
    ds_read_b64_tr_b16 v[128:129], v207 offset:30720
    ds_read_b64_tr_b16 v[130:131], v207 offset:32768
    v_mfma_f32_16x16x32_bf16 v[68:71], v[168:171], a[108:111], v[68:71]
    buffer_load_dwordx4 v27, s[12:15], s44 offen offset:1024 lds
    v_mfma_f32_16x16x32_bf16 v[72:75], v[172:175], a[108:111], v[72:75]
    ds_read_b64_tr_b16 v[132:133], v210 offset:30720
    ds_read_b64_tr_b16 v[134:135], v210 offset:32768
    v_mfma_f32_16x16x32_bf16 v[52:55], v[172:175], a[104:107], v[52:55]
    s_xor_b32 s4, s34, 36864
    buffer_load_dwordx4 a[32:35], v16, s[8:11], s4 offen offset:0 sc1
    v_mfma_f32_16x16x32_bf16 v[56:59], v[176:179], a[104:107], v[56:59]
    ds_read_b64_tr_b16 v[136:137], v213 offset:38912
    ds_read_b64_tr_b16 v[138:139], v213 offset:39936
    v_mfma_f32_16x16x32_bf16 v[76:79], v[176:179], a[108:111], v[76:79]
    s_waitcnt lgkmcnt(15)
    v_mfma_f32_16x16x32_bf16 v[100:103], v[180:183], a[108:111], v[100:103]
    ds_read_b64_tr_b16 v[140:141], v201 offset:34816
    ds_read_b64_tr_b16 v[142:143], v201 offset:36864
    v_mfma_f32_16x16x32_bf16 v[80:83], v[180:183], a[104:107], v[80:83]
    buffer_load_dwordx4 a[36:39], v17, s[8:11], s4 offen offset:0 sc1
    v_mfma_f32_16x16x32_bf16 v[84:87], v[184:187], a[104:107], v[84:87]
    ds_read_b64_tr_b16 v[144:145], v204 offset:34816
    ds_read_b64_tr_b16 v[146:147], v204 offset:36864
    v_mfma_f32_16x16x32_bf16 v[104:107], v[184:187], a[108:111], v[104:107]
    s_waitcnt lgkmcnt(14)
    v_mfma_f32_16x16x32_bf16 v[108:111], v[188:191], a[108:111], v[108:111]
    ds_read_b64_tr_b16 v[148:149], v207 offset:34816
    ds_read_b64_tr_b16 v[150:151], v207 offset:36864
    v_mfma_f32_16x16x32_bf16 v[88:91], v[188:191], a[104:107], v[88:91]
    buffer_load_dwordx4 a[40:43], v16, s[8:11], s4 offen offset:1024 sc1
    v_mfma_f32_16x16x32_bf16 v[92:95], v[192:195], a[104:107], v[92:95]
    ds_read_b64_tr_b16 v[152:153], v210 offset:34816
    ds_read_b64_tr_b16 v[154:155], v210 offset:36864
    v_mfma_f32_16x16x32_bf16 v[112:115], v[192:195], a[108:111], v[112:115]
    buffer_load_dwordx4 a[44:47], v17, s[8:11], s4 offen offset:1024 sc1
    v_mfma_f32_16x16x32_bf16 v[116:119], v[196:199], a[108:111], v[116:119]
    ds_read_b64_tr_b16 v[156:157], v216 offset:38912
    ds_read_b64_tr_b16 v[158:159], v216 offset:39936
    v_mfma_f32_16x16x32_bf16 v[96:99], v[196:199], a[104:107], v[96:99]
    s_waitcnt lgkmcnt(15)
    v_mfma_f32_16x16x32_bf16 v[40:43], v[120:123], a[112:115], v[40:43]
    ds_read_b64_tr_b16 v[160:161], v201 offset:40960
    ds_read_b64_tr_b16 v[162:163], v201 offset:43008
    v_mfma_f32_16x16x32_bf16 v[60:63], v[120:123], a[116:119], v[60:63]
    buffer_load_dwordx4 a[48:51], v16, s[8:11], s4 offen offset:2048 sc1
    v_mfma_f32_16x16x32_bf16 v[64:67], v[124:127], a[116:119], v[64:67]
    ds_read_b64_tr_b16 v[164:165], v204 offset:40960
    ds_read_b64_tr_b16 v[166:167], v204 offset:43008
    v_mfma_f32_16x16x32_bf16 v[44:47], v[124:127], a[112:115], v[44:47]
    s_waitcnt lgkmcnt(14)
    v_mfma_f32_16x16x32_bf16 v[48:51], v[128:131], a[112:115], v[48:51]
    ds_read_b64_tr_b16 v[168:169], v207 offset:40960
    ds_read_b64_tr_b16 v[170:171], v207 offset:43008
    v_mfma_f32_16x16x32_bf16 v[68:71], v[128:131], a[116:119], v[68:71]
    buffer_load_dwordx4 a[52:55], v17, s[8:11], s4 offen offset:2048 sc1
    v_mfma_f32_16x16x32_bf16 v[72:75], v[132:135], a[116:119], v[72:75]
    ds_read_b64_tr_b16 v[172:173], v210 offset:40960
    ds_read_b64_tr_b16 v[174:175], v210 offset:43008
    v_mfma_f32_16x16x32_bf16 v[52:55], v[132:135], a[112:115], v[52:55]
    buffer_load_dwordx4 a[56:59], v16, s[8:11], s4 offen offset:3072 sc1
    v_mfma_f32_16x16x32_bf16 v[56:59], v[136:139], a[112:115], v[56:59]
    ds_read_b64_tr_b16 v[176:177], v213 offset:49152
    ds_read_b64_tr_b16 v[178:179], v213 offset:50176
    v_mfma_f32_16x16x32_bf16 v[76:79], v[136:139], a[116:119], v[76:79]
    s_waitcnt lgkmcnt(15)
    v_mfma_f32_16x16x32_bf16 v[100:103], v[140:143], a[116:119], v[100:103]
    ds_read_b64_tr_b16 v[180:181], v201 offset:45056
    ds_read_b64_tr_b16 v[182:183], v201 offset:47104
    v_mfma_f32_16x16x32_bf16 v[80:83], v[140:143], a[112:115], v[80:83]
    buffer_load_dwordx4 a[60:63], v17, s[8:11], s4 offen offset:3072 sc1
    v_mfma_f32_16x16x32_bf16 v[84:87], v[144:147], a[112:115], v[84:87]
    ds_read_b64_tr_b16 v[184:185], v204 offset:45056
    ds_read_b64_tr_b16 v[186:187], v204 offset:47104
    v_mfma_f32_16x16x32_bf16 v[104:107], v[144:147], a[116:119], v[104:107]
    s_waitcnt lgkmcnt(14)
    v_mfma_f32_16x16x32_bf16 v[108:111], v[148:151], a[116:119], v[108:111]
    ds_read_b64_tr_b16 v[188:189], v207 offset:45056
    ds_read_b64_tr_b16 v[190:191], v207 offset:47104
    v_mfma_f32_16x16x32_bf16 v[88:91], v[148:151], a[112:115], v[88:91]
    v_mfma_f32_16x16x32_bf16 v[92:95], v[152:155], a[112:115], v[92:95]
    ds_read_b64_tr_b16 v[192:193], v210 offset:45056
    ds_read_b64_tr_b16 v[194:195], v210 offset:47104
    v_mfma_f32_16x16x32_bf16 v[112:115], v[152:155], a[116:119], v[112:115]
    v_mfma_f32_16x16x32_bf16 v[116:119], v[156:159], a[116:119], v[116:119]
    ds_read_b64_tr_b16 v[196:197], v216 offset:49152
    ds_read_b64_tr_b16 v[198:199], v216 offset:50176
    v_mfma_f32_16x16x32_bf16 v[96:99], v[156:159], a[112:115], v[96:99]
    s_waitcnt lgkmcnt(15)
    v_mfma_f32_16x16x32_bf16 v[40:43], v[160:163], a[120:123], v[40:43]
    v_mfma_f32_16x16x32_bf16 v[60:63], v[160:163], a[124:127], v[60:63]
    v_mfma_f32_16x16x32_bf16 v[64:67], v[164:167], a[124:127], v[64:67]
    v_mfma_f32_16x16x32_bf16 v[44:47], v[164:167], a[120:123], v[44:47]
    s_waitcnt vmcnt(36) lgkmcnt(0)
    s_barrier
    v_mfma_f32_16x16x32_bf16 v[48:51], v[168:171], a[120:123], v[48:51]
    ds_read_b64_tr_b16 v[120:121], v200 offset:30720
    ds_read_b64_tr_b16 v[122:123], v200 offset:32768
    v_mfma_f32_16x16x32_bf16 v[68:71], v[168:171], a[124:127], v[68:71]
    ds_read_b64_tr_b16 v[124:125], v203 offset:30720
    ds_read_b64_tr_b16 v[126:127], v203 offset:32768
    v_mfma_f32_16x16x32_bf16 v[72:75], v[172:175], a[124:127], v[72:75]
    s_add_u32 s44, s89, 163840
    s_add_u32 m0, s93, 0
    v_mfma_f32_16x16x32_bf16 v[52:55], v[172:175], a[120:123], v[52:55]
    ds_read_b64_tr_b16 v[128:129], v206 offset:30720
    ds_read_b64_tr_b16 v[130:131], v206 offset:32768
    v_mfma_f32_16x16x32_bf16 v[56:59], v[176:179], a[120:123], v[56:59]
    ds_read_b64_tr_b16 v[132:133], v209 offset:30720
    ds_read_b64_tr_b16 v[134:135], v209 offset:32768
    v_mfma_f32_16x16x32_bf16 v[76:79], v[176:179], a[124:127], v[76:79]
    v_mfma_f32_16x16x32_bf16 v[100:103], v[180:183], a[124:127], v[100:103]
    ds_read_b64_tr_b16 v[136:137], v212 offset:38912
    ds_read_b64_tr_b16 v[138:139], v212 offset:39936
    v_mfma_f32_16x16x32_bf16 v[80:83], v[180:183], a[120:123], v[80:83]
    ds_read_b64_tr_b16 v[140:141], v200 offset:34816
    ds_read_b64_tr_b16 v[142:143], v200 offset:36864
    v_mfma_f32_16x16x32_bf16 v[84:87], v[184:187], a[120:123], v[84:87]
    buffer_load_dwordx4 v18, s[12:15], s44 offen offset:0 lds
    v_mfma_f32_16x16x32_bf16 v[104:107], v[184:187], a[124:127], v[104:107]
    ds_read_b64_tr_b16 v[144:145], v203 offset:34816
    ds_read_b64_tr_b16 v[146:147], v203 offset:36864
    v_mfma_f32_16x16x32_bf16 v[108:111], v[188:191], a[124:127], v[108:111]
    ds_read_b64_tr_b16 v[148:149], v206 offset:34816
    ds_read_b64_tr_b16 v[150:151], v206 offset:36864
    v_mfma_f32_16x16x32_bf16 v[88:91], v[188:191], a[120:123], v[88:91]
    buffer_load_dwordx4 v19, s[12:15], s44 offen offset:1024 lds
    v_mfma_f32_16x16x32_bf16 v[92:95], v[192:195], a[120:123], v[92:95]
    ds_read_b64_tr_b16 v[152:153], v209 offset:34816
    ds_read_b64_tr_b16 v[154:155], v209 offset:36864
    v_mfma_f32_16x16x32_bf16 v[112:115], v[192:195], a[124:127], v[112:115]
    ds_read_b64_tr_b16 v[156:157], v215 offset:38912
    ds_read_b64_tr_b16 v[158:159], v215 offset:39936
    v_mfma_f32_16x16x32_bf16 v[116:119], v[196:199], a[124:127], v[116:119]
    buffer_load_dwordx4 v20, s[12:15], s44 offen offset:2048 lds
    v_mfma_f32_16x16x32_bf16 v[96:99], v[196:199], a[120:123], v[96:99]
    s_waitcnt lgkmcnt(15)
    v_mfma_f32_16x16x32_bf16 v[40:43], v[120:123], a[224:227], v[40:43]
    ds_read_b64_tr_b16 v[160:161], v202 offset:0
    ds_read_b64_tr_b16 v[162:163], v202 offset:2048
    v_mfma_f32_16x16x32_bf16 v[60:63], v[120:123], a[228:231], v[60:63]
    buffer_load_dwordx4 v21, s[12:15], s44 offen offset:3072 lds
    s_add_u32 m0, s93, 8192
    v_mfma_f32_16x16x32_bf16 v[64:67], v[124:127], a[228:231], v[64:67]
    ds_read_b64_tr_b16 v[164:165], v205 offset:0
    ds_read_b64_tr_b16 v[166:167], v205 offset:2048
    v_mfma_f32_16x16x32_bf16 v[44:47], v[124:127], a[224:227], v[44:47]
    s_waitcnt lgkmcnt(14)
    v_mfma_f32_16x16x32_bf16 v[48:51], v[128:131], a[224:227], v[48:51]
    ds_read_b64_tr_b16 v[168:169], v208 offset:0
    ds_read_b64_tr_b16 v[170:171], v208 offset:2048
    v_mfma_f32_16x16x32_bf16 v[68:71], v[128:131], a[228:231], v[68:71]
    buffer_load_dwordx4 v22, s[12:15], s44 offen offset:0 lds
    v_mfma_f32_16x16x32_bf16 v[72:75], v[132:135], a[228:231], v[72:75]
    ds_read_b64_tr_b16 v[172:173], v211 offset:0
    ds_read_b64_tr_b16 v[174:175], v211 offset:2048
    v_mfma_f32_16x16x32_bf16 v[52:55], v[132:135], a[224:227], v[52:55]
    s_add_u32 s44, s89, 163840
    s_add_u32 m0, s93, 4096
    v_mfma_f32_16x16x32_bf16 v[56:59], v[136:139], a[224:227], v[56:59]
    ds_read_b64_tr_b16 v[176:177], v214 offset:8192
    ds_read_b64_tr_b16 v[178:179], v214 offset:9216
    v_mfma_f32_16x16x32_bf16 v[76:79], v[136:139], a[228:231], v[76:79]
    s_waitcnt lgkmcnt(15)
    v_mfma_f32_16x16x32_bf16 v[100:103], v[140:143], a[228:231], v[100:103]
    ds_read_b64_tr_b16 v[180:181], v202 offset:4096
    ds_read_b64_tr_b16 v[182:183], v202 offset:6144
    v_mfma_f32_16x16x32_bf16 v[80:83], v[140:143], a[224:227], v[80:83]
    buffer_load_dwordx4 v23, s[12:15], s44 offen offset:0 lds
    v_mfma_f32_16x16x32_bf16 v[84:87], v[144:147], a[224:227], v[84:87]
    ds_read_b64_tr_b16 v[184:185], v205 offset:4096
    ds_read_b64_tr_b16 v[186:187], v205 offset:6144
    v_mfma_f32_16x16x32_bf16 v[104:107], v[144:147], a[228:231], v[104:107]
    s_waitcnt lgkmcnt(14)
    v_mfma_f32_16x16x32_bf16 v[108:111], v[148:151], a[228:231], v[108:111]
    ds_read_b64_tr_b16 v[188:189], v208 offset:4096
    ds_read_b64_tr_b16 v[190:191], v208 offset:6144
    v_mfma_f32_16x16x32_bf16 v[88:91], v[148:151], a[224:227], v[88:91]
    buffer_load_dwordx4 v24, s[12:15], s44 offen offset:1024 lds
    v_mfma_f32_16x16x32_bf16 v[92:95], v[152:155], a[224:227], v[92:95]
    ds_read_b64_tr_b16 v[192:193], v211 offset:4096
    ds_read_b64_tr_b16 v[194:195], v211 offset:6144
    v_mfma_f32_16x16x32_bf16 v[112:115], v[152:155], a[228:231], v[112:115]
    buffer_load_dwordx4 v25, s[12:15], s44 offen offset:2048 lds
    v_mfma_f32_16x16x32_bf16 v[116:119], v[156:159], a[228:231], v[116:119]
    ds_read_b64_tr_b16 v[196:197], v217 offset:8192
    ds_read_b64_tr_b16 v[198:199], v217 offset:9216
    v_mfma_f32_16x16x32_bf16 v[96:99], v[156:159], a[224:227], v[96:99]
    s_waitcnt lgkmcnt(15)
    v_mfma_f32_16x16x32_bf16 v[40:43], v[160:163], a[232:235], v[40:43]
    ds_read_b64_tr_b16 v[120:121], v200 offset:40960
    ds_read_b64_tr_b16 v[122:123], v200 offset:43008
    v_mfma_f32_16x16x32_bf16 v[60:63], v[160:163], a[236:239], v[60:63]
    buffer_load_dwordx4 v26, s[12:15], s44 offen offset:3072 lds
    s_add_u32 m0, s93, 8192
    v_mfma_f32_16x16x32_bf16 v[64:67], v[164:167], a[236:239], v[64:67]
    ds_read_b64_tr_b16 v[124:125], v203 offset:40960
    ds_read_b64_tr_b16 v[126:127], v203 offset:43008
    v_mfma_f32_16x16x32_bf16 v[44:47], v[164:167], a[232:235], v[44:47]
    s_waitcnt lgkmcnt(14)
    v_mfma_f32_16x16x32_bf16 v[48:51], v[168:171], a[232:235], v[48:51]
    ds_read_b64_tr_b16 v[128:129], v206 offset:40960
    ds_read_b64_tr_b16 v[130:131], v206 offset:43008
    v_mfma_f32_16x16x32_bf16 v[68:71], v[168:171], a[236:239], v[68:71]
    buffer_load_dwordx4 v27, s[12:15], s44 offen offset:1024 lds
    v_mfma_f32_16x16x32_bf16 v[72:75], v[172:175], a[236:239], v[72:75]
    ds_read_b64_tr_b16 v[132:133], v209 offset:40960
    ds_read_b64_tr_b16 v[134:135], v209 offset:43008
    v_mfma_f32_16x16x32_bf16 v[52:55], v[172:175], a[232:235], v[52:55]
    s_xor_b32 s4, s34, 45056
    buffer_load_dwordx4 a[128:131], v16, s[8:11], s4 offen offset:0 sc1
    v_mfma_f32_16x16x32_bf16 v[56:59], v[176:179], a[232:235], v[56:59]
    ds_read_b64_tr_b16 v[136:137], v212 offset:49152
    ds_read_b64_tr_b16 v[138:139], v212 offset:50176
    v_mfma_f32_16x16x32_bf16 v[76:79], v[176:179], a[236:239], v[76:79]
    s_waitcnt lgkmcnt(15)
    v_mfma_f32_16x16x32_bf16 v[100:103], v[180:183], a[236:239], v[100:103]
    ds_read_b64_tr_b16 v[140:141], v200 offset:45056
    ds_read_b64_tr_b16 v[142:143], v200 offset:47104
    v_mfma_f32_16x16x32_bf16 v[80:83], v[180:183], a[232:235], v[80:83]
    buffer_load_dwordx4 a[132:135], v17, s[8:11], s4 offen offset:0 sc1
    v_mfma_f32_16x16x32_bf16 v[84:87], v[184:187], a[232:235], v[84:87]
    ds_read_b64_tr_b16 v[144:145], v203 offset:45056
    ds_read_b64_tr_b16 v[146:147], v203 offset:47104
    v_mfma_f32_16x16x32_bf16 v[104:107], v[184:187], a[236:239], v[104:107]
    s_waitcnt lgkmcnt(14)
    v_mfma_f32_16x16x32_bf16 v[108:111], v[188:191], a[236:239], v[108:111]
    ds_read_b64_tr_b16 v[148:149], v206 offset:45056
    ds_read_b64_tr_b16 v[150:151], v206 offset:47104
    v_mfma_f32_16x16x32_bf16 v[88:91], v[188:191], a[232:235], v[88:91]
    buffer_load_dwordx4 a[136:139], v16, s[8:11], s4 offen offset:1024 sc1
    v_mfma_f32_16x16x32_bf16 v[92:95], v[192:195], a[232:235], v[92:95]
    ds_read_b64_tr_b16 v[152:153], v209 offset:45056
    ds_read_b64_tr_b16 v[154:155], v209 offset:47104
    v_mfma_f32_16x16x32_bf16 v[112:115], v[192:195], a[236:239], v[112:115]
    buffer_load_dwordx4 a[140:143], v17, s[8:11], s4 offen offset:1024 sc1
    v_mfma_f32_16x16x32_bf16 v[116:119], v[196:199], a[236:239], v[116:119]
    ds_read_b64_tr_b16 v[156:157], v215 offset:49152
    ds_read_b64_tr_b16 v[158:159], v215 offset:50176
    v_mfma_f32_16x16x32_bf16 v[96:99], v[196:199], a[232:235], v[96:99]
    s_waitcnt lgkmcnt(15)
    v_mfma_f32_16x16x32_bf16 v[40:43], v[120:123], a[240:243], v[40:43]
    ds_read_b64_tr_b16 v[160:161], v201 offset:0
    ds_read_b64_tr_b16 v[162:163], v201 offset:2048
    v_mfma_f32_16x16x32_bf16 v[60:63], v[120:123], a[244:247], v[60:63]
    buffer_load_dwordx4 a[144:147], v16, s[8:11], s4 offen offset:2048 sc1
    v_mfma_f32_16x16x32_bf16 v[64:67], v[124:127], a[244:247], v[64:67]
    ds_read_b64_tr_b16 v[164:165], v204 offset:0
    ds_read_b64_tr_b16 v[166:167], v204 offset:2048
    v_mfma_f32_16x16x32_bf16 v[44:47], v[124:127], a[240:243], v[44:47]
    s_waitcnt lgkmcnt(14)
    v_mfma_f32_16x16x32_bf16 v[48:51], v[128:131], a[240:243], v[48:51]
    ds_read_b64_tr_b16 v[168:169], v207 offset:0
    ds_read_b64_tr_b16 v[170:171], v207 offset:2048
    v_mfma_f32_16x16x32_bf16 v[68:71], v[128:131], a[244:247], v[68:71]
    buffer_load_dwordx4 a[148:151], v17, s[8:11], s4 offen offset:2048 sc1
    v_mfma_f32_16x16x32_bf16 v[72:75], v[132:135], a[244:247], v[72:75]
    ds_read_b64_tr_b16 v[172:173], v210 offset:0
    ds_read_b64_tr_b16 v[174:175], v210 offset:2048
    v_mfma_f32_16x16x32_bf16 v[52:55], v[132:135], a[240:243], v[52:55]
    buffer_load_dwordx4 a[152:155], v16, s[8:11], s4 offen offset:3072 sc1
    v_mfma_f32_16x16x32_bf16 v[56:59], v[136:139], a[240:243], v[56:59]
    ds_read_b64_tr_b16 v[176:177], v213 offset:8192
    ds_read_b64_tr_b16 v[178:179], v213 offset:9216
    v_mfma_f32_16x16x32_bf16 v[76:79], v[136:139], a[244:247], v[76:79]
    s_waitcnt lgkmcnt(15)
    v_mfma_f32_16x16x32_bf16 v[100:103], v[140:143], a[244:247], v[100:103]
    ds_read_b64_tr_b16 v[180:181], v201 offset:4096
    ds_read_b64_tr_b16 v[182:183], v201 offset:6144
    v_mfma_f32_16x16x32_bf16 v[80:83], v[140:143], a[240:243], v[80:83]
    buffer_load_dwordx4 a[156:159], v17, s[8:11], s4 offen offset:3072 sc1
    v_mfma_f32_16x16x32_bf16 v[84:87], v[144:147], a[240:243], v[84:87]
    ds_read_b64_tr_b16 v[184:185], v204 offset:4096
    ds_read_b64_tr_b16 v[186:187], v204 offset:6144
    v_mfma_f32_16x16x32_bf16 v[104:107], v[144:147], a[244:247], v[104:107]
    s_waitcnt lgkmcnt(14)
    v_mfma_f32_16x16x32_bf16 v[108:111], v[148:151], a[244:247], v[108:111]
    ds_read_b64_tr_b16 v[188:189], v207 offset:4096
    ds_read_b64_tr_b16 v[190:191], v207 offset:6144
    v_mfma_f32_16x16x32_bf16 v[88:91], v[148:151], a[240:243], v[88:91]
    v_mfma_f32_16x16x32_bf16 v[92:95], v[152:155], a[240:243], v[92:95]
    ds_read_b64_tr_b16 v[192:193], v210 offset:4096
    ds_read_b64_tr_b16 v[194:195], v210 offset:6144
    v_mfma_f32_16x16x32_bf16 v[112:115], v[152:155], a[244:247], v[112:115]
    v_mfma_f32_16x16x32_bf16 v[116:119], v[156:159], a[244:247], v[116:119]
    ds_read_b64_tr_b16 v[196:197], v216 offset:8192
    ds_read_b64_tr_b16 v[198:199], v216 offset:9216
    v_mfma_f32_16x16x32_bf16 v[96:99], v[156:159], a[240:243], v[96:99]
    s_waitcnt lgkmcnt(15)
    v_mfma_f32_16x16x32_bf16 v[40:43], v[160:163], a[248:251], v[40:43]
    v_mfma_f32_16x16x32_bf16 v[60:63], v[160:163], a[252:255], v[60:63]
    v_mfma_f32_16x16x32_bf16 v[64:67], v[164:167], a[252:255], v[64:67]
    v_mfma_f32_16x16x32_bf16 v[44:47], v[164:167], a[248:251], v[44:47]
    s_waitcnt vmcnt(36) lgkmcnt(0)
    s_barrier
    v_mfma_f32_16x16x32_bf16 v[48:51], v[168:171], a[248:251], v[48:51]
    ds_read_b64_tr_b16 v[120:121], v201 offset:10240
    ds_read_b64_tr_b16 v[122:123], v201 offset:12288
    v_mfma_f32_16x16x32_bf16 v[68:71], v[168:171], a[252:255], v[68:71]
    ds_read_b64_tr_b16 v[124:125], v204 offset:10240
    ds_read_b64_tr_b16 v[126:127], v204 offset:12288
    v_mfma_f32_16x16x32_bf16 v[72:75], v[172:175], a[252:255], v[72:75]
    s_add_u32 s44, s90, 163840
    s_add_u32 m0, s94, 0
    v_mfma_f32_16x16x32_bf16 v[52:55], v[172:175], a[248:251], v[52:55]
    ds_read_b64_tr_b16 v[128:129], v207 offset:10240
    ds_read_b64_tr_b16 v[130:131], v207 offset:12288
    v_mfma_f32_16x16x32_bf16 v[56:59], v[176:179], a[248:251], v[56:59]
    ds_read_b64_tr_b16 v[132:133], v210 offset:10240
    ds_read_b64_tr_b16 v[134:135], v210 offset:12288
    v_mfma_f32_16x16x32_bf16 v[76:79], v[176:179], a[252:255], v[76:79]
    v_mfma_f32_16x16x32_bf16 v[100:103], v[180:183], a[252:255], v[100:103]
    ds_read_b64_tr_b16 v[136:137], v213 offset:18432
    ds_read_b64_tr_b16 v[138:139], v213 offset:19456
    v_mfma_f32_16x16x32_bf16 v[80:83], v[180:183], a[248:251], v[80:83]
    ds_read_b64_tr_b16 v[140:141], v201 offset:14336
    ds_read_b64_tr_b16 v[142:143], v201 offset:16384
    v_mfma_f32_16x16x32_bf16 v[84:87], v[184:187], a[248:251], v[84:87]
    buffer_load_dwordx4 v18, s[12:15], s44 offen offset:0 lds
    v_mfma_f32_16x16x32_bf16 v[104:107], v[184:187], a[252:255], v[104:107]
    ds_read_b64_tr_b16 v[144:145], v204 offset:14336
    ds_read_b64_tr_b16 v[146:147], v204 offset:16384
    v_mfma_f32_16x16x32_bf16 v[108:111], v[188:191], a[252:255], v[108:111]
    ds_read_b64_tr_b16 v[148:149], v207 offset:14336
    ds_read_b64_tr_b16 v[150:151], v207 offset:16384
    v_mfma_f32_16x16x32_bf16 v[88:91], v[188:191], a[248:251], v[88:91]
    buffer_load_dwordx4 v19, s[12:15], s44 offen offset:1024 lds
    v_mfma_f32_16x16x32_bf16 v[92:95], v[192:195], a[248:251], v[92:95]
    ds_read_b64_tr_b16 v[152:153], v210 offset:14336
    ds_read_b64_tr_b16 v[154:155], v210 offset:16384
    v_mfma_f32_16x16x32_bf16 v[112:115], v[192:195], a[252:255], v[112:115]
    ds_read_b64_tr_b16 v[156:157], v216 offset:18432
    ds_read_b64_tr_b16 v[158:159], v216 offset:19456
    v_mfma_f32_16x16x32_bf16 v[116:119], v[196:199], a[252:255], v[116:119]
    buffer_load_dwordx4 v20, s[12:15], s44 offen offset:2048 lds
    v_mfma_f32_16x16x32_bf16 v[96:99], v[196:199], a[248:251], v[96:99]
    s_waitcnt lgkmcnt(15)
    v_mfma_f32_16x16x32_bf16 v[40:43], v[120:123], a[0:3], v[40:43]
    ds_read_b64_tr_b16 v[160:161], v201 offset:20480
    ds_read_b64_tr_b16 v[162:163], v201 offset:22528
    v_mfma_f32_16x16x32_bf16 v[60:63], v[120:123], a[4:7], v[60:63]
    buffer_load_dwordx4 v21, s[12:15], s44 offen offset:3072 lds
    s_add_u32 m0, s94, 8192
    v_mfma_f32_16x16x32_bf16 v[64:67], v[124:127], a[4:7], v[64:67]
    ds_read_b64_tr_b16 v[164:165], v204 offset:20480
    ds_read_b64_tr_b16 v[166:167], v204 offset:22528
    v_mfma_f32_16x16x32_bf16 v[44:47], v[124:127], a[0:3], v[44:47]
    s_waitcnt lgkmcnt(14)
    v_mfma_f32_16x16x32_bf16 v[48:51], v[128:131], a[0:3], v[48:51]
    ds_read_b64_tr_b16 v[168:169], v207 offset:20480
    ds_read_b64_tr_b16 v[170:171], v207 offset:22528
    v_mfma_f32_16x16x32_bf16 v[68:71], v[128:131], a[4:7], v[68:71]
    buffer_load_dwordx4 v22, s[12:15], s44 offen offset:0 lds
    v_mfma_f32_16x16x32_bf16 v[72:75], v[132:135], a[4:7], v[72:75]
    ds_read_b64_tr_b16 v[172:173], v210 offset:20480
    ds_read_b64_tr_b16 v[174:175], v210 offset:22528
    v_mfma_f32_16x16x32_bf16 v[52:55], v[132:135], a[0:3], v[52:55]
    s_add_u32 s44, s90, 163840
    s_add_u32 m0, s94, 4096
    v_mfma_f32_16x16x32_bf16 v[56:59], v[136:139], a[0:3], v[56:59]
    ds_read_b64_tr_b16 v[176:177], v213 offset:28672
    ds_read_b64_tr_b16 v[178:179], v213 offset:29696
    v_mfma_f32_16x16x32_bf16 v[76:79], v[136:139], a[4:7], v[76:79]
    s_waitcnt lgkmcnt(15)
    v_mfma_f32_16x16x32_bf16 v[100:103], v[140:143], a[4:7], v[100:103]
    ds_read_b64_tr_b16 v[180:181], v201 offset:24576
    ds_read_b64_tr_b16 v[182:183], v201 offset:26624
    v_mfma_f32_16x16x32_bf16 v[80:83], v[140:143], a[0:3], v[80:83]
    buffer_load_dwordx4 v23, s[12:15], s44 offen offset:0 lds
    v_mfma_f32_16x16x32_bf16 v[84:87], v[144:147], a[0:3], v[84:87]
    ds_read_b64_tr_b16 v[184:185], v204 offset:24576
    ds_read_b64_tr_b16 v[186:187], v204 offset:26624
    v_mfma_f32_16x16x32_bf16 v[104:107], v[144:147], a[4:7], v[104:107]
    s_waitcnt lgkmcnt(14)
    v_mfma_f32_16x16x32_bf16 v[108:111], v[148:151], a[4:7], v[108:111]
    ds_read_b64_tr_b16 v[188:189], v207 offset:24576
    ds_read_b64_tr_b16 v[190:191], v207 offset:26624
    v_mfma_f32_16x16x32_bf16 v[88:91], v[148:151], a[0:3], v[88:91]
    buffer_load_dwordx4 v24, s[12:15], s44 offen offset:1024 lds
    v_mfma_f32_16x16x32_bf16 v[92:95], v[152:155], a[0:3], v[92:95]
    ds_read_b64_tr_b16 v[192:193], v210 offset:24576
    ds_read_b64_tr_b16 v[194:195], v210 offset:26624
    v_mfma_f32_16x16x32_bf16 v[112:115], v[152:155], a[4:7], v[112:115]
    buffer_load_dwordx4 v25, s[12:15], s44 offen offset:2048 lds
    v_mfma_f32_16x16x32_bf16 v[116:119], v[156:159], a[4:7], v[116:119]
    ds_read_b64_tr_b16 v[196:197], v216 offset:28672
    ds_read_b64_tr_b16 v[198:199], v216 offset:29696
    v_mfma_f32_16x16x32_bf16 v[96:99], v[156:159], a[0:3], v[96:99]
    s_waitcnt lgkmcnt(15)
    v_mfma_f32_16x16x32_bf16 v[40:43], v[160:163], a[8:11], v[40:43]
    ds_read_b64_tr_b16 v[120:121], v202 offset:10240
    ds_read_b64_tr_b16 v[122:123], v202 offset:12288
    v_mfma_f32_16x16x32_bf16 v[60:63], v[160:163], a[12:15], v[60:63]
    buffer_load_dwordx4 v26, s[12:15], s44 offen offset:3072 lds
    s_add_u32 m0, s94, 8192
    v_mfma_f32_16x16x32_bf16 v[64:67], v[164:167], a[12:15], v[64:67]
    ds_read_b64_tr_b16 v[124:125], v205 offset:10240
    ds_read_b64_tr_b16 v[126:127], v205 offset:12288
    v_mfma_f32_16x16x32_bf16 v[44:47], v[164:167], a[8:11], v[44:47]
    s_waitcnt lgkmcnt(14)
    v_mfma_f32_16x16x32_bf16 v[48:51], v[168:171], a[8:11], v[48:51]
    ds_read_b64_tr_b16 v[128:129], v208 offset:10240
    ds_read_b64_tr_b16 v[130:131], v208 offset:12288
    v_mfma_f32_16x16x32_bf16 v[68:71], v[168:171], a[12:15], v[68:71]
    buffer_load_dwordx4 v27, s[12:15], s44 offen offset:1024 lds
    v_mfma_f32_16x16x32_bf16 v[72:75], v[172:175], a[12:15], v[72:75]
    ds_read_b64_tr_b16 v[132:133], v211 offset:10240
    ds_read_b64_tr_b16 v[134:135], v211 offset:12288
    v_mfma_f32_16x16x32_bf16 v[52:55], v[172:175], a[8:11], v[52:55]
    s_xor_b32 s4, s34, 53248
    buffer_load_dwordx4 a[160:163], v16, s[8:11], s4 offen offset:0 sc1
    v_mfma_f32_16x16x32_bf16 v[56:59], v[176:179], a[8:11], v[56:59]
    ds_read_b64_tr_b16 v[136:137], v214 offset:18432
    ds_read_b64_tr_b16 v[138:139], v214 offset:19456
    v_mfma_f32_16x16x32_bf16 v[76:79], v[176:179], a[12:15], v[76:79]
    s_waitcnt lgkmcnt(15)
    v_mfma_f32_16x16x32_bf16 v[100:103], v[180:183], a[12:15], v[100:103]
    ds_read_b64_tr_b16 v[140:141], v202 offset:14336
    ds_read_b64_tr_b16 v[142:143], v202 offset:16384
    v_mfma_f32_16x16x32_bf16 v[80:83], v[180:183], a[8:11], v[80:83]
    buffer_load_dwordx4 a[164:167], v17, s[8:11], s4 offen offset:0 sc1
    v_mfma_f32_16x16x32_bf16 v[84:87], v[184:187], a[8:11], v[84:87]
    ds_read_b64_tr_b16 v[144:145], v205 offset:14336
    ds_read_b64_tr_b16 v[146:147], v205 offset:16384
    v_mfma_f32_16x16x32_bf16 v[104:107], v[184:187], a[12:15], v[104:107]
    s_waitcnt lgkmcnt(14)
    v_mfma_f32_16x16x32_bf16 v[108:111], v[188:191], a[12:15], v[108:111]
    ds_read_b64_tr_b16 v[148:149], v208 offset:14336
    ds_read_b64_tr_b16 v[150:151], v208 offset:16384
    v_mfma_f32_16x16x32_bf16 v[88:91], v[188:191], a[8:11], v[88:91]
    buffer_load_dwordx4 a[168:171], v16, s[8:11], s4 offen offset:1024 sc1
    v_mfma_f32_16x16x32_bf16 v[92:95], v[192:195], a[8:11], v[92:95]
    ds_read_b64_tr_b16 v[152:153], v211 offset:14336
    ds_read_b64_tr_b16 v[154:155], v211 offset:16384
    v_mfma_f32_16x16x32_bf16 v[112:115], v[192:195], a[12:15], v[112:115]
    buffer_load_dwordx4 a[172:175], v17, s[8:11], s4 offen offset:1024 sc1
    v_mfma_f32_16x16x32_bf16 v[116:119], v[196:199], a[12:15], v[116:119]
    ds_read_b64_tr_b16 v[156:157], v217 offset:18432
    ds_read_b64_tr_b16 v[158:159], v217 offset:19456
    v_mfma_f32_16x16x32_bf16 v[96:99], v[196:199], a[8:11], v[96:99]
    s_waitcnt lgkmcnt(15)
    v_mfma_f32_16x16x32_bf16 v[40:43], v[120:123], a[16:19], v[40:43]
    ds_read_b64_tr_b16 v[160:161], v202 offset:20480
    ds_read_b64_tr_b16 v[162:163], v202 offset:22528
    v_mfma_f32_16x16x32_bf16 v[60:63], v[120:123], a[20:23], v[60:63]
    buffer_load_dwordx4 a[176:179], v16, s[8:11], s4 offen offset:2048 sc1
    v_mfma_f32_16x16x32_bf16 v[64:67], v[124:127], a[20:23], v[64:67]
    ds_read_b64_tr_b16 v[164:165], v205 offset:20480
    ds_read_b64_tr_b16 v[166:167], v205 offset:22528
    v_mfma_f32_16x16x32_bf16 v[44:47], v[124:127], a[16:19], v[44:47]
    s_waitcnt lgkmcnt(14)
    v_mfma_f32_16x16x32_bf16 v[48:51], v[128:131], a[16:19], v[48:51]
    ds_read_b64_tr_b16 v[168:169], v208 offset:20480
    ds_read_b64_tr_b16 v[170:171], v208 offset:22528
    v_mfma_f32_16x16x32_bf16 v[68:71], v[128:131], a[20:23], v[68:71]
    buffer_load_dwordx4 a[180:183], v17, s[8:11], s4 offen offset:2048 sc1
    v_mfma_f32_16x16x32_bf16 v[72:75], v[132:135], a[20:23], v[72:75]
    ds_read_b64_tr_b16 v[172:173], v211 offset:20480
    ds_read_b64_tr_b16 v[174:175], v211 offset:22528
    v_mfma_f32_16x16x32_bf16 v[52:55], v[132:135], a[16:19], v[52:55]
    buffer_load_dwordx4 a[184:187], v16, s[8:11], s4 offen offset:3072 sc1
    v_mfma_f32_16x16x32_bf16 v[56:59], v[136:139], a[16:19], v[56:59]
    ds_read_b64_tr_b16 v[176:177], v214 offset:28672
    ds_read_b64_tr_b16 v[178:179], v214 offset:29696
    v_mfma_f32_16x16x32_bf16 v[76:79], v[136:139], a[20:23], v[76:79]
    s_waitcnt lgkmcnt(15)
    v_mfma_f32_16x16x32_bf16 v[100:103], v[140:143], a[20:23], v[100:103]
    ds_read_b64_tr_b16 v[180:181], v202 offset:24576
    ds_read_b64_tr_b16 v[182:183], v202 offset:26624
    v_mfma_f32_16x16x32_bf16 v[80:83], v[140:143], a[16:19], v[80:83]
    buffer_load_dwordx4 a[188:191], v17, s[8:11], s4 offen offset:3072 sc1
    v_mfma_f32_16x16x32_bf16 v[84:87], v[144:147], a[16:19], v[84:87]
    ds_read_b64_tr_b16 v[184:185], v205 offset:24576
    ds_read_b64_tr_b16 v[186:187], v205 offset:26624
    v_mfma_f32_16x16x32_bf16 v[104:107], v[144:147], a[20:23], v[104:107]
    s_waitcnt lgkmcnt(14)
    v_mfma_f32_16x16x32_bf16 v[108:111], v[148:151], a[20:23], v[108:111]
    ds_read_b64_tr_b16 v[188:189], v208 offset:24576
    ds_read_b64_tr_b16 v[190:191], v208 offset:26624
    v_mfma_f32_16x16x32_bf16 v[88:91], v[148:151], a[16:19], v[88:91]
    v_mfma_f32_16x16x32_bf16 v[92:95], v[152:155], a[16:19], v[92:95]
    ds_read_b64_tr_b16 v[192:193], v211 offset:24576
    ds_read_b64_tr_b16 v[194:195], v211 offset:26624
    v_mfma_f32_16x16x32_bf16 v[112:115], v[152:155], a[20:23], v[112:115]
    v_mfma_f32_16x16x32_bf16 v[116:119], v[156:159], a[20:23], v[116:119]
    ds_read_b64_tr_b16 v[196:197], v217 offset:28672
    ds_read_b64_tr_b16 v[198:199], v217 offset:29696
    v_mfma_f32_16x16x32_bf16 v[96:99], v[156:159], a[16:19], v[96:99]
    s_waitcnt lgkmcnt(15)
    v_mfma_f32_16x16x32_bf16 v[40:43], v[160:163], a[24:27], v[40:43]
    v_mfma_f32_16x16x32_bf16 v[60:63], v[160:163], a[28:31], v[60:63]
    v_mfma_f32_16x16x32_bf16 v[64:67], v[164:167], a[28:31], v[64:67]
    v_mfma_f32_16x16x32_bf16 v[44:47], v[164:167], a[24:27], v[44:47]
    s_waitcnt vmcnt(36) lgkmcnt(0)
    s_barrier
    v_mfma_f32_16x16x32_bf16 v[48:51], v[168:171], a[24:27], v[48:51]
    ds_read_b64_tr_b16 v[120:121], v202 offset:30720
    ds_read_b64_tr_b16 v[122:123], v202 offset:32768
    v_mfma_f32_16x16x32_bf16 v[68:71], v[168:171], a[28:31], v[68:71]
    s_add_u32 s44, s91, 163840
    s_add_u32 m0, s95, 0
    v_mfma_f32_16x16x32_bf16 v[72:75], v[172:175], a[28:31], v[72:75]
    ds_read_b64_tr_b16 v[124:125], v205 offset:30720
    ds_read_b64_tr_b16 v[126:127], v205 offset:32768
    v_mfma_f32_16x16x32_bf16 v[52:55], v[172:175], a[24:27], v[52:55]
    buffer_load_dwordx4 v18, s[12:15], s44 offen offset:0 lds
    v_mfma_f32_16x16x32_bf16 v[56:59], v[176:179], a[24:27], v[56:59]
    ds_read_b64_tr_b16 v[128:129], v208 offset:30720
    ds_read_b64_tr_b16 v[130:131], v208 offset:32768
    v_mfma_f32_16x16x32_bf16 v[76:79], v[176:179], a[28:31], v[76:79]
    buffer_load_dwordx4 v19, s[12:15], s44 offen offset:1024 lds
    v_mfma_f32_16x16x32_bf16 v[100:103], v[180:183], a[28:31], v[100:103]
    ds_read_b64_tr_b16 v[132:133], v211 offset:30720
    ds_read_b64_tr_b16 v[134:135], v211 offset:32768
    v_mfma_f32_16x16x32_bf16 v[80:83], v[180:183], a[24:27], v[80:83]
    buffer_load_dwordx4 v20, s[12:15], s44 offen offset:2048 lds
    v_mfma_f32_16x16x32_bf16 v[84:87], v[184:187], a[24:27], v[84:87]
    ds_read_b64_tr_b16 v[136:137], v214 offset:38912
    ds_read_b64_tr_b16 v[138:139], v214 offset:39936
    v_mfma_f32_16x16x32_bf16 v[104:107], v[184:187], a[28:31], v[104:107]
    buffer_load_dwordx4 v21, s[12:15], s44 offen offset:3072 lds
    s_add_u32 m0, s95, 8192
    v_mfma_f32_16x16x32_bf16 v[108:111], v[188:191], a[28:31], v[108:111]
    v_mfma_f32_16x16x32_bf16 v[88:91], v[188:191], a[24:27], v[88:91]
    buffer_load_dwordx4 v22, s[12:15], s44 offen offset:0 lds
    v_mfma_f32_16x16x32_bf16 v[92:95], v[192:195], a[24:27], v[92:95]
    v_mfma_f32_16x16x32_bf16 v[112:115], v[192:195], a[28:31], v[112:115]
    s_add_u32 s44, s91, 163840
    s_add_u32 m0, s95, 4096
    v_mfma_f32_16x16x32_bf16 v[116:119], v[196:199], a[28:31], v[116:119]
    buffer_load_dwordx4 v23, s[12:15], s44 offen offset:0 lds
    v_mfma_f32_16x16x32_bf16 v[96:99], v[196:199], a[24:27], v[96:99]
    s_waitcnt lgkmcnt(6)
    v_mfma_f32_16x16x32_bf16 v[40:43], v[120:123], a[32:35], v[40:43]
    ds_read_b64_tr_b16 v[160:161], v202 offset:40960
    ds_read_b64_tr_b16 v[162:163], v202 offset:43008
    v_mfma_f32_16x16x32_bf16 v[60:63], v[120:123], a[36:39], v[60:63]
    buffer_load_dwordx4 v24, s[12:15], s44 offen offset:1024 lds
    v_mfma_f32_16x16x32_bf16 v[64:67], v[124:127], a[36:39], v[64:67]
    ds_read_b64_tr_b16 v[164:165], v205 offset:40960
    ds_read_b64_tr_b16 v[166:167], v205 offset:43008
    v_mfma_f32_16x16x32_bf16 v[44:47], v[124:127], a[32:35], v[44:47]
    buffer_load_dwordx4 v25, s[12:15], s44 offen offset:2048 lds
    s_waitcnt lgkmcnt(4)
    v_mfma_f32_16x16x32_bf16 v[48:51], v[128:131], a[32:35], v[48:51]
    ds_read_b64_tr_b16 v[168:169], v208 offset:40960
    ds_read_b64_tr_b16 v[170:171], v208 offset:43008
    v_mfma_f32_16x16x32_bf16 v[68:71], v[128:131], a[36:39], v[68:71]
    buffer_load_dwordx4 v26, s[12:15], s44 offen offset:3072 lds
    s_add_u32 m0, s95, 8192
    v_mfma_f32_16x16x32_bf16 v[72:75], v[132:135], a[36:39], v[72:75]
    ds_read_b64_tr_b16 v[172:173], v211 offset:40960
    ds_read_b64_tr_b16 v[174:175], v211 offset:43008
    v_mfma_f32_16x16x32_bf16 v[52:55], v[132:135], a[32:35], v[52:55]
    buffer_load_dwordx4 v27, s[12:15], s44 offen offset:1024 lds
    v_mfma_f32_16x16x32_bf16 v[56:59], v[136:139], a[32:35], v[56:59]
    ds_read_b64_tr_b16 v[176:177], v214 offset:49152
    ds_read_b64_tr_b16 v[178:179], v214 offset:50176
    v_mfma_f32_16x16x32_bf16 v[76:79], v[136:139], a[36:39], v[76:79]
    s_xor_b32 s4, s34, 61440
    buffer_load_dwordx4 a[192:195], v16, s[8:11], s4 offen offset:0 sc1
    s_waitcnt lgkmcnt(6)
    v_mfma_f32_16x16x32_bf16 v[40:43], v[160:163], a[40:43], v[40:43]
    ds_read_b64_tr_b16 v[120:121], v202 offset:51200
    ds_read_b64_tr_b16 v[122:123], v202 offset:53248
    v_mfma_f32_16x16x32_bf16 v[60:63], v[160:163], a[44:47], v[60:63]
    buffer_load_dwordx4 a[196:199], v17, s[8:11], s4 offen offset:0 sc1
    v_mfma_f32_16x16x32_bf16 v[64:67], v[164:167], a[44:47], v[64:67]
    ds_read_b64_tr_b16 v[124:125], v205 offset:51200
    ds_read_b64_tr_b16 v[126:127], v205 offset:53248
    v_mfma_f32_16x16x32_bf16 v[44:47], v[164:167], a[40:43], v[44:47]
    buffer_load_dwordx4 a[200:203], v16, s[8:11], s4 offen offset:1024 sc1
    s_waitcnt lgkmcnt(4)
    v_mfma_f32_16x16x32_bf16 v[48:51], v[168:171], a[40:43], v[48:51]
    ds_read_b64_tr_b16 v[128:129], v208 offset:51200
    ds_read_b64_tr_b16 v[130:131], v208 offset:53248
    v_mfma_f32_16x16x32_bf16 v[68:71], v[168:171], a[44:47], v[68:71]
    buffer_load_dwordx4 a[204:207], v17, s[8:11], s4 offen offset:1024 sc1
    v_mfma_f32_16x16x32_bf16 v[72:75], v[172:175], a[44:47], v[72:75]
    ds_read_b64_tr_b16 v[132:133], v211 offset:51200
    ds_read_b64_tr_b16 v[134:135], v211 offset:53248
    v_mfma_f32_16x16x32_bf16 v[52:55], v[172:175], a[40:43], v[52:55]
    buffer_load_dwordx4 a[208:211], v16, s[8:11], s4 offen offset:2048 sc1
    v_mfma_f32_16x16x32_bf16 v[56:59], v[176:179], a[40:43], v[56:59]
    ds_read_b64_tr_b16 v[136:137], v214 offset:59392
    ds_read_b64_tr_b16 v[138:139], v214 offset:60416
    v_mfma_f32_16x16x32_bf16 v[76:79], v[176:179], a[44:47], v[76:79]
    buffer_load_dwordx4 a[212:215], v17, s[8:11], s4 offen offset:2048 sc1
    s_waitcnt lgkmcnt(6)
    v_mfma_f32_16x16x32_bf16 v[40:43], v[120:123], a[48:51], v[40:43]
    ds_read_b64_tr_b16 v[160:161], v200 offset:0
    ds_read_b64_tr_b16 v[162:163], v200 offset:2048
    v_mfma_f32_16x16x32_bf16 v[60:63], v[120:123], a[52:55], v[60:63]
    buffer_load_dwordx4 a[216:219], v16, s[8:11], s4 offen offset:3072 sc1
    v_mfma_f32_16x16x32_bf16 v[64:67], v[124:127], a[52:55], v[64:67]
    ds_read_b64_tr_b16 v[164:165], v203 offset:0
    ds_read_b64_tr_b16 v[166:167], v203 offset:2048
    v_mfma_f32_16x16x32_bf16 v[44:47], v[124:127], a[48:51], v[44:47]
    buffer_load_dwordx4 a[220:223], v17, s[8:11], s4 offen offset:3072 sc1
    s_waitcnt lgkmcnt(4)
    v_mfma_f32_16x16x32_bf16 v[48:51], v[128:131], a[48:51], v[48:51]
    ds_read_b64_tr_b16 v[168:169], v206 offset:0
    ds_read_b64_tr_b16 v[170:171], v206 offset:2048
    v_mfma_f32_16x16x32_bf16 v[68:71], v[128:131], a[52:55], v[68:71]
    v_mfma_f32_16x16x32_bf16 v[72:75], v[132:135], a[52:55], v[72:75]
    ds_read_b64_tr_b16 v[172:173], v209 offset:0
    ds_read_b64_tr_b16 v[174:175], v209 offset:2048
    v_mfma_f32_16x16x32_bf16 v[52:55], v[132:135], a[48:51], v[52:55]
    v_mfma_f32_16x16x32_bf16 v[56:59], v[136:139], a[48:51], v[56:59]
    ds_read_b64_tr_b16 v[176:177], v212 offset:8192
    ds_read_b64_tr_b16 v[178:179], v212 offset:9216
    v_mfma_f32_16x16x32_bf16 v[76:79], v[136:139], a[52:55], v[76:79]
    s_waitcnt lgkmcnt(6)
    v_mfma_f32_16x16x32_bf16 v[40:43], v[160:163], a[56:59], v[40:43]
    v_mfma_f32_16x16x32_bf16 v[60:63], v[160:163], a[60:63], v[60:63]
    s_waitcnt vmcnt(36)
    s_barrier
    v_mfma_f32_16x16x32_bf16 v[64:67], v[164:167], a[60:63], v[64:67]
    ds_read_b64_tr_b16 v[120:121], v200 offset:10240
    ds_read_b64_tr_b16 v[122:123], v200 offset:12288
    v_mfma_f32_16x16x32_bf16 v[44:47], v[164:167], a[56:59], v[44:47]
    ds_read_b64_tr_b16 v[124:125], v203 offset:10240
    ds_read_b64_tr_b16 v[126:127], v203 offset:12288
    s_waitcnt lgkmcnt(4)
    v_mfma_f32_16x16x32_bf16 v[48:51], v[168:171], a[56:59], v[48:51]
    v_mfma_f32_16x16x32_bf16 v[68:71], v[168:171], a[60:63], v[68:71]
    ds_read_b64_tr_b16 v[128:129], v206 offset:10240
    ds_read_b64_tr_b16 v[130:131], v206 offset:12288
    v_mfma_f32_16x16x32_bf16 v[72:75], v[172:175], a[60:63], v[72:75]
    ds_read_b64_tr_b16 v[132:133], v209 offset:10240
    ds_read_b64_tr_b16 v[134:135], v209 offset:12288
    v_mfma_f32_16x16x32_bf16 v[52:55], v[172:175], a[56:59], v[52:55]
    v_mfma_f32_16x16x32_bf16 v[56:59], v[176:179], a[56:59], v[56:59]
    ds_read_b64_tr_b16 v[136:137], v212 offset:18432
    ds_read_b64_tr_b16 v[138:139], v212 offset:19456
    v_mfma_f32_16x16x32_bf16 v[76:79], v[176:179], a[60:63], v[76:79]
    s_waitcnt lgkmcnt(6)
    v_mfma_f32_16x16x32_bf16 v[40:43], v[120:123], a[128:131], v[40:43]
    ds_read_b64_tr_b16 v[160:161], v200 offset:20480
    ds_read_b64_tr_b16 v[162:163], v200 offset:22528
    v_mfma_f32_16x16x32_bf16 v[60:63], v[120:123], a[132:135], v[60:63]
    v_mfma_f32_16x16x32_bf16 v[64:67], v[124:127], a[132:135], v[64:67]
    ds_read_b64_tr_b16 v[164:165], v203 offset:20480
    ds_read_b64_tr_b16 v[166:167], v203 offset:22528
    v_mfma_f32_16x16x32_bf16 v[44:47], v[124:127], a[128:131], v[44:47]
    s_waitcnt lgkmcnt(4)
    v_mfma_f32_16x16x32_bf16 v[48:51], v[128:131], a[128:131], v[48:51]
    ds_read_b64_tr_b16 v[168:169], v206 offset:20480
    ds_read_b64_tr_b16 v[170:171], v206 offset:22528
    v_mfma_f32_16x16x32_bf16 v[68:71], v[128:131], a[132:135], v[68:71]
    v_mfma_f32_16x16x32_bf16 v[72:75], v[132:135], a[132:135], v[72:75]
    ds_read_b64_tr_b16 v[172:173], v209 offset:20480
    ds_read_b64_tr_b16 v[174:175], v209 offset:22528
    v_mfma_f32_16x16x32_bf16 v[52:55], v[132:135], a[128:131], v[52:55]
    v_mfma_f32_16x16x32_bf16 v[56:59], v[136:139], a[128:131], v[56:59]
    ds_read_b64_tr_b16 v[176:177], v212 offset:28672
    ds_read_b64_tr_b16 v[178:179], v212 offset:29696
    v_mfma_f32_16x16x32_bf16 v[76:79], v[136:139], a[132:135], v[76:79]
    s_waitcnt lgkmcnt(6)
    v_mfma_f32_16x16x32_bf16 v[40:43], v[160:163], a[136:139], v[40:43]
    ds_read_b64_tr_b16 v[120:121], v201 offset:30720
    ds_read_b64_tr_b16 v[122:123], v201 offset:32768
    v_mfma_f32_16x16x32_bf16 v[60:63], v[160:163], a[140:143], v[60:63]
    v_mfma_f32_16x16x32_bf16 v[64:67], v[164:167], a[140:143], v[64:67]
    ds_read_b64_tr_b16 v[124:125], v204 offset:30720
    ds_read_b64_tr_b16 v[126:127], v204 offset:32768
    v_mfma_f32_16x16x32_bf16 v[44:47], v[164:167], a[136:139], v[44:47]
    s_waitcnt lgkmcnt(4)
    v_mfma_f32_16x16x32_bf16 v[48:51], v[168:171], a[136:139], v[48:51]
    ds_read_b64_tr_b16 v[128:129], v207 offset:30720
    ds_read_b64_tr_b16 v[130:131], v207 offset:32768
    v_mfma_f32_16x16x32_bf16 v[68:71], v[168:171], a[140:143], v[68:71]
    v_mfma_f32_16x16x32_bf16 v[72:75], v[172:175], a[140:143], v[72:75]
    ds_read_b64_tr_b16 v[132:133], v210 offset:30720
    ds_read_b64_tr_b16 v[134:135], v210 offset:32768
    v_mfma_f32_16x16x32_bf16 v[52:55], v[172:175], a[136:139], v[52:55]
    v_mfma_f32_16x16x32_bf16 v[56:59], v[176:179], a[136:139], v[56:59]
    ds_read_b64_tr_b16 v[136:137], v213 offset:38912
    ds_read_b64_tr_b16 v[138:139], v213 offset:39936
    v_mfma_f32_16x16x32_bf16 v[76:79], v[176:179], a[140:143], v[76:79]
    s_waitcnt lgkmcnt(6)
    v_mfma_f32_16x16x32_bf16 v[40:43], v[120:123], a[144:147], v[40:43]
    ds_read_b64_tr_b16 v[160:161], v201 offset:40960
    ds_read_b64_tr_b16 v[162:163], v201 offset:43008
    v_mfma_f32_16x16x32_bf16 v[60:63], v[120:123], a[148:151], v[60:63]
    v_mfma_f32_16x16x32_bf16 v[64:67], v[124:127], a[148:151], v[64:67]
    ds_read_b64_tr_b16 v[164:165], v204 offset:40960
    ds_read_b64_tr_b16 v[166:167], v204 offset:43008
    v_mfma_f32_16x16x32_bf16 v[44:47], v[124:127], a[144:147], v[44:47]
    s_waitcnt lgkmcnt(4)
    v_mfma_f32_16x16x32_bf16 v[48:51], v[128:131], a[144:147], v[48:51]
    ds_read_b64_tr_b16 v[168:169], v207 offset:40960
    ds_read_b64_tr_b16 v[170:171], v207 offset:43008
    v_mfma_f32_16x16x32_bf16 v[68:71], v[128:131], a[148:151], v[68:71]
    v_mfma_f32_16x16x32_bf16 v[72:75], v[132:135], a[148:151], v[72:75]
    ds_read_b64_tr_b16 v[172:173], v210 offset:40960
    ds_read_b64_tr_b16 v[174:175], v210 offset:43008
    v_mfma_f32_16x16x32_bf16 v[52:55], v[132:135], a[144:147], v[52:55]
    v_mfma_f32_16x16x32_bf16 v[56:59], v[136:139], a[144:147], v[56:59]
    ds_read_b64_tr_b16 v[176:177], v213 offset:49152
    ds_read_b64_tr_b16 v[178:179], v213 offset:50176
    v_mfma_f32_16x16x32_bf16 v[76:79], v[136:139], a[148:151], v[76:79]
    s_waitcnt lgkmcnt(6)
    v_mfma_f32_16x16x32_bf16 v[40:43], v[160:163], a[152:155], v[40:43]
    v_mfma_f32_16x16x32_bf16 v[60:63], v[160:163], a[156:159], v[60:63]
    s_waitcnt vmcnt(18)
    s_barrier
    v_mfma_f32_16x16x32_bf16 v[64:67], v[164:167], a[156:159], v[64:67]
    ds_read_b64_tr_b16 v[120:121], v200 offset:30720
    ds_read_b64_tr_b16 v[122:123], v200 offset:32768
    v_mfma_f32_16x16x32_bf16 v[44:47], v[164:167], a[152:155], v[44:47]
    ds_read_b64_tr_b16 v[124:125], v203 offset:30720
    ds_read_b64_tr_b16 v[126:127], v203 offset:32768
    s_waitcnt lgkmcnt(4)
    v_mfma_f32_16x16x32_bf16 v[48:51], v[168:171], a[152:155], v[48:51]
    v_mfma_f32_16x16x32_bf16 v[68:71], v[168:171], a[156:159], v[68:71]
    ds_read_b64_tr_b16 v[128:129], v206 offset:30720
    ds_read_b64_tr_b16 v[130:131], v206 offset:32768
    v_mfma_f32_16x16x32_bf16 v[72:75], v[172:175], a[156:159], v[72:75]
    ds_read_b64_tr_b16 v[132:133], v209 offset:30720
    ds_read_b64_tr_b16 v[134:135], v209 offset:32768
    v_mfma_f32_16x16x32_bf16 v[52:55], v[172:175], a[152:155], v[52:55]
    v_mfma_f32_16x16x32_bf16 v[56:59], v[176:179], a[152:155], v[56:59]
    ds_read_b64_tr_b16 v[136:137], v212 offset:38912
    ds_read_b64_tr_b16 v[138:139], v212 offset:39936
    v_mfma_f32_16x16x32_bf16 v[76:79], v[176:179], a[156:159], v[76:79]
    s_waitcnt lgkmcnt(6)
    v_mfma_f32_16x16x32_bf16 v[40:43], v[120:123], a[160:163], v[40:43]
    ds_read_b64_tr_b16 v[160:161], v202 offset:0
    ds_read_b64_tr_b16 v[162:163], v202 offset:2048
    v_mfma_f32_16x16x32_bf16 v[60:63], v[120:123], a[164:167], v[60:63]
    v_mfma_f32_16x16x32_bf16 v[64:67], v[124:127], a[164:167], v[64:67]
    ds_read_b64_tr_b16 v[164:165], v205 offset:0
    ds_read_b64_tr_b16 v[166:167], v205 offset:2048
    v_mfma_f32_16x16x32_bf16 v[44:47], v[124:127], a[160:163], v[44:47]
    s_waitcnt lgkmcnt(4)
    v_mfma_f32_16x16x32_bf16 v[48:51], v[128:131], a[160:163], v[48:51]
    ds_read_b64_tr_b16 v[168:169], v208 offset:0
    ds_read_b64_tr_b16 v[170:171], v208 offset:2048
    v_mfma_f32_16x16x32_bf16 v[68:71], v[128:131], a[164:167], v[68:71]
    v_mfma_f32_16x16x32_bf16 v[72:75], v[132:135], a[164:167], v[72:75]
    ds_read_b64_tr_b16 v[172:173], v211 offset:0
    ds_read_b64_tr_b16 v[174:175], v211 offset:2048
    v_mfma_f32_16x16x32_bf16 v[52:55], v[132:135], a[160:163], v[52:55]
    v_mfma_f32_16x16x32_bf16 v[56:59], v[136:139], a[160:163], v[56:59]
    ds_read_b64_tr_b16 v[176:177], v214 offset:8192
    ds_read_b64_tr_b16 v[178:179], v214 offset:9216
    v_mfma_f32_16x16x32_bf16 v[76:79], v[136:139], a[164:167], v[76:79]
    s_waitcnt lgkmcnt(6)
    v_mfma_f32_16x16x32_bf16 v[40:43], v[160:163], a[168:171], v[40:43]
    ds_read_b64_tr_b16 v[120:121], v200 offset:40960
    ds_read_b64_tr_b16 v[122:123], v200 offset:43008
    v_mfma_f32_16x16x32_bf16 v[60:63], v[160:163], a[172:175], v[60:63]
    v_mfma_f32_16x16x32_bf16 v[64:67], v[164:167], a[172:175], v[64:67]
    ds_read_b64_tr_b16 v[124:125], v203 offset:40960
    ds_read_b64_tr_b16 v[126:127], v203 offset:43008
    v_mfma_f32_16x16x32_bf16 v[44:47], v[164:167], a[168:171], v[44:47]
    s_waitcnt lgkmcnt(4)
    v_mfma_f32_16x16x32_bf16 v[48:51], v[168:171], a[168:171], v[48:51]
    ds_read_b64_tr_b16 v[128:129], v206 offset:40960
    ds_read_b64_tr_b16 v[130:131], v206 offset:43008
    v_mfma_f32_16x16x32_bf16 v[68:71], v[168:171], a[172:175], v[68:71]
    v_mfma_f32_16x16x32_bf16 v[72:75], v[172:175], a[172:175], v[72:75]
    ds_read_b64_tr_b16 v[132:133], v209 offset:40960
    ds_read_b64_tr_b16 v[134:135], v209 offset:43008
    v_mfma_f32_16x16x32_bf16 v[52:55], v[172:175], a[168:171], v[52:55]
    v_mfma_f32_16x16x32_bf16 v[56:59], v[176:179], a[168:171], v[56:59]
    ds_read_b64_tr_b16 v[136:137], v212 offset:49152
    ds_read_b64_tr_b16 v[138:139], v212 offset:50176
    v_mfma_f32_16x16x32_bf16 v[76:79], v[176:179], a[172:175], v[76:79]
    s_waitcnt lgkmcnt(6)
    v_mfma_f32_16x16x32_bf16 v[40:43], v[120:123], a[176:179], v[40:43]
    ds_read_b64_tr_b16 v[160:161], v201 offset:0
    ds_read_b64_tr_b16 v[162:163], v201 offset:2048
    v_mfma_f32_16x16x32_bf16 v[60:63], v[120:123], a[180:183], v[60:63]
    v_mfma_f32_16x16x32_bf16 v[64:67], v[124:127], a[180:183], v[64:67]
    ds_read_b64_tr_b16 v[164:165], v204 offset:0
    ds_read_b64_tr_b16 v[166:167], v204 offset:2048
    v_mfma_f32_16x16x32_bf16 v[44:47], v[124:127], a[176:179], v[44:47]
    s_waitcnt lgkmcnt(4)
    v_mfma_f32_16x16x32_bf16 v[48:51], v[128:131], a[176:179], v[48:51]
    ds_read_b64_tr_b16 v[168:169], v207 offset:0
    ds_read_b64_tr_b16 v[170:171], v207 offset:2048
    v_mfma_f32_16x16x32_bf16 v[68:71], v[128:131], a[180:183], v[68:71]
    v_mfma_f32_16x16x32_bf16 v[72:75], v[132:135], a[180:183], v[72:75]
    ds_read_b64_tr_b16 v[172:173], v210 offset:0
    ds_read_b64_tr_b16 v[174:175], v210 offset:2048
    v_mfma_f32_16x16x32_bf16 v[52:55], v[132:135], a[176:179], v[52:55]
    v_mfma_f32_16x16x32_bf16 v[56:59], v[136:139], a[176:179], v[56:59]
    ds_read_b64_tr_b16 v[176:177], v213 offset:8192
    ds_read_b64_tr_b16 v[178:179], v213 offset:9216
    v_mfma_f32_16x16x32_bf16 v[76:79], v[136:139], a[180:183], v[76:79]
    s_waitcnt lgkmcnt(6)
    v_mfma_f32_16x16x32_bf16 v[40:43], v[160:163], a[184:187], v[40:43]
    v_mfma_f32_16x16x32_bf16 v[60:63], v[160:163], a[188:191], v[60:63]
    s_waitcnt vmcnt(0)
    s_barrier
    v_mfma_f32_16x16x32_bf16 v[64:67], v[164:167], a[188:191], v[64:67]
    ds_read_b64_tr_b16 v[120:121], v201 offset:10240
    ds_read_b64_tr_b16 v[122:123], v201 offset:12288
    v_mfma_f32_16x16x32_bf16 v[44:47], v[164:167], a[184:187], v[44:47]
    ds_read_b64_tr_b16 v[124:125], v204 offset:10240
    ds_read_b64_tr_b16 v[126:127], v204 offset:12288
    s_waitcnt lgkmcnt(4)
    v_mfma_f32_16x16x32_bf16 v[48:51], v[168:171], a[184:187], v[48:51]
    v_mfma_f32_16x16x32_bf16 v[68:71], v[168:171], a[188:191], v[68:71]
    ds_read_b64_tr_b16 v[128:129], v207 offset:10240
    ds_read_b64_tr_b16 v[130:131], v207 offset:12288
    v_mfma_f32_16x16x32_bf16 v[72:75], v[172:175], a[188:191], v[72:75]
    ds_read_b64_tr_b16 v[132:133], v210 offset:10240
    ds_read_b64_tr_b16 v[134:135], v210 offset:12288
    v_mfma_f32_16x16x32_bf16 v[52:55], v[172:175], a[184:187], v[52:55]
    v_mfma_f32_16x16x32_bf16 v[56:59], v[176:179], a[184:187], v[56:59]
    ds_read_b64_tr_b16 v[136:137], v213 offset:18432
    ds_read_b64_tr_b16 v[138:139], v213 offset:19456
    v_mfma_f32_16x16x32_bf16 v[76:79], v[176:179], a[188:191], v[76:79]
    s_waitcnt lgkmcnt(6)
    v_mfma_f32_16x16x32_bf16 v[40:43], v[120:123], a[192:195], v[40:43]
    ds_read_b64_tr_b16 v[160:161], v201 offset:20480
    ds_read_b64_tr_b16 v[162:163], v201 offset:22528
    v_mfma_f32_16x16x32_bf16 v[60:63], v[120:123], a[196:199], v[60:63]
    v_mfma_f32_16x16x32_bf16 v[64:67], v[124:127], a[196:199], v[64:67]
    ds_read_b64_tr_b16 v[164:165], v204 offset:20480
    ds_read_b64_tr_b16 v[166:167], v204 offset:22528
    v_mfma_f32_16x16x32_bf16 v[44:47], v[124:127], a[192:195], v[44:47]
    s_waitcnt lgkmcnt(4)
    v_mfma_f32_16x16x32_bf16 v[48:51], v[128:131], a[192:195], v[48:51]
    ds_read_b64_tr_b16 v[168:169], v207 offset:20480
    ds_read_b64_tr_b16 v[170:171], v207 offset:22528
    v_mfma_f32_16x16x32_bf16 v[68:71], v[128:131], a[196:199], v[68:71]
    v_mfma_f32_16x16x32_bf16 v[72:75], v[132:135], a[196:199], v[72:75]
    ds_read_b64_tr_b16 v[172:173], v210 offset:20480
    ds_read_b64_tr_b16 v[174:175], v210 offset:22528
    v_mfma_f32_16x16x32_bf16 v[52:55], v[132:135], a[192:195], v[52:55]
    v_mfma_f32_16x16x32_bf16 v[56:59], v[136:139], a[192:195], v[56:59]
    ds_read_b64_tr_b16 v[176:177], v213 offset:28672
    ds_read_b64_tr_b16 v[178:179], v213 offset:29696
    v_mfma_f32_16x16x32_bf16 v[76:79], v[136:139], a[196:199], v[76:79]
    s_waitcnt lgkmcnt(6)
    v_mfma_f32_16x16x32_bf16 v[40:43], v[160:163], a[200:203], v[40:43]
    ds_read_b64_tr_b16 v[120:121], v202 offset:10240
    ds_read_b64_tr_b16 v[122:123], v202 offset:12288
    v_mfma_f32_16x16x32_bf16 v[60:63], v[160:163], a[204:207], v[60:63]
    v_mfma_f32_16x16x32_bf16 v[64:67], v[164:167], a[204:207], v[64:67]
    ds_read_b64_tr_b16 v[124:125], v205 offset:10240
    ds_read_b64_tr_b16 v[126:127], v205 offset:12288
    v_mfma_f32_16x16x32_bf16 v[44:47], v[164:167], a[200:203], v[44:47]
    s_waitcnt lgkmcnt(4)
    v_mfma_f32_16x16x32_bf16 v[48:51], v[168:171], a[200:203], v[48:51]
    ds_read_b64_tr_b16 v[128:129], v208 offset:10240
    ds_read_b64_tr_b16 v[130:131], v208 offset:12288
    v_mfma_f32_16x16x32_bf16 v[68:71], v[168:171], a[204:207], v[68:71]
    v_mfma_f32_16x16x32_bf16 v[72:75], v[172:175], a[204:207], v[72:75]
    ds_read_b64_tr_b16 v[132:133], v211 offset:10240
    ds_read_b64_tr_b16 v[134:135], v211 offset:12288
    v_mfma_f32_16x16x32_bf16 v[52:55], v[172:175], a[200:203], v[52:55]
    v_mfma_f32_16x16x32_bf16 v[56:59], v[176:179], a[200:203], v[56:59]
    ds_read_b64_tr_b16 v[136:137], v214 offset:18432
    ds_read_b64_tr_b16 v[138:139], v214 offset:19456
    v_mfma_f32_16x16x32_bf16 v[76:79], v[176:179], a[204:207], v[76:79]
    s_waitcnt lgkmcnt(6)
    v_mfma_f32_16x16x32_bf16 v[40:43], v[120:123], a[208:211], v[40:43]
    ds_read_b64_tr_b16 v[160:161], v202 offset:20480
    ds_read_b64_tr_b16 v[162:163], v202 offset:22528
    v_mfma_f32_16x16x32_bf16 v[60:63], v[120:123], a[212:215], v[60:63]
    v_mfma_f32_16x16x32_bf16 v[64:67], v[124:127], a[212:215], v[64:67]
    ds_read_b64_tr_b16 v[164:165], v205 offset:20480
    ds_read_b64_tr_b16 v[166:167], v205 offset:22528
    v_mfma_f32_16x16x32_bf16 v[44:47], v[124:127], a[208:211], v[44:47]
    s_waitcnt lgkmcnt(4)
    v_mfma_f32_16x16x32_bf16 v[48:51], v[128:131], a[208:211], v[48:51]
    ds_read_b64_tr_b16 v[168:169], v208 offset:20480
    ds_read_b64_tr_b16 v[170:171], v208 offset:22528
    v_mfma_f32_16x16x32_bf16 v[68:71], v[128:131], a[212:215], v[68:71]
    v_mfma_f32_16x16x32_bf16 v[72:75], v[132:135], a[212:215], v[72:75]
    ds_read_b64_tr_b16 v[172:173], v211 offset:20480
    ds_read_b64_tr_b16 v[174:175], v211 offset:22528
    v_mfma_f32_16x16x32_bf16 v[52:55], v[132:135], a[208:211], v[52:55]
    v_mfma_f32_16x16x32_bf16 v[56:59], v[136:139], a[208:211], v[56:59]
    ds_read_b64_tr_b16 v[176:177], v214 offset:28672
    ds_read_b64_tr_b16 v[178:179], v214 offset:29696
    v_mfma_f32_16x16x32_bf16 v[76:79], v[136:139], a[212:215], v[76:79]
    s_waitcnt lgkmcnt(6)
    v_mfma_f32_16x16x32_bf16 v[40:43], v[160:163], a[216:219], v[40:43]
    ds_read_b64_tr_b16 v[120:121], v202 offset:34816
    ds_read_b64_tr_b16 v[122:123], v202 offset:36864
    v_mfma_f32_16x16x32_bf16 v[60:63], v[160:163], a[220:223], v[60:63]
    v_mfma_f32_16x16x32_bf16 v[64:67], v[164:167], a[220:223], v[64:67]
    ds_read_b64_tr_b16 v[124:125], v205 offset:34816
    ds_read_b64_tr_b16 v[126:127], v205 offset:36864
    v_mfma_f32_16x16x32_bf16 v[44:47], v[164:167], a[216:219], v[44:47]
    s_waitcnt lgkmcnt(4)
    v_mfma_f32_16x16x32_bf16 v[48:51], v[168:171], a[216:219], v[48:51]
    ds_read_b64_tr_b16 v[128:129], v208 offset:34816
    ds_read_b64_tr_b16 v[130:131], v208 offset:36864
    v_mfma_f32_16x16x32_bf16 v[68:71], v[168:171], a[220:223], v[68:71]
    v_mfma_f32_16x16x32_bf16 v[72:75], v[172:175], a[220:223], v[72:75]
    ds_read_b64_tr_b16 v[132:133], v211 offset:34816
    ds_read_b64_tr_b16 v[134:135], v211 offset:36864
    v_mfma_f32_16x16x32_bf16 v[52:55], v[172:175], a[216:219], v[52:55]
    v_mfma_f32_16x16x32_bf16 v[56:59], v[176:179], a[216:219], v[56:59]
    ds_read_b64_tr_b16 v[136:137], v217 offset:38912
    ds_read_b64_tr_b16 v[138:139], v217 offset:39936
    v_mfma_f32_16x16x32_bf16 v[76:79], v[176:179], a[220:223], v[76:79]
    s_waitcnt lgkmcnt(6)
    v_mfma_f32_16x16x32_bf16 v[80:83], v[120:123], a[32:35], v[80:83]
    ds_read_b64_tr_b16 v[160:161], v202 offset:45056
    ds_read_b64_tr_b16 v[162:163], v202 offset:47104
    v_mfma_f32_16x16x32_bf16 v[100:103], v[120:123], a[36:39], v[100:103]
    v_cvt_pk_bf16_f32 v220, v40, v41
    v_cvt_pk_bf16_f32 v221, v42, v43
    v_mfma_f32_16x16x32_bf16 v[104:107], v[124:127], a[36:39], v[104:107]
    ds_read_b64_tr_b16 v[164:165], v205 offset:45056
    ds_read_b64_tr_b16 v[166:167], v205 offset:47104
    v_mfma_f32_16x16x32_bf16 v[84:87], v[124:127], a[32:35], v[84:87]
    v_cvt_pk_bf16_f32 v222, v44, v45
    v_cvt_pk_bf16_f32 v223, v46, v47
    s_waitcnt lgkmcnt(4)
    v_mfma_f32_16x16x32_bf16 v[88:91], v[128:131], a[32:35], v[88:91]
    ds_read_b64_tr_b16 v[168:169], v208 offset:45056
    ds_read_b64_tr_b16 v[170:171], v208 offset:47104
    v_mfma_f32_16x16x32_bf16 v[108:111], v[128:131], a[36:39], v[108:111]
    buffer_store_dwordx4 v[220:223], v14, s[24:27], s79 offen offset:0 sc1
    v_mfma_f32_16x16x32_bf16 v[112:115], v[132:135], a[36:39], v[112:115]
    ds_read_b64_tr_b16 v[172:173], v211 offset:45056
    ds_read_b64_tr_b16 v[174:175], v211 offset:47104
    v_mfma_f32_16x16x32_bf16 v[92:95], v[132:135], a[32:35], v[92:95]
    v_cvt_pk_bf16_f32 v228, v56, v57
    v_cvt_pk_bf16_f32 v229, v58, v59
    v_mfma_f32_16x16x32_bf16 v[96:99], v[136:139], a[32:35], v[96:99]
    ds_read_b64_tr_b16 v[176:177], v217 offset:49152
    ds_read_b64_tr_b16 v[178:179], v217 offset:50176
    v_mfma_f32_16x16x32_bf16 v[116:119], v[136:139], a[36:39], v[116:119]
    v_cvt_pk_bf16_f32 v230, v60, v61
    v_cvt_pk_bf16_f32 v231, v62, v63
    s_waitcnt lgkmcnt(6)
    v_mfma_f32_16x16x32_bf16 v[80:83], v[160:163], a[40:43], v[80:83]
    ds_read_b64_tr_b16 v[120:121], v202 offset:55296
    ds_read_b64_tr_b16 v[122:123], v202 offset:57344
    v_mfma_f32_16x16x32_bf16 v[100:103], v[160:163], a[44:47], v[100:103]
    buffer_store_dwordx4 v[228:231], v14, s[24:27], s79 offen offset:2048 sc1
    v_mfma_f32_16x16x32_bf16 v[104:107], v[164:167], a[44:47], v[104:107]
    ds_read_b64_tr_b16 v[124:125], v205 offset:55296
    ds_read_b64_tr_b16 v[126:127], v205 offset:57344
    v_mfma_f32_16x16x32_bf16 v[84:87], v[164:167], a[40:43], v[84:87]
    v_cvt_pk_bf16_f32 v232, v64, v65
    v_cvt_pk_bf16_f32 v233, v66, v67
    s_waitcnt lgkmcnt(4)
    v_mfma_f32_16x16x32_bf16 v[88:91], v[168:171], a[40:43], v[88:91]
    ds_read_b64_tr_b16 v[128:129], v208 offset:55296
    ds_read_b64_tr_b16 v[130:131], v208 offset:57344
    v_mfma_f32_16x16x32_bf16 v[108:111], v[168:171], a[44:47], v[108:111]
    v_cvt_pk_bf16_f32 v234, v68, v69
    v_cvt_pk_bf16_f32 v235, v70, v71
    v_mfma_f32_16x16x32_bf16 v[112:115], v[172:175], a[44:47], v[112:115]
    ds_read_b64_tr_b16 v[132:133], v211 offset:55296
    ds_read_b64_tr_b16 v[134:135], v211 offset:57344
    v_mfma_f32_16x16x32_bf16 v[92:95], v[172:175], a[40:43], v[92:95]
    buffer_store_dwordx4 v[232:235], v14, s[24:27], s79 offen offset:3072 sc1
    v_mfma_f32_16x16x32_bf16 v[96:99], v[176:179], a[40:43], v[96:99]
    ds_read_b64_tr_b16 v[136:137], v217 offset:59392
    ds_read_b64_tr_b16 v[138:139], v217 offset:60416
    v_mfma_f32_16x16x32_bf16 v[116:119], v[176:179], a[44:47], v[116:119]
    v_cvt_pk_bf16_f32 v224, v48, v49
    v_cvt_pk_bf16_f32 v225, v50, v51
    s_waitcnt lgkmcnt(6)
    v_mfma_f32_16x16x32_bf16 v[80:83], v[120:123], a[48:51], v[80:83]
    ds_read_b64_tr_b16 v[160:161], v200 offset:4096
    ds_read_b64_tr_b16 v[162:163], v200 offset:6144
    v_mfma_f32_16x16x32_bf16 v[100:103], v[120:123], a[52:55], v[100:103]
    v_cvt_pk_bf16_f32 v226, v52, v53
    v_cvt_pk_bf16_f32 v227, v54, v55
    v_mfma_f32_16x16x32_bf16 v[104:107], v[124:127], a[52:55], v[104:107]
    ds_read_b64_tr_b16 v[164:165], v203 offset:4096
    ds_read_b64_tr_b16 v[166:167], v203 offset:6144
    v_mfma_f32_16x16x32_bf16 v[84:87], v[124:127], a[48:51], v[84:87]
    buffer_store_dwordx4 v[224:227], v14, s[24:27], s79 offen offset:1024 sc1
    s_waitcnt lgkmcnt(4)
    v_mfma_f32_16x16x32_bf16 v[88:91], v[128:131], a[48:51], v[88:91]
    ds_read_b64_tr_b16 v[168:169], v206 offset:4096
    ds_read_b64_tr_b16 v[170:171], v206 offset:6144
    v_mfma_f32_16x16x32_bf16 v[108:111], v[128:131], a[52:55], v[108:111]
    v_cvt_pk_bf16_f32 v236, v72, v73
    v_cvt_pk_bf16_f32 v237, v74, v75
    v_mfma_f32_16x16x32_bf16 v[112:115], v[132:135], a[52:55], v[112:115]
    ds_read_b64_tr_b16 v[172:173], v209 offset:4096
    ds_read_b64_tr_b16 v[174:175], v209 offset:6144
    v_mfma_f32_16x16x32_bf16 v[92:95], v[132:135], a[48:51], v[92:95]
    v_cvt_pk_bf16_f32 v238, v76, v77
    v_cvt_pk_bf16_f32 v239, v78, v79
    v_mfma_f32_16x16x32_bf16 v[96:99], v[136:139], a[48:51], v[96:99]
    ds_read_b64_tr_b16 v[176:177], v215 offset:8192
    ds_read_b64_tr_b16 v[178:179], v215 offset:9216
    v_mfma_f32_16x16x32_bf16 v[116:119], v[136:139], a[52:55], v[116:119]
    s_add_u32 s37, s79, 4096
    s_waitcnt lgkmcnt(6)
    v_mfma_f32_16x16x32_bf16 v[80:83], v[160:163], a[56:59], v[80:83]
    ds_read_b64_tr_b16 v[120:121], v200 offset:14336
    ds_read_b64_tr_b16 v[122:123], v200 offset:16384
    v_mfma_f32_16x16x32_bf16 v[100:103], v[160:163], a[60:63], v[100:103]
    buffer_store_dwordx4 v[236:239], v14, s[24:27], s37 offen offset:0 sc1
    v_mfma_f32_16x16x32_bf16 v[104:107], v[164:167], a[60:63], v[104:107]
    ds_read_b64_tr_b16 v[124:125], v203 offset:14336
    ds_read_b64_tr_b16 v[126:127], v203 offset:16384
    v_mfma_f32_16x16x32_bf16 v[84:87], v[164:167], a[56:59], v[84:87]
    s_waitcnt lgkmcnt(4)
    v_mfma_f32_16x16x32_bf16 v[88:91], v[168:171], a[56:59], v[88:91]
    ds_read_b64_tr_b16 v[128:129], v206 offset:14336
    ds_read_b64_tr_b16 v[130:131], v206 offset:16384
    v_mfma_f32_16x16x32_bf16 v[108:111], v[168:171], a[60:63], v[108:111]
    v_mfma_f32_16x16x32_bf16 v[112:115], v[172:175], a[60:63], v[112:115]
    ds_read_b64_tr_b16 v[132:133], v209 offset:14336
    ds_read_b64_tr_b16 v[134:135], v209 offset:16384
    v_mfma_f32_16x16x32_bf16 v[92:95], v[172:175], a[56:59], v[92:95]
    v_mfma_f32_16x16x32_bf16 v[96:99], v[176:179], a[56:59], v[96:99]
    ds_read_b64_tr_b16 v[136:137], v215 offset:18432
    ds_read_b64_tr_b16 v[138:139], v215 offset:19456
    v_mfma_f32_16x16x32_bf16 v[116:119], v[176:179], a[60:63], v[116:119]
    s_waitcnt lgkmcnt(6)
    v_mfma_f32_16x16x32_bf16 v[80:83], v[120:123], a[128:131], v[80:83]
    ds_read_b64_tr_b16 v[160:161], v200 offset:24576
    ds_read_b64_tr_b16 v[162:163], v200 offset:26624
    v_mfma_f32_16x16x32_bf16 v[100:103], v[120:123], a[132:135], v[100:103]
    v_mfma_f32_16x16x32_bf16 v[104:107], v[124:127], a[132:135], v[104:107]
    ds_read_b64_tr_b16 v[164:165], v203 offset:24576
    ds_read_b64_tr_b16 v[166:167], v203 offset:26624
    v_mfma_f32_16x16x32_bf16 v[84:87], v[124:127], a[128:131], v[84:87]
    s_waitcnt lgkmcnt(4)
    v_mfma_f32_16x16x32_bf16 v[88:91], v[128:131], a[128:131], v[88:91]
    ds_read_b64_tr_b16 v[168:169], v206 offset:24576
    ds_read_b64_tr_b16 v[170:171], v206 offset:26624
    v_mfma_f32_16x16x32_bf16 v[108:111], v[128:131], a[132:135], v[108:111]
    v_mfma_f32_16x16x32_bf16 v[112:115], v[132:135], a[132:135], v[112:115]
    ds_read_b64_tr_b16 v[172:173], v209 offset:24576
    ds_read_b64_tr_b16 v[174:175], v209 offset:26624
    v_mfma_f32_16x16x32_bf16 v[92:95], v[132:135], a[128:131], v[92:95]
    v_mfma_f32_16x16x32_bf16 v[96:99], v[136:139], a[128:131], v[96:99]
    ds_read_b64_tr_b16 v[176:177], v215 offset:28672
    ds_read_b64_tr_b16 v[178:179], v215 offset:29696
    v_mfma_f32_16x16x32_bf16 v[116:119], v[136:139], a[132:135], v[116:119]
    s_waitcnt lgkmcnt(6)
    v_mfma_f32_16x16x32_bf16 v[80:83], v[160:163], a[136:139], v[80:83]
    ds_read_b64_tr_b16 v[120:121], v201 offset:34816
    ds_read_b64_tr_b16 v[122:123], v201 offset:36864
    v_mfma_f32_16x16x32_bf16 v[100:103], v[160:163], a[140:143], v[100:103]
    v_mfma_f32_16x16x32_bf16 v[104:107], v[164:167], a[140:143], v[104:107]
    ds_read_b64_tr_b16 v[124:125], v204 offset:34816
    ds_read_b64_tr_b16 v[126:127], v204 offset:36864
    v_mfma_f32_16x16x32_bf16 v[84:87], v[164:167], a[136:139], v[84:87]
    s_waitcnt lgkmcnt(4)
    v_mfma_f32_16x16x32_bf16 v[88:91], v[168:171], a[136:139], v[88:91]
    ds_read_b64_tr_b16 v[128:129], v207 offset:34816
    ds_read_b64_tr_b16 v[130:131], v207 offset:36864
    v_mfma_f32_16x16x32_bf16 v[108:111], v[168:171], a[140:143], v[108:111]
    v_mfma_f32_16x16x32_bf16 v[112:115], v[172:175], a[140:143], v[112:115]
    ds_read_b64_tr_b16 v[132:133], v210 offset:34816
    ds_read_b64_tr_b16 v[134:135], v210 offset:36864
    v_mfma_f32_16x16x32_bf16 v[92:95], v[172:175], a[136:139], v[92:95]
    v_mfma_f32_16x16x32_bf16 v[96:99], v[176:179], a[136:139], v[96:99]
    ds_read_b64_tr_b16 v[136:137], v216 offset:38912
    ds_read_b64_tr_b16 v[138:139], v216 offset:39936
    v_mfma_f32_16x16x32_bf16 v[116:119], v[176:179], a[140:143], v[116:119]
    s_waitcnt lgkmcnt(6)
    v_mfma_f32_16x16x32_bf16 v[80:83], v[120:123], a[144:147], v[80:83]
    ds_read_b64_tr_b16 v[160:161], v201 offset:45056
    ds_read_b64_tr_b16 v[162:163], v201 offset:47104
    v_mfma_f32_16x16x32_bf16 v[100:103], v[120:123], a[148:151], v[100:103]
    v_mfma_f32_16x16x32_bf16 v[104:107], v[124:127], a[148:151], v[104:107]
    ds_read_b64_tr_b16 v[164:165], v204 offset:45056
    ds_read_b64_tr_b16 v[166:167], v204 offset:47104
    v_mfma_f32_16x16x32_bf16 v[84:87], v[124:127], a[144:147], v[84:87]
    s_waitcnt lgkmcnt(4)
    v_mfma_f32_16x16x32_bf16 v[88:91], v[128:131], a[144:147], v[88:91]
    ds_read_b64_tr_b16 v[168:169], v207 offset:45056
    ds_read_b64_tr_b16 v[170:171], v207 offset:47104
    v_mfma_f32_16x16x32_bf16 v[108:111], v[128:131], a[148:151], v[108:111]
    v_mfma_f32_16x16x32_bf16 v[112:115], v[132:135], a[148:151], v[112:115]
    ds_read_b64_tr_b16 v[172:173], v210 offset:45056
    ds_read_b64_tr_b16 v[174:175], v210 offset:47104
    v_mfma_f32_16x16x32_bf16 v[92:95], v[132:135], a[144:147], v[92:95]
    v_mfma_f32_16x16x32_bf16 v[96:99], v[136:139], a[144:147], v[96:99]
    ds_read_b64_tr_b16 v[176:177], v216 offset:49152
    ds_read_b64_tr_b16 v[178:179], v216 offset:50176
    v_mfma_f32_16x16x32_bf16 v[116:119], v[136:139], a[148:151], v[116:119]
    s_waitcnt lgkmcnt(6)
    v_mfma_f32_16x16x32_bf16 v[80:83], v[160:163], a[152:155], v[80:83]
    ds_read_b64_tr_b16 v[120:121], v200 offset:34816
    ds_read_b64_tr_b16 v[122:123], v200 offset:36864
    v_mfma_f32_16x16x32_bf16 v[100:103], v[160:163], a[156:159], v[100:103]
    v_mfma_f32_16x16x32_bf16 v[104:107], v[164:167], a[156:159], v[104:107]
    ds_read_b64_tr_b16 v[124:125], v203 offset:34816
    ds_read_b64_tr_b16 v[126:127], v203 offset:36864
    v_mfma_f32_16x16x32_bf16 v[84:87], v[164:167], a[152:155], v[84:87]
    s_waitcnt lgkmcnt(4)
    v_mfma_f32_16x16x32_bf16 v[88:91], v[168:171], a[152:155], v[88:91]
    ds_read_b64_tr_b16 v[128:129], v206 offset:34816
    ds_read_b64_tr_b16 v[130:131], v206 offset:36864
    v_mfma_f32_16x16x32_bf16 v[108:111], v[168:171], a[156:159], v[108:111]
    v_mfma_f32_16x16x32_bf16 v[112:115], v[172:175], a[156:159], v[112:115]
    ds_read_b64_tr_b16 v[132:133], v209 offset:34816
    ds_read_b64_tr_b16 v[134:135], v209 offset:36864
    v_mfma_f32_16x16x32_bf16 v[92:95], v[172:175], a[152:155], v[92:95]
    v_mfma_f32_16x16x32_bf16 v[96:99], v[176:179], a[152:155], v[96:99]
    ds_read_b64_tr_b16 v[136:137], v215 offset:38912
    ds_read_b64_tr_b16 v[138:139], v215 offset:39936
    v_mfma_f32_16x16x32_bf16 v[116:119], v[176:179], a[156:159], v[116:119]
    s_waitcnt lgkmcnt(6)
    v_mfma_f32_16x16x32_bf16 v[80:83], v[120:123], a[160:163], v[80:83]
    ds_read_b64_tr_b16 v[160:161], v202 offset:4096
    ds_read_b64_tr_b16 v[162:163], v202 offset:6144
    v_mfma_f32_16x16x32_bf16 v[100:103], v[120:123], a[164:167], v[100:103]
    v_mfma_f32_16x16x32_bf16 v[104:107], v[124:127], a[164:167], v[104:107]
    ds_read_b64_tr_b16 v[164:165], v205 offset:4096
    ds_read_b64_tr_b16 v[166:167], v205 offset:6144
    v_mfma_f32_16x16x32_bf16 v[84:87], v[124:127], a[160:163], v[84:87]
    s_waitcnt lgkmcnt(4)
    v_mfma_f32_16x16x32_bf16 v[88:91], v[128:131], a[160:163], v[88:91]
    ds_read_b64_tr_b16 v[168:169], v208 offset:4096
    ds_read_b64_tr_b16 v[170:171], v208 offset:6144
    v_mfma_f32_16x16x32_bf16 v[108:111], v[128:131], a[164:167], v[108:111]
    v_mfma_f32_16x16x32_bf16 v[112:115], v[132:135], a[164:167], v[112:115]
    ds_read_b64_tr_b16 v[172:173], v211 offset:4096
    ds_read_b64_tr_b16 v[174:175], v211 offset:6144
    v_mfma_f32_16x16x32_bf16 v[92:95], v[132:135], a[160:163], v[92:95]
    v_mfma_f32_16x16x32_bf16 v[96:99], v[136:139], a[160:163], v[96:99]
    ds_read_b64_tr_b16 v[176:177], v217 offset:8192
    ds_read_b64_tr_b16 v[178:179], v217 offset:9216
    v_mfma_f32_16x16x32_bf16 v[116:119], v[136:139], a[164:167], v[116:119]
    s_waitcnt lgkmcnt(6)
    v_mfma_f32_16x16x32_bf16 v[80:83], v[160:163], a[168:171], v[80:83]
    ds_read_b64_tr_b16 v[120:121], v200 offset:45056
    ds_read_b64_tr_b16 v[122:123], v200 offset:47104
    v_mfma_f32_16x16x32_bf16 v[100:103], v[160:163], a[172:175], v[100:103]
    v_mfma_f32_16x16x32_bf16 v[104:107], v[164:167], a[172:175], v[104:107]
    ds_read_b64_tr_b16 v[124:125], v203 offset:45056
    ds_read_b64_tr_b16 v[126:127], v203 offset:47104
    v_mfma_f32_16x16x32_bf16 v[84:87], v[164:167], a[168:171], v[84:87]
    s_waitcnt lgkmcnt(4)
    v_mfma_f32_16x16x32_bf16 v[88:91], v[168:171], a[168:171], v[88:91]
    ds_read_b64_tr_b16 v[128:129], v206 offset:45056
    ds_read_b64_tr_b16 v[130:131], v206 offset:47104
    v_mfma_f32_16x16x32_bf16 v[108:111], v[168:171], a[172:175], v[108:111]
    v_mfma_f32_16x16x32_bf16 v[112:115], v[172:175], a[172:175], v[112:115]
    ds_read_b64_tr_b16 v[132:133], v209 offset:45056
    ds_read_b64_tr_b16 v[134:135], v209 offset:47104
    v_mfma_f32_16x16x32_bf16 v[92:95], v[172:175], a[168:171], v[92:95]
    v_mfma_f32_16x16x32_bf16 v[96:99], v[176:179], a[168:171], v[96:99]
    ds_read_b64_tr_b16 v[136:137], v215 offset:49152
    ds_read_b64_tr_b16 v[138:139], v215 offset:50176
    v_mfma_f32_16x16x32_bf16 v[116:119], v[176:179], a[172:175], v[116:119]
    s_waitcnt lgkmcnt(6)
    v_mfma_f32_16x16x32_bf16 v[80:83], v[120:123], a[176:179], v[80:83]
    ds_read_b64_tr_b16 v[160:161], v201 offset:4096
    ds_read_b64_tr_b16 v[162:163], v201 offset:6144
    v_mfma_f32_16x16x32_bf16 v[100:103], v[120:123], a[180:183], v[100:103]
    v_mfma_f32_16x16x32_bf16 v[104:107], v[124:127], a[180:183], v[104:107]
    ds_read_b64_tr_b16 v[164:165], v204 offset:4096
    ds_read_b64_tr_b16 v[166:167], v204 offset:6144
    v_mfma_f32_16x16x32_bf16 v[84:87], v[124:127], a[176:179], v[84:87]
    s_waitcnt lgkmcnt(4)
    v_mfma_f32_16x16x32_bf16 v[88:91], v[128:131], a[176:179], v[88:91]
    ds_read_b64_tr_b16 v[168:169], v207 offset:4096
    ds_read_b64_tr_b16 v[170:171], v207 offset:6144
    v_mfma_f32_16x16x32_bf16 v[108:111], v[128:131], a[180:183], v[108:111]
    v_mfma_f32_16x16x32_bf16 v[112:115], v[132:135], a[180:183], v[112:115]
    ds_read_b64_tr_b16 v[172:173], v210 offset:4096
    ds_read_b64_tr_b16 v[174:175], v210 offset:6144
    v_mfma_f32_16x16x32_bf16 v[92:95], v[132:135], a[176:179], v[92:95]
    v_mfma_f32_16x16x32_bf16 v[96:99], v[136:139], a[176:179], v[96:99]
    ds_read_b64_tr_b16 v[176:177], v216 offset:8192
    ds_read_b64_tr_b16 v[178:179], v216 offset:9216
    v_mfma_f32_16x16x32_bf16 v[116:119], v[136:139], a[180:183], v[116:119]
    s_waitcnt lgkmcnt(6)
    v_mfma_f32_16x16x32_bf16 v[80:83], v[160:163], a[184:187], v[80:83]
    ds_read_b64_tr_b16 v[120:121], v201 offset:14336
    ds_read_b64_tr_b16 v[122:123], v201 offset:16384
    v_mfma_f32_16x16x32_bf16 v[100:103], v[160:163], a[188:191], v[100:103]
    v_mfma_f32_16x16x32_bf16 v[104:107], v[164:167], a[188:191], v[104:107]
    ds_read_b64_tr_b16 v[124:125], v204 offset:14336
    ds_read_b64_tr_b16 v[126:127], v204 offset:16384
    v_mfma_f32_16x16x32_bf16 v[84:87], v[164:167], a[184:187], v[84:87]
    s_waitcnt lgkmcnt(4)
    v_mfma_f32_16x16x32_bf16 v[88:91], v[168:171], a[184:187], v[88:91]
    ds_read_b64_tr_b16 v[128:129], v207 offset:14336
    ds_read_b64_tr_b16 v[130:131], v207 offset:16384
    v_mfma_f32_16x16x32_bf16 v[108:111], v[168:171], a[188:191], v[108:111]
    v_mfma_f32_16x16x32_bf16 v[112:115], v[172:175], a[188:191], v[112:115]
    ds_read_b64_tr_b16 v[132:133], v210 offset:14336
    ds_read_b64_tr_b16 v[134:135], v210 offset:16384
    v_mfma_f32_16x16x32_bf16 v[92:95], v[172:175], a[184:187], v[92:95]
    v_mfma_f32_16x16x32_bf16 v[96:99], v[176:179], a[184:187], v[96:99]
    ds_read_b64_tr_b16 v[136:137], v216 offset:18432
    ds_read_b64_tr_b16 v[138:139], v216 offset:19456
    v_mfma_f32_16x16x32_bf16 v[116:119], v[176:179], a[188:191], v[116:119]
    s_waitcnt lgkmcnt(6)
    v_mfma_f32_16x16x32_bf16 v[80:83], v[120:123], a[192:195], v[80:83]
    ds_read_b64_tr_b16 v[160:161], v201 offset:24576
    ds_read_b64_tr_b16 v[162:163], v201 offset:26624
    v_mfma_f32_16x16x32_bf16 v[100:103], v[120:123], a[196:199], v[100:103]
    buffer_load_dwordx4 v[40:43], v14, s[24:27], s78 offen offset:0 sc1
    v_mfma_f32_16x16x32_bf16 v[104:107], v[124:127], a[196:199], v[104:107]
    ds_read_b64_tr_b16 v[164:165], v204 offset:24576
    ds_read_b64_tr_b16 v[166:167], v204 offset:26624
    v_mfma_f32_16x16x32_bf16 v[84:87], v[124:127], a[192:195], v[84:87]
    buffer_load_dwordx4 v[44:47], v14, s[24:27], s78 offen offset:1024 sc1
    s_waitcnt lgkmcnt(4)
    v_mfma_f32_16x16x32_bf16 v[88:91], v[128:131], a[192:195], v[88:91]
    ds_read_b64_tr_b16 v[168:169], v207 offset:24576
    ds_read_b64_tr_b16 v[170:171], v207 offset:26624
    v_mfma_f32_16x16x32_bf16 v[108:111], v[128:131], a[196:199], v[108:111]
    buffer_load_dwordx4 v[48:51], v14, s[24:27], s78 offen offset:2048 sc1
    v_mfma_f32_16x16x32_bf16 v[112:115], v[132:135], a[196:199], v[112:115]
    ds_read_b64_tr_b16 v[172:173], v210 offset:24576
    ds_read_b64_tr_b16 v[174:175], v210 offset:26624
    v_mfma_f32_16x16x32_bf16 v[92:95], v[132:135], a[192:195], v[92:95]
    buffer_load_dwordx4 v[52:55], v14, s[24:27], s78 offen offset:3072 sc1
    s_add_u32 s37, s78, 4096
    v_mfma_f32_16x16x32_bf16 v[96:99], v[136:139], a[192:195], v[96:99]
    ds_read_b64_tr_b16 v[176:177], v216 offset:28672
    ds_read_b64_tr_b16 v[178:179], v216 offset:29696
    v_mfma_f32_16x16x32_bf16 v[116:119], v[136:139], a[196:199], v[116:119]
    buffer_load_dwordx4 v[56:59], v14, s[24:27], s37 offen offset:0 sc1
    s_waitcnt lgkmcnt(6)
    v_mfma_f32_16x16x32_bf16 v[80:83], v[160:163], a[200:203], v[80:83]
    ds_read_b64_tr_b16 v[120:121], v202 offset:14336
    ds_read_b64_tr_b16 v[122:123], v202 offset:16384
    v_mfma_f32_16x16x32_bf16 v[100:103], v[160:163], a[204:207], v[100:103]
    v_mfma_f32_16x16x32_bf16 v[104:107], v[164:167], a[204:207], v[104:107]
    ds_read_b64_tr_b16 v[124:125], v205 offset:14336
    ds_read_b64_tr_b16 v[126:127], v205 offset:16384
    v_mfma_f32_16x16x32_bf16 v[84:87], v[164:167], a[200:203], v[84:87]
    s_waitcnt lgkmcnt(4)
    v_mfma_f32_16x16x32_bf16 v[88:91], v[168:171], a[200:203], v[88:91]
    ds_read_b64_tr_b16 v[128:129], v208 offset:14336
    ds_read_b64_tr_b16 v[130:131], v208 offset:16384
    v_mfma_f32_16x16x32_bf16 v[108:111], v[168:171], a[204:207], v[108:111]
    v_mfma_f32_16x16x32_bf16 v[112:115], v[172:175], a[204:207], v[112:115]
    ds_read_b64_tr_b16 v[132:133], v211 offset:14336
    ds_read_b64_tr_b16 v[134:135], v211 offset:16384
    v_mfma_f32_16x16x32_bf16 v[92:95], v[172:175], a[200:203], v[92:95]
    v_mfma_f32_16x16x32_bf16 v[96:99], v[176:179], a[200:203], v[96:99]
    ds_read_b64_tr_b16 v[136:137], v217 offset:18432
    ds_read_b64_tr_b16 v[138:139], v217 offset:19456
    v_mfma_f32_16x16x32_bf16 v[116:119], v[176:179], a[204:207], v[116:119]
    s_waitcnt lgkmcnt(6)
    v_mfma_f32_16x16x32_bf16 v[80:83], v[120:123], a[208:211], v[80:83]
    ds_read_b64_tr_b16 v[160:161], v202 offset:24576
    ds_read_b64_tr_b16 v[162:163], v202 offset:26624
    v_mfma_f32_16x16x32_bf16 v[100:103], v[120:123], a[212:215], v[100:103]
    v_mfma_f32_16x16x32_bf16 v[104:107], v[124:127], a[212:215], v[104:107]
    ds_read_b64_tr_b16 v[164:165], v205 offset:24576
    ds_read_b64_tr_b16 v[166:167], v205 offset:26624
    v_mfma_f32_16x16x32_bf16 v[84:87], v[124:127], a[208:211], v[84:87]
    s_waitcnt lgkmcnt(4)
    v_mfma_f32_16x16x32_bf16 v[88:91], v[128:131], a[208:211], v[88:91]
    ds_read_b64_tr_b16 v[168:169], v208 offset:24576
    ds_read_b64_tr_b16 v[170:171], v208 offset:26624
    v_mfma_f32_16x16x32_bf16 v[108:111], v[128:131], a[212:215], v[108:111]
    v_mfma_f32_16x16x32_bf16 v[112:115], v[132:135], a[212:215], v[112:115]
    ds_read_b64_tr_b16 v[172:173], v211 offset:24576
    ds_read_b64_tr_b16 v[174:175], v211 offset:26624
    v_mfma_f32_16x16x32_bf16 v[92:95], v[132:135], a[208:211], v[92:95]
    v_mfma_f32_16x16x32_bf16 v[96:99], v[136:139], a[208:211], v[96:99]
    ds_read_b64_tr_b16 v[176:177], v217 offset:28672
    ds_read_b64_tr_b16 v[178:179], v217 offset:29696
    v_mfma_f32_16x16x32_bf16 v[116:119], v[136:139], a[212:215], v[116:119]
    s_waitcnt lgkmcnt(6)
    v_mfma_f32_16x16x32_bf16 v[80:83], v[160:163], a[216:219], v[80:83]
    v_mfma_f32_16x16x32_bf16 v[100:103], v[160:163], a[220:223], v[100:103]
    v_mfma_f32_16x16x32_bf16 v[104:107], v[164:167], a[220:223], v[104:107]
    v_mfma_f32_16x16x32_bf16 v[84:87], v[164:167], a[216:219], v[84:87]
    s_waitcnt lgkmcnt(0)
    v_mfma_f32_16x16x32_bf16 v[88:91], v[168:171], a[216:219], v[88:91]
    v_mfma_f32_16x16x32_bf16 v[108:111], v[168:171], a[220:223], v[108:111]
    v_mfma_f32_16x16x32_bf16 v[112:115], v[172:175], a[220:223], v[112:115]
    v_mfma_f32_16x16x32_bf16 v[92:95], v[172:175], a[216:219], v[92:95]
    v_mfma_f32_16x16x32_bf16 v[96:99], v[176:179], a[216:219], v[96:99]
    v_mfma_f32_16x16x32_bf16 v[116:119], v[176:179], a[220:223], v[116:119]
    v_and_b32 v39, 15, v38
    v_mul_u32_u24 v39, 2560, v39
    v_lshrrev_b32 v37, 4, v38
    s_mul_i32 s37, s28, 81920
    s_and_b32 s3, s7, 1
    s_lshr_b32 s4, s7, 3
    s_lshl_b32 s44, s4, 1
    s_add_u32 s44, s44, s3
    s_lshl_b32 s44, s44, 6
    s_add_u32 s44, s44, s37
    s_xor_b32 s3, s3, 1
    s_lshl_b32 s3, s3, 3
    s_add_u32 s3, s3, s4
    s_lshl_b32 s3, s3, 5
    s_add_u32 s3, s3, s37
    v_lshl_add_u32 v17, v37, 3, v39
    v_add_u32 v17, s3, v17
    v_bfe_u32 v37, v38, 4, 1
    v_lshl_add_u32 v39, v37, 5, v39
    v_lshrrev_b32 v37, 5, v38
    v_lshl_add_u32 v16, v37, 4, v39
    v_add_u32 v16, s44, v16
    s_mov_b32 s4, 0x40000
L_xpoll:
    s_waitcnt vmcnt(0)
    v_max3_u32 v39, v40, v41, v42
    v_max3_u32 v37, v43, v44, v45
    v_max3_u32 v39, v39, v46, v47
    v_max3_u32 v37, v37, v48, v49
    v_max3_u32 v39, v39, v50, v51
    v_max3_u32 v37, v37, v52, v53
    v_max3_u32 v39, v39, v54, v55
    v_max3_u32 v37, v37, v56, v57
    v_max3_u32 v39, v39, v58, v59
    v_max_u32 v39, v39, v37
    v_cmp_eq_u32 vcc, -1, v39
    s_cbranch_vccz L_xdone
    buffer_load_dwordx4 v[40:43], v14, s[24:27], s78 offen offset:0 sc1
    buffer_load_dwordx4 v[44:47], v14, s[24:27], s78 offen offset:1024 sc1
    buffer_load_dwordx4 v[48:51], v14, s[24:27], s78 offen offset:2048 sc1
    buffer_load_dwordx4 v[52:55], v14, s[24:27], s78 offen offset:3072 sc1
    s_add_u32 s37, s78, 4096
    buffer_load_dwordx4 v[56:59], v14, s[24:27], s37 offen offset:0 sc1
    s_sub_u32 s4, s4, 1
    s_cmp_lg_u32 s4, 0
    s_cbranch_scc1 L_xpoll
    s_waitcnt vmcnt(0)
L_xdone:
    s_mov_b32 s37, 40960
    s_movk_i32 s3, 0x3f80
    s_mov_b32 s4, 0x3f800000
    v_dot2_f32_bf16 v80, v40, s3, v80
    v_dot2_f32_bf16 v81, v40, s4, v81
    v_dot2_f32_bf16 v82, v41, s3, v82
    v_dot2_f32_bf16 v83, v41, s4, v83
    v_dot2_f32_bf16 v84, v42, s3, v84
    v_dot2_f32_bf16 v85, v42, s4, v85
    v_dot2_f32_bf16 v86, v43, s3, v86
    v_dot2_f32_bf16 v87, v43, s4, v87
    v_dot2_f32_bf16 v88, v44, s3, v88
    v_dot2_f32_bf16 v89, v44, s4, v89
    v_dot2_f32_bf16 v90, v45, s3, v90
    v_dot2_f32_bf16 v91, v45, s4, v91
    v_dot2_f32_bf16 v92, v46, s3, v92
    v_dot2_f32_bf16 v93, v46, s4, v93
    v_dot2_f32_bf16 v94, v47, s3, v94
    v_dot2_f32_bf16 v95, v47, s4, v95
    v_dot2_f32_bf16 v96, v48, s3, v96
    v_dot2_f32_bf16 v97, v48, s4, v97
    v_dot2_f32_bf16 v98, v49, s3, v98
    v_dot2_f32_bf16 v99, v49, s4, v99
    v_cvt_pk_bf16_f32 v120, v80, v81
    v_cvt_pk_bf16_f32 v121, v82, v83
    v_cvt_pk_bf16_f32 v122, v84, v85
    v_cvt_pk_bf16_f32 v123, v86, v87
    v_cvt_pk_bf16_f32 v124, v88, v89
    v_cvt_pk_bf16_f32 v125, v90, v91
    v_cvt_pk_bf16_f32 v126, v92, v93
    v_cvt_pk_bf16_f32 v127, v94, v95
    v_cvt_pk_bf16_f32 v128, v96, v97
    v_cvt_pk_bf16_f32 v129, v98, v99
    s_nop 0
    v_permlane16_swap_b32 v120, v122
    v_permlane16_swap_b32 v121, v123
    v_permlane16_swap_b32 v124, v126
    v_permlane16_swap_b32 v125, v127
    buffer_store_dwordx2 v[128:129], v17, s[96:99], 0 offen
    buffer_store_dwordx4 v[120:123], v16, s[96:99], 0 offen
    buffer_store_dwordx4 v[124:127], v16, s[96:99], 0 offen offset:64
    v_dot2_f32_bf16 v100, v50, s3, v100
    v_dot2_f32_bf16 v101, v50, s4, v101
    v_dot2_f32_bf16 v102, v51, s3, v102
    v_dot2_f32_bf16 v103, v51, s4, v103
    v_dot2_f32_bf16 v104, v52, s3, v104
    v_dot2_f32_bf16 v105, v52, s4, v105
    v_dot2_f32_bf16 v106, v53, s3, v106
    v_dot2_f32_bf16 v107, v53, s4, v107
    v_dot2_f32_bf16 v108, v54, s3, v108
    v_dot2_f32_bf16 v109, v54, s4, v109
    v_dot2_f32_bf16 v110, v55, s3, v110
    v_dot2_f32_bf16 v111, v55, s4, v111
    v_dot2_f32_bf16 v112, v56, s3, v112
    v_dot2_f32_bf16 v113, v56, s4, v113
    v_dot2_f32_bf16 v114, v57, s3, v114
    v_dot2_f32_bf16 v115, v57, s4, v115
    v_dot2_f32_bf16 v116, v58, s3, v116
    v_dot2_f32_bf16 v117, v58, s4, v117
    v_dot2_f32_bf16 v118, v59, s3, v118
    v_dot2_f32_bf16 v119, v59, s4, v119
    v_cvt_pk_bf16_f32 v130, v100, v101
    v_cvt_pk_bf16_f32 v131, v102, v103
    v_cvt_pk_bf16_f32 v132, v104, v105
    v_cvt_pk_bf16_f32 v133, v106, v107
    v_cvt_pk_bf16_f32 v134, v108, v109
    v_cvt_pk_bf16_f32 v135, v110, v111
    v_cvt_pk_bf16_f32 v136, v112, v113
    v_cvt_pk_bf16_f32 v137, v114, v115
    v_cvt_pk_bf16_f32 v138, v116, v117
    v_cvt_pk_bf16_f32 v139, v118, v119
    s_nop 0
    v_permlane16_swap_b32 v130, v132
    v_permlane16_swap_b32 v131, v133
    v_permlane16_swap_b32 v134, v136
    v_permlane16_swap_b32 v135, v137
    buffer_store_dwordx2 v[138:139], v17, s[96:99], s37 offen
    buffer_store_dwordx4 v[130:133], v16, s[96:99], s37 offen
    buffer_store_dwordx4 v[134:137], v16, s[96:99], s37 offen offset:64
L_end:
    s_endpgm
L_fb:
    s_waitcnt vmcnt(0) lgkmcnt(0)
    s_nop 7
    v_mbcnt_lo_u32_b32 v64, -1, 0
    v_mbcnt_hi_u32_b32 v64, -1, v64
    v_lshrrev_b32 v65, 4, v64
    v_and_b32 v66, 15, v64
    v_and_b32 v72, 1, v65
    v_lshlrev_b32 v72, 1, v72
    v_lshrrev_b32 v73, 1, v65
    v_or_b32 v72, v72, v73
    v_lshlrev_b32 v72, 4, v72
    v_lshl_add_u32 v68, v66, 8, v72
    v_add_u32 v69, 4096, v68
    v_lshlrev_b32 v71, 4, v64
    s_lshl_b32 s39, s28, 13
    s_add_u32 s39, s39, 131072
    s_cmp_eq_u32 s36, 0
    s_cselect_b32 s39, s39, s95
    v_lshrrev_b32 v67, 2, v66
    v_lshl_add_u32 v72, v65, 2, v67
    v_lshlrev_b32 v72, 8, v72
    v_and_b32 v73, 3, v66
    v_lshl_add_u32 v72, v73, 3, v72
    v_add_u32 v70, s39, v72
    v_mov_b32 v76, 0xff800000
    v_mov_b32 v77, 0xff800000
    v_mov_b32 v78, 0xff800000
    v_mov_b32 v79, 0xff800000
    s_lshl_b32 s37, s36, 18
    s_add_u32 s44, s37, 0x40000
L_fb1:
    buffer_load_dwordx4 a[128:131], v68, s[16:19], s37 offen offset:0
    buffer_load_dwordx4 a[132:135], v68, s[16:19], s37 offen offset:64
    buffer_load_dwordx4 a[136:139], v68, s[16:19], s37 offen offset:128
    buffer_load_dwordx4 a[140:143], v68, s[16:19], s37 offen offset:192
    buffer_load_dwordx4 a[144:147], v69, s[16:19], s37 offen offset:0
    buffer_load_dwordx4 a[148:151], v69, s[16:19], s37 offen offset:64
    buffer_load_dwordx4 a[152:155], v69, s[16:19], s37 offen offset:128
    buffer_load_dwordx4 a[156:159], v69, s[16:19], s37 offen offset:192
    s_waitcnt vmcnt(0)
    v_mfma_f32_16x16x32_bf16 v[32:35], a[128:131], a[0:3], 0
    v_mfma_f32_16x16x32_bf16 v[32:35], a[132:135], a[4:7], v[32:35]
    v_mfma_f32_16x16x32_bf16 v[32:35], a[136:139], a[8:11], v[32:35]
    v_mfma_f32_16x16x32_bf16 v[32:35], a[140:143], a[12:15], v[32:35]
    v_mfma_f32_16x16x32_bf16 v[36:39], a[144:147], a[0:3], 0
    v_mfma_f32_16x16x32_bf16 v[36:39], a[148:151], a[4:7], v[36:39]
    v_mfma_f32_16x16x32_bf16 v[36:39], a[152:155], a[8:11], v[36:39]
    v_mfma_f32_16x16x32_bf16 v[36:39], a[156:159], a[12:15], v[36:39]
    v_mfma_f32_16x16x32_bf16 v[40:43], a[128:131], a[16:19], 0
    v_mfma_f32_16x16x32_bf16 v[40:43], a[132:135], a[20:23], v[40:43]
    v_mfma_f32_16x16x32_bf16 v[40:43], a[136:139], a[24:27], v[40:43]
    v_mfma_f32_16x16x32_bf16 v[40:43], a[140:143], a[28:31], v[40:43]
    v_mfma_f32_16x16x32_bf16 v[44:47], a[144:147], a[16:19], 0
    v_mfma_f32_16x16x32_bf16 v[44:47], a[148:151], a[20:23], v[44:47]
    v_mfma_f32_16x16x32_bf16 v[44:47], a[152:155], a[24:27], v[44:47]
    v_mfma_f32_16x16x32_bf16 v[44:47], a[156:159], a[28:31], v[44:47]
    v_mfma_f32_16x16x32_bf16 v[48:51], a[128:131], a[32:35], 0
    v_mfma_f32_16x16x32_bf16 v[48:51], a[132:135], a[36:39], v[48:51]
    v_mfma_f32_16x16x32_bf16 v[48:51], a[136:139], a[40:43], v[48:51]
    v_mfma_f32_16x16x32_bf16 v[48:51], a[140:143], a[44:47], v[48:51]
    v_mfma_f32_16x16x32_bf16 v[52:55], a[144:147], a[32:35], 0
    v_mfma_f32_16x16x32_bf16 v[52:55], a[148:151], a[36:39], v[52:55]
    v_mfma_f32_16x16x32_bf16 v[52:55], a[152:155], a[40:43], v[52:55]
    v_mfma_f32_16x16x32_bf16 v[52:55], a[156:159], a[44:47], v[52:55]
    v_mfma_f32_16x16x32_bf16 v[56:59], a[128:131], a[48:51], 0
    v_mfma_f32_16x16x32_bf16 v[56:59], a[132:135], a[52:55], v[56:59]
    v_mfma_f32_16x16x32_bf16 v[56:59], a[136:139], a[56:59], v[56:59]
    v_mfma_f32_16x16x32_bf16 v[56:59], a[140:143], a[60:63], v[56:59]
    v_mfma_f32_16x16x32_bf16 v[60:63], a[144:147], a[48:51], 0
    v_mfma_f32_16x16x32_bf16 v[60:63], a[148:151], a[52:55], v[60:63]
    v_mfma_f32_16x16x32_bf16 v[60:63], a[152:155], a[56:59], v[60:63]
    v_mfma_f32_16x16x32_bf16 v[60:63], a[156:159], a[60:63], v[60:63]
    s_nop 7
    v_max3_f32 v72, v32, v33, v34
    v_max3_f32 v73, v35, v36, v37
    v_max3_f32 v72, v72, v38, v39
    v_max3_f32 v76, v76, v72, v73
    v_max3_f32 v72, v40, v41, v42
    v_max3_f32 v73, v43, v44, v45
    v_max3_f32 v72, v72, v46, v47
    v_max3_f32 v77, v77, v72, v73
    v_max3_f32 v72, v48, v49, v50
    v_max3_f32 v73, v51, v52, v53
    v_max3_f32 v72, v72, v54, v55
    v_max3_f32 v78, v78, v72, v73
    v_max3_f32 v72, v56, v57, v58
    v_max3_f32 v73, v59, v60, v61
    v_max3_f32 v72, v72, v62, v63
    v_max3_f32 v79, v79, v72, v73
    s_add_u32 s37, s37, 0x2000
    s_cmp_lt_u32 s37, s44
    s_cbranch_scc1 L_fb1
    v_mov_b32 v73, v76
    s_nop 1
    v_permlane32_swap_b32 v76, v73
    s_nop 0
    v_max_f32 v76, v76, v73
    v_mov_b32 v73, v76
    s_nop 1
    v_permlane16_swap_b32 v76, v73
    s_nop 0
    v_max_f32 v76, v76, v73
    v_sub_f32 v16, 0, v76
    v_sub_f32 v17, 0, v76
    v_sub_f32 v18, 0, v76
    v_sub_f32 v19, 0, v76
    v_mov_b32 v73, v77
    s_nop 1
    v_permlane32_swap_b32 v77, v73
    s_nop 0
    v_max_f32 v77, v77, v73
    v_mov_b32 v73, v77
    s_nop 1
    v_permlane16_swap_b32 v77, v73
    s_nop 0
    v_max_f32 v77, v77, v73
    v_sub_f32 v20, 0, v77
    v_sub_f32 v21, 0, v77
    v_sub_f32 v22, 0, v77
    v_sub_f32 v23, 0, v77
    v_mov_b32 v73, v78
    s_nop 1
    v_permlane32_swap_b32 v78, v73
    s_nop 0
    v_max_f32 v78, v78, v73
    v_mov_b32 v73, v78
    s_nop 1
    v_permlane16_swap_b32 v78, v73
    s_nop 0
    v_max_f32 v78, v78, v73
    v_sub_f32 v24, 0, v78
    v_sub_f32 v25, 0, v78
    v_sub_f32 v26, 0, v78
    v_sub_f32 v27, 0, v78
    v_mov_b32 v73, v79
    s_nop 1
    v_permlane32_swap_b32 v79, v73
    s_nop 0
    v_max_f32 v79, v79, v73
    v_mov_b32 v73, v79
    s_nop 1
    v_permlane16_swap_b32 v79, v73
    s_nop 0
    v_max_f32 v79, v79, v73
    v_sub_f32 v28, 0, v79
    v_sub_f32 v29, 0, v79
    v_sub_f32 v30, 0, v79
    v_sub_f32 v31, 0, v79
    v_mov_b32 v128, 0
    v_mov_b32 v129, 0
    v_mov_b32 v130, 0
    v_mov_b32 v131, 0
    v_mov_b32 v132, 0
    v_mov_b32 v133, 0
    v_mov_b32 v134, 0
    v_mov_b32 v135, 0
    v_mov_b32 v136, 0
    v_mov_b32 v137, 0
    v_mov_b32 v138, 0
    v_mov_b32 v139, 0
    v_mov_b32 v140, 0
    v_mov_b32 v141, 0
    v_mov_b32 v142, 0
    v_mov_b32 v143, 0
    v_mov_b32 v144, 0
    v_mov_b32 v145, 0
    v_mov_b32 v146, 0
    v_mov_b32 v147, 0
    v_mov_b32 v148, 0
    v_mov_b32 v149, 0
    v_mov_b32 v150, 0
    v_mov_b32 v151, 0
    v_mov_b32 v152, 0
    v_mov_b32 v153, 0
    v_mov_b32 v154, 0
    v_mov_b32 v155, 0
    v_mov_b32 v156, 0
    v_mov_b32 v157, 0
    v_mov_b32 v158, 0
    v_mov_b32 v159, 0
    v_mov_b32 v160, 0
    v_mov_b32 v161, 0
    v_mov_b32 v162, 0
    v_mov_b32 v163, 0
    v_mov_b32 v164, 0
    v_mov_b32 v165, 0
    v_mov_b32 v166, 0
    v_mov_b32 v167, 0
    v_mov_b32 v168, 0
    v_mov_b32 v169, 0
    v_mov_b32 v170, 0
    v_mov_b32 v171, 0
    v_mov_b32 v172, 0
    v_mov_b32 v173, 0
    v_mov_b32 v174, 0
    v_mov_b32 v175, 0
    v_mov_b32 v176, 0
    v_mov_b32 v177, 0
    v_mov_b32 v178, 0
    v_mov_b32 v179, 0
    v_mov_b32 v180, 0
    v_mov_b32 v181, 0
    v_mov_b32 v182, 0
    v_mov_b32 v183, 0
    v_mov_b32 v184, 0
    v_mov_b32 v185, 0
    v_mov_b32 v186, 0
    v_mov_b32 v187, 0
    v_mov_b32 v188, 0
    v_mov_b32 v189, 0
    v_mov_b32 v190, 0
    v_mov_b32 v191, 0
    v_mov_b32 v192, 0
    v_mov_b32 v193, 0
    v_mov_b32 v194, 0
    v_mov_b32 v195, 0
    v_mov_b32 v196, 0
    v_mov_b32 v197, 0
    v_mov_b32 v198, 0
    v_mov_b32 v199, 0
    v_mov_b32 v200, 0
    v_mov_b32 v201, 0
    v_mov_b32 v202, 0
    v_mov_b32 v203, 0
    v_mov_b32 v204, 0
    v_mov_b32 v205, 0
    v_mov_b32 v206, 0
    v_mov_b32 v207, 0
    v_mov_b32 v208, 0
    v_mov_b32 v209, 0
    v_mov_b32 v210, 0
    v_mov_b32 v211, 0
    v_mov_b32 v212, 0
    v_mov_b32 v213, 0
    v_mov_b32 v214, 0
    v_mov_b32 v215, 0
    v_mov_b32 v216, 0
    v_mov_b32 v217, 0
    v_mov_b32 v218, 0
    v_mov_b32 v219, 0
    v_mov_b32 v220, 0
    v_mov_b32 v221, 0
    v_mov_b32 v222, 0
    v_mov_b32 v223, 0
    v_mov_b32 v224, 0
    v_mov_b32 v225, 0
    v_mov_b32 v226, 0
    v_mov_b32 v227, 0
    v_mov_b32 v228, 0
    v_mov_b32 v229, 0
    v_mov_b32 v230, 0
    v_mov_b32 v231, 0
    v_mov_b32 v232, 0
    v_mov_b32 v233, 0
    v_mov_b32 v234, 0
    v_mov_b32 v235, 0
    v_mov_b32 v236, 0
    v_mov_b32 v237, 0
    v_mov_b32 v238, 0
    v_mov_b32 v239, 0
    v_mov_b32 v240, 0
    v_mov_b32 v241, 0
    v_mov_b32 v242, 0
    v_mov_b32 v243, 0
    v_mov_b32 v244, 0
    v_mov_b32 v245, 0
    v_mov_b32 v246, 0
    v_mov_b32 v247, 0
    v_mov_b32 v248, 0
    v_mov_b32 v249, 0
    v_mov_b32 v250, 0
    v_mov_b32 v251, 0
    v_mov_b32 v252, 0
    v_mov_b32 v253, 0
    v_mov_b32 v254, 0
    v_mov_b32 v255, 0
    v_accvgpr_write_b32 a192, 0
    v_accvgpr_write_b32 a193, 0
    v_accvgpr_write_b32 a194, 0
    v_accvgpr_write_b32 a195, 0
    v_accvgpr_write_b32 a196, 0
    v_accvgpr_write_b32 a197, 0
    v_accvgpr_write_b32 a198, 0
    v_accvgpr_write_b32 a199, 0
    s_lshl_b32 s37, s36, 18
L_fb2:
    buffer_load_dwordx4 a[128:131], v68, s[16:19], s37 offen offset:0
    buffer_load_dwordx4 a[132:135], v68, s[16:19], s37 offen offset:64
    buffer_load_dwordx4 a[136:139], v68, s[16:19], s37 offen offset:128
    buffer_load_dwordx4 a[140:143], v68, s[16:19], s37 offen offset:192
    buffer_load_dwordx4 a[144:147], v69, s[16:19], s37 offen offset:0
    buffer_load_dwordx4 a[148:151], v69, s[16:19], s37 offen offset:64
    buffer_load_dwordx4 a[152:155], v69, s[16:19], s37 offen offset:128
    buffer_load_dwordx4 a[156:159], v69, s[16:19], s37 offen offset:192
    s_add_u32 m0, s39, 0
    s_add_u32 s3, s37, 0
    buffer_load_dwordx4 v71, s[20:23], s3 offen offset:0 lds
    buffer_load_dwordx4 v71, s[20:23], s3 offen offset:1024 lds
    buffer_load_dwordx4 v71, s[20:23], s3 offen offset:2048 lds
    buffer_load_dwordx4 v71, s[20:23], s3 offen offset:3072 lds
    s_add_u32 m0, s39, 4096
    s_add_u32 s3, s37, 4096
    buffer_load_dwordx4 v71, s[20:23], s3 offen offset:0 lds
    buffer_load_dwordx4 v71, s[20:23], s3 offen offset:1024 lds
    buffer_load_dwordx4 v71, s[20:23], s3 offen offset:2048 lds
    buffer_load_dwordx4 v71, s[20:23], s3 offen offset:3072 lds
    s_waitcnt vmcnt(0)
    ds_read_b64_tr_b16 a[160:161], v70 offset:0
    ds_read_b64_tr_b16 a[162:163], v70 offset:4096
    ds_read_b64_tr_b16 a[164:165], v70 offset:32
    ds_read_b64_tr_b16 a[166:167], v70 offset:4128
    ds_read_b64_tr_b16 a[168:169], v70 offset:64
    ds_read_b64_tr_b16 a[170:171], v70 offset:4160
    ds_read_b64_tr_b16 a[172:173], v70 offset:96
    ds_read_b64_tr_b16 a[174:175], v70 offset:4192
    ds_read_b64_tr_b16 a[176:177], v70 offset:128
    ds_read_b64_tr_b16 a[178:179], v70 offset:4224
    ds_read_b64_tr_b16 a[180:181], v70 offset:160
    ds_read_b64_tr_b16 a[182:183], v70 offset:4256
    ds_read_b64_tr_b16 a[184:185], v70 offset:192
    ds_read_b64_tr_b16 a[186:187], v70 offset:4288
    ds_read_b64_tr_b16 a[188:189], v70 offset:224
    ds_read_b64_tr_b16 a[190:191], v70 offset:4320
    v_mfma_f32_16x16x32_bf16 v[32:35], a[128:131], a[0:3], v[16:19]
    v_mfma_f32_16x16x32_bf16 v[32:35], a[132:135], a[4:7], v[32:35]
    v_mfma_f32_16x16x32_bf16 v[32:35], a[136:139], a[8:11], v[32:35]
    v_mfma_f32_16x16x32_bf16 v[32:35], a[140:143], a[12:15], v[32:35]
    v_mfma_f32_16x16x32_bf16 v[36:39], a[144:147], a[0:3], v[16:19]
    v_mfma_f32_16x16x32_bf16 v[36:39], a[148:151], a[4:7], v[36:39]
    v_mfma_f32_16x16x32_bf16 v[36:39], a[152:155], a[8:11], v[36:39]
    v_mfma_f32_16x16x32_bf16 v[36:39], a[156:159], a[12:15], v[36:39]
    v_mfma_f32_16x16x32_bf16 v[40:43], a[128:131], a[16:19], v[20:23]
    v_mfma_f32_16x16x32_bf16 v[40:43], a[132:135], a[20:23], v[40:43]
    v_mfma_f32_16x16x32_bf16 v[40:43], a[136:139], a[24:27], v[40:43]
    v_mfma_f32_16x16x32_bf16 v[40:43], a[140:143], a[28:31], v[40:43]
    v_mfma_f32_16x16x32_bf16 v[44:47], a[144:147], a[16:19], v[20:23]
    v_mfma_f32_16x16x32_bf16 v[44:47], a[148:151], a[20:23], v[44:47]
    v_mfma_f32_16x16x32_bf16 v[44:47], a[152:155], a[24:27], v[44:47]
    v_mfma_f32_16x16x32_bf16 v[44:47], a[156:159], a[28:31], v[44:47]
    v_mfma_f32_16x16x32_bf16 v[48:51], a[128:131], a[32:35], v[24:27]
    v_mfma_f32_16x16x32_bf16 v[48:51], a[132:135], a[36:39], v[48:51]
    v_mfma_f32_16x16x32_bf16 v[48:51], a[136:139], a[40:43], v[48:51]
    v_mfma_f32_16x16x32_bf16 v[48:51], a[140:143], a[44:47], v[48:51]
    v_mfma_f32_16x16x32_bf16 v[52:55], a[144:147], a[32:35], v[24:27]
    v_mfma_f32_16x16x32_bf16 v[52:55], a[148:151], a[36:39], v[52:55]
    v_mfma_f32_16x16x32_bf16 v[52:55], a[152:155], a[40:43], v[52:55]
    v_mfma_f32_16x16x32_bf16 v[52:55], a[156:159], a[44:47], v[52:55]
    v_mfma_f32_16x16x32_bf16 v[56:59], a[128:131], a[48:51], v[28:31]
    v_mfma_f32_16x16x32_bf16 v[56:59], a[132:135], a[52:55], v[56:59]
    v_mfma_f32_16x16x32_bf16 v[56:59], a[136:139], a[56:59], v[56:59]
    v_mfma_f32_16x16x32_bf16 v[56:59], a[140:143], a[60:63], v[56:59]
    v_mfma_f32_16x16x32_bf16 v[60:63], a[144:147], a[48:51], v[28:31]
    v_mfma_f32_16x16x32_bf16 v[60:63], a[148:151], a[52:55], v[60:63]
    v_mfma_f32_16x16x32_bf16 v[60:63], a[152:155], a[56:59], v[60:63]
    v_mfma_f32_16x16x32_bf16 v[60:63], a[156:159], a[60:63], v[60:63]
    s_nop 7
    v_exp_f32 v32, v32
    v_exp_f32 v33, v33
    v_exp_f32 v34, v34
    v_exp_f32 v35, v35
    v_exp_f32 v36, v36
    v_exp_f32 v37, v37
    v_exp_f32 v38, v38
    v_exp_f32 v39, v39
    v_exp_f32 v40, v40
    v_exp_f32 v41, v41
    v_exp_f32 v42, v42
    v_exp_f32 v43, v43
    v_exp_f32 v44, v44
    v_exp_f32 v45, v45
    v_exp_f32 v46, v46
    v_exp_f32 v47, v47
    v_exp_f32 v48, v48
    v_exp_f32 v49, v49
    v_exp_f32 v50, v50
    v_exp_f32 v51, v51
    v_exp_f32 v52, v52
    v_exp_f32 v53, v53
    v_exp_f32 v54, v54
    v_exp_f32 v55, v55
    v_exp_f32 v56, v56
    v_exp_f32 v57, v57
    v_exp_f32 v58, v58
    v_exp_f32 v59, v59
    v_exp_f32 v60, v60
    v_exp_f32 v61, v61
    v_exp_f32 v62, v62
    v_exp_f32 v63, v63
    s_nop 0
    v_cvt_pk_bf16_f32 v96, v32, v33
    v_cvt_pk_bf16_f32 v97, v34, v35
    v_cvt_pk_bf16_f32 v98, v36, v37
    v_cvt_pk_bf16_f32 v99, v38, v39
    v_cvt_pk_bf16_f32 v100, v40, v41
    v_cvt_pk_bf16_f32 v101, v42, v43
    v_cvt_pk_bf16_f32 v102, v44, v45
    v_cvt_pk_bf16_f32 v103, v46, v47
    v_cvt_pk_bf16_f32 v104, v48, v49
    v_cvt_pk_bf16_f32 v105, v50, v51
    v_cvt_pk_bf16_f32 v106, v52, v53
    v_cvt_pk_bf16_f32 v107, v54, v55
    v_cvt_pk_bf16_f32 v108, v56, v57
    v_cvt_pk_bf16_f32 v109, v58, v59
    v_cvt_pk_bf16_f32 v110, v60, v61
    v_cvt_pk_bf16_f32 v111, v62, v63
    s_waitcnt lgkmcnt(0)
    s_nop 1
    v_mfma_f32_16x16x32_bf16 v[128:131], a[160:163], v[96:99], v[128:131]
    v_mfma_f32_16x16x32_bf16 v[160:163], a[160:163], v[100:103], v[160:163]
    v_mfma_f32_16x16x32_bf16 v[192:195], a[160:163], v[104:107], v[192:195]
    v_mfma_f32_16x16x32_bf16 v[224:227], a[160:163], v[108:111], v[224:227]
    v_mfma_f32_16x16x32_bf16 v[228:231], a[164:167], v[108:111], v[228:231]
    v_mfma_f32_16x16x32_bf16 v[196:199], a[164:167], v[104:107], v[196:199]
    v_mfma_f32_16x16x32_bf16 v[164:167], a[164:167], v[100:103], v[164:167]
    v_mfma_f32_16x16x32_bf16 v[132:135], a[164:167], v[96:99], v[132:135]
    v_mfma_f32_16x16x32_bf16 v[136:139], a[168:171], v[96:99], v[136:139]
    v_mfma_f32_16x16x32_bf16 v[168:171], a[168:171], v[100:103], v[168:171]
    v_mfma_f32_16x16x32_bf16 v[200:203], a[168:171], v[104:107], v[200:203]
    v_mfma_f32_16x16x32_bf16 v[232:235], a[168:171], v[108:111], v[232:235]
    v_mfma_f32_16x16x32_bf16 v[236:239], a[172:175], v[108:111], v[236:239]
    v_mfma_f32_16x16x32_bf16 v[204:207], a[172:175], v[104:107], v[204:207]
    v_mfma_f32_16x16x32_bf16 v[172:175], a[172:175], v[100:103], v[172:175]
    v_mfma_f32_16x16x32_bf16 v[140:143], a[172:175], v[96:99], v[140:143]
    v_smfmac_f32_16x16x64_bf16 a[192:195], a[208:211], v[96:103], v15
    v_mfma_f32_16x16x32_bf16 v[144:147], a[176:179], v[96:99], v[144:147]
    v_mfma_f32_16x16x32_bf16 v[176:179], a[176:179], v[100:103], v[176:179]
    v_mfma_f32_16x16x32_bf16 v[208:211], a[176:179], v[104:107], v[208:211]
    v_mfma_f32_16x16x32_bf16 v[240:243], a[176:179], v[108:111], v[240:243]
    v_mfma_f32_16x16x32_bf16 v[244:247], a[180:183], v[108:111], v[244:247]
    v_mfma_f32_16x16x32_bf16 v[212:215], a[180:183], v[104:107], v[212:215]
    v_mfma_f32_16x16x32_bf16 v[180:183], a[180:183], v[100:103], v[180:183]
    v_mfma_f32_16x16x32_bf16 v[148:151], a[180:183], v[96:99], v[148:151]
    v_mfma_f32_16x16x32_bf16 v[152:155], a[184:187], v[96:99], v[152:155]
    v_mfma_f32_16x16x32_bf16 v[184:187], a[184:187], v[100:103], v[184:187]
    v_mfma_f32_16x16x32_bf16 v[216:219], a[184:187], v[104:107], v[216:219]
    v_mfma_f32_16x16x32_bf16 v[248:251], a[184:187], v[108:111], v[248:251]
    v_mfma_f32_16x16x32_bf16 v[252:255], a[188:191], v[108:111], v[252:255]
    v_mfma_f32_16x16x32_bf16 v[220:223], a[188:191], v[104:107], v[220:223]
    v_mfma_f32_16x16x32_bf16 v[188:191], a[188:191], v[100:103], v[188:191]
    v_mfma_f32_16x16x32_bf16 v[156:159], a[188:191], v[96:99], v[156:159]
    v_smfmac_f32_16x16x64_bf16 a[196:199], a[208:211], v[104:111], v15
    s_add_u32 s37, s37, 0x2000
    s_cmp_lt_u32 s37, s44
    s_cbranch_scc1 L_fb2
    s_nop 7
    v_accvgpr_read_b32 v96, a192
    v_accvgpr_read_b32 v97, a193
    v_add_f32 v97, v96, v97
    v_rcp_f32 v96, v97
    v_cmp_nle_f32 vcc, v97, s38
    s_add_u32 s37, s42, 0
    s_or_b64 s[100:101], s[100:101], vcc
    v_pk_mul_f32 v[128:129], v[128:129], v[96:97] op_sel_hi:[1,0]
    v_pk_mul_f32 v[130:131], v[130:131], v[96:97] op_sel_hi:[1,0]
    v_pk_mul_f32 v[132:133], v[132:133], v[96:97] op_sel_hi:[1,0]
    v_pk_mul_f32 v[134:135], v[134:135], v[96:97] op_sel_hi:[1,0]
    v_cvt_pk_bf16_f32 v32, v128, v129
    v_cvt_pk_bf16_f32 v33, v130, v131
    v_cvt_pk_bf16_f32 v34, v132, v133
    v_cvt_pk_bf16_f32 v35, v134, v135
    v_pk_mul_f32 v[136:137], v[136:137], v[96:97] op_sel_hi:[1,0]
    v_pk_mul_f32 v[138:139], v[138:139], v[96:97] op_sel_hi:[1,0]
    v_pk_mul_f32 v[140:141], v[140:141], v[96:97] op_sel_hi:[1,0]
    v_pk_mul_f32 v[142:143], v[142:143], v[96:97] op_sel_hi:[1,0]
    v_cvt_pk_bf16_f32 v36, v136, v137
    v_cvt_pk_bf16_f32 v37, v138, v139
    v_cvt_pk_bf16_f32 v38, v140, v141
    v_cvt_pk_bf16_f32 v39, v142, v143
    v_pk_mul_f32 v[144:145], v[144:145], v[96:97] op_sel_hi:[1,0]
    v_pk_mul_f32 v[146:147], v[146:147], v[96:97] op_sel_hi:[1,0]
    v_pk_mul_f32 v[148:149], v[148:149], v[96:97] op_sel_hi:[1,0]
    v_pk_mul_f32 v[150:151], v[150:151], v[96:97] op_sel_hi:[1,0]
    v_cvt_pk_bf16_f32 v40, v144, v145
    v_cvt_pk_bf16_f32 v41, v146, v147
    v_cvt_pk_bf16_f32 v42, v148, v149
    v_cvt_pk_bf16_f32 v43, v150, v151
    v_pk_mul_f32 v[152:153], v[152:153], v[96:97] op_sel_hi:[1,0]
    v_pk_mul_f32 v[154:155], v[154:155], v[96:97] op_sel_hi:[1,0]
    v_pk_mul_f32 v[156:157], v[156:157], v[96:97] op_sel_hi:[1,0]
    v_pk_mul_f32 v[158:159], v[158:159], v[96:97] op_sel_hi:[1,0]
    v_cvt_pk_bf16_f32 v44, v152, v153
    v_cvt_pk_bf16_f32 v45, v154, v155
    v_cvt_pk_bf16_f32 v46, v156, v157
    v_cvt_pk_bf16_f32 v47, v158, v159
    v_accvgpr_read_b32 v98, a194
    v_accvgpr_read_b32 v99, a195
    v_add_f32 v99, v98, v99
    v_rcp_f32 v98, v99
    v_cmp_nle_f32 vcc, v99, s38
    s_add_u32 s37, s42, 131072
    s_or_b64 s[100:101], s[100:101], vcc
    v_pk_mul_f32 v[160:161], v[160:161], v[98:99] op_sel_hi:[1,0]
    v_pk_mul_f32 v[162:163], v[162:163], v[98:99] op_sel_hi:[1,0]
    v_pk_mul_f32 v[164:165], v[164:165], v[98:99] op_sel_hi:[1,0]
    v_pk_mul_f32 v[166:167], v[166:167], v[98:99] op_sel_hi:[1,0]
    v_cvt_pk_bf16_f32 v48, v160, v161
    v_cvt_pk_bf16_f32 v49, v162, v163
    v_cvt_pk_bf16_f32 v50, v164, v165
    v_cvt_pk_bf16_f32 v51, v166, v167
    v_pk_mul_f32 v[168:169], v[168:169], v[98:99] op_sel_hi:[1,0]
    v_pk_mul_f32 v[170:171], v[170:171], v[98:99] op_sel_hi:[1,0]
    v_pk_mul_f32 v[172:173], v[172:173], v[98:99] op_sel_hi:[1,0]
    v_pk_mul_f32 v[174:175], v[174:175], v[98:99] op_sel_hi:[1,0]
    v_cvt_pk_bf16_f32 v52, v168, v169
    v_cvt_pk_bf16_f32 v53, v170, v171
    v_cvt_pk_bf16_f32 v54, v172, v173
    v_cvt_pk_bf16_f32 v55, v174, v175
    v_pk_mul_f32 v[176:177], v[176:177], v[98:99] op_sel_hi:[1,0]
    v_pk_mul_f32 v[178:179], v[178:179], v[98:99] op_sel_hi:[1,0]
    v_pk_mul_f32 v[180:181], v[180:181], v[98:99] op_sel_hi:[1,0]
    v_pk_mul_f32 v[182:183], v[182:183], v[98:99] op_sel_hi:[1,0]
    v_cvt_pk_bf16_f32 v56, v176, v177
    v_cvt_pk_bf16_f32 v57, v178, v179
    v_cvt_pk_bf16_f32 v58, v180, v181
    v_cvt_pk_bf16_f32 v59, v182, v183
    v_pk_mul_f32 v[184:185], v[184:185], v[98:99] op_sel_hi:[1,0]
    v_pk_mul_f32 v[186:187], v[186:187], v[98:99] op_sel_hi:[1,0]
    v_pk_mul_f32 v[188:189], v[188:189], v[98:99] op_sel_hi:[1,0]
    v_pk_mul_f32 v[190:191], v[190:191], v[98:99] op_sel_hi:[1,0]
    v_cvt_pk_bf16_f32 v60, v184, v185
    v_cvt_pk_bf16_f32 v61, v186, v187
    v_cvt_pk_bf16_f32 v62, v188, v189
    v_cvt_pk_bf16_f32 v63, v190, v191
    v_accvgpr_read_b32 v96, a196
    v_accvgpr_read_b32 v97, a197
    v_add_f32 v97, v96, v97
    v_rcp_f32 v96, v97
    v_cmp_nle_f32 vcc, v97, s38
    s_add_u32 s37, s42, 262144
    s_or_b64 s[100:101], s[100:101], vcc
    v_pk_mul_f32 v[192:193], v[192:193], v[96:97] op_sel_hi:[1,0]
    v_pk_mul_f32 v[194:195], v[194:195], v[96:97] op_sel_hi:[1,0]
    v_pk_mul_f32 v[196:197], v[196:197], v[96:97] op_sel_hi:[1,0]
    v_pk_mul_f32 v[198:199], v[198:199], v[96:97] op_sel_hi:[1,0]
    v_cvt_pk_bf16_f32 v64, v192, v193
    v_cvt_pk_bf16_f32 v65, v194, v195
    v_cvt_pk_bf16_f32 v66, v196, v197
    v_cvt_pk_bf16_f32 v67, v198, v199
    v_pk_mul_f32 v[200:201], v[200:201], v[96:97] op_sel_hi:[1,0]
    v_pk_mul_f32 v[202:203], v[202:203], v[96:97] op_sel_hi:[1,0]
    v_pk_mul_f32 v[204:205], v[204:205], v[96:97] op_sel_hi:[1,0]
    v_pk_mul_f32 v[206:207], v[206:207], v[96:97] op_sel_hi:[1,0]
    v_cvt_pk_bf16_f32 v68, v200, v201
    v_cvt_pk_bf16_f32 v69, v202, v203
    v_cvt_pk_bf16_f32 v70, v204, v205
    v_cvt_pk_bf16_f32 v71, v206, v207
    v_pk_mul_f32 v[208:209], v[208:209], v[96:97] op_sel_hi:[1,0]
    v_pk_mul_f32 v[210:211], v[210:211], v[96:97] op_sel_hi:[1,0]
    v_pk_mul_f32 v[212:213], v[212:213], v[96:97] op_sel_hi:[1,0]
    v_pk_mul_f32 v[214:215], v[214:215], v[96:97] op_sel_hi:[1,0]
    v_cvt_pk_bf16_f32 v72, v208, v209
    v_cvt_pk_bf16_f32 v73, v210, v211
    v_cvt_pk_bf16_f32 v74, v212, v213
    v_cvt_pk_bf16_f32 v75, v214, v215
    v_pk_mul_f32 v[216:217], v[216:217], v[96:97] op_sel_hi:[1,0]
    v_pk_mul_f32 v[218:219], v[218:219], v[96:97] op_sel_hi:[1,0]
    v_pk_mul_f32 v[220:221], v[220:221], v[96:97] op_sel_hi:[1,0]
    v_pk_mul_f32 v[222:223], v[222:223], v[96:97] op_sel_hi:[1,0]
    v_cvt_pk_bf16_f32 v76, v216, v217
    v_cvt_pk_bf16_f32 v77, v218, v219
    v_cvt_pk_bf16_f32 v78, v220, v221
    v_cvt_pk_bf16_f32 v79, v222, v223
    v_accvgpr_read_b32 v98, a198
    v_accvgpr_read_b32 v99, a199
    v_add_f32 v99, v98, v99
    v_rcp_f32 v98, v99
    v_cmp_nle_f32 vcc, v99, s38
    s_add_u32 s37, s42, 393216
    s_or_b64 s[100:101], s[100:101], vcc
    v_pk_mul_f32 v[224:225], v[224:225], v[98:99] op_sel_hi:[1,0]
    v_pk_mul_f32 v[226:227], v[226:227], v[98:99] op_sel_hi:[1,0]
    v_pk_mul_f32 v[228:229], v[228:229], v[98:99] op_sel_hi:[1,0]
    v_pk_mul_f32 v[230:231], v[230:231], v[98:99] op_sel_hi:[1,0]
    v_cvt_pk_bf16_f32 v80, v224, v225
    v_cvt_pk_bf16_f32 v81, v226, v227
    v_cvt_pk_bf16_f32 v82, v228, v229
    v_cvt_pk_bf16_f32 v83, v230, v231
    v_pk_mul_f32 v[232:233], v[232:233], v[98:99] op_sel_hi:[1,0]
    v_pk_mul_f32 v[234:235], v[234:235], v[98:99] op_sel_hi:[1,0]
    v_pk_mul_f32 v[236:237], v[236:237], v[98:99] op_sel_hi:[1,0]
    v_pk_mul_f32 v[238:239], v[238:239], v[98:99] op_sel_hi:[1,0]
    v_cvt_pk_bf16_f32 v84, v232, v233
    v_cvt_pk_bf16_f32 v85, v234, v235
    v_cvt_pk_bf16_f32 v86, v236, v237
    v_cvt_pk_bf16_f32 v87, v238, v239
    v_pk_mul_f32 v[240:241], v[240:241], v[98:99] op_sel_hi:[1,0]
    v_pk_mul_f32 v[242:243], v[242:243], v[98:99] op_sel_hi:[1,0]
    v_pk_mul_f32 v[244:245], v[244:245], v[98:99] op_sel_hi:[1,0]
    v_pk_mul_f32 v[246:247], v[246:247], v[98:99] op_sel_hi:[1,0]
    v_cvt_pk_bf16_f32 v88, v240, v241
    v_cvt_pk_bf16_f32 v89, v242, v243
    v_cvt_pk_bf16_f32 v90, v244, v245
    v_cvt_pk_bf16_f32 v91, v246, v247
    v_pk_mul_f32 v[248:249], v[248:249], v[98:99] op_sel_hi:[1,0]
    v_pk_mul_f32 v[250:251], v[250:251], v[98:99] op_sel_hi:[1,0]
    v_pk_mul_f32 v[252:253], v[252:253], v[98:99] op_sel_hi:[1,0]
    v_pk_mul_f32 v[254:255], v[254:255], v[98:99] op_sel_hi:[1,0]
    v_cvt_pk_bf16_f32 v92, v248, v249
    v_cvt_pk_bf16_f32 v93, v250, v251
    v_cvt_pk_bf16_f32 v94, v252, v253
    v_cvt_pk_bf16_f32 v95, v254, v255
    s_add_u32 s37, s42, 0
    buffer_store_dwordx4 v[32:35], v14, s[24:27], s37 offen offset:0 sc1
    buffer_store_dwordx4 v[36:39], v14, s[24:27], s37 offen offset:1024 sc1
    buffer_store_dwordx4 v[40:43], v14, s[24:27], s37 offen offset:2048 sc1
    buffer_store_dwordx4 v[44:47], v14, s[24:27], s37 offen offset:3072 sc1
    s_cmp_eq_u32 s36, 0
    s_cbranch_scc1 L_fbret0
    s_add_u32 s37, s42, 131072
    buffer_store_dwordx4 v[48:51], v14, s[24:27], s37 offen offset:0 sc1
    buffer_store_dwordx4 v[52:55], v14, s[24:27], s37 offen offset:1024 sc1
    buffer_store_dwordx4 v[56:59], v14, s[24:27], s37 offen offset:2048 sc1
    buffer_store_dwordx4 v[60:63], v14, s[24:27], s37 offen offset:3072 sc1
    s_add_u32 s37, s42, 262144
    buffer_store_dwordx4 v[64:67], v14, s[24:27], s37 offen offset:0 sc1
    buffer_store_dwordx4 v[68:71], v14, s[24:27], s37 offen offset:1024 sc1
    buffer_store_dwordx4 v[72:75], v14, s[24:27], s37 offen offset:2048 sc1
    buffer_store_dwordx4 v[76:79], v14, s[24:27], s37 offen offset:3072 sc1
    s_add_u32 s37, s42, 393216
    buffer_store_dwordx4 v[80:83], v14, s[24:27], s37 offen offset:0 sc1
    buffer_store_dwordx4 v[84:87], v14, s[24:27], s37 offen offset:1024 sc1
    buffer_store_dwordx4 v[88:91], v14, s[24:27], s37 offen offset:2048 sc1
    buffer_store_dwordx4 v[92:95], v14, s[24:27], s37 offen offset:3072 sc1
    v_accvgpr_read_b32 v30, a222
    s_lshl_b32 s37, s28, 18
    v_and_b32 v16, 0x3ff, v14
    v_add_u32 v16, s37, v16
    v_add_u32 v17, 0x20000, v16
    v_accvgpr_read_b32 v18, a212
    v_accvgpr_read_b32 v19, a213
    v_accvgpr_read_b32 v20, a214
    v_accvgpr_read_b32 v21, a215
    v_accvgpr_read_b32 v22, a216
    v_accvgpr_read_b32 v23, a217
    v_accvgpr_read_b32 v24, a218
    v_accvgpr_read_b32 v25, a219
    v_accvgpr_read_b32 v26, a220
    v_accvgpr_read_b32 v27, a221
    s_and_b32 s37, s45, 0xfc
    s_and_b32 s3, s45, 3
    s_lshl_b32 s3, s3, 3
    s_lshl_b32 s3, 0xff, s3
    v_cmp_eq_u32 vcc, s37, v30
    v_mov_b32 v28, s3
    s_xor_b32 s37, s37, 8
    v_cndmask_b32 v28, 0, v28, vcc
    v_cmp_eq_u32 vcc, s37, v30
    s_not_b32 s3, s3
    v_mov_b32 v29, s3
    v_cndmask_b32 v29, -1, v29, vcc
    v_xor_b32 v31, s45, v30
    v_bfe_i32 v31, v31, 3, 1
    v_and_or_b32 v29, v29, v31, v28
    v_or_b32 v28, v28, v31
    s_branch L_fbret1
L_spin_u1:
    s_mov_b32 s3, 0x40000
L_spinl_u1:
    buffer_load_dword v0, v30, s[80:83], 0 offen sc1
    s_waitcnt vmcnt(0)
    v_or_b32 v0, v0, v29
    v_and_b32 v0, 0x1010101, v0
    v_cmp_ne_u32 vcc, 0x1010101, v0
    s_cbranch_vccz L_spun_u1
    s_sub_u32 s3, s3, 1
    s_cmp_lg_u32 s3, 0
    s_cbranch_scc1 L_spinl_u1
    s_branch L_spun_u1
L_spin_u2:
    s_mov_b32 s3, 0x40000
L_spinl_u2:
    buffer_load_dword v0, v30, s[80:83], 0 offen sc1
    s_waitcnt vmcnt(0)
    v_or_b32 v0, v0, v28
    v_and_b32 v0, 0x3030303, v0
    v_cmp_ne_u32 vcc, 0x3030303, v0
    s_cbranch_vccz L_spun_u2
    s_sub_u32 s3, s3, 1
    s_cmp_lg_u32 s3, 0
    s_cbranch_scc1 L_spinl_u2
    s_branch L_spun_u2
L_codeend:
.section .rodata,"a"
.p2align 6
.amdhsa_kernel attn_kernel
  .amdhsa_next_free_vgpr 512
  .amdhsa_next_free_sgpr 102
  .amdhsa_accum_offset 256
  .amdhsa_group_segment_fixed_size 0
  .amdhsa_kernarg_size 104
  .amdhsa_user_sgpr_count 2
  .amdhsa_user_sgpr_kernarg_segment_ptr 1
  .amdhsa_system_sgpr_workgroup_id_x 1
.end_amdhsa_kernel
.text
```
